```python
import torch

def _softmax(x, axis=-1):
    return torch.softmax(x, dim=axis)
def _gelu(x):
    return torch.nn.functional.gelu(x, approximate="tanh")
def _silu(x):
    return torch.nn.functional.silu(x)
def _sigmoid(x):
    return torch.sigmoid(x)
def _layernorm(x, axis=-1, eps=1e-5):
    m = x.mean(dim=axis, keepdim=True)
    v = x.var(dim=axis, keepdim=True, unbiased=False)
    return (x - m) / torch.sqrt(v + eps)
def _scatter_add(tgt, idx, src, axis=0):
    return tgt.clone().index_add_(axis, idx, src)
def _segment_sum(src, seg, n):
    out = torch.zeros((n,) + src.shape[1:], dtype=src.dtype)
    return out.index_add_(0, seg, src)
def _pad(x, pw):
    flat = tuple(v for pair in reversed(pw) for v in pair)
    return torch.nn.functional.pad(x, flat)

kernel_name = 'standalone__mha_block_cached__near_ridge'

def setup_inputs():

    _w = (lambda a: (lambda t: t.to(torch.bfloat16) if t.is_floating_point() else t)(torch.as_tensor(a)))
    B, Sq, D = 16, 256, 512
    H, Sk, Dh = 32, 1024, 128
    return {
        "x": _w((lambda *s: torch.randn(*s, dtype=torch.bfloat16) * 0.8)(B, Sq, D)),
        "k_cache": _w((lambda *s: torch.randn(*s, dtype=torch.bfloat16) * 0.8)(B, H, Sk, Dh)),
        "v_cache": _w((lambda *s: torch.randn(*s, dtype=torch.bfloat16) * 0.05)(B, H, Sk, Dh)),
        "wq": _w((lambda *s: torch.randn(*s, dtype=torch.bfloat16) * 0.8)(D, H * Dh) * (D ** -0.5)),
        "wo": _w((lambda *s: torch.randn(*s, dtype=torch.bfloat16) * 0.05)(H * Dh, D) * ((H * Dh) ** -0.5)),
    }

def reference(x, k_cache, v_cache, wq, wo):
    B, Sq, D = x.shape
    H, Dh = 32, 128
    q = (lambda x, *d: x.permute(*d))((x @ wq).reshape(B, Sq, H, Dh), 0, 2, 1, 3)
    scores = torch.einsum("bhqd,bhkd->bhqk", q, k_cache) * (Dh ** -0.5)
    p = _softmax(scores, axis=-1)
    o = torch.einsum("bhqk,bhkd->bhqd", p, v_cache)
    return (lambda x, *d: x.permute(*d))(o, 0, 2, 1, 3).reshape(B, Sq, H * Dh) @ wo
```

```asm
; @launch grid=(256,1,1) block=(256,1,1) lds=163840
.amdgcn_target "amdgcn-amd-amdhsa--gfx950"
.text
.globl standalone__mha_block_cached__near_ridge_kernel
.p2align 8
.type standalone__mha_block_cached__near_ridge_kernel,@function
standalone__mha_block_cached__near_ridge_kernel:
    s_cmp_ge_u32 s2, 256
    s_cbranch_scc1 L_done
    s_mov_b32 s87, 0
L_start:
    s_mov_b64 s[88:89], 0
    s_load_dwordx4 s[4:7], s[0:1], 8
    s_load_dwordx2 s[30:31], s[0:1], 56
    s_load_dwordx2 s[32:33], s[0:1], 0
    s_load_dwordx2 s[36:37], s[0:1], 24
    s_load_dwordx2 s[84:85], s[0:1], 32
    s_load_dwordx4 s[92:95], s[0:1], 40
    v_and_b32 v1, 63, v0
    v_lshrrev_b32 v2, 6, v0
    v_and_b32 v3, 15, v0
    v_bfe_u32 v22, v0, 4, 2
    v_readfirstlane_b32 s24, v2
    s_getpc_b64 s[98:99]
L_pcref:
    s_sub_u32 s98, s98, L_pcref-standalone__mha_block_cached__near_ridge_kernel
    s_subb_u32 s99, s99, 0
    s_mov_b32 s97, L_codeend-standalone__mha_block_cached__near_ridge_kernel-4
    v_mul_u32_u24 v23, 24576, v2
    v_lshl_add_u32 v23, v1, 7, v23
    v_min_u32 v24, s97, v23
    global_load_dword v31, v24, s[98:99]
    v_add_u32 v23, 0x2000, v23
    v_min_u32 v24, s97, v23
    global_load_dword v31, v24, s[98:99]
    v_add_u32 v23, 0x2000, v23
    v_min_u32 v24, s97, v23
    global_load_dword v31, v24, s[98:99]
    v_add_u32 v23, 0x2000, v23
    s_and_b32 s75, s2, 3
    s_lshl_b32 s75, s75, 2
    s_bfe_u32 s3, s2, 0x20003
    s_add_u32 s75, s75, s3
    s_bfe_u32 s76, s2, 0x10002
    s_lshl_b32 s76, s76, 3
    s_lshr_b32 s3, s2, 5
    s_add_u32 s76, s76, s3
    s_lshl_b32 s24, s24, 12
    v_lshrrev_b32 v23, 2, v3
    v_lshl_add_u32 v24, v22, 3, v23
    v_and_b32 v25, 3, v3
    v_lshlrev_b32 v24, 8, v24
    v_lshl_add_u32 v26, v23, 2, v25
    v_lshl_add_u32 v26, v26, 4, v24
    v_add_u32 v122, 147456, v26
    v_add_u32 v24, 0x10000, v24
    v_xor_b32 v26, 0, v23
    v_lshl_add_u32 v26, v26, 2, v25
    v_lshl_add_u32 v64, v26, 4, v24
    v_xor_b32 v26, 1, v23
    v_lshl_add_u32 v26, v26, 2, v25
    v_lshl_add_u32 v65, v26, 4, v24
    v_xor_b32 v26, 2, v23
    v_lshl_add_u32 v26, v26, 2, v25
    v_lshl_add_u32 v66, v26, 4, v24
    v_xor_b32 v26, 3, v23
    v_lshl_add_u32 v26, v26, 2, v25
    v_lshl_add_u32 v67, v26, 4, v24
    v_lshrrev_b32 v23, 1, v3
    v_lshlrev_b32 v24, 13, v2
    v_lshl_add_u32 v24, v3, 7, v24
    v_add_u32 v25, 0, v22
    v_xor_b32 v25, v25, v23
    v_lshl_add_u32 v25, v25, 4, v24
    v_add_u32 v68, 16384, v25
    v_add_u32 v25, 4, v22
    v_xor_b32 v25, v25, v23
    v_lshl_add_u32 v25, v25, 4, v24
    v_add_u32 v69, 16384, v25
    v_add_u32 v25, 0, v22
    v_xor_b32 v25, v25, v23
    v_lshl_add_u32 v25, v25, 4, v24
    v_add_u32 v70, 131072, v25
    v_add_u32 v25, 4, v22
    v_xor_b32 v25, v25, v23
    v_lshl_add_u32 v25, v25, 4, v24
    v_add_u32 v71, 131072, v25
    v_lshlrev_b32 v23, 2, v22
    v_xor_b32 v23, v23, v3
    v_lshl_add_u32 v24, v2, 3, v22
    v_lshlrev_b32 v24, 13, v24
    v_lshl_add_u32 v24, v23, 4, v24
    v_mov_b32 v72, v24
    v_add_u32 v73, 31744, v24
    v_add_u32 v19, 256, v24
    v_lshrrev_b32 v23, 3, v1
    v_and_b32 v24, 7, v1
    v_lshrrev_b32 v27, 4, v1
    v_add_u32 v26, 0, v27
    v_and_b32 v26, 7, v26
    v_xor_b32 v26, v26, v24
    v_lshl_add_u32 v25, v2, 6, v23
    v_add_u32 v25, 0, v25
    v_lshlrev_b32 v25, 10, v25
    v_lshl_add_u32 v25, v26, 4, v25
    v_subrev_u32 v76, 0, v25
    v_add_u32 v26, 4, v27
    v_and_b32 v26, 7, v26
    v_xor_b32 v26, v26, v24
    v_lshl_add_u32 v25, v2, 6, v23
    v_add_u32 v25, 8, v25
    v_lshlrev_b32 v25, 10, v25
    v_lshl_add_u32 v25, v26, 4, v25
    v_subrev_u32 v77, 1024, v25
    v_add_u32 v26, 8, v27
    v_and_b32 v26, 7, v26
    v_xor_b32 v26, v26, v24
    v_lshl_add_u32 v25, v2, 6, v23
    v_add_u32 v25, 16, v25
    v_lshlrev_b32 v25, 10, v25
    v_lshl_add_u32 v25, v26, 4, v25
    v_subrev_u32 v78, 2048, v25
    v_add_u32 v26, 12, v27
    v_and_b32 v26, 7, v26
    v_xor_b32 v26, v26, v24
    v_lshl_add_u32 v25, v2, 6, v23
    v_add_u32 v25, 24, v25
    v_lshlrev_b32 v25, 10, v25
    v_lshl_add_u32 v25, v26, 4, v25
    v_subrev_u32 v79, 3072, v25
    v_lshrrev_b32 v23, 2, v3
    v_sub_u32 v23, 0, v23
    v_and_b32 v23, 3, v23
    v_xor_b32 v23, v23, v22
    v_lshlrev_b32 v23, 4, v23
    v_lshl_add_u32 v23, v3, 6, v23
    v_lshl_add_u32 v23, v2, 12, v23
    v_add_u32 v121, 131072, v23
    v_lshrrev_b32 v23, 4, v1
    v_sub_u32 v23, 0, v23
    v_and_b32 v23, 3, v23
    v_and_b32 v24, 3, v1
    v_xor_b32 v23, v23, v24
    v_lshlrev_b32 v23, 4, v23
    v_lshrrev_b32 v24, 2, v1
    v_lshl_add_u32 v24, v2, 6, v24
    v_lshl_add_u32 v18, v24, 10, v23
    v_lshlrev_b32 v23, 3, v2
    v_add_u32 v23, 0, v23
    v_add_u32 v23, v23, v22
    v_and_b32 v24, 15, v23
    v_xor_b32 v24, v24, v3
    v_lshlrev_b32 v24, 4, v24
    v_subrev_u32 v23, 0, v23
    v_lshl_add_u32 v29, v23, 8, v24
    v_lshlrev_b32 v23, 3, v2
    v_add_u32 v23, 4, v23
    v_add_u32 v23, v23, v22
    v_and_b32 v24, 15, v23
    v_xor_b32 v24, v24, v3
    v_lshlrev_b32 v24, 4, v24
    v_subrev_u32 v23, 4, v23
    v_lshl_add_u32 v30, v23, 8, v24
    s_waitcnt lgkmcnt(0)
    s_waitcnt lgkmcnt(0)
    s_lshl_b32 s3, s75, 18
    s_add_u32 s32, s32, s3
    s_addc_u32 s33, s33, 0
    s_mov_b32 s34, 0x40000
    s_mov_b32 s35, 0x20000
    s_lshl_b32 s3, s76, 9
    s_add_u32 s36, s36, s3
    s_addc_u32 s37, s37, 0
    s_sub_u32 s38, 0x400000, s3
    s_mov_b32 s39, 0x20000
    s_lshr_b32 s74, s24, 1
    s_add_u32 m0, s74, 98304
    s_mov_b32 s73, 0
    buffer_load_dwordx4 v72, s[36:39], s73 offen offset:0 lds
    buffer_load_dwordx4 v73, s[36:39], s73 offen offset:1024 lds
    s_lshl_b32 s74, s24, 1
    s_add_u32 m0, s74, 16384
    s_mov_b32 s72, 0
    buffer_load_dwordx4 v76, s[32:35], s72 offen offset:0 lds
    buffer_load_dwordx4 v77, s[32:35], s72 offen offset:1024 lds
    buffer_load_dwordx4 v78, s[32:35], s72 offen offset:2048 lds
    buffer_load_dwordx4 v79, s[32:35], s72 offen offset:3072 lds
    s_lshl_b32 s74, s24, 1
    s_add_u32 m0, s74, 20480
    s_mov_b32 s72, 32768
    buffer_load_dwordx4 v76, s[32:35], s72 offen offset:0 lds
    buffer_load_dwordx4 v77, s[32:35], s72 offen offset:1024 lds
    buffer_load_dwordx4 v78, s[32:35], s72 offen offset:2048 lds
    buffer_load_dwordx4 v79, s[32:35], s72 offen offset:3072 lds
    s_lshl_b32 s3, s75, 23
    s_lshl_b32 s77, s76, 19
    s_add_u32 s3, s3, s77
    s_add_u32 s8, s4, s3
    s_addc_u32 s9, s5, 0
    s_mov_b32 s10, 0x80000
    s_mov_b32 s11, 0x20000
    s_add_u32 s12, s6, s3
    s_addc_u32 s13, s7, 0
    s_mov_b32 s14, 0x80000
    s_mov_b32 s15, 0x20000
    s_lshl_b32 s3, s75, 21
    s_add_u32 s3, s3, 33554432
    s_add_u32 s20, s30, s3
    s_addc_u32 s21, s31, 0
    s_mov_b32 s22, 0x200000
    s_mov_b32 s23, 0x20000
    s_lshl_b32 s29, s76, 13
    s_mov_b32 s16, s20
    s_mov_b32 s17, s21
    s_mov_b32 s18, 0x200000
    s_mov_b32 s19, 0x20000
    s_add_u32 s4, s30, 75497472
    s_addc_u32 s5, s31, 0
    s_cmp_eq_u32 s87, 0
    s_cselect_b32 s6, 0x800000, 0
    s_mov_b32 s7, 0x20000
    s_lshl_b32 s79, s75, 4
    s_add_u32 s79, s79, s76
    s_lshl_b32 s79, s79, 15
    v_mov_b32 v112, -1
    v_mov_b32 v113, -1
    v_mov_b32 v114, -1
    v_mov_b32 v115, -1
    v_lshlrev_b32 v126, 13, v2
    v_lshl_add_u32 v126, v1, 4, v126
    v_add_u32 v127, 0x1000, v126
    v_mov_b32 v23, s29
    global_load_dword v31, v23, s[20:21] sc1
    v_mov_b32 v23, s79
    global_load_dword v31, v23, s[4:5] sc1
    s_lshr_b32 s3, s76, 3
    s_lshl_b32 s3, s3, 21
    v_mov_b32 v23, s3
    global_load_dword v31, v23, s[84:85]
    s_lshl_b32 s3, s75, 18
    v_mov_b32 v23, s3
    global_load_dword v31, v23, s[92:93]
    v_mov_b32 v23, 0
    global_load_dword v31, v23, s[94:95] sc1
    s_lshr_b32 s74, s24, 1
    s_add_u32 m0, s74, 106496
    s_mov_b32 s73, 262144
    buffer_load_dwordx4 v72, s[36:39], s73 offen offset:0 lds
    buffer_load_dwordx4 v73, s[36:39], s73 offen offset:1024 lds
    s_lshl_b32 s74, s24, 1
    s_add_u32 m0, s74, 131072
    s_mov_b32 s72, 128
    buffer_load_dwordx4 v76, s[32:35], s72 offen offset:0 lds
    buffer_load_dwordx4 v77, s[32:35], s72 offen offset:1024 lds
    buffer_load_dwordx4 v78, s[32:35], s72 offen offset:2048 lds
    buffer_load_dwordx4 v79, s[32:35], s72 offen offset:3072 lds
    s_lshl_b32 s74, s24, 1
    s_add_u32 m0, s74, 135168
    s_mov_b32 s72, 32896
    buffer_load_dwordx4 v76, s[32:35], s72 offen offset:0 lds
    buffer_load_dwordx4 v77, s[32:35], s72 offen offset:1024 lds
    buffer_load_dwordx4 v78, s[32:35], s72 offen offset:2048 lds
    buffer_load_dwordx4 v79, s[32:35], s72 offen offset:3072 lds
    v_add_u32 v23, 0, v22
    v_xor_b32 v23, v23, v3
    v_lshlrev_b32 v23, 4, v23
    v_lshl_add_u32 v4, v3, 8, v23
    v_add_u32 v23, 4, v22
    v_xor_b32 v23, v23, v3
    v_lshlrev_b32 v23, 4, v23
    v_lshl_add_u32 v5, v3, 8, v23
    v_add_u32 v23, 8, v22
    v_xor_b32 v23, v23, v3
    v_lshlrev_b32 v23, 4, v23
    v_lshl_add_u32 v6, v3, 8, v23
    v_add_u32 v23, 12, v22
    v_xor_b32 v23, v23, v3
    v_lshlrev_b32 v23, 4, v23
    v_lshl_add_u32 v7, v3, 8, v23
    v_lshrrev_b32 v23, 2, v3
    v_lshl_add_u32 v23, v22, 2, v23
    v_and_b32 v24, 7, v23
    v_lshlrev_b32 v24, 1, v24
    v_bfe_u32 v25, v3, 1, 1
    v_and_b32 v26, 1, v3
    v_lshlrev_b32 v26, 3, v26
    v_lshl_add_u32 v26, v23, 8, v26
    v_add_u32 v26, 0x10000, v26
    v_add_u32 v27, 0, v25
    v_xor_b32 v27, v27, v24
    v_lshl_add_u32 v8, v27, 4, v26
    v_add_u32 v27, 2, v25
    v_xor_b32 v27, v27, v24
    v_lshl_add_u32 v9, v27, 4, v26
    v_add_u32 v27, 4, v25
    v_xor_b32 v27, v27, v24
    v_lshl_add_u32 v10, v27, 4, v26
    v_add_u32 v27, 6, v25
    v_xor_b32 v27, v27, v24
    v_lshl_add_u32 v11, v27, 4, v26
    v_add_u32 v27, 8, v25
    v_xor_b32 v27, v27, v24
    v_lshl_add_u32 v12, v27, 4, v26
    v_add_u32 v27, 10, v25
    v_xor_b32 v27, v27, v24
    v_lshl_add_u32 v13, v27, 4, v26
    v_add_u32 v27, 12, v25
    v_xor_b32 v27, v27, v24
    v_lshl_add_u32 v14, v27, 4, v26
    v_add_u32 v27, 14, v25
    v_xor_b32 v27, v27, v24
    v_lshl_add_u32 v15, v27, 4, v26
    v_lshl_add_u32 v23, v2, 2, v22
    v_xor_b32 v24, v23, v3
    v_lshlrev_b32 v24, 4, v24
    v_lshl_add_u32 v16, v23, 8, v24
    v_add_u32 v17, 0x1000, v16
    v_and_b32 v24, 7, v23
    v_lshlrev_b32 v24, 1, v24
    v_xor_b32 v24, v24, v3
    v_lshlrev_b32 v24, 4, v24
    v_lshl_add_u32 v20, v23, 8, v24
    v_add_u32 v21, 0x1000, v20
    s_lshr_b32 s3, s24, 1
    s_add_u32 m0, s3, 57344
    s_mov_b32 s25, 0
    buffer_load_dwordx4 v29, s[8:11], 0 offen offset:0 nt lds
    buffer_load_dwordx4 v30, s[8:11], 0 offen offset:1024 nt lds
    s_mov_b32 s26, 8192
    s_lshr_b32 s80, s24, 2
    s_mov_b32 s81, 8192
    s_mov_b32 s82, 16384
    s_lshr_b32 s74, s24, 1
    s_add_u32 m0, s74, 114688
    s_mov_b32 s73, 524288
    buffer_load_dwordx4 v72, s[36:39], s73 offen offset:0 lds
    buffer_load_dwordx4 v73, s[36:39], s73 offen offset:1024 lds
    s_lshr_b32 s74, s24, 1
    s_add_u32 m0, s74, 122880
    s_mov_b32 s73, 786432
    buffer_load_dwordx4 v72, s[36:39], s73 offen offset:0 lds
    buffer_load_dwordx4 v73, s[36:39], s73 offen offset:1024 lds
    s_add_u32 m0, s80, 0
    s_nop 0
    buffer_load_dwordx4 v16, s[8:11], s26 offen nt lds
    s_add_u32 m0, s80, 4096
    s_nop 0
    buffer_load_dwordx4 v17, s[8:11], s26 offen nt lds
    s_add_u32 m0, s80, 8192
    s_nop 0
    buffer_load_dwordx4 v16, s[8:11], s82 offen nt lds
    s_add_u32 m0, s80, 12288
    s_nop 0
    buffer_load_dwordx4 v17, s[8:11], s82 offen nt lds
    s_add_u32 s26, s26, 16384
    s_add_u32 s82, s82, 16384
    s_add_u32 m0, s80, 65536
    s_nop 0
    buffer_load_dwordx4 v20, s[12:15], s25 offen nt lds
    s_add_u32 m0, s80, 69632
    s_nop 0
    buffer_load_dwordx4 v21, s[12:15], s25 offen nt lds
    s_add_u32 m0, s80, 73728
    s_nop 0
    buffer_load_dwordx4 v20, s[12:15], s81 offen nt lds
    s_add_u32 m0, s80, 77824
    s_nop 0
    buffer_load_dwordx4 v21, s[12:15], s81 offen nt lds
    s_add_u32 s25, s25, 16384
    s_add_u32 s81, s81, 16384
    s_add_u32 m0, s80, 81920
    s_nop 0
    buffer_load_dwordx4 v20, s[12:15], s25 offen nt lds
    s_add_u32 m0, s80, 86016
    s_nop 0
    buffer_load_dwordx4 v21, s[12:15], s25 offen nt lds
    s_add_u32 m0, s80, 90112
    s_nop 0
    buffer_load_dwordx4 v20, s[12:15], s81 offen nt lds
    s_add_u32 m0, s80, 94208
    s_nop 0
    buffer_load_dwordx4 v21, s[12:15], s81 offen nt lds
    s_add_u32 s25, s25, 16384
    s_add_u32 s81, s81, 16384
    buffer_store_dwordx4 v[112:115], v126, s[4:7], s79 offen offset:0 sc1
    buffer_store_dwordx4 v[112:115], v126, s[4:7], s79 offen offset:1024 sc1
    buffer_store_dwordx4 v[112:115], v126, s[4:7], s79 offen offset:2048 sc1
    buffer_store_dwordx4 v[112:115], v126, s[4:7], s79 offen offset:3072 sc1
    buffer_store_dwordx4 v[112:115], v127, s[4:7], s79 offen offset:0 sc1
    buffer_store_dwordx4 v[112:115], v127, s[4:7], s79 offen offset:1024 sc1
    buffer_store_dwordx4 v[112:115], v127, s[4:7], s79 offen offset:2048 sc1
    buffer_store_dwordx4 v[112:115], v127, s[4:7], s79 offen offset:3072 sc1
    s_waitcnt vmcnt(41)
    s_barrier
    ds_read_b128 a[0:3], v68 offset:0
    ds_read_b128 a[4:7], v68 offset:2048
    ds_read_b128 a[8:11], v68 offset:4096
    ds_read_b128 a[12:15], v68 offset:6144
    ds_read_b64_tr_b16 v[32:33], v64 offset:32768
    ds_read_b64_tr_b16 v[34:35], v64 offset:33792
    ds_read_b64_tr_b16 v[36:37], v64 offset:32776
    ds_read_b64_tr_b16 v[38:39], v64 offset:33800
    ds_read_b64_tr_b16 v[40:41], v65 offset:32768
    ds_read_b64_tr_b16 v[42:43], v65 offset:33792
    ds_read_b64_tr_b16 v[44:45], v65 offset:32776
    ds_read_b64_tr_b16 v[46:47], v65 offset:33800
    s_waitcnt lgkmcnt(6)
    v_mfma_f32_16x16x32_bf16 v[128:131], v[32:35], a[0:3], 0
    ds_read_b64_tr_b16 v[48:49], v66 offset:32768
    ds_read_b64_tr_b16 v[50:51], v66 offset:33792
    v_mfma_f32_16x16x32_bf16 v[160:163], v[32:35], a[4:7], 0
    v_mfma_f32_16x16x32_bf16 v[192:195], v[32:35], a[8:11], 0
    v_mfma_f32_16x16x32_bf16 v[224:227], v[32:35], a[12:15], 0
    s_waitcnt lgkmcnt(6)
    v_mfma_f32_16x16x32_bf16 v[132:135], v[36:39], a[0:3], 0
    ds_read_b64_tr_b16 v[52:53], v66 offset:32776
    ds_read_b64_tr_b16 v[54:55], v66 offset:33800
    v_mfma_f32_16x16x32_bf16 v[164:167], v[36:39], a[4:7], 0
    v_mfma_f32_16x16x32_bf16 v[196:199], v[36:39], a[8:11], 0
    v_mfma_f32_16x16x32_bf16 v[228:231], v[36:39], a[12:15], 0
    s_waitcnt lgkmcnt(6)
    v_mfma_f32_16x16x32_bf16 v[136:139], v[40:43], a[0:3], 0
    ds_read_b64_tr_b16 v[56:57], v67 offset:32768
    ds_read_b64_tr_b16 v[58:59], v67 offset:33792
    v_mfma_f32_16x16x32_bf16 v[168:171], v[40:43], a[4:7], 0
    v_mfma_f32_16x16x32_bf16 v[200:203], v[40:43], a[8:11], 0
    v_mfma_f32_16x16x32_bf16 v[232:235], v[40:43], a[12:15], 0
    s_waitcnt lgkmcnt(6)
    v_mfma_f32_16x16x32_bf16 v[140:143], v[44:47], a[0:3], 0
    ds_read_b64_tr_b16 v[60:61], v67 offset:32776
    ds_read_b64_tr_b16 v[62:63], v67 offset:33800
    v_mfma_f32_16x16x32_bf16 v[172:175], v[44:47], a[4:7], 0
    v_mfma_f32_16x16x32_bf16 v[204:207], v[44:47], a[8:11], 0
    v_mfma_f32_16x16x32_bf16 v[236:239], v[44:47], a[12:15], 0
    s_waitcnt lgkmcnt(6)
    v_mfma_f32_16x16x32_bf16 v[144:147], v[48:51], a[0:3], 0
    v_mfma_f32_16x16x32_bf16 v[176:179], v[48:51], a[4:7], 0
    v_mfma_f32_16x16x32_bf16 v[208:211], v[48:51], a[8:11], 0
    v_mfma_f32_16x16x32_bf16 v[240:243], v[48:51], a[12:15], 0
    s_waitcnt vmcnt(34) lgkmcnt(0)
    s_barrier
    v_mfma_f32_16x16x32_bf16 v[148:151], v[52:55], a[0:3], 0
    ds_read_b128 a[16:19], v69 offset:0
    ds_read_b128 a[20:23], v69 offset:2048
    v_mfma_f32_16x16x32_bf16 v[180:183], v[52:55], a[4:7], 0
    ds_read_b128 a[24:27], v69 offset:4096
    ds_read_b128 a[28:31], v69 offset:6144
    v_mfma_f32_16x16x32_bf16 v[212:215], v[52:55], a[8:11], 0
    ds_read_b64_tr_b16 v[32:33], v64 offset:40960
    ds_read_b64_tr_b16 v[34:35], v64 offset:41984
    v_mfma_f32_16x16x32_bf16 v[244:247], v[52:55], a[12:15], 0
    s_lshr_b32 s74, s24, 1
    s_add_u32 m0, s74, 98304
    v_mfma_f32_16x16x32_bf16 v[152:155], v[56:59], a[0:3], 0
    ds_read_b64_tr_b16 v[36:37], v64 offset:40968
    ds_read_b64_tr_b16 v[38:39], v64 offset:41992
    v_mfma_f32_16x16x32_bf16 v[184:187], v[56:59], a[4:7], 0
    s_mov_b32 s73, 1048576
    buffer_load_dwordx4 v72, s[36:39], s73 offen offset:0 lds
    v_mfma_f32_16x16x32_bf16 v[216:219], v[56:59], a[8:11], 0
    v_mfma_f32_16x16x32_bf16 v[248:251], v[56:59], a[12:15], 0
    v_mfma_f32_16x16x32_bf16 v[156:159], v[60:63], a[0:3], 0
    ds_read_b64_tr_b16 v[40:41], v65 offset:40960
    ds_read_b64_tr_b16 v[42:43], v65 offset:41984
    v_mfma_f32_16x16x32_bf16 v[188:191], v[60:63], a[4:7], 0
    ds_read_b64_tr_b16 v[44:45], v65 offset:40968
    ds_read_b64_tr_b16 v[46:47], v65 offset:41992
    v_mfma_f32_16x16x32_bf16 v[220:223], v[60:63], a[8:11], 0
    buffer_load_dwordx4 v73, s[36:39], s73 offen offset:1024 lds
    v_mfma_f32_16x16x32_bf16 v[252:255], v[60:63], a[12:15], 0
    s_waitcnt lgkmcnt(6)
    v_mfma_f32_16x16x32_bf16 v[128:131], v[32:35], a[16:19], v[128:131]
    ds_read_b64_tr_b16 v[48:49], v66 offset:40960
    ds_read_b64_tr_b16 v[50:51], v66 offset:41984
    v_mfma_f32_16x16x32_bf16 v[160:163], v[32:35], a[20:23], v[160:163]
    s_lshl_b32 s74, s24, 1
    s_add_u32 m0, s74, 16384
    v_mfma_f32_16x16x32_bf16 v[192:195], v[32:35], a[24:27], v[192:195]
    s_mov_b32 s72, 256
    buffer_load_dwordx4 v76, s[32:35], s72 offen offset:0 lds
    v_mfma_f32_16x16x32_bf16 v[224:227], v[32:35], a[28:31], v[224:227]
    s_waitcnt lgkmcnt(6)
    v_mfma_f32_16x16x32_bf16 v[132:135], v[36:39], a[16:19], v[132:135]
    ds_read_b64_tr_b16 v[52:53], v66 offset:40968
    ds_read_b64_tr_b16 v[54:55], v66 offset:41992
    v_mfma_f32_16x16x32_bf16 v[164:167], v[36:39], a[20:23], v[164:167]
    v_mfma_f32_16x16x32_bf16 v[196:199], v[36:39], a[24:27], v[196:199]
    buffer_load_dwordx4 v77, s[32:35], s72 offen offset:1024 lds
    v_mfma_f32_16x16x32_bf16 v[228:231], v[36:39], a[28:31], v[228:231]
    s_waitcnt lgkmcnt(6)
    v_mfma_f32_16x16x32_bf16 v[136:139], v[40:43], a[16:19], v[136:139]
    ds_read_b64_tr_b16 v[56:57], v67 offset:40960
    ds_read_b64_tr_b16 v[58:59], v67 offset:41984
    v_mfma_f32_16x16x32_bf16 v[168:171], v[40:43], a[20:23], v[168:171]
    v_mfma_f32_16x16x32_bf16 v[200:203], v[40:43], a[24:27], v[200:203]
    buffer_load_dwordx4 v78, s[32:35], s72 offen offset:2048 lds
    v_mfma_f32_16x16x32_bf16 v[232:235], v[40:43], a[28:31], v[232:235]
    s_waitcnt lgkmcnt(6)
    v_mfma_f32_16x16x32_bf16 v[140:143], v[44:47], a[16:19], v[140:143]
    ds_read_b64_tr_b16 v[60:61], v67 offset:40968
    ds_read_b64_tr_b16 v[62:63], v67 offset:41992
    v_mfma_f32_16x16x32_bf16 v[172:175], v[44:47], a[20:23], v[172:175]
    v_mfma_f32_16x16x32_bf16 v[204:207], v[44:47], a[24:27], v[204:207]
    buffer_load_dwordx4 v79, s[32:35], s72 offen offset:3072 lds
    s_lshl_b32 s74, s24, 1
    v_mfma_f32_16x16x32_bf16 v[236:239], v[44:47], a[28:31], v[236:239]
    s_add_u32 m0, s74, 20480
    s_mov_b32 s72, 33024
    s_waitcnt lgkmcnt(6)
    v_mfma_f32_16x16x32_bf16 v[144:147], v[48:51], a[16:19], v[144:147]
    v_mfma_f32_16x16x32_bf16 v[176:179], v[48:51], a[20:23], v[176:179]
    v_mfma_f32_16x16x32_bf16 v[208:211], v[48:51], a[24:27], v[208:211]
    buffer_load_dwordx4 v76, s[32:35], s72 offen offset:0 lds
    v_mfma_f32_16x16x32_bf16 v[240:243], v[48:51], a[28:31], v[240:243]
    s_waitcnt vmcnt(29) lgkmcnt(0)
    s_barrier
    v_mfma_f32_16x16x32_bf16 v[148:151], v[52:55], a[16:19], v[148:151]
    ds_read_b128 a[0:3], v70 offset:0
    ds_read_b128 a[4:7], v70 offset:2048
    v_mfma_f32_16x16x32_bf16 v[180:183], v[52:55], a[20:23], v[180:183]
    ds_read_b128 a[8:11], v70 offset:4096
    ds_read_b128 a[12:15], v70 offset:6144
    v_mfma_f32_16x16x32_bf16 v[212:215], v[52:55], a[24:27], v[212:215]
    ds_read_b64_tr_b16 v[32:33], v64 offset:49152
    ds_read_b64_tr_b16 v[34:35], v64 offset:50176
    v_mfma_f32_16x16x32_bf16 v[244:247], v[52:55], a[28:31], v[244:247]
    buffer_load_dwordx4 v77, s[32:35], s72 offen offset:1024 lds
    v_mfma_f32_16x16x32_bf16 v[152:155], v[56:59], a[16:19], v[152:155]
    ds_read_b64_tr_b16 v[36:37], v64 offset:49160
    ds_read_b64_tr_b16 v[38:39], v64 offset:50184
    v_mfma_f32_16x16x32_bf16 v[184:187], v[56:59], a[20:23], v[184:187]
    v_mfma_f32_16x16x32_bf16 v[216:219], v[56:59], a[24:27], v[216:219]
    v_mfma_f32_16x16x32_bf16 v[248:251], v[56:59], a[28:31], v[248:251]
    buffer_load_dwordx4 v78, s[32:35], s72 offen offset:2048 lds
    v_mfma_f32_16x16x32_bf16 v[156:159], v[60:63], a[16:19], v[156:159]
    ds_read_b64_tr_b16 v[40:41], v65 offset:49152
    ds_read_b64_tr_b16 v[42:43], v65 offset:50176
    v_mfma_f32_16x16x32_bf16 v[188:191], v[60:63], a[20:23], v[188:191]
    ds_read_b64_tr_b16 v[44:45], v65 offset:49160
    ds_read_b64_tr_b16 v[46:47], v65 offset:50184
    v_mfma_f32_16x16x32_bf16 v[220:223], v[60:63], a[24:27], v[220:223]
    v_mfma_f32_16x16x32_bf16 v[252:255], v[60:63], a[28:31], v[252:255]
    buffer_load_dwordx4 v79, s[32:35], s72 offen offset:3072 lds
    s_lshr_b32 s74, s24, 1
    s_waitcnt lgkmcnt(6)
    v_mfma_f32_16x16x32_bf16 v[128:131], v[32:35], a[0:3], v[128:131]
    ds_read_b64_tr_b16 v[48:49], v66 offset:49152
    ds_read_b64_tr_b16 v[50:51], v66 offset:50176
    v_mfma_f32_16x16x32_bf16 v[160:163], v[32:35], a[4:7], v[160:163]
    s_add_u32 m0, s74, 106496
    s_mov_b32 s73, 1310720
    v_mfma_f32_16x16x32_bf16 v[192:195], v[32:35], a[8:11], v[192:195]
    v_mfma_f32_16x16x32_bf16 v[224:227], v[32:35], a[12:15], v[224:227]
    buffer_load_dwordx4 v72, s[36:39], s73 offen offset:0 lds
    s_waitcnt lgkmcnt(6)
    v_mfma_f32_16x16x32_bf16 v[132:135], v[36:39], a[0:3], v[132:135]
    ds_read_b64_tr_b16 v[52:53], v66 offset:49160
    ds_read_b64_tr_b16 v[54:55], v66 offset:50184
    v_mfma_f32_16x16x32_bf16 v[164:167], v[36:39], a[4:7], v[164:167]
    v_mfma_f32_16x16x32_bf16 v[196:199], v[36:39], a[8:11], v[196:199]
    v_mfma_f32_16x16x32_bf16 v[228:231], v[36:39], a[12:15], v[228:231]
    buffer_load_dwordx4 v73, s[36:39], s73 offen offset:1024 lds
    s_waitcnt lgkmcnt(6)
    v_mfma_f32_16x16x32_bf16 v[136:139], v[40:43], a[0:3], v[136:139]
    ds_read_b64_tr_b16 v[56:57], v67 offset:49152
    ds_read_b64_tr_b16 v[58:59], v67 offset:50176
    v_mfma_f32_16x16x32_bf16 v[168:171], v[40:43], a[4:7], v[168:171]
    v_mfma_f32_16x16x32_bf16 v[200:203], v[40:43], a[8:11], v[200:203]
    v_mfma_f32_16x16x32_bf16 v[232:235], v[40:43], a[12:15], v[232:235]
    s_waitcnt lgkmcnt(6)
    v_mfma_f32_16x16x32_bf16 v[140:143], v[44:47], a[0:3], v[140:143]
    ds_read_b64_tr_b16 v[60:61], v67 offset:49160
    ds_read_b64_tr_b16 v[62:63], v67 offset:50184
    v_mfma_f32_16x16x32_bf16 v[172:175], v[44:47], a[4:7], v[172:175]
    v_mfma_f32_16x16x32_bf16 v[204:207], v[44:47], a[8:11], v[204:207]
    v_mfma_f32_16x16x32_bf16 v[236:239], v[44:47], a[12:15], v[236:239]
    s_waitcnt lgkmcnt(6)
    v_mfma_f32_16x16x32_bf16 v[144:147], v[48:51], a[0:3], v[144:147]
    v_mfma_f32_16x16x32_bf16 v[176:179], v[48:51], a[4:7], v[176:179]
    v_mfma_f32_16x16x32_bf16 v[208:211], v[48:51], a[8:11], v[208:211]
    v_mfma_f32_16x16x32_bf16 v[240:243], v[48:51], a[12:15], v[240:243]
    s_waitcnt vmcnt(32) lgkmcnt(0)
    s_barrier
    v_mfma_f32_16x16x32_bf16 v[148:151], v[52:55], a[0:3], v[148:151]
    ds_read_b128 a[16:19], v71 offset:0
    ds_read_b128 a[20:23], v71 offset:2048
    v_mfma_f32_16x16x32_bf16 v[180:183], v[52:55], a[4:7], v[180:183]
    ds_read_b128 a[24:27], v71 offset:4096
    ds_read_b128 a[28:31], v71 offset:6144
    v_mfma_f32_16x16x32_bf16 v[212:215], v[52:55], a[8:11], v[212:215]
    ds_read_b64_tr_b16 v[32:33], v64 offset:57344
    ds_read_b64_tr_b16 v[34:35], v64 offset:58368
    v_mfma_f32_16x16x32_bf16 v[244:247], v[52:55], a[12:15], v[244:247]
    s_lshr_b32 s74, s24, 1
    s_add_u32 m0, s74, 114688
    v_mfma_f32_16x16x32_bf16 v[152:155], v[56:59], a[0:3], v[152:155]
    ds_read_b64_tr_b16 v[36:37], v64 offset:57352
    ds_read_b64_tr_b16 v[38:39], v64 offset:58376
    v_mfma_f32_16x16x32_bf16 v[184:187], v[56:59], a[4:7], v[184:187]
    s_mov_b32 s73, 1572864
    buffer_load_dwordx4 v72, s[36:39], s73 offen offset:0 lds
    v_mfma_f32_16x16x32_bf16 v[216:219], v[56:59], a[8:11], v[216:219]
    v_mfma_f32_16x16x32_bf16 v[248:251], v[56:59], a[12:15], v[248:251]
    v_mfma_f32_16x16x32_bf16 v[156:159], v[60:63], a[0:3], v[156:159]
    ds_read_b64_tr_b16 v[40:41], v65 offset:57344
    ds_read_b64_tr_b16 v[42:43], v65 offset:58368
    v_mfma_f32_16x16x32_bf16 v[188:191], v[60:63], a[4:7], v[188:191]
    ds_read_b64_tr_b16 v[44:45], v65 offset:57352
    ds_read_b64_tr_b16 v[46:47], v65 offset:58376
    v_mfma_f32_16x16x32_bf16 v[220:223], v[60:63], a[8:11], v[220:223]
    buffer_load_dwordx4 v73, s[36:39], s73 offen offset:1024 lds
    v_mfma_f32_16x16x32_bf16 v[252:255], v[60:63], a[12:15], v[252:255]
    s_waitcnt lgkmcnt(6)
    v_mfma_f32_16x16x32_bf16 v[128:131], v[32:35], a[16:19], v[128:131]
    ds_read_b64_tr_b16 v[48:49], v66 offset:57344
    ds_read_b64_tr_b16 v[50:51], v66 offset:58368
    v_mfma_f32_16x16x32_bf16 v[160:163], v[32:35], a[20:23], v[160:163]
    s_lshl_b32 s74, s24, 1
    s_add_u32 m0, s74, 131072
    v_mfma_f32_16x16x32_bf16 v[192:195], v[32:35], a[24:27], v[192:195]
    s_mov_b32 s72, 384
    buffer_load_dwordx4 v76, s[32:35], s72 offen offset:0 lds
    v_mfma_f32_16x16x32_bf16 v[224:227], v[32:35], a[28:31], v[224:227]
    s_waitcnt lgkmcnt(6)
    v_mfma_f32_16x16x32_bf16 v[132:135], v[36:39], a[16:19], v[132:135]
    ds_read_b64_tr_b16 v[52:53], v66 offset:57352
    ds_read_b64_tr_b16 v[54:55], v66 offset:58376
    v_mfma_f32_16x16x32_bf16 v[164:167], v[36:39], a[20:23], v[164:167]
    v_mfma_f32_16x16x32_bf16 v[196:199], v[36:39], a[24:27], v[196:199]
    buffer_load_dwordx4 v77, s[32:35], s72 offen offset:1024 lds
    v_mfma_f32_16x16x32_bf16 v[228:231], v[36:39], a[28:31], v[228:231]
    s_waitcnt lgkmcnt(6)
    v_mfma_f32_16x16x32_bf16 v[136:139], v[40:43], a[16:19], v[136:139]
    ds_read_b64_tr_b16 v[56:57], v67 offset:57344
    ds_read_b64_tr_b16 v[58:59], v67 offset:58368
    v_mfma_f32_16x16x32_bf16 v[168:171], v[40:43], a[20:23], v[168:171]
    v_mfma_f32_16x16x32_bf16 v[200:203], v[40:43], a[24:27], v[200:203]
    buffer_load_dwordx4 v78, s[32:35], s72 offen offset:2048 lds
    v_mfma_f32_16x16x32_bf16 v[232:235], v[40:43], a[28:31], v[232:235]
    s_waitcnt lgkmcnt(6)
    v_mfma_f32_16x16x32_bf16 v[140:143], v[44:47], a[16:19], v[140:143]
    ds_read_b64_tr_b16 v[60:61], v67 offset:57352
    ds_read_b64_tr_b16 v[62:63], v67 offset:58376
    v_mfma_f32_16x16x32_bf16 v[172:175], v[44:47], a[20:23], v[172:175]
    v_mfma_f32_16x16x32_bf16 v[204:207], v[44:47], a[24:27], v[204:207]
    buffer_load_dwordx4 v79, s[32:35], s72 offen offset:3072 lds
    s_lshl_b32 s74, s24, 1
    v_mfma_f32_16x16x32_bf16 v[236:239], v[44:47], a[28:31], v[236:239]
    s_add_u32 m0, s74, 135168
    s_mov_b32 s72, 33152
    s_waitcnt lgkmcnt(6)
    v_mfma_f32_16x16x32_bf16 v[144:147], v[48:51], a[16:19], v[144:147]
    v_mfma_f32_16x16x32_bf16 v[176:179], v[48:51], a[20:23], v[176:179]
    v_mfma_f32_16x16x32_bf16 v[208:211], v[48:51], a[24:27], v[208:211]
    buffer_load_dwordx4 v76, s[32:35], s72 offen offset:0 lds
    v_mfma_f32_16x16x32_bf16 v[240:243], v[48:51], a[28:31], v[240:243]
    s_waitcnt vmcnt(9) lgkmcnt(0)
    s_barrier
    v_mfma_f32_16x16x32_bf16 v[148:151], v[52:55], a[16:19], v[148:151]
    ds_read_b128 a[0:3], v68 offset:0
    ds_read_b128 a[4:7], v68 offset:2048
    v_mfma_f32_16x16x32_bf16 v[180:183], v[52:55], a[20:23], v[180:183]
    ds_read_b128 a[8:11], v68 offset:4096
    ds_read_b128 a[12:15], v68 offset:6144
    v_mfma_f32_16x16x32_bf16 v[212:215], v[52:55], a[24:27], v[212:215]
    ds_read_b64_tr_b16 v[32:33], v64 offset:32768
    ds_read_b64_tr_b16 v[34:35], v64 offset:33792
    v_mfma_f32_16x16x32_bf16 v[244:247], v[52:55], a[28:31], v[244:247]
    buffer_load_dwordx4 v77, s[32:35], s72 offen offset:1024 lds
    v_mfma_f32_16x16x32_bf16 v[152:155], v[56:59], a[16:19], v[152:155]
    ds_read_b64_tr_b16 v[36:37], v64 offset:32776
    ds_read_b64_tr_b16 v[38:39], v64 offset:33800
    v_mfma_f32_16x16x32_bf16 v[184:187], v[56:59], a[20:23], v[184:187]
    v_mfma_f32_16x16x32_bf16 v[216:219], v[56:59], a[24:27], v[216:219]
    v_mfma_f32_16x16x32_bf16 v[248:251], v[56:59], a[28:31], v[248:251]
    buffer_load_dwordx4 v78, s[32:35], s72 offen offset:2048 lds
    v_mfma_f32_16x16x32_bf16 v[156:159], v[60:63], a[16:19], v[156:159]
    ds_read_b64_tr_b16 v[40:41], v65 offset:32768
    ds_read_b64_tr_b16 v[42:43], v65 offset:33792
    v_mfma_f32_16x16x32_bf16 v[188:191], v[60:63], a[20:23], v[188:191]
    ds_read_b64_tr_b16 v[44:45], v65 offset:32776
    ds_read_b64_tr_b16 v[46:47], v65 offset:33800
    v_mfma_f32_16x16x32_bf16 v[220:223], v[60:63], a[24:27], v[220:223]
    v_mfma_f32_16x16x32_bf16 v[252:255], v[60:63], a[28:31], v[252:255]
    buffer_load_dwordx4 v79, s[32:35], s72 offen offset:3072 lds
    s_lshr_b32 s74, s24, 1
    s_waitcnt lgkmcnt(6)
    v_mfma_f32_16x16x32_bf16 v[128:131], v[32:35], a[0:3], v[128:131]
    ds_read_b64_tr_b16 v[48:49], v66 offset:32768
    ds_read_b64_tr_b16 v[50:51], v66 offset:33792
    v_mfma_f32_16x16x32_bf16 v[160:163], v[32:35], a[4:7], v[160:163]
    s_add_u32 m0, s74, 122880
    s_mov_b32 s73, 1835008
    v_mfma_f32_16x16x32_bf16 v[192:195], v[32:35], a[8:11], v[192:195]
    v_mfma_f32_16x16x32_bf16 v[224:227], v[32:35], a[12:15], v[224:227]
    buffer_load_dwordx4 v72, s[36:39], s73 offen offset:0 lds
    s_waitcnt lgkmcnt(6)
    v_mfma_f32_16x16x32_bf16 v[132:135], v[36:39], a[0:3], v[132:135]
    ds_read_b64_tr_b16 v[52:53], v66 offset:32776
    ds_read_b64_tr_b16 v[54:55], v66 offset:33800
    v_mfma_f32_16x16x32_bf16 v[164:167], v[36:39], a[4:7], v[164:167]
    v_mfma_f32_16x16x32_bf16 v[196:199], v[36:39], a[8:11], v[196:199]
    v_mfma_f32_16x16x32_bf16 v[228:231], v[36:39], a[12:15], v[228:231]
    buffer_load_dwordx4 v73, s[36:39], s73 offen offset:1024 lds
    s_waitcnt lgkmcnt(6)
    v_mfma_f32_16x16x32_bf16 v[136:139], v[40:43], a[0:3], v[136:139]
    ds_read_b64_tr_b16 v[56:57], v67 offset:32768
    ds_read_b64_tr_b16 v[58:59], v67 offset:33792
    v_mfma_f32_16x16x32_bf16 v[168:171], v[40:43], a[4:7], v[168:171]
    v_mfma_f32_16x16x32_bf16 v[200:203], v[40:43], a[8:11], v[200:203]
    v_mfma_f32_16x16x32_bf16 v[232:235], v[40:43], a[12:15], v[232:235]
    s_waitcnt lgkmcnt(6)
    v_mfma_f32_16x16x32_bf16 v[140:143], v[44:47], a[0:3], v[140:143]
    ds_read_b64_tr_b16 v[60:61], v67 offset:32776
    ds_read_b64_tr_b16 v[62:63], v67 offset:33800
    v_mfma_f32_16x16x32_bf16 v[172:175], v[44:47], a[4:7], v[172:175]
    v_mfma_f32_16x16x32_bf16 v[204:207], v[44:47], a[8:11], v[204:207]
    v_mfma_f32_16x16x32_bf16 v[236:239], v[44:47], a[12:15], v[236:239]
    s_waitcnt lgkmcnt(6)
    v_mfma_f32_16x16x32_bf16 v[144:147], v[48:51], a[0:3], v[144:147]
    v_mfma_f32_16x16x32_bf16 v[176:179], v[48:51], a[4:7], v[176:179]
    v_mfma_f32_16x16x32_bf16 v[208:211], v[48:51], a[8:11], v[208:211]
    v_mfma_f32_16x16x32_bf16 v[240:243], v[48:51], a[12:15], v[240:243]
    s_waitcnt vmcnt(12) lgkmcnt(0)
    s_barrier
    v_mfma_f32_16x16x32_bf16 v[148:151], v[52:55], a[0:3], v[148:151]
    ds_read_b128 a[16:19], v69 offset:0
    ds_read_b128 a[20:23], v69 offset:2048
    v_mfma_f32_16x16x32_bf16 v[180:183], v[52:55], a[4:7], v[180:183]
    ds_read_b128 a[24:27], v69 offset:4096
    ds_read_b128 a[28:31], v69 offset:6144
    v_mfma_f32_16x16x32_bf16 v[212:215], v[52:55], a[8:11], v[212:215]
    ds_read_b64_tr_b16 v[32:33], v64 offset:40960
    ds_read_b64_tr_b16 v[34:35], v64 offset:41984
    v_mfma_f32_16x16x32_bf16 v[244:247], v[52:55], a[12:15], v[244:247]
    s_lshr_b32 s74, s24, 1
    s_add_u32 m0, s74, 98304
    v_mfma_f32_16x16x32_bf16 v[152:155], v[56:59], a[0:3], v[152:155]
    ds_read_b64_tr_b16 v[36:37], v64 offset:40968
    ds_read_b64_tr_b16 v[38:39], v64 offset:41992
    v_mfma_f32_16x16x32_bf16 v[184:187], v[56:59], a[4:7], v[184:187]
    s_mov_b32 s73, 2097152
    buffer_load_dwordx4 v72, s[36:39], s73 offen offset:0 lds
    v_mfma_f32_16x16x32_bf16 v[216:219], v[56:59], a[8:11], v[216:219]
    v_mfma_f32_16x16x32_bf16 v[248:251], v[56:59], a[12:15], v[248:251]
    v_mfma_f32_16x16x32_bf16 v[156:159], v[60:63], a[0:3], v[156:159]
    ds_read_b64_tr_b16 v[40:41], v65 offset:40960
    ds_read_b64_tr_b16 v[42:43], v65 offset:41984
    v_mfma_f32_16x16x32_bf16 v[188:191], v[60:63], a[4:7], v[188:191]
    ds_read_b64_tr_b16 v[44:45], v65 offset:40968
    ds_read_b64_tr_b16 v[46:47], v65 offset:41992
    v_mfma_f32_16x16x32_bf16 v[220:223], v[60:63], a[8:11], v[220:223]
    buffer_load_dwordx4 v73, s[36:39], s73 offen offset:1024 lds
    v_mfma_f32_16x16x32_bf16 v[252:255], v[60:63], a[12:15], v[252:255]
    s_waitcnt lgkmcnt(6)
    v_mfma_f32_16x16x32_bf16 v[128:131], v[32:35], a[16:19], v[128:131]
    ds_read_b64_tr_b16 v[48:49], v66 offset:40960
    ds_read_b64_tr_b16 v[50:51], v66 offset:41984
    v_mfma_f32_16x16x32_bf16 v[160:163], v[32:35], a[20:23], v[160:163]
    s_lshl_b32 s74, s24, 1
    s_add_u32 m0, s74, 16384
    v_mfma_f32_16x16x32_bf16 v[192:195], v[32:35], a[24:27], v[192:195]
    s_mov_b32 s72, 512
    buffer_load_dwordx4 v76, s[32:35], s72 offen offset:0 lds
    v_mfma_f32_16x16x32_bf16 v[224:227], v[32:35], a[28:31], v[224:227]
    s_waitcnt lgkmcnt(6)
    v_mfma_f32_16x16x32_bf16 v[132:135], v[36:39], a[16:19], v[132:135]
    ds_read_b64_tr_b16 v[52:53], v66 offset:40968
    ds_read_b64_tr_b16 v[54:55], v66 offset:41992
    v_mfma_f32_16x16x32_bf16 v[164:167], v[36:39], a[20:23], v[164:167]
    v_mfma_f32_16x16x32_bf16 v[196:199], v[36:39], a[24:27], v[196:199]
    buffer_load_dwordx4 v77, s[32:35], s72 offen offset:1024 lds
    v_mfma_f32_16x16x32_bf16 v[228:231], v[36:39], a[28:31], v[228:231]
    s_waitcnt lgkmcnt(6)
    v_mfma_f32_16x16x32_bf16 v[136:139], v[40:43], a[16:19], v[136:139]
    ds_read_b64_tr_b16 v[56:57], v67 offset:40960
    ds_read_b64_tr_b16 v[58:59], v67 offset:41984
    v_mfma_f32_16x16x32_bf16 v[168:171], v[40:43], a[20:23], v[168:171]
    v_mfma_f32_16x16x32_bf16 v[200:203], v[40:43], a[24:27], v[200:203]
    buffer_load_dwordx4 v78, s[32:35], s72 offen offset:2048 lds
    v_mfma_f32_16x16x32_bf16 v[232:235], v[40:43], a[28:31], v[232:235]
    s_waitcnt lgkmcnt(6)
    v_mfma_f32_16x16x32_bf16 v[140:143], v[44:47], a[16:19], v[140:143]
    ds_read_b64_tr_b16 v[60:61], v67 offset:40968
    ds_read_b64_tr_b16 v[62:63], v67 offset:41992
    v_mfma_f32_16x16x32_bf16 v[172:175], v[44:47], a[20:23], v[172:175]
    v_mfma_f32_16x16x32_bf16 v[204:207], v[44:47], a[24:27], v[204:207]
    buffer_load_dwordx4 v79, s[32:35], s72 offen offset:3072 lds
    s_lshl_b32 s74, s24, 1
    v_mfma_f32_16x16x32_bf16 v[236:239], v[44:47], a[28:31], v[236:239]
    s_add_u32 m0, s74, 20480
    s_mov_b32 s72, 33280
    s_waitcnt lgkmcnt(6)
    v_mfma_f32_16x16x32_bf16 v[144:147], v[48:51], a[16:19], v[144:147]
    v_mfma_f32_16x16x32_bf16 v[176:179], v[48:51], a[20:23], v[176:179]
    v_mfma_f32_16x16x32_bf16 v[208:211], v[48:51], a[24:27], v[208:211]
    buffer_load_dwordx4 v76, s[32:35], s72 offen offset:0 lds
    v_mfma_f32_16x16x32_bf16 v[240:243], v[48:51], a[28:31], v[240:243]
    s_waitcnt vmcnt(9) lgkmcnt(0)
    s_barrier
    v_mfma_f32_16x16x32_bf16 v[148:151], v[52:55], a[16:19], v[148:151]
    ds_read_b128 a[0:3], v70 offset:0
    ds_read_b128 a[4:7], v70 offset:2048
    v_mfma_f32_16x16x32_bf16 v[180:183], v[52:55], a[20:23], v[180:183]
    ds_read_b128 a[8:11], v70 offset:4096
    ds_read_b128 a[12:15], v70 offset:6144
    v_mfma_f32_16x16x32_bf16 v[212:215], v[52:55], a[24:27], v[212:215]
    ds_read_b64_tr_b16 v[32:33], v64 offset:49152
    ds_read_b64_tr_b16 v[34:35], v64 offset:50176
    v_mfma_f32_16x16x32_bf16 v[244:247], v[52:55], a[28:31], v[244:247]
    buffer_load_dwordx4 v77, s[32:35], s72 offen offset:1024 lds
    v_mfma_f32_16x16x32_bf16 v[152:155], v[56:59], a[16:19], v[152:155]
    ds_read_b64_tr_b16 v[36:37], v64 offset:49160
    ds_read_b64_tr_b16 v[38:39], v64 offset:50184
    v_mfma_f32_16x16x32_bf16 v[184:187], v[56:59], a[20:23], v[184:187]
    v_mfma_f32_16x16x32_bf16 v[216:219], v[56:59], a[24:27], v[216:219]
    v_mfma_f32_16x16x32_bf16 v[248:251], v[56:59], a[28:31], v[248:251]
    buffer_load_dwordx4 v78, s[32:35], s72 offen offset:2048 lds
    v_mfma_f32_16x16x32_bf16 v[156:159], v[60:63], a[16:19], v[156:159]
    ds_read_b64_tr_b16 v[40:41], v65 offset:49152
    ds_read_b64_tr_b16 v[42:43], v65 offset:50176
    v_mfma_f32_16x16x32_bf16 v[188:191], v[60:63], a[20:23], v[188:191]
    ds_read_b64_tr_b16 v[44:45], v65 offset:49160
    ds_read_b64_tr_b16 v[46:47], v65 offset:50184
    v_mfma_f32_16x16x32_bf16 v[220:223], v[60:63], a[24:27], v[220:223]
    v_mfma_f32_16x16x32_bf16 v[252:255], v[60:63], a[28:31], v[252:255]
    buffer_load_dwordx4 v79, s[32:35], s72 offen offset:3072 lds
    s_lshr_b32 s74, s24, 1
    s_waitcnt lgkmcnt(6)
    v_mfma_f32_16x16x32_bf16 v[128:131], v[32:35], a[0:3], v[128:131]
    ds_read_b64_tr_b16 v[48:49], v66 offset:49152
    ds_read_b64_tr_b16 v[50:51], v66 offset:50176
    v_mfma_f32_16x16x32_bf16 v[160:163], v[32:35], a[4:7], v[160:163]
    s_add_u32 m0, s74, 106496
    s_mov_b32 s73, 2359296
    v_mfma_f32_16x16x32_bf16 v[192:195], v[32:35], a[8:11], v[192:195]
    v_mfma_f32_16x16x32_bf16 v[224:227], v[32:35], a[12:15], v[224:227]
    buffer_load_dwordx4 v72, s[36:39], s73 offen offset:0 lds
    s_waitcnt lgkmcnt(6)
    v_mfma_f32_16x16x32_bf16 v[132:135], v[36:39], a[0:3], v[132:135]
    ds_read_b64_tr_b16 v[52:53], v66 offset:49160
    ds_read_b64_tr_b16 v[54:55], v66 offset:50184
    v_mfma_f32_16x16x32_bf16 v[164:167], v[36:39], a[4:7], v[164:167]
    v_mfma_f32_16x16x32_bf16 v[196:199], v[36:39], a[8:11], v[196:199]
    v_mfma_f32_16x16x32_bf16 v[228:231], v[36:39], a[12:15], v[228:231]
    buffer_load_dwordx4 v73, s[36:39], s73 offen offset:1024 lds
    s_waitcnt lgkmcnt(6)
    v_mfma_f32_16x16x32_bf16 v[136:139], v[40:43], a[0:3], v[136:139]
    ds_read_b64_tr_b16 v[56:57], v67 offset:49152
    ds_read_b64_tr_b16 v[58:59], v67 offset:50176
    v_mfma_f32_16x16x32_bf16 v[168:171], v[40:43], a[4:7], v[168:171]
    v_mfma_f32_16x16x32_bf16 v[200:203], v[40:43], a[8:11], v[200:203]
    v_mfma_f32_16x16x32_bf16 v[232:235], v[40:43], a[12:15], v[232:235]
    s_waitcnt lgkmcnt(6)
    v_mfma_f32_16x16x32_bf16 v[140:143], v[44:47], a[0:3], v[140:143]
    ds_read_b64_tr_b16 v[60:61], v67 offset:49160
    ds_read_b64_tr_b16 v[62:63], v67 offset:50184
    v_mfma_f32_16x16x32_bf16 v[172:175], v[44:47], a[4:7], v[172:175]
    v_mfma_f32_16x16x32_bf16 v[204:207], v[44:47], a[8:11], v[204:207]
    v_mfma_f32_16x16x32_bf16 v[236:239], v[44:47], a[12:15], v[236:239]
    s_waitcnt lgkmcnt(6)
    v_mfma_f32_16x16x32_bf16 v[144:147], v[48:51], a[0:3], v[144:147]
    v_mfma_f32_16x16x32_bf16 v[176:179], v[48:51], a[4:7], v[176:179]
    v_mfma_f32_16x16x32_bf16 v[208:211], v[48:51], a[8:11], v[208:211]
    v_mfma_f32_16x16x32_bf16 v[240:243], v[48:51], a[12:15], v[240:243]
    s_waitcnt vmcnt(12) lgkmcnt(0)
    s_barrier
    v_mfma_f32_16x16x32_bf16 v[148:151], v[52:55], a[0:3], v[148:151]
    ds_read_b128 a[16:19], v71 offset:0
    ds_read_b128 a[20:23], v71 offset:2048
    v_mfma_f32_16x16x32_bf16 v[180:183], v[52:55], a[4:7], v[180:183]
    ds_read_b128 a[24:27], v71 offset:4096
    ds_read_b128 a[28:31], v71 offset:6144
    v_mfma_f32_16x16x32_bf16 v[212:215], v[52:55], a[8:11], v[212:215]
    ds_read_b64_tr_b16 v[32:33], v64 offset:57344
    ds_read_b64_tr_b16 v[34:35], v64 offset:58368
    v_mfma_f32_16x16x32_bf16 v[244:247], v[52:55], a[12:15], v[244:247]
    s_lshr_b32 s74, s24, 1
    s_add_u32 m0, s74, 114688
    v_mfma_f32_16x16x32_bf16 v[152:155], v[56:59], a[0:3], v[152:155]
    ds_read_b64_tr_b16 v[36:37], v64 offset:57352
    ds_read_b64_tr_b16 v[38:39], v64 offset:58376
    v_mfma_f32_16x16x32_bf16 v[184:187], v[56:59], a[4:7], v[184:187]
    s_mov_b32 s73, 2621440
    buffer_load_dwordx4 v72, s[36:39], s73 offen offset:0 lds
    v_mfma_f32_16x16x32_bf16 v[216:219], v[56:59], a[8:11], v[216:219]
    v_mfma_f32_16x16x32_bf16 v[248:251], v[56:59], a[12:15], v[248:251]
    v_mfma_f32_16x16x32_bf16 v[156:159], v[60:63], a[0:3], v[156:159]
    ds_read_b64_tr_b16 v[40:41], v65 offset:57344
    ds_read_b64_tr_b16 v[42:43], v65 offset:58368
    v_mfma_f32_16x16x32_bf16 v[188:191], v[60:63], a[4:7], v[188:191]
    ds_read_b64_tr_b16 v[44:45], v65 offset:57352
    ds_read_b64_tr_b16 v[46:47], v65 offset:58376
    v_mfma_f32_16x16x32_bf16 v[220:223], v[60:63], a[8:11], v[220:223]
    buffer_load_dwordx4 v73, s[36:39], s73 offen offset:1024 lds
    v_mfma_f32_16x16x32_bf16 v[252:255], v[60:63], a[12:15], v[252:255]
    s_waitcnt lgkmcnt(6)
    v_mfma_f32_16x16x32_bf16 v[128:131], v[32:35], a[16:19], v[128:131]
    ds_read_b64_tr_b16 v[48:49], v66 offset:57344
    ds_read_b64_tr_b16 v[50:51], v66 offset:58368
    v_mfma_f32_16x16x32_bf16 v[160:163], v[32:35], a[20:23], v[160:163]
    s_lshl_b32 s74, s24, 1
    s_add_u32 m0, s74, 131072
    v_mfma_f32_16x16x32_bf16 v[192:195], v[32:35], a[24:27], v[192:195]
    s_mov_b32 s72, 640
    buffer_load_dwordx4 v76, s[32:35], s72 offen offset:0 lds
    v_mfma_f32_16x16x32_bf16 v[224:227], v[32:35], a[28:31], v[224:227]
    s_waitcnt lgkmcnt(6)
    v_mfma_f32_16x16x32_bf16 v[132:135], v[36:39], a[16:19], v[132:135]
    ds_read_b64_tr_b16 v[52:53], v66 offset:57352
    ds_read_b64_tr_b16 v[54:55], v66 offset:58376
    v_mfma_f32_16x16x32_bf16 v[164:167], v[36:39], a[20:23], v[164:167]
    v_mfma_f32_16x16x32_bf16 v[196:199], v[36:39], a[24:27], v[196:199]
    buffer_load_dwordx4 v77, s[32:35], s72 offen offset:1024 lds
    v_mfma_f32_16x16x32_bf16 v[228:231], v[36:39], a[28:31], v[228:231]
    s_waitcnt lgkmcnt(6)
    v_mfma_f32_16x16x32_bf16 v[136:139], v[40:43], a[16:19], v[136:139]
    ds_read_b64_tr_b16 v[56:57], v67 offset:57344
    ds_read_b64_tr_b16 v[58:59], v67 offset:58368
    v_mfma_f32_16x16x32_bf16 v[168:171], v[40:43], a[20:23], v[168:171]
    v_mfma_f32_16x16x32_bf16 v[200:203], v[40:43], a[24:27], v[200:203]
    buffer_load_dwordx4 v78, s[32:35], s72 offen offset:2048 lds
    v_mfma_f32_16x16x32_bf16 v[232:235], v[40:43], a[28:31], v[232:235]
    s_waitcnt lgkmcnt(6)
    v_mfma_f32_16x16x32_bf16 v[140:143], v[44:47], a[16:19], v[140:143]
    ds_read_b64_tr_b16 v[60:61], v67 offset:57352
    ds_read_b64_tr_b16 v[62:63], v67 offset:58376
    v_mfma_f32_16x16x32_bf16 v[172:175], v[44:47], a[20:23], v[172:175]
    v_mfma_f32_16x16x32_bf16 v[204:207], v[44:47], a[24:27], v[204:207]
    buffer_load_dwordx4 v79, s[32:35], s72 offen offset:3072 lds
    s_lshl_b32 s74, s24, 1
    v_mfma_f32_16x16x32_bf16 v[236:239], v[44:47], a[28:31], v[236:239]
    s_add_u32 m0, s74, 135168
    s_mov_b32 s72, 33408
    s_waitcnt lgkmcnt(6)
    v_mfma_f32_16x16x32_bf16 v[144:147], v[48:51], a[16:19], v[144:147]
    v_mfma_f32_16x16x32_bf16 v[176:179], v[48:51], a[20:23], v[176:179]
    v_mfma_f32_16x16x32_bf16 v[208:211], v[48:51], a[24:27], v[208:211]
    buffer_load_dwordx4 v76, s[32:35], s72 offen offset:0 lds
    v_mfma_f32_16x16x32_bf16 v[240:243], v[48:51], a[28:31], v[240:243]
    s_waitcnt vmcnt(9) lgkmcnt(0)
    s_barrier
    v_mfma_f32_16x16x32_bf16 v[148:151], v[52:55], a[16:19], v[148:151]
    ds_read_b128 a[0:3], v68 offset:0
    ds_read_b128 a[4:7], v68 offset:2048
    v_mfma_f32_16x16x32_bf16 v[180:183], v[52:55], a[20:23], v[180:183]
    ds_read_b128 a[8:11], v68 offset:4096
    ds_read_b128 a[12:15], v68 offset:6144
    v_mfma_f32_16x16x32_bf16 v[212:215], v[52:55], a[24:27], v[212:215]
    ds_read_b64_tr_b16 v[32:33], v64 offset:32768
    ds_read_b64_tr_b16 v[34:35], v64 offset:33792
    v_mfma_f32_16x16x32_bf16 v[244:247], v[52:55], a[28:31], v[244:247]
    buffer_load_dwordx4 v77, s[32:35], s72 offen offset:1024 lds
    v_mfma_f32_16x16x32_bf16 v[152:155], v[56:59], a[16:19], v[152:155]
    ds_read_b64_tr_b16 v[36:37], v64 offset:32776
    ds_read_b64_tr_b16 v[38:39], v64 offset:33800
    v_mfma_f32_16x16x32_bf16 v[184:187], v[56:59], a[20:23], v[184:187]
    v_mfma_f32_16x16x32_bf16 v[216:219], v[56:59], a[24:27], v[216:219]
    v_mfma_f32_16x16x32_bf16 v[248:251], v[56:59], a[28:31], v[248:251]
    buffer_load_dwordx4 v78, s[32:35], s72 offen offset:2048 lds
    v_mfma_f32_16x16x32_bf16 v[156:159], v[60:63], a[16:19], v[156:159]
    ds_read_b64_tr_b16 v[40:41], v65 offset:32768
    ds_read_b64_tr_b16 v[42:43], v65 offset:33792
    v_mfma_f32_16x16x32_bf16 v[188:191], v[60:63], a[20:23], v[188:191]
    ds_read_b64_tr_b16 v[44:45], v65 offset:32776
    ds_read_b64_tr_b16 v[46:47], v65 offset:33800
    v_mfma_f32_16x16x32_bf16 v[220:223], v[60:63], a[24:27], v[220:223]
    v_mfma_f32_16x16x32_bf16 v[252:255], v[60:63], a[28:31], v[252:255]
    buffer_load_dwordx4 v79, s[32:35], s72 offen offset:3072 lds
    s_lshr_b32 s74, s24, 1
    s_waitcnt lgkmcnt(6)
    v_mfma_f32_16x16x32_bf16 v[128:131], v[32:35], a[0:3], v[128:131]
    ds_read_b64_tr_b16 v[48:49], v66 offset:32768
    ds_read_b64_tr_b16 v[50:51], v66 offset:33792
    v_mfma_f32_16x16x32_bf16 v[160:163], v[32:35], a[4:7], v[160:163]
    s_add_u32 m0, s74, 122880
    s_mov_b32 s73, 2883584
    v_mfma_f32_16x16x32_bf16 v[192:195], v[32:35], a[8:11], v[192:195]
    v_mfma_f32_16x16x32_bf16 v[224:227], v[32:35], a[12:15], v[224:227]
    buffer_load_dwordx4 v72, s[36:39], s73 offen offset:0 lds
    s_waitcnt lgkmcnt(6)
    v_mfma_f32_16x16x32_bf16 v[132:135], v[36:39], a[0:3], v[132:135]
    ds_read_b64_tr_b16 v[52:53], v66 offset:32776
    ds_read_b64_tr_b16 v[54:55], v66 offset:33800
    v_mfma_f32_16x16x32_bf16 v[164:167], v[36:39], a[4:7], v[164:167]
    v_mfma_f32_16x16x32_bf16 v[196:199], v[36:39], a[8:11], v[196:199]
    v_mfma_f32_16x16x32_bf16 v[228:231], v[36:39], a[12:15], v[228:231]
    buffer_load_dwordx4 v73, s[36:39], s73 offen offset:1024 lds
    s_waitcnt lgkmcnt(6)
    v_mfma_f32_16x16x32_bf16 v[136:139], v[40:43], a[0:3], v[136:139]
    ds_read_b64_tr_b16 v[56:57], v67 offset:32768
    ds_read_b64_tr_b16 v[58:59], v67 offset:33792
    v_mfma_f32_16x16x32_bf16 v[168:171], v[40:43], a[4:7], v[168:171]
    v_mfma_f32_16x16x32_bf16 v[200:203], v[40:43], a[8:11], v[200:203]
    v_mfma_f32_16x16x32_bf16 v[232:235], v[40:43], a[12:15], v[232:235]
    s_waitcnt lgkmcnt(6)
    v_mfma_f32_16x16x32_bf16 v[140:143], v[44:47], a[0:3], v[140:143]
    ds_read_b64_tr_b16 v[60:61], v67 offset:32776
    ds_read_b64_tr_b16 v[62:63], v67 offset:33800
    v_mfma_f32_16x16x32_bf16 v[172:175], v[44:47], a[4:7], v[172:175]
    v_mfma_f32_16x16x32_bf16 v[204:207], v[44:47], a[8:11], v[204:207]
    v_mfma_f32_16x16x32_bf16 v[236:239], v[44:47], a[12:15], v[236:239]
    s_waitcnt lgkmcnt(6)
    v_mfma_f32_16x16x32_bf16 v[144:147], v[48:51], a[0:3], v[144:147]
    v_mfma_f32_16x16x32_bf16 v[176:179], v[48:51], a[4:7], v[176:179]
    v_mfma_f32_16x16x32_bf16 v[208:211], v[48:51], a[8:11], v[208:211]
    v_mfma_f32_16x16x32_bf16 v[240:243], v[48:51], a[12:15], v[240:243]
    s_waitcnt vmcnt(12) lgkmcnt(0)
    s_barrier
    v_mfma_f32_16x16x32_bf16 v[148:151], v[52:55], a[0:3], v[148:151]
    ds_read_b128 a[16:19], v69 offset:0
    ds_read_b128 a[20:23], v69 offset:2048
    v_mfma_f32_16x16x32_bf16 v[180:183], v[52:55], a[4:7], v[180:183]
    ds_read_b128 a[24:27], v69 offset:4096
    ds_read_b128 a[28:31], v69 offset:6144
    v_mfma_f32_16x16x32_bf16 v[212:215], v[52:55], a[8:11], v[212:215]
    ds_read_b64_tr_b16 v[32:33], v64 offset:40960
    ds_read_b64_tr_b16 v[34:35], v64 offset:41984
    v_mfma_f32_16x16x32_bf16 v[244:247], v[52:55], a[12:15], v[244:247]
    s_lshr_b32 s74, s24, 1
    s_add_u32 m0, s74, 98304
    v_mfma_f32_16x16x32_bf16 v[152:155], v[56:59], a[0:3], v[152:155]
    ds_read_b64_tr_b16 v[36:37], v64 offset:40968
    ds_read_b64_tr_b16 v[38:39], v64 offset:41992
    v_mfma_f32_16x16x32_bf16 v[184:187], v[56:59], a[4:7], v[184:187]
    s_mov_b32 s73, 3145728
    buffer_load_dwordx4 v72, s[36:39], s73 offen offset:0 lds
    v_mfma_f32_16x16x32_bf16 v[216:219], v[56:59], a[8:11], v[216:219]
    v_mfma_f32_16x16x32_bf16 v[248:251], v[56:59], a[12:15], v[248:251]
    v_mfma_f32_16x16x32_bf16 v[156:159], v[60:63], a[0:3], v[156:159]
    ds_read_b64_tr_b16 v[40:41], v65 offset:40960
    ds_read_b64_tr_b16 v[42:43], v65 offset:41984
    v_mfma_f32_16x16x32_bf16 v[188:191], v[60:63], a[4:7], v[188:191]
    ds_read_b64_tr_b16 v[44:45], v65 offset:40968
    ds_read_b64_tr_b16 v[46:47], v65 offset:41992
    v_mfma_f32_16x16x32_bf16 v[220:223], v[60:63], a[8:11], v[220:223]
    buffer_load_dwordx4 v73, s[36:39], s73 offen offset:1024 lds
    v_mfma_f32_16x16x32_bf16 v[252:255], v[60:63], a[12:15], v[252:255]
    s_waitcnt lgkmcnt(6)
    v_mfma_f32_16x16x32_bf16 v[128:131], v[32:35], a[16:19], v[128:131]
    ds_read_b64_tr_b16 v[48:49], v66 offset:40960
    ds_read_b64_tr_b16 v[50:51], v66 offset:41984
    v_mfma_f32_16x16x32_bf16 v[160:163], v[32:35], a[20:23], v[160:163]
    s_lshl_b32 s74, s24, 1
    s_add_u32 m0, s74, 16384
    v_mfma_f32_16x16x32_bf16 v[192:195], v[32:35], a[24:27], v[192:195]
    s_mov_b32 s72, 768
    buffer_load_dwordx4 v76, s[32:35], s72 offen offset:0 lds
    v_mfma_f32_16x16x32_bf16 v[224:227], v[32:35], a[28:31], v[224:227]
    s_waitcnt lgkmcnt(6)
    v_mfma_f32_16x16x32_bf16 v[132:135], v[36:39], a[16:19], v[132:135]
    ds_read_b64_tr_b16 v[52:53], v66 offset:40968
    ds_read_b64_tr_b16 v[54:55], v66 offset:41992
    v_mfma_f32_16x16x32_bf16 v[164:167], v[36:39], a[20:23], v[164:167]
    v_mfma_f32_16x16x32_bf16 v[196:199], v[36:39], a[24:27], v[196:199]
    buffer_load_dwordx4 v77, s[32:35], s72 offen offset:1024 lds
    v_mfma_f32_16x16x32_bf16 v[228:231], v[36:39], a[28:31], v[228:231]
    s_waitcnt lgkmcnt(6)
    v_mfma_f32_16x16x32_bf16 v[136:139], v[40:43], a[16:19], v[136:139]
    ds_read_b64_tr_b16 v[56:57], v67 offset:40960
    ds_read_b64_tr_b16 v[58:59], v67 offset:41984
    v_mfma_f32_16x16x32_bf16 v[168:171], v[40:43], a[20:23], v[168:171]
    v_mfma_f32_16x16x32_bf16 v[200:203], v[40:43], a[24:27], v[200:203]
    buffer_load_dwordx4 v78, s[32:35], s72 offen offset:2048 lds
    v_mfma_f32_16x16x32_bf16 v[232:235], v[40:43], a[28:31], v[232:235]
    s_waitcnt lgkmcnt(6)
    v_mfma_f32_16x16x32_bf16 v[140:143], v[44:47], a[16:19], v[140:143]
    ds_read_b64_tr_b16 v[60:61], v67 offset:40968
    ds_read_b64_tr_b16 v[62:63], v67 offset:41992
    v_mfma_f32_16x16x32_bf16 v[172:175], v[44:47], a[20:23], v[172:175]
    v_mfma_f32_16x16x32_bf16 v[204:207], v[44:47], a[24:27], v[204:207]
    buffer_load_dwordx4 v79, s[32:35], s72 offen offset:3072 lds
    s_lshl_b32 s74, s24, 1
    v_mfma_f32_16x16x32_bf16 v[236:239], v[44:47], a[28:31], v[236:239]
    s_add_u32 m0, s74, 20480
    s_mov_b32 s72, 33536
    s_waitcnt lgkmcnt(6)
    v_mfma_f32_16x16x32_bf16 v[144:147], v[48:51], a[16:19], v[144:147]
    v_mfma_f32_16x16x32_bf16 v[176:179], v[48:51], a[20:23], v[176:179]
    v_mfma_f32_16x16x32_bf16 v[208:211], v[48:51], a[24:27], v[208:211]
    buffer_load_dwordx4 v76, s[32:35], s72 offen offset:0 lds
    v_mfma_f32_16x16x32_bf16 v[240:243], v[48:51], a[28:31], v[240:243]
    s_waitcnt vmcnt(9) lgkmcnt(0)
    s_barrier
    v_mfma_f32_16x16x32_bf16 v[148:151], v[52:55], a[16:19], v[148:151]
    ds_read_b128 a[0:3], v70 offset:0
    ds_read_b128 a[4:7], v70 offset:2048
    v_mfma_f32_16x16x32_bf16 v[180:183], v[52:55], a[20:23], v[180:183]
    ds_read_b128 a[8:11], v70 offset:4096
    ds_read_b128 a[12:15], v70 offset:6144
    v_mfma_f32_16x16x32_bf16 v[212:215], v[52:55], a[24:27], v[212:215]
    ds_read_b64_tr_b16 v[32:33], v64 offset:49152
    ds_read_b64_tr_b16 v[34:35], v64 offset:50176
    v_mfma_f32_16x16x32_bf16 v[244:247], v[52:55], a[28:31], v[244:247]
    buffer_load_dwordx4 v77, s[32:35], s72 offen offset:1024 lds
    v_mfma_f32_16x16x32_bf16 v[152:155], v[56:59], a[16:19], v[152:155]
    ds_read_b64_tr_b16 v[36:37], v64 offset:49160
    ds_read_b64_tr_b16 v[38:39], v64 offset:50184
    v_mfma_f32_16x16x32_bf16 v[184:187], v[56:59], a[20:23], v[184:187]
    v_mfma_f32_16x16x32_bf16 v[216:219], v[56:59], a[24:27], v[216:219]
    v_mfma_f32_16x16x32_bf16 v[248:251], v[56:59], a[28:31], v[248:251]
    buffer_load_dwordx4 v78, s[32:35], s72 offen offset:2048 lds
    v_mfma_f32_16x16x32_bf16 v[156:159], v[60:63], a[16:19], v[156:159]
    ds_read_b64_tr_b16 v[40:41], v65 offset:49152
    ds_read_b64_tr_b16 v[42:43], v65 offset:50176
    v_mfma_f32_16x16x32_bf16 v[188:191], v[60:63], a[20:23], v[188:191]
    ds_read_b64_tr_b16 v[44:45], v65 offset:49160
    ds_read_b64_tr_b16 v[46:47], v65 offset:50184
    v_mfma_f32_16x16x32_bf16 v[220:223], v[60:63], a[24:27], v[220:223]
    v_mfma_f32_16x16x32_bf16 v[252:255], v[60:63], a[28:31], v[252:255]
    buffer_load_dwordx4 v79, s[32:35], s72 offen offset:3072 lds
    s_lshr_b32 s74, s24, 1
    s_waitcnt lgkmcnt(6)
    v_mfma_f32_16x16x32_bf16 v[128:131], v[32:35], a[0:3], v[128:131]
    ds_read_b64_tr_b16 v[48:49], v66 offset:49152
    ds_read_b64_tr_b16 v[50:51], v66 offset:50176
    v_mfma_f32_16x16x32_bf16 v[160:163], v[32:35], a[4:7], v[160:163]
    s_add_u32 m0, s74, 106496
    s_mov_b32 s73, 3407872
    v_mfma_f32_16x16x32_bf16 v[192:195], v[32:35], a[8:11], v[192:195]
    v_mfma_f32_16x16x32_bf16 v[224:227], v[32:35], a[12:15], v[224:227]
    buffer_load_dwordx4 v72, s[36:39], s73 offen offset:0 lds
    s_waitcnt lgkmcnt(6)
    v_mfma_f32_16x16x32_bf16 v[132:135], v[36:39], a[0:3], v[132:135]
    ds_read_b64_tr_b16 v[52:53], v66 offset:49160
    ds_read_b64_tr_b16 v[54:55], v66 offset:50184
    v_mfma_f32_16x16x32_bf16 v[164:167], v[36:39], a[4:7], v[164:167]
    v_mfma_f32_16x16x32_bf16 v[196:199], v[36:39], a[8:11], v[196:199]
    v_mfma_f32_16x16x32_bf16 v[228:231], v[36:39], a[12:15], v[228:231]
    buffer_load_dwordx4 v73, s[36:39], s73 offen offset:1024 lds
    s_waitcnt lgkmcnt(6)
    v_mfma_f32_16x16x32_bf16 v[136:139], v[40:43], a[0:3], v[136:139]
    ds_read_b64_tr_b16 v[56:57], v67 offset:49152
    ds_read_b64_tr_b16 v[58:59], v67 offset:50176
    v_mfma_f32_16x16x32_bf16 v[168:171], v[40:43], a[4:7], v[168:171]
    v_mfma_f32_16x16x32_bf16 v[200:203], v[40:43], a[8:11], v[200:203]
    v_mfma_f32_16x16x32_bf16 v[232:235], v[40:43], a[12:15], v[232:235]
    s_waitcnt lgkmcnt(6)
    v_mfma_f32_16x16x32_bf16 v[140:143], v[44:47], a[0:3], v[140:143]
    ds_read_b64_tr_b16 v[60:61], v67 offset:49160
    ds_read_b64_tr_b16 v[62:63], v67 offset:50184
    v_mfma_f32_16x16x32_bf16 v[172:175], v[44:47], a[4:7], v[172:175]
    v_mfma_f32_16x16x32_bf16 v[204:207], v[44:47], a[8:11], v[204:207]
    v_mfma_f32_16x16x32_bf16 v[236:239], v[44:47], a[12:15], v[236:239]
    s_waitcnt lgkmcnt(6)
    v_mfma_f32_16x16x32_bf16 v[144:147], v[48:51], a[0:3], v[144:147]
    v_mfma_f32_16x16x32_bf16 v[176:179], v[48:51], a[4:7], v[176:179]
    v_mfma_f32_16x16x32_bf16 v[208:211], v[48:51], a[8:11], v[208:211]
    v_mfma_f32_16x16x32_bf16 v[240:243], v[48:51], a[12:15], v[240:243]
    s_waitcnt vmcnt(12) lgkmcnt(0)
    s_barrier
    v_mfma_f32_16x16x32_bf16 v[148:151], v[52:55], a[0:3], v[148:151]
    ds_read_b128 a[16:19], v71 offset:0
    ds_read_b128 a[20:23], v71 offset:2048
    v_mfma_f32_16x16x32_bf16 v[180:183], v[52:55], a[4:7], v[180:183]
    ds_read_b128 a[24:27], v71 offset:4096
    ds_read_b128 a[28:31], v71 offset:6144
    v_mfma_f32_16x16x32_bf16 v[212:215], v[52:55], a[8:11], v[212:215]
    ds_read_b64_tr_b16 v[32:33], v64 offset:57344
    ds_read_b64_tr_b16 v[34:35], v64 offset:58368
    v_mfma_f32_16x16x32_bf16 v[244:247], v[52:55], a[12:15], v[244:247]
    s_lshr_b32 s74, s24, 1
    s_add_u32 m0, s74, 114688
    v_mfma_f32_16x16x32_bf16 v[152:155], v[56:59], a[0:3], v[152:155]
    ds_read_b64_tr_b16 v[36:37], v64 offset:57352
    ds_read_b64_tr_b16 v[38:39], v64 offset:58376
    v_mfma_f32_16x16x32_bf16 v[184:187], v[56:59], a[4:7], v[184:187]
    s_mov_b32 s73, 3670016
    buffer_load_dwordx4 v72, s[36:39], s73 offen offset:0 lds
    v_mfma_f32_16x16x32_bf16 v[216:219], v[56:59], a[8:11], v[216:219]
    v_mfma_f32_16x16x32_bf16 v[248:251], v[56:59], a[12:15], v[248:251]
    v_mfma_f32_16x16x32_bf16 v[156:159], v[60:63], a[0:3], v[156:159]
    ds_read_b64_tr_b16 v[40:41], v65 offset:57344
    ds_read_b64_tr_b16 v[42:43], v65 offset:58368
    v_mfma_f32_16x16x32_bf16 v[188:191], v[60:63], a[4:7], v[188:191]
    ds_read_b64_tr_b16 v[44:45], v65 offset:57352
    ds_read_b64_tr_b16 v[46:47], v65 offset:58376
    v_mfma_f32_16x16x32_bf16 v[220:223], v[60:63], a[8:11], v[220:223]
    buffer_load_dwordx4 v73, s[36:39], s73 offen offset:1024 lds
    v_mfma_f32_16x16x32_bf16 v[252:255], v[60:63], a[12:15], v[252:255]
    s_waitcnt lgkmcnt(6)
    v_mfma_f32_16x16x32_bf16 v[128:131], v[32:35], a[16:19], v[128:131]
    ds_read_b64_tr_b16 v[48:49], v66 offset:57344
    ds_read_b64_tr_b16 v[50:51], v66 offset:58368
    v_mfma_f32_16x16x32_bf16 v[160:163], v[32:35], a[20:23], v[160:163]
    s_lshl_b32 s74, s24, 1
    s_add_u32 m0, s74, 131072
    v_mfma_f32_16x16x32_bf16 v[192:195], v[32:35], a[24:27], v[192:195]
    s_mov_b32 s72, 896
    buffer_load_dwordx4 v76, s[32:35], s72 offen offset:0 lds
    v_mfma_f32_16x16x32_bf16 v[224:227], v[32:35], a[28:31], v[224:227]
    s_waitcnt lgkmcnt(6)
    v_mfma_f32_16x16x32_bf16 v[132:135], v[36:39], a[16:19], v[132:135]
    ds_read_b64_tr_b16 v[52:53], v66 offset:57352
    ds_read_b64_tr_b16 v[54:55], v66 offset:58376
    v_mfma_f32_16x16x32_bf16 v[164:167], v[36:39], a[20:23], v[164:167]
    v_mfma_f32_16x16x32_bf16 v[196:199], v[36:39], a[24:27], v[196:199]
    buffer_load_dwordx4 v77, s[32:35], s72 offen offset:1024 lds
    v_mfma_f32_16x16x32_bf16 v[228:231], v[36:39], a[28:31], v[228:231]
    s_waitcnt lgkmcnt(6)
    v_mfma_f32_16x16x32_bf16 v[136:139], v[40:43], a[16:19], v[136:139]
    ds_read_b64_tr_b16 v[56:57], v67 offset:57344
    ds_read_b64_tr_b16 v[58:59], v67 offset:58368
    v_mfma_f32_16x16x32_bf16 v[168:171], v[40:43], a[20:23], v[168:171]
    v_mfma_f32_16x16x32_bf16 v[200:203], v[40:43], a[24:27], v[200:203]
    buffer_load_dwordx4 v78, s[32:35], s72 offen offset:2048 lds
    v_mfma_f32_16x16x32_bf16 v[232:235], v[40:43], a[28:31], v[232:235]
    s_waitcnt lgkmcnt(6)
    v_mfma_f32_16x16x32_bf16 v[140:143], v[44:47], a[16:19], v[140:143]
    ds_read_b64_tr_b16 v[60:61], v67 offset:57352
    ds_read_b64_tr_b16 v[62:63], v67 offset:58376
    v_mfma_f32_16x16x32_bf16 v[172:175], v[44:47], a[20:23], v[172:175]
    v_mfma_f32_16x16x32_bf16 v[204:207], v[44:47], a[24:27], v[204:207]
    buffer_load_dwordx4 v79, s[32:35], s72 offen offset:3072 lds
    s_lshl_b32 s74, s24, 1
    v_mfma_f32_16x16x32_bf16 v[236:239], v[44:47], a[28:31], v[236:239]
    s_add_u32 m0, s74, 135168
    s_mov_b32 s72, 33664
    s_waitcnt lgkmcnt(6)
    v_mfma_f32_16x16x32_bf16 v[144:147], v[48:51], a[16:19], v[144:147]
    v_mfma_f32_16x16x32_bf16 v[176:179], v[48:51], a[20:23], v[176:179]
    v_mfma_f32_16x16x32_bf16 v[208:211], v[48:51], a[24:27], v[208:211]
    buffer_load_dwordx4 v76, s[32:35], s72 offen offset:0 lds
    v_mfma_f32_16x16x32_bf16 v[240:243], v[48:51], a[28:31], v[240:243]
    s_waitcnt vmcnt(9) lgkmcnt(0)
    s_barrier
    v_mfma_f32_16x16x32_bf16 v[148:151], v[52:55], a[16:19], v[148:151]
    ds_read_b128 a[0:3], v68 offset:0
    ds_read_b128 a[4:7], v68 offset:2048
    v_mfma_f32_16x16x32_bf16 v[180:183], v[52:55], a[20:23], v[180:183]
    ds_read_b128 a[8:11], v68 offset:4096
    ds_read_b128 a[12:15], v68 offset:6144
    v_mfma_f32_16x16x32_bf16 v[212:215], v[52:55], a[24:27], v[212:215]
    ds_read_b64_tr_b16 v[32:33], v64 offset:32768
    ds_read_b64_tr_b16 v[34:35], v64 offset:33792
    v_mfma_f32_16x16x32_bf16 v[244:247], v[52:55], a[28:31], v[244:247]
    buffer_load_dwordx4 v77, s[32:35], s72 offen offset:1024 lds
    v_mfma_f32_16x16x32_bf16 v[152:155], v[56:59], a[16:19], v[152:155]
    ds_read_b64_tr_b16 v[36:37], v64 offset:32776
    ds_read_b64_tr_b16 v[38:39], v64 offset:33800
    v_mfma_f32_16x16x32_bf16 v[184:187], v[56:59], a[20:23], v[184:187]
    v_mfma_f32_16x16x32_bf16 v[216:219], v[56:59], a[24:27], v[216:219]
    v_mfma_f32_16x16x32_bf16 v[248:251], v[56:59], a[28:31], v[248:251]
    buffer_load_dwordx4 v78, s[32:35], s72 offen offset:2048 lds
    v_mfma_f32_16x16x32_bf16 v[156:159], v[60:63], a[16:19], v[156:159]
    ds_read_b64_tr_b16 v[40:41], v65 offset:32768
    ds_read_b64_tr_b16 v[42:43], v65 offset:33792
    v_mfma_f32_16x16x32_bf16 v[188:191], v[60:63], a[20:23], v[188:191]
    ds_read_b64_tr_b16 v[44:45], v65 offset:32776
    ds_read_b64_tr_b16 v[46:47], v65 offset:33800
    v_mfma_f32_16x16x32_bf16 v[220:223], v[60:63], a[24:27], v[220:223]
    v_mfma_f32_16x16x32_bf16 v[252:255], v[60:63], a[28:31], v[252:255]
    buffer_load_dwordx4 v79, s[32:35], s72 offen offset:3072 lds
    s_lshr_b32 s74, s24, 1
    s_waitcnt lgkmcnt(6)
    v_mfma_f32_16x16x32_bf16 v[128:131], v[32:35], a[0:3], v[128:131]
    ds_read_b64_tr_b16 v[48:49], v66 offset:32768
    ds_read_b64_tr_b16 v[50:51], v66 offset:33792
    v_mfma_f32_16x16x32_bf16 v[160:163], v[32:35], a[4:7], v[160:163]
    s_add_u32 m0, s74, 122880
    s_mov_b32 s73, 3932160
    v_mfma_f32_16x16x32_bf16 v[192:195], v[32:35], a[8:11], v[192:195]
    v_mfma_f32_16x16x32_bf16 v[224:227], v[32:35], a[12:15], v[224:227]
    buffer_load_dwordx4 v72, s[36:39], s73 offen offset:0 lds
    s_waitcnt lgkmcnt(6)
    v_mfma_f32_16x16x32_bf16 v[132:135], v[36:39], a[0:3], v[132:135]
    ds_read_b64_tr_b16 v[52:53], v66 offset:32776
    ds_read_b64_tr_b16 v[54:55], v66 offset:33800
    v_mfma_f32_16x16x32_bf16 v[164:167], v[36:39], a[4:7], v[164:167]
    v_mfma_f32_16x16x32_bf16 v[196:199], v[36:39], a[8:11], v[196:199]
    v_mfma_f32_16x16x32_bf16 v[228:231], v[36:39], a[12:15], v[228:231]
    buffer_load_dwordx4 v73, s[36:39], s73 offen offset:1024 lds
    s_waitcnt lgkmcnt(6)
    v_mfma_f32_16x16x32_bf16 v[136:139], v[40:43], a[0:3], v[136:139]
    ds_read_b64_tr_b16 v[56:57], v67 offset:32768
    ds_read_b64_tr_b16 v[58:59], v67 offset:33792
    v_mfma_f32_16x16x32_bf16 v[168:171], v[40:43], a[4:7], v[168:171]
    v_mfma_f32_16x16x32_bf16 v[200:203], v[40:43], a[8:11], v[200:203]
    v_mfma_f32_16x16x32_bf16 v[232:235], v[40:43], a[12:15], v[232:235]
    s_waitcnt lgkmcnt(6)
    v_mfma_f32_16x16x32_bf16 v[140:143], v[44:47], a[0:3], v[140:143]
    ds_read_b64_tr_b16 v[60:61], v67 offset:32776
    ds_read_b64_tr_b16 v[62:63], v67 offset:33800
    v_mfma_f32_16x16x32_bf16 v[172:175], v[44:47], a[4:7], v[172:175]
    v_mfma_f32_16x16x32_bf16 v[204:207], v[44:47], a[8:11], v[204:207]
    v_mfma_f32_16x16x32_bf16 v[236:239], v[44:47], a[12:15], v[236:239]
    s_waitcnt lgkmcnt(6)
    v_mfma_f32_16x16x32_bf16 v[144:147], v[48:51], a[0:3], v[144:147]
    v_mfma_f32_16x16x32_bf16 v[176:179], v[48:51], a[4:7], v[176:179]
    v_mfma_f32_16x16x32_bf16 v[208:211], v[48:51], a[8:11], v[208:211]
    v_mfma_f32_16x16x32_bf16 v[240:243], v[48:51], a[12:15], v[240:243]
    s_waitcnt vmcnt(12) lgkmcnt(0)
    s_barrier
    v_mfma_f32_16x16x32_bf16 v[148:151], v[52:55], a[0:3], v[148:151]
    ds_read_b128 a[16:19], v69 offset:0
    ds_read_b128 a[20:23], v69 offset:2048
    v_mfma_f32_16x16x32_bf16 v[180:183], v[52:55], a[4:7], v[180:183]
    ds_read_b128 a[24:27], v69 offset:4096
    ds_read_b128 a[28:31], v69 offset:6144
    v_mfma_f32_16x16x32_bf16 v[212:215], v[52:55], a[8:11], v[212:215]
    ds_read_b64_tr_b16 v[32:33], v64 offset:40960
    ds_read_b64_tr_b16 v[34:35], v64 offset:41984
    v_mfma_f32_16x16x32_bf16 v[244:247], v[52:55], a[12:15], v[244:247]
    v_mfma_f32_16x16x32_bf16 v[152:155], v[56:59], a[0:3], v[152:155]
    ds_read_b64_tr_b16 v[36:37], v64 offset:40968
    ds_read_b64_tr_b16 v[38:39], v64 offset:41992
    v_mfma_f32_16x16x32_bf16 v[184:187], v[56:59], a[4:7], v[184:187]
    v_mfma_f32_16x16x32_bf16 v[216:219], v[56:59], a[8:11], v[216:219]
    v_mfma_f32_16x16x32_bf16 v[248:251], v[56:59], a[12:15], v[248:251]
    v_mfma_f32_16x16x32_bf16 v[156:159], v[60:63], a[0:3], v[156:159]
    ds_read_b64_tr_b16 v[40:41], v65 offset:40960
    ds_read_b64_tr_b16 v[42:43], v65 offset:41984
    v_mfma_f32_16x16x32_bf16 v[188:191], v[60:63], a[4:7], v[188:191]
    ds_read_b64_tr_b16 v[44:45], v65 offset:40968
    ds_read_b64_tr_b16 v[46:47], v65 offset:41992
    v_mfma_f32_16x16x32_bf16 v[220:223], v[60:63], a[8:11], v[220:223]
    v_mfma_f32_16x16x32_bf16 v[252:255], v[60:63], a[12:15], v[252:255]
    s_waitcnt lgkmcnt(6)
    v_mfma_f32_16x16x32_bf16 v[128:131], v[32:35], a[16:19], v[128:131]
    ds_read_b64_tr_b16 v[48:49], v66 offset:40960
    ds_read_b64_tr_b16 v[50:51], v66 offset:41984
    v_mfma_f32_16x16x32_bf16 v[160:163], v[32:35], a[20:23], v[160:163]
    v_mfma_f32_16x16x32_bf16 v[192:195], v[32:35], a[24:27], v[192:195]
    v_mfma_f32_16x16x32_bf16 v[224:227], v[32:35], a[28:31], v[224:227]
    s_waitcnt lgkmcnt(6)
    v_mfma_f32_16x16x32_bf16 v[132:135], v[36:39], a[16:19], v[132:135]
    ds_read_b64_tr_b16 v[52:53], v66 offset:40968
    ds_read_b64_tr_b16 v[54:55], v66 offset:41992
    v_mfma_f32_16x16x32_bf16 v[164:167], v[36:39], a[20:23], v[164:167]
    v_mfma_f32_16x16x32_bf16 v[196:199], v[36:39], a[24:27], v[196:199]
    v_mfma_f32_16x16x32_bf16 v[228:231], v[36:39], a[28:31], v[228:231]
    s_waitcnt lgkmcnt(6)
    v_mfma_f32_16x16x32_bf16 v[136:139], v[40:43], a[16:19], v[136:139]
    ds_read_b64_tr_b16 v[56:57], v67 offset:40960
    ds_read_b64_tr_b16 v[58:59], v67 offset:41984
    v_mfma_f32_16x16x32_bf16 v[168:171], v[40:43], a[20:23], v[168:171]
    v_mfma_f32_16x16x32_bf16 v[200:203], v[40:43], a[24:27], v[200:203]
    v_mfma_f32_16x16x32_bf16 v[232:235], v[40:43], a[28:31], v[232:235]
    s_waitcnt lgkmcnt(6)
    v_mfma_f32_16x16x32_bf16 v[140:143], v[44:47], a[16:19], v[140:143]
    ds_read_b64_tr_b16 v[60:61], v67 offset:40968
    ds_read_b64_tr_b16 v[62:63], v67 offset:41992
    v_mfma_f32_16x16x32_bf16 v[172:175], v[44:47], a[20:23], v[172:175]
    v_mfma_f32_16x16x32_bf16 v[204:207], v[44:47], a[24:27], v[204:207]
    v_mfma_f32_16x16x32_bf16 v[236:239], v[44:47], a[28:31], v[236:239]
    s_waitcnt lgkmcnt(6)
    v_mfma_f32_16x16x32_bf16 v[144:147], v[48:51], a[16:19], v[144:147]
    v_mfma_f32_16x16x32_bf16 v[176:179], v[48:51], a[20:23], v[176:179]
    v_mfma_f32_16x16x32_bf16 v[208:211], v[48:51], a[24:27], v[208:211]
    v_mfma_f32_16x16x32_bf16 v[240:243], v[48:51], a[28:31], v[240:243]
    s_waitcnt vmcnt(2) lgkmcnt(0)
    s_barrier
    v_mfma_f32_16x16x32_bf16 v[148:151], v[52:55], a[16:19], v[148:151]
    ds_read_b128 a[0:3], v70 offset:0
    ds_read_b128 a[4:7], v70 offset:2048
    v_mfma_f32_16x16x32_bf16 v[180:183], v[52:55], a[20:23], v[180:183]
    ds_read_b128 a[8:11], v70 offset:4096
    ds_read_b128 a[12:15], v70 offset:6144
    v_mfma_f32_16x16x32_bf16 v[212:215], v[52:55], a[24:27], v[212:215]
    ds_read_b64_tr_b16 v[32:33], v64 offset:49152
    ds_read_b64_tr_b16 v[34:35], v64 offset:50176
    v_mfma_f32_16x16x32_bf16 v[244:247], v[52:55], a[28:31], v[244:247]
    s_add_u32 m0, s80, 98304
    s_nop 0
    v_mfma_f32_16x16x32_bf16 v[152:155], v[56:59], a[16:19], v[152:155]
    ds_read_b64_tr_b16 v[36:37], v64 offset:49160
    ds_read_b64_tr_b16 v[38:39], v64 offset:50184
    v_mfma_f32_16x16x32_bf16 v[184:187], v[56:59], a[20:23], v[184:187]
    buffer_load_dwordx4 v20, s[12:15], s25 offen nt lds
    s_add_u32 m0, s80, 102400
    v_mfma_f32_16x16x32_bf16 v[216:219], v[56:59], a[24:27], v[216:219]
    s_nop 0
    v_mfma_f32_16x16x32_bf16 v[248:251], v[56:59], a[28:31], v[248:251]
    v_mfma_f32_16x16x32_bf16 v[156:159], v[60:63], a[16:19], v[156:159]
    ds_read_b64_tr_b16 v[40:41], v65 offset:49152
    ds_read_b64_tr_b16 v[42:43], v65 offset:50176
    v_mfma_f32_16x16x32_bf16 v[188:191], v[60:63], a[20:23], v[188:191]
    ds_read_b64_tr_b16 v[44:45], v65 offset:49160
    ds_read_b64_tr_b16 v[46:47], v65 offset:50184
    v_mfma_f32_16x16x32_bf16 v[220:223], v[60:63], a[24:27], v[220:223]
    buffer_load_dwordx4 v21, s[12:15], s25 offen nt lds
    s_add_u32 m0, s80, 106496
    v_mfma_f32_16x16x32_bf16 v[252:255], v[60:63], a[28:31], v[252:255]
    s_nop 0
    s_waitcnt lgkmcnt(6)
    v_mfma_f32_16x16x32_bf16 v[128:131], v[32:35], a[0:3], v[128:131]
    ds_read_b64_tr_b16 v[48:49], v66 offset:49152
    ds_read_b64_tr_b16 v[50:51], v66 offset:50176
    v_mfma_f32_16x16x32_bf16 v[160:163], v[32:35], a[4:7], v[160:163]
    v_mfma_f32_16x16x32_bf16 v[192:195], v[32:35], a[8:11], v[192:195]
    buffer_load_dwordx4 v20, s[12:15], s81 offen nt lds
    s_add_u32 m0, s80, 110592
    v_mfma_f32_16x16x32_bf16 v[224:227], v[32:35], a[12:15], v[224:227]
    s_nop 0
    s_waitcnt lgkmcnt(6)
    v_mfma_f32_16x16x32_bf16 v[132:135], v[36:39], a[0:3], v[132:135]
    ds_read_b64_tr_b16 v[52:53], v66 offset:49160
    ds_read_b64_tr_b16 v[54:55], v66 offset:50184
    v_mfma_f32_16x16x32_bf16 v[164:167], v[36:39], a[4:7], v[164:167]
    v_mfma_f32_16x16x32_bf16 v[196:199], v[36:39], a[8:11], v[196:199]
    buffer_load_dwordx4 v21, s[12:15], s81 offen nt lds
    s_add_u32 s25, s25, 16384
    v_mfma_f32_16x16x32_bf16 v[228:231], v[36:39], a[12:15], v[228:231]
    s_add_u32 s81, s81, 16384
    s_add_u32 m0, s80, 16384
    s_waitcnt lgkmcnt(6)
    v_mfma_f32_16x16x32_bf16 v[136:139], v[40:43], a[0:3], v[136:139]
    ds_read_b64_tr_b16 v[56:57], v67 offset:49152
    ds_read_b64_tr_b16 v[58:59], v67 offset:50176
    v_mfma_f32_16x16x32_bf16 v[168:171], v[40:43], a[4:7], v[168:171]
    s_nop 0
    v_mfma_f32_16x16x32_bf16 v[200:203], v[40:43], a[8:11], v[200:203]
    buffer_load_dwordx4 v16, s[8:11], s26 offen nt lds
    s_add_u32 m0, s80, 20480
    v_mfma_f32_16x16x32_bf16 v[232:235], v[40:43], a[12:15], v[232:235]
    s_nop 0
    s_waitcnt lgkmcnt(6)
    v_mfma_f32_16x16x32_bf16 v[140:143], v[44:47], a[0:3], v[140:143]
    ds_read_b64_tr_b16 v[60:61], v67 offset:49160
    ds_read_b64_tr_b16 v[62:63], v67 offset:50184
    v_mfma_f32_16x16x32_bf16 v[172:175], v[44:47], a[4:7], v[172:175]
    v_mfma_f32_16x16x32_bf16 v[204:207], v[44:47], a[8:11], v[204:207]
    buffer_load_dwordx4 v17, s[8:11], s26 offen nt lds
    s_add_u32 m0, s80, 24576
    v_mfma_f32_16x16x32_bf16 v[236:239], v[44:47], a[12:15], v[236:239]
    s_nop 0
    s_waitcnt lgkmcnt(6)
    v_mfma_f32_16x16x32_bf16 v[144:147], v[48:51], a[0:3], v[144:147]
    v_mfma_f32_16x16x32_bf16 v[176:179], v[48:51], a[4:7], v[176:179]
    v_mfma_f32_16x16x32_bf16 v[208:211], v[48:51], a[8:11], v[208:211]
    buffer_load_dwordx4 v16, s[8:11], s82 offen nt lds
    s_add_u32 m0, s80, 28672
    v_mfma_f32_16x16x32_bf16 v[240:243], v[48:51], a[12:15], v[240:243]
    s_nop 0
    s_waitcnt vmcnt(7) lgkmcnt(0)
    s_barrier
    v_mfma_f32_16x16x32_bf16 v[148:151], v[52:55], a[0:3], v[148:151]
    ds_read_b128 a[16:19], v71 offset:0
    ds_read_b128 a[20:23], v71 offset:2048
    v_mfma_f32_16x16x32_bf16 v[180:183], v[52:55], a[4:7], v[180:183]
    ds_read_b128 a[24:27], v71 offset:4096
    ds_read_b128 a[28:31], v71 offset:6144
    v_mfma_f32_16x16x32_bf16 v[212:215], v[52:55], a[8:11], v[212:215]
    ds_read_b64_tr_b16 v[32:33], v64 offset:57344
    ds_read_b64_tr_b16 v[34:35], v64 offset:58368
    v_mfma_f32_16x16x32_bf16 v[244:247], v[52:55], a[12:15], v[244:247]
    buffer_load_dwordx4 v17, s[8:11], s82 offen nt lds
    s_add_u32 s26, s26, 16384
    v_mfma_f32_16x16x32_bf16 v[152:155], v[56:59], a[0:3], v[152:155]
    ds_read_b64_tr_b16 v[36:37], v64 offset:57352
    ds_read_b64_tr_b16 v[38:39], v64 offset:58376
    v_mfma_f32_16x16x32_bf16 v[184:187], v[56:59], a[4:7], v[184:187]
    s_add_u32 s82, s82, 16384
    s_add_u32 m0, s80, 32768
    v_mfma_f32_16x16x32_bf16 v[216:219], v[56:59], a[8:11], v[216:219]
    s_nop 0
    v_mfma_f32_16x16x32_bf16 v[248:251], v[56:59], a[12:15], v[248:251]
    buffer_load_dwordx4 v16, s[8:11], s26 offen nt lds
    s_add_u32 m0, s80, 36864
    v_mfma_f32_16x16x32_bf16 v[156:159], v[60:63], a[0:3], v[156:159]
    ds_read_b64_tr_b16 v[40:41], v65 offset:57344
    ds_read_b64_tr_b16 v[42:43], v65 offset:58368
    v_mfma_f32_16x16x32_bf16 v[188:191], v[60:63], a[4:7], v[188:191]
    ds_read_b64_tr_b16 v[44:45], v65 offset:57352
    ds_read_b64_tr_b16 v[46:47], v65 offset:58376
    v_mfma_f32_16x16x32_bf16 v[220:223], v[60:63], a[8:11], v[220:223]
    s_nop 0
    v_mfma_f32_16x16x32_bf16 v[252:255], v[60:63], a[12:15], v[252:255]
    buffer_load_dwordx4 v17, s[8:11], s26 offen nt lds
    s_add_u32 m0, s80, 40960
    s_waitcnt lgkmcnt(6)
    v_mfma_f32_16x16x32_bf16 v[128:131], v[32:35], a[16:19], v[128:131]
    ds_read_b64_tr_b16 v[48:49], v66 offset:57344
    ds_read_b64_tr_b16 v[50:51], v66 offset:58368
    v_mfma_f32_16x16x32_bf16 v[160:163], v[32:35], a[20:23], v[160:163]
    s_nop 0
    v_mfma_f32_16x16x32_bf16 v[192:195], v[32:35], a[24:27], v[192:195]
    v_mfma_f32_16x16x32_bf16 v[224:227], v[32:35], a[28:31], v[224:227]
    buffer_load_dwordx4 v16, s[8:11], s82 offen nt lds
    s_add_u32 m0, s80, 45056
    s_waitcnt lgkmcnt(6)
    v_mfma_f32_16x16x32_bf16 v[132:135], v[36:39], a[16:19], v[132:135]
    ds_read_b64_tr_b16 v[52:53], v66 offset:57352
    ds_read_b64_tr_b16 v[54:55], v66 offset:58376
    v_mfma_f32_16x16x32_bf16 v[164:167], v[36:39], a[20:23], v[164:167]
    s_nop 0
    v_mfma_f32_16x16x32_bf16 v[196:199], v[36:39], a[24:27], v[196:199]
    v_mfma_f32_16x16x32_bf16 v[228:231], v[36:39], a[28:31], v[228:231]
    buffer_load_dwordx4 v17, s[8:11], s82 offen nt lds
    s_add_u32 s26, s26, 16384
    s_waitcnt lgkmcnt(6)
    v_mfma_f32_16x16x32_bf16 v[136:139], v[40:43], a[16:19], v[136:139]
    ds_read_b64_tr_b16 v[56:57], v67 offset:57344
    ds_read_b64_tr_b16 v[58:59], v67 offset:58368
    v_mfma_f32_16x16x32_bf16 v[168:171], v[40:43], a[20:23], v[168:171]
    s_add_u32 s82, s82, 16384
    v_mfma_f32_16x16x32_bf16 v[200:203], v[40:43], a[24:27], v[200:203]
    v_mfma_f32_16x16x32_bf16 v[232:235], v[40:43], a[28:31], v[232:235]
    s_waitcnt lgkmcnt(6)
    v_mfma_f32_16x16x32_bf16 v[140:143], v[44:47], a[16:19], v[140:143]
    ds_read_b64_tr_b16 v[60:61], v67 offset:57352
    ds_read_b64_tr_b16 v[62:63], v67 offset:58376
    v_mfma_f32_16x16x32_bf16 v[172:175], v[44:47], a[20:23], v[172:175]
    v_mfma_f32_16x16x32_bf16 v[204:207], v[44:47], a[24:27], v[204:207]
    v_mfma_f32_16x16x32_bf16 v[236:239], v[44:47], a[28:31], v[236:239]
    s_waitcnt lgkmcnt(6)
    v_mfma_f32_16x16x32_bf16 v[144:147], v[48:51], a[16:19], v[144:147]
    v_mfma_f32_16x16x32_bf16 v[176:179], v[48:51], a[20:23], v[176:179]
    v_mfma_f32_16x16x32_bf16 v[208:211], v[48:51], a[24:27], v[208:211]
    v_mfma_f32_16x16x32_bf16 v[240:243], v[48:51], a[28:31], v[240:243]
    s_waitcnt lgkmcnt(4)
    v_mfma_f32_16x16x32_bf16 v[148:151], v[52:55], a[16:19], v[148:151]
    v_mfma_f32_16x16x32_bf16 v[180:183], v[52:55], a[20:23], v[180:183]
    v_mfma_f32_16x16x32_bf16 v[212:215], v[52:55], a[24:27], v[212:215]
    v_mfma_f32_16x16x32_bf16 v[244:247], v[52:55], a[28:31], v[244:247]
    s_waitcnt lgkmcnt(2)
    v_mfma_f32_16x16x32_bf16 v[152:155], v[56:59], a[16:19], v[152:155]
    v_mfma_f32_16x16x32_bf16 v[184:187], v[56:59], a[20:23], v[184:187]
    v_mfma_f32_16x16x32_bf16 v[216:219], v[56:59], a[24:27], v[216:219]
    v_mfma_f32_16x16x32_bf16 v[248:251], v[56:59], a[28:31], v[248:251]
    s_waitcnt lgkmcnt(0)
    v_mfma_f32_16x16x32_bf16 v[156:159], v[60:63], a[16:19], v[156:159]
    v_mfma_f32_16x16x32_bf16 v[188:191], v[60:63], a[20:23], v[188:191]
    v_mfma_f32_16x16x32_bf16 v[220:223], v[60:63], a[24:27], v[220:223]
    v_mfma_f32_16x16x32_bf16 v[252:255], v[60:63], a[28:31], v[252:255]
    s_mov_b32 s71, 0
    s_mov_b32 s70, 0
    s_nop 7
    v_mov_b32 v120, 0x3e0293ee
    v_pk_mul_f32 v[128:129], v[128:129], v[120:121] op_sel_hi:[1,0]
    v_pk_mul_f32 v[130:131], v[130:131], v[120:121] op_sel_hi:[1,0]
    v_pk_mul_f32 v[132:133], v[132:133], v[120:121] op_sel_hi:[1,0]
    v_pk_mul_f32 v[134:135], v[134:135], v[120:121] op_sel_hi:[1,0]
    v_cvt_pk_bf16_f32 v128, v128, v129
    v_cvt_pk_bf16_f32 v129, v130, v131
    v_cvt_pk_bf16_f32 v130, v132, v133
    v_cvt_pk_bf16_f32 v131, v134, v135
    v_accvgpr_write_b32 a0, v128
    v_accvgpr_write_b32 a1, v129
    v_accvgpr_write_b32 a2, v130
    v_accvgpr_write_b32 a3, v131
    v_pk_mul_f32 v[136:137], v[136:137], v[120:121] op_sel_hi:[1,0]
    v_pk_mul_f32 v[138:139], v[138:139], v[120:121] op_sel_hi:[1,0]
    v_pk_mul_f32 v[140:141], v[140:141], v[120:121] op_sel_hi:[1,0]
    v_pk_mul_f32 v[142:143], v[142:143], v[120:121] op_sel_hi:[1,0]
    v_cvt_pk_bf16_f32 v136, v136, v137
    v_cvt_pk_bf16_f32 v137, v138, v139
    v_cvt_pk_bf16_f32 v138, v140, v141
    v_cvt_pk_bf16_f32 v139, v142, v143
    v_accvgpr_write_b32 a4, v136
    v_accvgpr_write_b32 a5, v137
    v_accvgpr_write_b32 a6, v138
    v_accvgpr_write_b32 a7, v139
    v_pk_mul_f32 v[144:145], v[144:145], v[120:121] op_sel_hi:[1,0]
    v_pk_mul_f32 v[146:147], v[146:147], v[120:121] op_sel_hi:[1,0]
    v_pk_mul_f32 v[148:149], v[148:149], v[120:121] op_sel_hi:[1,0]
    v_pk_mul_f32 v[150:151], v[150:151], v[120:121] op_sel_hi:[1,0]
    v_cvt_pk_bf16_f32 v144, v144, v145
    v_cvt_pk_bf16_f32 v145, v146, v147
    v_cvt_pk_bf16_f32 v146, v148, v149
    v_cvt_pk_bf16_f32 v147, v150, v151
    v_accvgpr_write_b32 a8, v144
    v_accvgpr_write_b32 a9, v145
    v_accvgpr_write_b32 a10, v146
    v_accvgpr_write_b32 a11, v147
    v_pk_mul_f32 v[152:153], v[152:153], v[120:121] op_sel_hi:[1,0]
    v_pk_mul_f32 v[154:155], v[154:155], v[120:121] op_sel_hi:[1,0]
    v_pk_mul_f32 v[156:157], v[156:157], v[120:121] op_sel_hi:[1,0]
    v_pk_mul_f32 v[158:159], v[158:159], v[120:121] op_sel_hi:[1,0]
    v_cvt_pk_bf16_f32 v152, v152, v153
    v_cvt_pk_bf16_f32 v153, v154, v155
    v_cvt_pk_bf16_f32 v154, v156, v157
    v_cvt_pk_bf16_f32 v155, v158, v159
    v_accvgpr_write_b32 a12, v152
    v_accvgpr_write_b32 a13, v153
    v_accvgpr_write_b32 a14, v154
    v_accvgpr_write_b32 a15, v155
    v_pk_mul_f32 v[160:161], v[160:161], v[120:121] op_sel_hi:[1,0]
    v_pk_mul_f32 v[162:163], v[162:163], v[120:121] op_sel_hi:[1,0]
    v_pk_mul_f32 v[164:165], v[164:165], v[120:121] op_sel_hi:[1,0]
    v_pk_mul_f32 v[166:167], v[166:167], v[120:121] op_sel_hi:[1,0]
    v_cvt_pk_bf16_f32 v160, v160, v161
    v_cvt_pk_bf16_f32 v161, v162, v163
    v_cvt_pk_bf16_f32 v162, v164, v165
    v_cvt_pk_bf16_f32 v163, v166, v167
    v_accvgpr_write_b32 a16, v160
    v_accvgpr_write_b32 a17, v161
    v_accvgpr_write_b32 a18, v162
    v_accvgpr_write_b32 a19, v163
    v_pk_mul_f32 v[168:169], v[168:169], v[120:121] op_sel_hi:[1,0]
    v_pk_mul_f32 v[170:171], v[170:171], v[120:121] op_sel_hi:[1,0]
    v_pk_mul_f32 v[172:173], v[172:173], v[120:121] op_sel_hi:[1,0]
    v_pk_mul_f32 v[174:175], v[174:175], v[120:121] op_sel_hi:[1,0]
    v_cvt_pk_bf16_f32 v168, v168, v169
    v_cvt_pk_bf16_f32 v169, v170, v171
    v_cvt_pk_bf16_f32 v170, v172, v173
    v_cvt_pk_bf16_f32 v171, v174, v175
    v_accvgpr_write_b32 a20, v168
    v_accvgpr_write_b32 a21, v169
    v_accvgpr_write_b32 a22, v170
    v_accvgpr_write_b32 a23, v171
    v_pk_mul_f32 v[176:177], v[176:177], v[120:121] op_sel_hi:[1,0]
    v_pk_mul_f32 v[178:179], v[178:179], v[120:121] op_sel_hi:[1,0]
    v_pk_mul_f32 v[180:181], v[180:181], v[120:121] op_sel_hi:[1,0]
    v_pk_mul_f32 v[182:183], v[182:183], v[120:121] op_sel_hi:[1,0]
    v_cvt_pk_bf16_f32 v176, v176, v177
    v_cvt_pk_bf16_f32 v177, v178, v179
    v_cvt_pk_bf16_f32 v178, v180, v181
    v_cvt_pk_bf16_f32 v179, v182, v183
    v_accvgpr_write_b32 a24, v176
    v_accvgpr_write_b32 a25, v177
    v_accvgpr_write_b32 a26, v178
    v_accvgpr_write_b32 a27, v179
    v_pk_mul_f32 v[184:185], v[184:185], v[120:121] op_sel_hi:[1,0]
    v_pk_mul_f32 v[186:187], v[186:187], v[120:121] op_sel_hi:[1,0]
    v_pk_mul_f32 v[188:189], v[188:189], v[120:121] op_sel_hi:[1,0]
    v_pk_mul_f32 v[190:191], v[190:191], v[120:121] op_sel_hi:[1,0]
    v_cvt_pk_bf16_f32 v184, v184, v185
    v_cvt_pk_bf16_f32 v185, v186, v187
    v_cvt_pk_bf16_f32 v186, v188, v189
    v_cvt_pk_bf16_f32 v187, v190, v191
    v_accvgpr_write_b32 a28, v184
    v_accvgpr_write_b32 a29, v185
    v_accvgpr_write_b32 a30, v186
    v_accvgpr_write_b32 a31, v187
    v_pk_mul_f32 v[192:193], v[192:193], v[120:121] op_sel_hi:[1,0]
    v_pk_mul_f32 v[194:195], v[194:195], v[120:121] op_sel_hi:[1,0]
    v_pk_mul_f32 v[196:197], v[196:197], v[120:121] op_sel_hi:[1,0]
    v_pk_mul_f32 v[198:199], v[198:199], v[120:121] op_sel_hi:[1,0]
    v_cvt_pk_bf16_f32 v192, v192, v193
    v_cvt_pk_bf16_f32 v193, v194, v195
    v_cvt_pk_bf16_f32 v194, v196, v197
    v_cvt_pk_bf16_f32 v195, v198, v199
    v_accvgpr_write_b32 a32, v192
    v_accvgpr_write_b32 a33, v193
    v_accvgpr_write_b32 a34, v194
    v_accvgpr_write_b32 a35, v195
    v_pk_mul_f32 v[200:201], v[200:201], v[120:121] op_sel_hi:[1,0]
    v_pk_mul_f32 v[202:203], v[202:203], v[120:121] op_sel_hi:[1,0]
    v_pk_mul_f32 v[204:205], v[204:205], v[120:121] op_sel_hi:[1,0]
    v_pk_mul_f32 v[206:207], v[206:207], v[120:121] op_sel_hi:[1,0]
    v_cvt_pk_bf16_f32 v200, v200, v201
    v_cvt_pk_bf16_f32 v201, v202, v203
    v_cvt_pk_bf16_f32 v202, v204, v205
    v_cvt_pk_bf16_f32 v203, v206, v207
    v_accvgpr_write_b32 a36, v200
    v_accvgpr_write_b32 a37, v201
    v_accvgpr_write_b32 a38, v202
    v_accvgpr_write_b32 a39, v203
    v_pk_mul_f32 v[208:209], v[208:209], v[120:121] op_sel_hi:[1,0]
    v_pk_mul_f32 v[210:211], v[210:211], v[120:121] op_sel_hi:[1,0]
    v_pk_mul_f32 v[212:213], v[212:213], v[120:121] op_sel_hi:[1,0]
    v_pk_mul_f32 v[214:215], v[214:215], v[120:121] op_sel_hi:[1,0]
    v_cvt_pk_bf16_f32 v208, v208, v209
    v_cvt_pk_bf16_f32 v209, v210, v211
    v_cvt_pk_bf16_f32 v210, v212, v213
    v_cvt_pk_bf16_f32 v211, v214, v215
    v_accvgpr_write_b32 a40, v208
    v_accvgpr_write_b32 a41, v209
    v_accvgpr_write_b32 a42, v210
    v_accvgpr_write_b32 a43, v211
    v_pk_mul_f32 v[216:217], v[216:217], v[120:121] op_sel_hi:[1,0]
    v_pk_mul_f32 v[218:219], v[218:219], v[120:121] op_sel_hi:[1,0]
    v_pk_mul_f32 v[220:221], v[220:221], v[120:121] op_sel_hi:[1,0]
    v_pk_mul_f32 v[222:223], v[222:223], v[120:121] op_sel_hi:[1,0]
    v_cvt_pk_bf16_f32 v216, v216, v217
    v_cvt_pk_bf16_f32 v217, v218, v219
    v_cvt_pk_bf16_f32 v218, v220, v221
    v_cvt_pk_bf16_f32 v219, v222, v223
    v_accvgpr_write_b32 a44, v216
    v_accvgpr_write_b32 a45, v217
    v_accvgpr_write_b32 a46, v218
    v_accvgpr_write_b32 a47, v219
    v_pk_mul_f32 v[224:225], v[224:225], v[120:121] op_sel_hi:[1,0]
    v_pk_mul_f32 v[226:227], v[226:227], v[120:121] op_sel_hi:[1,0]
    v_pk_mul_f32 v[228:229], v[228:229], v[120:121] op_sel_hi:[1,0]
    v_pk_mul_f32 v[230:231], v[230:231], v[120:121] op_sel_hi:[1,0]
    v_cvt_pk_bf16_f32 v224, v224, v225
    v_cvt_pk_bf16_f32 v225, v226, v227
    v_cvt_pk_bf16_f32 v226, v228, v229
    v_cvt_pk_bf16_f32 v227, v230, v231
    v_accvgpr_write_b32 a48, v224
    v_accvgpr_write_b32 a49, v225
    v_accvgpr_write_b32 a50, v226
    v_accvgpr_write_b32 a51, v227
    v_pk_mul_f32 v[232:233], v[232:233], v[120:121] op_sel_hi:[1,0]
    v_pk_mul_f32 v[234:235], v[234:235], v[120:121] op_sel_hi:[1,0]
    v_pk_mul_f32 v[236:237], v[236:237], v[120:121] op_sel_hi:[1,0]
    v_pk_mul_f32 v[238:239], v[238:239], v[120:121] op_sel_hi:[1,0]
    v_cvt_pk_bf16_f32 v232, v232, v233
    v_cvt_pk_bf16_f32 v233, v234, v235
    v_cvt_pk_bf16_f32 v234, v236, v237
    v_cvt_pk_bf16_f32 v235, v238, v239
    v_accvgpr_write_b32 a52, v232
    v_accvgpr_write_b32 a53, v233
    v_accvgpr_write_b32 a54, v234
    v_accvgpr_write_b32 a55, v235
    v_pk_mul_f32 v[240:241], v[240:241], v[120:121] op_sel_hi:[1,0]
    v_pk_mul_f32 v[242:243], v[242:243], v[120:121] op_sel_hi:[1,0]
    v_pk_mul_f32 v[244:245], v[244:245], v[120:121] op_sel_hi:[1,0]
    v_pk_mul_f32 v[246:247], v[246:247], v[120:121] op_sel_hi:[1,0]
    v_cvt_pk_bf16_f32 v240, v240, v241
    v_cvt_pk_bf16_f32 v241, v242, v243
    v_cvt_pk_bf16_f32 v242, v244, v245
    v_cvt_pk_bf16_f32 v243, v246, v247
    v_accvgpr_write_b32 a56, v240
    v_accvgpr_write_b32 a57, v241
    v_accvgpr_write_b32 a58, v242
    v_accvgpr_write_b32 a59, v243
    v_pk_mul_f32 v[248:249], v[248:249], v[120:121] op_sel_hi:[1,0]
    v_pk_mul_f32 v[250:251], v[250:251], v[120:121] op_sel_hi:[1,0]
    v_pk_mul_f32 v[252:253], v[252:253], v[120:121] op_sel_hi:[1,0]
    v_pk_mul_f32 v[254:255], v[254:255], v[120:121] op_sel_hi:[1,0]
    v_cvt_pk_bf16_f32 v248, v248, v249
    v_cvt_pk_bf16_f32 v249, v250, v251
    v_cvt_pk_bf16_f32 v250, v252, v253
    v_cvt_pk_bf16_f32 v251, v254, v255
    v_accvgpr_write_b32 a60, v248
    v_accvgpr_write_b32 a61, v249
    v_accvgpr_write_b32 a62, v250
    v_accvgpr_write_b32 a63, v251
    v_lshlrev_b32 v116, 2, v2
    v_add_u32 v116, 0, v116
    v_lshlrev_b32 v116, 17, v116
    v_lshl_add_u32 v116, v1, 4, v116
    v_lshlrev_b32 v117, 2, v2
    v_add_u32 v117, 1, v117
    v_lshlrev_b32 v117, 17, v117
    v_lshl_add_u32 v117, v1, 4, v117
    v_lshlrev_b32 v118, 2, v2
    v_add_u32 v118, 2, v118
    v_lshlrev_b32 v118, 17, v118
    v_lshl_add_u32 v118, v1, 4, v118
    v_lshlrev_b32 v119, 2, v2
    v_add_u32 v119, 3, v119
    v_lshlrev_b32 v119, 17, v119
    v_lshl_add_u32 v119, v1, 4, v119
    v_mov_b32 v112, 0x3f803f80
    v_mov_b32 v113, 0x3f803f80
    v_mov_b32 v114, 0x3f803f80
    v_mov_b32 v115, 0x3f803f80
    s_mov_b32 s28, 0
    s_cmp_eq_u32 s87, 0
    s_cbranch_scc1 L_nopre0
    v_bfe_u32 v28, v0, 4, 2
    v_lshlrev_b32 v23, 3, v2
    v_add_u32 v23, 0, v23
    v_add_u32 v23, v23, v28
    v_and_b32 v24, 15, v23
    v_xor_b32 v24, v24, v3
    v_lshlrev_b32 v24, 4, v24
    v_subrev_u32 v23, 0, v23
    v_lshl_add_u32 v29, v23, 8, v24
    v_lshlrev_b32 v23, 3, v2
    v_add_u32 v23, 4, v23
    v_add_u32 v23, v23, v28
    v_and_b32 v24, 15, v23
    v_xor_b32 v24, v24, v3
    v_lshlrev_b32 v24, 4, v24
    v_subrev_u32 v23, 4, v23
    v_lshl_add_u32 v30, v23, 8, v24
    v_add_u32 v24, 0x20000, v4
    v_add_u32 v25, 0x20000, v5
    v_add_u32 v26, 0x20000, v6
    v_add_u32 v27, 0x20000, v7
    v_mov_b32 v124, 0xff800000
    v_mov_b32 v125, 0xff800000
    v_mov_b32 v126, 0xff800000
    v_mov_b32 v127, 0xff800000
    s_lshl_b32 s90, s28, 18
    s_mov_b32 s91, 32
    s_waitcnt vmcnt(0) lgkmcnt(0)
    s_barrier
L_pre0:
    s_lshr_b32 s3, s24, 1
    s_add_u32 m0, s3, 0x20000
    s_nop 0
    buffer_load_dwordx4 v29, s[8:11], s90 offen offset:0 lds
    buffer_load_dwordx4 v30, s[8:11], s90 offen offset:1024 lds
    s_add_u32 s90, s90, 8192
    s_waitcnt vmcnt(0)
    s_barrier
    ds_read_b128 a[64:67], v24 offset:0
    ds_read_b128 a[68:71], v25 offset:0
    ds_read_b128 a[72:75], v26 offset:0
    ds_read_b128 a[76:79], v27 offset:0
    ds_read_b128 a[80:83], v24 offset:4096
    ds_read_b128 a[84:87], v25 offset:4096
    ds_read_b128 a[88:91], v26 offset:4096
    ds_read_b128 a[92:95], v27 offset:4096
    s_waitcnt lgkmcnt(0)
    s_barrier
    v_mfma_f32_16x16x32_bf16 v[32:35], a[64:67], a[0:3], 0
    v_mfma_f32_16x16x32_bf16 v[40:43], a[64:67], a[16:19], 0
    v_mfma_f32_16x16x32_bf16 v[32:35], a[68:71], a[4:7], v[32:35]
    v_mfma_f32_16x16x32_bf16 v[40:43], a[68:71], a[20:23], v[40:43]
    v_mfma_f32_16x16x32_bf16 v[32:35], a[72:75], a[8:11], v[32:35]
    v_mfma_f32_16x16x32_bf16 v[40:43], a[72:75], a[24:27], v[40:43]
    v_mfma_f32_16x16x32_bf16 v[32:35], a[76:79], a[12:15], v[32:35]
    v_mfma_f32_16x16x32_bf16 v[40:43], a[76:79], a[28:31], v[40:43]
    v_mfma_f32_16x16x32_bf16 v[36:39], a[80:83], a[0:3], 0
    v_mfma_f32_16x16x32_bf16 v[44:47], a[80:83], a[16:19], 0
    v_mfma_f32_16x16x32_bf16 v[36:39], a[84:87], a[4:7], v[36:39]
    v_mfma_f32_16x16x32_bf16 v[44:47], a[84:87], a[20:23], v[44:47]
    v_mfma_f32_16x16x32_bf16 v[36:39], a[88:91], a[8:11], v[36:39]
    v_mfma_f32_16x16x32_bf16 v[44:47], a[88:91], a[24:27], v[44:47]
    v_mfma_f32_16x16x32_bf16 v[36:39], a[92:95], a[12:15], v[36:39]
    v_mfma_f32_16x16x32_bf16 v[44:47], a[92:95], a[28:31], v[44:47]
    v_mfma_f32_16x16x32_bf16 v[48:51], a[64:67], a[32:35], 0
    v_mfma_f32_16x16x32_bf16 v[56:59], a[64:67], a[48:51], 0
    v_mfma_f32_16x16x32_bf16 v[48:51], a[68:71], a[36:39], v[48:51]
    v_mfma_f32_16x16x32_bf16 v[56:59], a[68:71], a[52:55], v[56:59]
    v_mfma_f32_16x16x32_bf16 v[48:51], a[72:75], a[40:43], v[48:51]
    v_mfma_f32_16x16x32_bf16 v[56:59], a[72:75], a[56:59], v[56:59]
    v_mfma_f32_16x16x32_bf16 v[48:51], a[76:79], a[44:47], v[48:51]
    v_mfma_f32_16x16x32_bf16 v[56:59], a[76:79], a[60:63], v[56:59]
    v_mfma_f32_16x16x32_bf16 v[52:55], a[80:83], a[32:35], 0
    v_mfma_f32_16x16x32_bf16 v[60:63], a[80:83], a[48:51], 0
    v_mfma_f32_16x16x32_bf16 v[52:55], a[84:87], a[36:39], v[52:55]
    v_mfma_f32_16x16x32_bf16 v[60:63], a[84:87], a[52:55], v[60:63]
    v_mfma_f32_16x16x32_bf16 v[52:55], a[88:91], a[40:43], v[52:55]
    v_mfma_f32_16x16x32_bf16 v[60:63], a[88:91], a[56:59], v[60:63]
    v_mfma_f32_16x16x32_bf16 v[52:55], a[92:95], a[44:47], v[52:55]
    v_mfma_f32_16x16x32_bf16 v[60:63], a[92:95], a[60:63], v[60:63]
    s_nop 7
    v_max3_f32 v124, v124, v32, v33
    v_max3_f32 v124, v124, v34, v35
    v_max3_f32 v124, v124, v36, v37
    v_max3_f32 v124, v124, v38, v39
    v_max3_f32 v125, v125, v40, v41
    v_max3_f32 v125, v125, v42, v43
    v_max3_f32 v125, v125, v44, v45
    v_max3_f32 v125, v125, v46, v47
    v_max3_f32 v126, v126, v48, v49
    v_max3_f32 v126, v126, v50, v51
    v_max3_f32 v126, v126, v52, v53
    v_max3_f32 v126, v126, v54, v55
    v_max3_f32 v127, v127, v56, v57
    v_max3_f32 v127, v127, v58, v59
    v_max3_f32 v127, v127, v60, v61
    v_max3_f32 v127, v127, v62, v63
    s_sub_u32 s91, s91, 1
    s_cmp_lg_u32 s91, 0
    s_cbranch_scc1 L_pre0
    v_mov_b32 v22, v124
    v_mov_b32 v23, v125
    v_mov_b32 v24, v126
    v_mov_b32 v25, v127
    v_mov_b32 v26, v22
    v_mov_b32 v27, v23
    v_mov_b32 v28, v24
    v_mov_b32 v29, v25
    s_nop 1
    v_permlane16_swap_b32 v22, v26
    v_permlane16_swap_b32 v23, v27
    v_permlane16_swap_b32 v24, v28
    v_permlane16_swap_b32 v25, v29
    s_nop 1
    v_max_f32 v22, v22, v26
    v_max_f32 v23, v23, v27
    v_max_f32 v24, v24, v28
    v_max_f32 v25, v25, v29
    v_mov_b32 v26, v22
    v_mov_b32 v27, v23
    v_mov_b32 v28, v24
    v_mov_b32 v29, v25
    s_nop 1
    v_permlane32_swap_b32 v22, v26
    v_permlane32_swap_b32 v23, v27
    v_permlane32_swap_b32 v24, v28
    v_permlane32_swap_b32 v25, v29
    s_nop 1
    v_max_f32 v22, v22, v26
    v_max_f32 v23, v23, v27
    v_max_f32 v24, v24, v28
    v_max_f32 v25, v25, v29
    v_mov_b32 v124, v22
    v_mov_b32 v125, v23
    v_mov_b32 v126, v24
    v_mov_b32 v127, v25
L_nopre0:
    ds_read_b128 a[64:67], v4 offset:57344
    ds_read_b128 a[68:71], v5 offset:57344
    ds_read_b128 a[72:75], v6 offset:57344
    ds_read_b128 a[76:79], v7 offset:57344
    ds_read_b128 a[80:83], v4 offset:61440
    ds_read_b128 a[84:87], v5 offset:61440
    ds_read_b128 a[88:91], v6 offset:61440
    ds_read_b128 a[92:95], v7 offset:61440
    s_waitcnt vmcnt(12) lgkmcnt(0)
    s_barrier
    v_mfma_f32_16x16x32_bf16 v[32:35], a[64:67], a[0:3], 0
    ds_read_b64_tr_b16 a[96:97], v8 offset:0
    s_lshr_b32 s74, s24, 1
    v_mfma_f32_16x16x32_bf16 v[40:43], a[64:67], a[16:19], 0
    ds_read_b64_tr_b16 a[98:99], v8 offset:4096
    v_mfma_f32_16x16x32_bf16 v[32:35], a[68:71], a[4:7], v[32:35]
    ds_read_b64_tr_b16 a[100:101], v9 offset:0
    s_add_u32 m0, s74, 147456
    v_mfma_f32_16x16x32_bf16 v[40:43], a[68:71], a[20:23], v[40:43]
    ds_read_b64_tr_b16 a[102:103], v9 offset:4096
    v_mfma_f32_16x16x32_bf16 v[32:35], a[72:75], a[8:11], v[32:35]
    ds_read_b64_tr_b16 a[104:105], v10 offset:0
    buffer_load_dwordx4 v19, s[36:39], s71 offen lds
    v_mfma_f32_16x16x32_bf16 v[40:43], a[72:75], a[24:27], v[40:43]
    ds_read_b64_tr_b16 a[106:107], v10 offset:4096
    v_mfma_f32_16x16x32_bf16 v[32:35], a[76:79], a[12:15], v[32:35]
    ds_read_b64_tr_b16 a[108:109], v11 offset:0
    s_add_u32 s72, s71, 32768
    v_mfma_f32_16x16x32_bf16 v[40:43], a[76:79], a[28:31], v[40:43]
    ds_read_b64_tr_b16 a[110:111], v11 offset:4096
    v_mfma_f32_16x16x32_bf16 v[36:39], a[80:83], a[0:3], 0
    ds_read_b64_tr_b16 a[112:113], v12 offset:0
    s_add_u32 m0, s74, 148480
    v_mfma_f32_16x16x32_bf16 v[44:47], a[80:83], a[16:19], 0
    ds_read_b64_tr_b16 a[114:115], v12 offset:4096
    v_mfma_f32_16x16x32_bf16 v[36:39], a[84:87], a[4:7], v[36:39]
    ds_read_b64_tr_b16 a[116:117], v13 offset:0
    buffer_load_dwordx4 v19, s[36:39], s72 offen lds
    v_mfma_f32_16x16x32_bf16 v[44:47], a[84:87], a[20:23], v[44:47]
    ds_read_b64_tr_b16 a[118:119], v13 offset:4096
    v_mfma_f32_16x16x32_bf16 v[36:39], a[88:91], a[8:11], v[36:39]
    ds_read_b64_tr_b16 a[120:121], v14 offset:0
    s_add_u32 s71, s71, 262144
    v_mfma_f32_16x16x32_bf16 v[44:47], a[88:91], a[24:27], v[44:47]
    ds_read_b64_tr_b16 a[122:123], v14 offset:4096
    v_mfma_f32_16x16x32_bf16 v[36:39], a[92:95], a[12:15], v[36:39]
    ds_read_b64_tr_b16 a[124:125], v15 offset:0
    s_add_u32 m0, s80, 114688
    v_mfma_f32_16x16x32_bf16 v[44:47], a[92:95], a[28:31], v[44:47]
    ds_read_b64_tr_b16 a[126:127], v15 offset:4096
    v_mfma_f32_16x16x32_bf16 v[48:51], a[64:67], a[32:35], 0
    buffer_load_dwordx4 v20, s[12:15], s25 offen nt lds
    v_mfma_f32_16x16x32_bf16 v[56:59], a[64:67], a[48:51], 0
    ds_read_b128 a[64:67], v4 offset:0
    v_mfma_f32_16x16x32_bf16 v[48:51], a[68:71], a[36:39], v[48:51]
    s_add_u32 m0, s80, 118784
    v_mfma_f32_16x16x32_bf16 v[56:59], a[68:71], a[52:55], v[56:59]
    ds_read_b128 a[68:71], v5 offset:0
    v_mfma_f32_16x16x32_bf16 v[48:51], a[72:75], a[40:43], v[48:51]
    buffer_load_dwordx4 v21, s[12:15], s25 offen nt lds
    v_mfma_f32_16x16x32_bf16 v[56:59], a[72:75], a[56:59], v[56:59]
    ds_read_b128 a[72:75], v6 offset:0
    v_mfma_f32_16x16x32_bf16 v[48:51], a[76:79], a[44:47], v[48:51]
    s_add_u32 m0, s80, 122880
    v_mfma_f32_16x16x32_bf16 v[56:59], a[76:79], a[60:63], v[56:59]
    ds_read_b128 a[76:79], v7 offset:0
    v_mfma_f32_16x16x32_bf16 v[52:55], a[80:83], a[32:35], 0
    buffer_load_dwordx4 v20, s[12:15], s81 offen nt lds
    v_mfma_f32_16x16x32_bf16 v[60:63], a[80:83], a[48:51], 0
    ds_read_b128 a[80:83], v4 offset:4096
    v_mfma_f32_16x16x32_bf16 v[52:55], a[84:87], a[36:39], v[52:55]
    s_add_u32 m0, s80, 126976
    v_mfma_f32_16x16x32_bf16 v[60:63], a[84:87], a[52:55], v[60:63]
    ds_read_b128 a[84:87], v5 offset:4096
    v_mfma_f32_16x16x32_bf16 v[52:55], a[88:91], a[40:43], v[52:55]
    buffer_load_dwordx4 v21, s[12:15], s81 offen nt lds
    v_mfma_f32_16x16x32_bf16 v[60:63], a[88:91], a[56:59], v[60:63]
    ds_read_b128 a[88:91], v6 offset:4096
    v_mfma_f32_16x16x32_bf16 v[52:55], a[92:95], a[44:47], v[52:55]
    s_add_u32 s25, s25, 16384
    v_mfma_f32_16x16x32_bf16 v[60:63], a[92:95], a[60:63], v[60:63]
    ds_read_b128 a[92:95], v7 offset:4096
    s_add_u32 s81, s81, 16384
    s_add_u32 m0, s80, 49152
    s_nop 0
    buffer_load_dwordx4 v16, s[8:11], s26 offen nt lds
    s_add_u32 m0, s80, 53248
    s_nop 7
    s_cmp_eq_u32 s87, 0
    s_cbranch_scc0 L_usepre1
    v_max3_f32 v22, v32, v33, v34
    v_max3_f32 v26, v35, v36, v37
    v_max3_f32 v22, v22, v38, v39
    v_max_f32 v22, v22, v26
    v_max3_f32 v23, v40, v41, v42
    v_max3_f32 v27, v43, v44, v45
    v_max3_f32 v23, v23, v46, v47
    v_max_f32 v23, v23, v27
    v_max3_f32 v24, v48, v49, v50
    v_max3_f32 v28, v51, v52, v53
    v_max3_f32 v24, v24, v54, v55
    v_max_f32 v24, v24, v28
    v_max3_f32 v25, v56, v57, v58
    v_max3_f32 v29, v59, v60, v61
    v_max3_f32 v25, v25, v62, v63
    v_max_f32 v25, v25, v29
    v_mov_b32 v26, v22
    v_mov_b32 v27, v23
    v_mov_b32 v28, v24
    v_mov_b32 v29, v25
    s_nop 1
    v_permlane16_swap_b32 v22, v26
    v_permlane16_swap_b32 v23, v27
    v_permlane16_swap_b32 v24, v28
    v_permlane16_swap_b32 v25, v29
    s_nop 1
    v_max_f32 v22, v22, v26
    v_max_f32 v23, v23, v27
    v_max_f32 v24, v24, v28
    v_max_f32 v25, v25, v29
    v_mov_b32 v26, v22
    v_mov_b32 v27, v23
    v_mov_b32 v28, v24
    v_mov_b32 v29, v25
    s_nop 1
    v_permlane32_swap_b32 v22, v26
    v_permlane32_swap_b32 v23, v27
    v_permlane32_swap_b32 v24, v28
    v_permlane32_swap_b32 v25, v29
    s_nop 1
    v_max_f32 v22, v22, v26
    v_max_f32 v23, v23, v27
    v_max_f32 v24, v24, v28
    v_max_f32 v25, v25, v29
    s_branch L_havem1
L_usepre1:
    v_mov_b32 v22, v124
    v_mov_b32 v23, v125
    v_mov_b32 v24, v126
    v_mov_b32 v25, v127
L_havem1:
    v_sub_f32 v80, 0, v22
    v_sub_f32 v81, 0, v22
    v_sub_f32 v82, 0, v22
    v_sub_f32 v83, 0, v22
    v_sub_f32 v84, 0, v23
    v_sub_f32 v85, 0, v23
    v_sub_f32 v86, 0, v23
    v_sub_f32 v87, 0, v23
    v_sub_f32 v88, 0, v24
    v_sub_f32 v89, 0, v24
    v_sub_f32 v90, 0, v24
    v_sub_f32 v91, 0, v24
    v_sub_f32 v92, 0, v25
    v_sub_f32 v93, 0, v25
    v_sub_f32 v94, 0, v25
    v_sub_f32 v95, 0, v25
    v_sub_f32 v32, v32, v22
    v_sub_f32 v33, v33, v22
    v_sub_f32 v34, v34, v22
    v_sub_f32 v35, v35, v22
    v_sub_f32 v36, v36, v22
    v_sub_f32 v37, v37, v22
    v_sub_f32 v38, v38, v22
    v_sub_f32 v39, v39, v22
    v_sub_f32 v40, v40, v23
    v_sub_f32 v41, v41, v23
    v_sub_f32 v42, v42, v23
    v_sub_f32 v43, v43, v23
    v_sub_f32 v44, v44, v23
    v_sub_f32 v45, v45, v23
    v_sub_f32 v46, v46, v23
    v_sub_f32 v47, v47, v23
    v_sub_f32 v48, v48, v24
    v_sub_f32 v49, v49, v24
    v_sub_f32 v50, v50, v24
    v_sub_f32 v51, v51, v24
    v_sub_f32 v52, v52, v24
    v_sub_f32 v53, v53, v24
    v_sub_f32 v54, v54, v24
    v_sub_f32 v55, v55, v24
    v_sub_f32 v56, v56, v25
    v_sub_f32 v57, v57, v25
    v_sub_f32 v58, v58, v25
    v_sub_f32 v59, v59, v25
    v_sub_f32 v60, v60, v25
    v_sub_f32 v61, v61, v25
    v_sub_f32 v62, v62, v25
    v_sub_f32 v63, v63, v25
    v_exp_f32 v32, v32
    v_exp_f32 v33, v33
    v_exp_f32 v34, v34
    v_exp_f32 v35, v35
    v_exp_f32 v36, v36
    v_exp_f32 v37, v37
    v_exp_f32 v38, v38
    v_exp_f32 v39, v39
    v_exp_f32 v40, v40
    v_exp_f32 v41, v41
    v_exp_f32 v42, v42
    v_exp_f32 v43, v43
    v_exp_f32 v44, v44
    v_exp_f32 v45, v45
    v_exp_f32 v46, v46
    v_exp_f32 v47, v47
    s_nop 0
    v_cvt_pk_bf16_f32 v64, v32, v33
    v_cvt_pk_bf16_f32 v65, v34, v35
    v_cvt_pk_bf16_f32 v66, v36, v37
    v_cvt_pk_bf16_f32 v67, v38, v39
    v_cvt_pk_bf16_f32 v68, v40, v41
    v_cvt_pk_bf16_f32 v69, v42, v43
    v_cvt_pk_bf16_f32 v70, v44, v45
    v_cvt_pk_bf16_f32 v71, v46, v47
    s_waitcnt lgkmcnt(8)
    v_mfma_f32_16x16x32_bf16 v[128:131], a[96:99], v[64:67], 0
    v_exp_f32 v48, v48
    v_mfma_f32_16x16x32_bf16 v[160:163], a[96:99], v[68:71], 0
    v_exp_f32 v49, v49
    v_mfma_f32_16x16x32_bf16 v[132:135], a[100:103], v[64:67], 0
    v_exp_f32 v50, v50
    v_mfma_f32_16x16x32_bf16 v[164:167], a[100:103], v[68:71], 0
    v_exp_f32 v51, v51
    v_mfma_f32_16x16x32_bf16 v[136:139], a[104:107], v[64:67], 0
    v_exp_f32 v56, v56
    v_mfma_f32_16x16x32_bf16 v[168:171], a[104:107], v[68:71], 0
    v_exp_f32 v57, v57
    v_mfma_f32_16x16x32_bf16 v[140:143], a[108:111], v[64:67], 0
    v_exp_f32 v58, v58
    v_mfma_f32_16x16x32_bf16 v[172:175], a[108:111], v[68:71], 0
    v_exp_f32 v59, v59
    v_mfma_f32_16x16x32_bf16 v[144:147], a[112:115], v[64:67], 0
    v_exp_f32 v52, v52
    v_mfma_f32_16x16x32_bf16 v[176:179], a[112:115], v[68:71], 0
    v_exp_f32 v53, v53
    v_mfma_f32_16x16x32_bf16 v[148:151], a[116:119], v[64:67], 0
    v_exp_f32 v54, v54
    v_mfma_f32_16x16x32_bf16 v[180:183], a[116:119], v[68:71], 0
    v_exp_f32 v55, v55
    v_mfma_f32_16x16x32_bf16 v[152:155], a[120:123], v[64:67], 0
    v_cvt_pk_bf16_f32 v72, v48, v49
    v_cvt_pk_bf16_f32 v73, v50, v51
    v_mfma_f32_16x16x32_bf16 v[184:187], a[120:123], v[68:71], 0
    v_cvt_pk_bf16_f32 v76, v56, v57
    v_cvt_pk_bf16_f32 v77, v58, v59
    v_mfma_f32_16x16x32_bf16 v[156:159], a[124:127], v[64:67], 0
    v_mfma_f32_16x16x32_bf16 v[188:191], a[124:127], v[68:71], 0
    v_mfma_f32_16x16x32_bf16 v[96:99], v[112:115], v[64:67], 0
    v_mfma_f32_16x16x32_bf16 v[100:103], v[112:115], v[68:71], 0
    s_waitcnt lgkmcnt(0)
    v_mfma_f32_16x16x32_bf16 v[32:35], a[64:67], a[0:3], v[80:83]
    v_exp_f32 v60, v60
    v_mfma_f32_16x16x32_bf16 v[40:43], a[64:67], a[16:19], v[84:87]
    v_cvt_pk_bf16_f32 v74, v52, v53
    v_mfma_f32_16x16x32_bf16 v[32:35], a[68:71], a[4:7], v[32:35]
    v_exp_f32 v61, v61
    v_mfma_f32_16x16x32_bf16 v[40:43], a[68:71], a[20:23], v[40:43]
    v_cvt_pk_bf16_f32 v75, v54, v55
    v_cvt_pk_bf16_f32 v78, v60, v61
    v_mfma_f32_16x16x32_bf16 v[32:35], a[72:75], a[8:11], v[32:35]
    v_exp_f32 v62, v62
    v_mfma_f32_16x16x32_bf16 v[40:43], a[72:75], a[24:27], v[40:43]
    buffer_load_dwordx4 v17, s[8:11], s26 offen nt lds
    v_mfma_f32_16x16x32_bf16 v[32:35], a[76:79], a[12:15], v[32:35]
    v_exp_f32 v63, v63
    v_mfma_f32_16x16x32_bf16 v[40:43], a[76:79], a[28:31], v[40:43]
    v_cvt_pk_bf16_f32 v79, v62, v63
    v_mfma_f32_16x16x32_bf16 v[36:39], a[80:83], a[0:3], v[80:83]
    v_mfma_f32_16x16x32_bf16 v[44:47], a[80:83], a[16:19], v[84:87]
    s_add_u32 m0, s80, 57344
    v_mfma_f32_16x16x32_bf16 v[36:39], a[84:87], a[4:7], v[36:39]
    v_exp_f32 v32, v32
    v_mfma_f32_16x16x32_bf16 v[44:47], a[84:87], a[20:23], v[44:47]
    buffer_load_dwordx4 v16, s[8:11], s82 offen nt lds
    v_mfma_f32_16x16x32_bf16 v[36:39], a[88:91], a[8:11], v[36:39]
    v_exp_f32 v33, v33
    v_mfma_f32_16x16x32_bf16 v[44:47], a[88:91], a[24:27], v[44:47]
    v_cvt_pk_bf16_f32 v64, v32, v33
    s_add_u32 m0, s80, 61440
    v_mfma_f32_16x16x32_bf16 v[36:39], a[92:95], a[12:15], v[36:39]
    v_exp_f32 v34, v34
    v_mfma_f32_16x16x32_bf16 v[44:47], a[92:95], a[28:31], v[44:47]
    buffer_load_dwordx4 v17, s[8:11], s82 offen nt lds
    s_add_u32 s26, s26, 16384
    v_mfma_f32_16x16x32_bf16 v[192:195], a[96:99], v[72:75], 0
    v_exp_f32 v35, v35
    v_mfma_f32_16x16x32_bf16 v[224:227], a[96:99], v[76:79], 0
    ds_read_b64_tr_b16 a[96:97], v8 offset:8192
    ds_read_b64_tr_b16 a[98:99], v8 offset:12288
    v_mfma_f32_16x16x32_bf16 v[196:199], a[100:103], v[72:75], 0
    v_exp_f32 v40, v40
    v_mfma_f32_16x16x32_bf16 v[228:231], a[100:103], v[76:79], 0
    ds_read_b64_tr_b16 a[100:101], v9 offset:8192
    ds_read_b64_tr_b16 a[102:103], v9 offset:12288
    v_mfma_f32_16x16x32_bf16 v[200:203], a[104:107], v[72:75], 0
    v_exp_f32 v41, v41
    v_mfma_f32_16x16x32_bf16 v[232:235], a[104:107], v[76:79], 0
    ds_read_b64_tr_b16 a[104:105], v10 offset:8192
    ds_read_b64_tr_b16 a[106:107], v10 offset:12288
    v_mfma_f32_16x16x32_bf16 v[204:207], a[108:111], v[72:75], 0
    v_exp_f32 v42, v42
    v_mfma_f32_16x16x32_bf16 v[236:239], a[108:111], v[76:79], 0
    ds_read_b64_tr_b16 a[108:109], v11 offset:8192
    ds_read_b64_tr_b16 a[110:111], v11 offset:12288
    v_mfma_f32_16x16x32_bf16 v[208:211], a[112:115], v[72:75], 0
    v_exp_f32 v43, v43
    v_mfma_f32_16x16x32_bf16 v[240:243], a[112:115], v[76:79], 0
    ds_read_b64_tr_b16 a[112:113], v12 offset:8192
    ds_read_b64_tr_b16 a[114:115], v12 offset:12288
    v_mfma_f32_16x16x32_bf16 v[212:215], a[116:119], v[72:75], 0
    v_exp_f32 v36, v36
    v_mfma_f32_16x16x32_bf16 v[244:247], a[116:119], v[76:79], 0
    ds_read_b64_tr_b16 a[116:117], v13 offset:8192
    ds_read_b64_tr_b16 a[118:119], v13 offset:12288
    v_mfma_f32_16x16x32_bf16 v[216:219], a[120:123], v[72:75], 0
    v_exp_f32 v37, v37
    v_mfma_f32_16x16x32_bf16 v[248:251], a[120:123], v[76:79], 0
    ds_read_b64_tr_b16 a[120:121], v14 offset:8192
    ds_read_b64_tr_b16 a[122:123], v14 offset:12288
    v_mfma_f32_16x16x32_bf16 v[220:223], a[124:127], v[72:75], 0
    v_exp_f32 v38, v38
    v_mfma_f32_16x16x32_bf16 v[252:255], a[124:127], v[76:79], 0
    ds_read_b64_tr_b16 a[124:125], v15 offset:8192
    ds_read_b64_tr_b16 a[126:127], v15 offset:12288
    v_mfma_f32_16x16x32_bf16 v[104:107], v[112:115], v[72:75], 0
    v_exp_f32 v39, v39
    v_mfma_f32_16x16x32_bf16 v[108:111], v[112:115], v[76:79], 0
    v_cvt_pk_bf16_f32 v65, v34, v35
    v_cvt_pk_bf16_f32 v68, v40, v41
    v_mfma_f32_16x16x32_bf16 v[48:51], a[64:67], a[32:35], v[88:91]
    v_exp_f32 v44, v44
    v_mfma_f32_16x16x32_bf16 v[56:59], a[64:67], a[48:51], v[92:95]
    ds_read_b128 a[64:67], v4 offset:8192
    v_cvt_pk_bf16_f32 v69, v42, v43
    v_mfma_f32_16x16x32_bf16 v[48:51], a[68:71], a[36:39], v[48:51]
    v_exp_f32 v45, v45
    v_mfma_f32_16x16x32_bf16 v[56:59], a[68:71], a[52:55], v[56:59]
    ds_read_b128 a[68:71], v5 offset:8192
    v_cvt_pk_bf16_f32 v66, v36, v37
    v_mfma_f32_16x16x32_bf16 v[48:51], a[72:75], a[40:43], v[48:51]
    v_exp_f32 v46, v46
    v_mfma_f32_16x16x32_bf16 v[56:59], a[72:75], a[56:59], v[56:59]
    ds_read_b128 a[72:75], v6 offset:8192
    v_cvt_pk_bf16_f32 v67, v38, v39
    v_mfma_f32_16x16x32_bf16 v[48:51], a[76:79], a[44:47], v[48:51]
    v_exp_f32 v47, v47
    v_mfma_f32_16x16x32_bf16 v[56:59], a[76:79], a[60:63], v[56:59]
    ds_read_b128 a[76:79], v7 offset:8192
    v_cvt_pk_bf16_f32 v70, v44, v45
    v_mfma_f32_16x16x32_bf16 v[52:55], a[80:83], a[32:35], v[88:91]
    s_add_u32 s82, s82, 16384
    s_add_u32 m0, s24, 131072
    s_add_u32 s72, s70, 0
    v_mfma_f32_16x16x32_bf16 v[60:63], a[80:83], a[48:51], v[92:95]
    ds_read_b128 a[80:83], v4 offset:12288
    v_cvt_pk_bf16_f32 v71, v46, v47
    v_mfma_f32_16x16x32_bf16 v[52:55], a[84:87], a[36:39], v[52:55]
    v_exp_f32 v48, v48
    v_mfma_f32_16x16x32_bf16 v[60:63], a[84:87], a[52:55], v[60:63]
    ds_read_b128 a[84:87], v5 offset:12288
    buffer_load_dwordx4 v18, s[32:35], s72 offen lds
    v_mfma_f32_16x16x32_bf16 v[52:55], a[88:91], a[40:43], v[52:55]
    v_exp_f32 v49, v49
    v_mfma_f32_16x16x32_bf16 v[60:63], a[88:91], a[56:59], v[60:63]
    ds_read_b128 a[88:91], v6 offset:12288
    v_mfma_f32_16x16x32_bf16 v[52:55], a[92:95], a[44:47], v[52:55]
    v_exp_f32 v50, v50
    v_mfma_f32_16x16x32_bf16 v[60:63], a[92:95], a[60:63], v[60:63]
    ds_read_b128 a[92:95], v7 offset:12288
    s_waitcnt lgkmcnt(8)
    v_mfma_f32_16x16x32_bf16 v[128:131], a[96:99], v[64:67], v[128:131]
    v_exp_f32 v51, v51
    v_mfma_f32_16x16x32_bf16 v[160:163], a[96:99], v[68:71], v[160:163]
    v_cvt_pk_bf16_f32 v72, v48, v49
    v_cvt_pk_bf16_f32 v73, v50, v51
    s_add_u32 m0, s24, 132096
    s_add_u32 s72, s70, 16384
    v_mfma_f32_16x16x32_bf16 v[132:135], a[100:103], v[64:67], v[132:135]
    v_exp_f32 v56, v56
    v_mfma_f32_16x16x32_bf16 v[164:167], a[100:103], v[68:71], v[164:167]
    buffer_load_dwordx4 v18, s[32:35], s72 offen lds
    v_mfma_f32_16x16x32_bf16 v[136:139], a[104:107], v[64:67], v[136:139]
    v_exp_f32 v57, v57
    v_mfma_f32_16x16x32_bf16 v[168:171], a[104:107], v[68:71], v[168:171]
    v_cvt_pk_bf16_f32 v76, v56, v57
    s_add_u32 m0, s24, 133120
    s_add_u32 s72, s70, 32768
    v_mfma_f32_16x16x32_bf16 v[140:143], a[108:111], v[64:67], v[140:143]
    v_exp_f32 v58, v58
    v_mfma_f32_16x16x32_bf16 v[172:175], a[108:111], v[68:71], v[172:175]
    buffer_load_dwordx4 v18, s[32:35], s72 offen lds
    v_mfma_f32_16x16x32_bf16 v[144:147], a[112:115], v[64:67], v[144:147]
    v_exp_f32 v59, v59
    v_mfma_f32_16x16x32_bf16 v[176:179], a[112:115], v[68:71], v[176:179]
    v_cvt_pk_bf16_f32 v77, v58, v59
    s_add_u32 m0, s24, 134144
    s_add_u32 s72, s70, 49152
    v_mfma_f32_16x16x32_bf16 v[148:151], a[116:119], v[64:67], v[148:151]
    v_exp_f32 v52, v52
    v_mfma_f32_16x16x32_bf16 v[180:183], a[116:119], v[68:71], v[180:183]
    buffer_load_dwordx4 v18, s[32:35], s72 offen lds
    s_add_u32 s70, s70, 64
    v_mfma_f32_16x16x32_bf16 v[152:155], a[120:123], v[64:67], v[152:155]
    v_exp_f32 v53, v53
    v_mfma_f32_16x16x32_bf16 v[184:187], a[120:123], v[68:71], v[184:187]
    v_mfma_f32_16x16x32_bf16 v[156:159], a[124:127], v[64:67], v[156:159]
    v_exp_f32 v54, v54
    v_mfma_f32_16x16x32_bf16 v[188:191], a[124:127], v[68:71], v[188:191]
    v_mfma_f32_16x16x32_bf16 v[96:99], v[112:115], v[64:67], v[96:99]
    v_exp_f32 v55, v55
    v_mfma_f32_16x16x32_bf16 v[100:103], v[112:115], v[68:71], v[100:103]
    s_waitcnt vmcnt(12) lgkmcnt(0)
    s_barrier
    v_mfma_f32_16x16x32_bf16 v[32:35], a[64:67], a[0:3], v[80:83]
    v_exp_f32 v60, v60
    v_mfma_f32_16x16x32_bf16 v[40:43], a[64:67], a[16:19], v[84:87]
    v_cvt_pk_bf16_f32 v74, v52, v53
    s_lshr_b32 s74, s24, 1
    v_mfma_f32_16x16x32_bf16 v[32:35], a[68:71], a[4:7], v[32:35]
    v_exp_f32 v61, v61
    v_mfma_f32_16x16x32_bf16 v[40:43], a[68:71], a[20:23], v[40:43]
    v_cvt_pk_bf16_f32 v75, v54, v55
    v_cvt_pk_bf16_f32 v78, v60, v61
    v_mfma_f32_16x16x32_bf16 v[32:35], a[72:75], a[8:11], v[32:35]
    v_exp_f32 v62, v62
    v_mfma_f32_16x16x32_bf16 v[40:43], a[72:75], a[24:27], v[40:43]
    s_add_u32 m0, s74, 155648
    s_add_u32 s72, s71, 32768
    v_mfma_f32_16x16x32_bf16 v[32:35], a[76:79], a[12:15], v[32:35]
    v_exp_f32 v63, v63
    v_mfma_f32_16x16x32_bf16 v[40:43], a[76:79], a[28:31], v[40:43]
    v_cvt_pk_bf16_f32 v79, v62, v63
    buffer_load_dwordx4 v19, s[36:39], s71 offen lds
    v_mfma_f32_16x16x32_bf16 v[36:39], a[80:83], a[0:3], v[80:83]
    s_add_u32 m0, s74, 156672
    v_mfma_f32_16x16x32_bf16 v[44:47], a[80:83], a[16:19], v[84:87]
    s_add_u32 s71, s71, 262144
    v_mfma_f32_16x16x32_bf16 v[36:39], a[84:87], a[4:7], v[36:39]
    v_exp_f32 v32, v32
    v_mfma_f32_16x16x32_bf16 v[44:47], a[84:87], a[20:23], v[44:47]
    buffer_load_dwordx4 v19, s[36:39], s72 offen lds
    v_mfma_f32_16x16x32_bf16 v[36:39], a[88:91], a[8:11], v[36:39]
    v_exp_f32 v33, v33
    v_mfma_f32_16x16x32_bf16 v[44:47], a[88:91], a[24:27], v[44:47]
    v_cvt_pk_bf16_f32 v64, v32, v33
    s_add_u32 m0, s80, 65536
    v_mfma_f32_16x16x32_bf16 v[36:39], a[92:95], a[12:15], v[36:39]
    v_exp_f32 v34, v34
    v_mfma_f32_16x16x32_bf16 v[44:47], a[92:95], a[28:31], v[44:47]
    buffer_load_dwordx4 v20, s[12:15], s25 offen nt lds
    s_add_u32 m0, s80, 69632
    v_mfma_f32_16x16x32_bf16 v[192:195], a[96:99], v[72:75], v[192:195]
    v_exp_f32 v35, v35
    v_mfma_f32_16x16x32_bf16 v[224:227], a[96:99], v[76:79], v[224:227]
    ds_read_b64_tr_b16 a[96:97], v8 offset:16384
    ds_read_b64_tr_b16 a[98:99], v8 offset:20480
    v_mfma_f32_16x16x32_bf16 v[196:199], a[100:103], v[72:75], v[196:199]
    v_exp_f32 v40, v40
    v_mfma_f32_16x16x32_bf16 v[228:231], a[100:103], v[76:79], v[228:231]
    ds_read_b64_tr_b16 a[100:101], v9 offset:16384
    ds_read_b64_tr_b16 a[102:103], v9 offset:20480
    v_mfma_f32_16x16x32_bf16 v[200:203], a[104:107], v[72:75], v[200:203]
    v_exp_f32 v41, v41
    v_mfma_f32_16x16x32_bf16 v[232:235], a[104:107], v[76:79], v[232:235]
    ds_read_b64_tr_b16 a[104:105], v10 offset:16384
    ds_read_b64_tr_b16 a[106:107], v10 offset:20480
    v_mfma_f32_16x16x32_bf16 v[204:207], a[108:111], v[72:75], v[204:207]
    v_exp_f32 v42, v42
    v_mfma_f32_16x16x32_bf16 v[236:239], a[108:111], v[76:79], v[236:239]
    ds_read_b64_tr_b16 a[108:109], v11 offset:16384
    ds_read_b64_tr_b16 a[110:111], v11 offset:20480
    v_mfma_f32_16x16x32_bf16 v[208:211], a[112:115], v[72:75], v[208:211]
    v_exp_f32 v43, v43
    v_mfma_f32_16x16x32_bf16 v[240:243], a[112:115], v[76:79], v[240:243]
    ds_read_b64_tr_b16 a[112:113], v12 offset:16384
    ds_read_b64_tr_b16 a[114:115], v12 offset:20480
    v_mfma_f32_16x16x32_bf16 v[212:215], a[116:119], v[72:75], v[212:215]
    v_exp_f32 v36, v36
    v_mfma_f32_16x16x32_bf16 v[244:247], a[116:119], v[76:79], v[244:247]
    ds_read_b64_tr_b16 a[116:117], v13 offset:16384
    ds_read_b64_tr_b16 a[118:119], v13 offset:20480
    v_mfma_f32_16x16x32_bf16 v[216:219], a[120:123], v[72:75], v[216:219]
    v_exp_f32 v37, v37
    v_mfma_f32_16x16x32_bf16 v[248:251], a[120:123], v[76:79], v[248:251]
    ds_read_b64_tr_b16 a[120:121], v14 offset:16384
    ds_read_b64_tr_b16 a[122:123], v14 offset:20480
    v_mfma_f32_16x16x32_bf16 v[220:223], a[124:127], v[72:75], v[220:223]
    v_exp_f32 v38, v38
    v_mfma_f32_16x16x32_bf16 v[252:255], a[124:127], v[76:79], v[252:255]
    ds_read_b64_tr_b16 a[124:125], v15 offset:16384
    ds_read_b64_tr_b16 a[126:127], v15 offset:20480
    v_mfma_f32_16x16x32_bf16 v[104:107], v[112:115], v[72:75], v[104:107]
    v_exp_f32 v39, v39
    v_mfma_f32_16x16x32_bf16 v[108:111], v[112:115], v[76:79], v[108:111]
    v_cvt_pk_bf16_f32 v65, v34, v35
    v_cvt_pk_bf16_f32 v68, v40, v41
    v_mfma_f32_16x16x32_bf16 v[48:51], a[64:67], a[32:35], v[88:91]
    v_exp_f32 v44, v44
    v_mfma_f32_16x16x32_bf16 v[56:59], a[64:67], a[48:51], v[92:95]
    ds_read_b128 a[64:67], v4 offset:16384
    v_cvt_pk_bf16_f32 v69, v42, v43
    v_mfma_f32_16x16x32_bf16 v[48:51], a[68:71], a[36:39], v[48:51]
    v_exp_f32 v45, v45
    v_mfma_f32_16x16x32_bf16 v[56:59], a[68:71], a[52:55], v[56:59]
    ds_read_b128 a[68:71], v5 offset:16384
    v_cvt_pk_bf16_f32 v66, v36, v37
    v_mfma_f32_16x16x32_bf16 v[48:51], a[72:75], a[40:43], v[48:51]
    v_exp_f32 v46, v46
    v_mfma_f32_16x16x32_bf16 v[56:59], a[72:75], a[56:59], v[56:59]
    ds_read_b128 a[72:75], v6 offset:16384
    v_cvt_pk_bf16_f32 v67, v38, v39
    v_mfma_f32_16x16x32_bf16 v[48:51], a[76:79], a[44:47], v[48:51]
    v_exp_f32 v47, v47
    v_mfma_f32_16x16x32_bf16 v[56:59], a[76:79], a[60:63], v[56:59]
    ds_read_b128 a[76:79], v7 offset:16384
    v_cvt_pk_bf16_f32 v70, v44, v45
    v_mfma_f32_16x16x32_bf16 v[52:55], a[80:83], a[32:35], v[88:91]
    buffer_load_dwordx4 v21, s[12:15], s25 offen nt lds
    v_mfma_f32_16x16x32_bf16 v[60:63], a[80:83], a[48:51], v[92:95]
    ds_read_b128 a[80:83], v4 offset:20480
    v_cvt_pk_bf16_f32 v71, v46, v47
    v_mfma_f32_16x16x32_bf16 v[52:55], a[84:87], a[36:39], v[52:55]
    v_exp_f32 v48, v48
    v_mfma_f32_16x16x32_bf16 v[60:63], a[84:87], a[52:55], v[60:63]
    ds_read_b128 a[84:87], v5 offset:20480
    s_add_u32 m0, s80, 73728
    v_mfma_f32_16x16x32_bf16 v[52:55], a[88:91], a[40:43], v[52:55]
    v_exp_f32 v49, v49
    v_mfma_f32_16x16x32_bf16 v[60:63], a[88:91], a[56:59], v[60:63]
    ds_read_b128 a[88:91], v6 offset:20480
    buffer_load_dwordx4 v20, s[12:15], s81 offen nt lds
    v_mfma_f32_16x16x32_bf16 v[52:55], a[92:95], a[44:47], v[52:55]
    v_exp_f32 v50, v50
    v_mfma_f32_16x16x32_bf16 v[60:63], a[92:95], a[60:63], v[60:63]
    ds_read_b128 a[92:95], v7 offset:20480
    s_waitcnt lgkmcnt(8)
    v_mfma_f32_16x16x32_bf16 v[128:131], a[96:99], v[64:67], v[128:131]
    v_exp_f32 v51, v51
    v_mfma_f32_16x16x32_bf16 v[160:163], a[96:99], v[68:71], v[160:163]
    v_cvt_pk_bf16_f32 v72, v48, v49
    v_cvt_pk_bf16_f32 v73, v50, v51
    v_mfma_f32_16x16x32_bf16 v[132:135], a[100:103], v[64:67], v[132:135]
    v_exp_f32 v56, v56
    v_mfma_f32_16x16x32_bf16 v[164:167], a[100:103], v[68:71], v[164:167]
    s_add_u32 m0, s80, 77824
    v_mfma_f32_16x16x32_bf16 v[136:139], a[104:107], v[64:67], v[136:139]
    v_exp_f32 v57, v57
    v_mfma_f32_16x16x32_bf16 v[168:171], a[104:107], v[68:71], v[168:171]
    v_cvt_pk_bf16_f32 v76, v56, v57
    v_mfma_f32_16x16x32_bf16 v[140:143], a[108:111], v[64:67], v[140:143]
    v_exp_f32 v58, v58
    v_mfma_f32_16x16x32_bf16 v[172:175], a[108:111], v[68:71], v[172:175]
    buffer_load_dwordx4 v21, s[12:15], s81 offen nt lds
    v_mfma_f32_16x16x32_bf16 v[144:147], a[112:115], v[64:67], v[144:147]
    v_exp_f32 v59, v59
    v_mfma_f32_16x16x32_bf16 v[176:179], a[112:115], v[68:71], v[176:179]
    v_cvt_pk_bf16_f32 v77, v58, v59
    s_add_u32 s25, s25, 16384
    v_mfma_f32_16x16x32_bf16 v[148:151], a[116:119], v[64:67], v[148:151]
    v_exp_f32 v52, v52
    v_mfma_f32_16x16x32_bf16 v[180:183], a[116:119], v[68:71], v[180:183]
    s_add_u32 s81, s81, 16384
    s_add_u32 m0, s80, 0
    v_mfma_f32_16x16x32_bf16 v[152:155], a[120:123], v[64:67], v[152:155]
    v_exp_f32 v53, v53
    v_mfma_f32_16x16x32_bf16 v[184:187], a[120:123], v[68:71], v[184:187]
    buffer_load_dwordx4 v16, s[8:11], s26 offen nt lds
    v_mfma_f32_16x16x32_bf16 v[156:159], a[124:127], v[64:67], v[156:159]
    v_exp_f32 v54, v54
    v_mfma_f32_16x16x32_bf16 v[188:191], a[124:127], v[68:71], v[188:191]
    s_add_u32 m0, s80, 4096
    v_mfma_f32_16x16x32_bf16 v[96:99], v[112:115], v[64:67], v[96:99]
    v_exp_f32 v55, v55
    v_mfma_f32_16x16x32_bf16 v[100:103], v[112:115], v[68:71], v[100:103]
    s_waitcnt lgkmcnt(0)
    v_mfma_f32_16x16x32_bf16 v[32:35], a[64:67], a[0:3], v[80:83]
    v_exp_f32 v60, v60
    v_mfma_f32_16x16x32_bf16 v[40:43], a[64:67], a[16:19], v[84:87]
    v_cvt_pk_bf16_f32 v74, v52, v53
    v_mfma_f32_16x16x32_bf16 v[32:35], a[68:71], a[4:7], v[32:35]
    v_exp_f32 v61, v61
    v_mfma_f32_16x16x32_bf16 v[40:43], a[68:71], a[20:23], v[40:43]
    v_cvt_pk_bf16_f32 v75, v54, v55
    v_cvt_pk_bf16_f32 v78, v60, v61
    v_mfma_f32_16x16x32_bf16 v[32:35], a[72:75], a[8:11], v[32:35]
    v_exp_f32 v62, v62
    v_mfma_f32_16x16x32_bf16 v[40:43], a[72:75], a[24:27], v[40:43]
    buffer_load_dwordx4 v17, s[8:11], s26 offen nt lds
    v_mfma_f32_16x16x32_bf16 v[32:35], a[76:79], a[12:15], v[32:35]
    v_exp_f32 v63, v63
    v_mfma_f32_16x16x32_bf16 v[40:43], a[76:79], a[28:31], v[40:43]
    v_cvt_pk_bf16_f32 v79, v62, v63
    v_mfma_f32_16x16x32_bf16 v[36:39], a[80:83], a[0:3], v[80:83]
    v_mfma_f32_16x16x32_bf16 v[44:47], a[80:83], a[16:19], v[84:87]
    s_add_u32 m0, s80, 8192
    v_mfma_f32_16x16x32_bf16 v[36:39], a[84:87], a[4:7], v[36:39]
    v_exp_f32 v32, v32
    v_mfma_f32_16x16x32_bf16 v[44:47], a[84:87], a[20:23], v[44:47]
    buffer_load_dwordx4 v16, s[8:11], s82 offen nt lds
    v_mfma_f32_16x16x32_bf16 v[36:39], a[88:91], a[8:11], v[36:39]
    v_exp_f32 v33, v33
    v_mfma_f32_16x16x32_bf16 v[44:47], a[88:91], a[24:27], v[44:47]
    v_cvt_pk_bf16_f32 v64, v32, v33
    s_add_u32 m0, s80, 12288
    v_mfma_f32_16x16x32_bf16 v[36:39], a[92:95], a[12:15], v[36:39]
    v_exp_f32 v34, v34
    v_mfma_f32_16x16x32_bf16 v[44:47], a[92:95], a[28:31], v[44:47]
    buffer_load_dwordx4 v17, s[8:11], s82 offen nt lds
    s_add_u32 s26, s26, 16384
    v_mfma_f32_16x16x32_bf16 v[192:195], a[96:99], v[72:75], v[192:195]
    v_exp_f32 v35, v35
    v_mfma_f32_16x16x32_bf16 v[224:227], a[96:99], v[76:79], v[224:227]
    ds_read_b64_tr_b16 a[96:97], v8 offset:24576
    ds_read_b64_tr_b16 a[98:99], v8 offset:28672
    v_mfma_f32_16x16x32_bf16 v[196:199], a[100:103], v[72:75], v[196:199]
    v_exp_f32 v40, v40
    v_mfma_f32_16x16x32_bf16 v[228:231], a[100:103], v[76:79], v[228:231]
    ds_read_b64_tr_b16 a[100:101], v9 offset:24576
    ds_read_b64_tr_b16 a[102:103], v9 offset:28672
    v_mfma_f32_16x16x32_bf16 v[200:203], a[104:107], v[72:75], v[200:203]
    v_exp_f32 v41, v41
    v_mfma_f32_16x16x32_bf16 v[232:235], a[104:107], v[76:79], v[232:235]
    ds_read_b64_tr_b16 a[104:105], v10 offset:24576
    ds_read_b64_tr_b16 a[106:107], v10 offset:28672
    v_mfma_f32_16x16x32_bf16 v[204:207], a[108:111], v[72:75], v[204:207]
    v_exp_f32 v42, v42
    v_mfma_f32_16x16x32_bf16 v[236:239], a[108:111], v[76:79], v[236:239]
    ds_read_b64_tr_b16 a[108:109], v11 offset:24576
    ds_read_b64_tr_b16 a[110:111], v11 offset:28672
    v_mfma_f32_16x16x32_bf16 v[208:211], a[112:115], v[72:75], v[208:211]
    v_exp_f32 v43, v43
    v_mfma_f32_16x16x32_bf16 v[240:243], a[112:115], v[76:79], v[240:243]
    ds_read_b64_tr_b16 a[112:113], v12 offset:24576
    ds_read_b64_tr_b16 a[114:115], v12 offset:28672
    v_mfma_f32_16x16x32_bf16 v[212:215], a[116:119], v[72:75], v[212:215]
    v_exp_f32 v36, v36
    v_mfma_f32_16x16x32_bf16 v[244:247], a[116:119], v[76:79], v[244:247]
    ds_read_b64_tr_b16 a[116:117], v13 offset:24576
    ds_read_b64_tr_b16 a[118:119], v13 offset:28672
    v_mfma_f32_16x16x32_bf16 v[216:219], a[120:123], v[72:75], v[216:219]
    v_exp_f32 v37, v37
    v_mfma_f32_16x16x32_bf16 v[248:251], a[120:123], v[76:79], v[248:251]
    ds_read_b64_tr_b16 a[120:121], v14 offset:24576
    ds_read_b64_tr_b16 a[122:123], v14 offset:28672
    v_mfma_f32_16x16x32_bf16 v[220:223], a[124:127], v[72:75], v[220:223]
    v_exp_f32 v38, v38
    v_mfma_f32_16x16x32_bf16 v[252:255], a[124:127], v[76:79], v[252:255]
    ds_read_b64_tr_b16 a[124:125], v15 offset:24576
    ds_read_b64_tr_b16 a[126:127], v15 offset:28672
    v_mfma_f32_16x16x32_bf16 v[104:107], v[112:115], v[72:75], v[104:107]
    v_exp_f32 v39, v39
    v_mfma_f32_16x16x32_bf16 v[108:111], v[112:115], v[76:79], v[108:111]
    v_cvt_pk_bf16_f32 v65, v34, v35
    v_cvt_pk_bf16_f32 v68, v40, v41
    v_mfma_f32_16x16x32_bf16 v[48:51], a[64:67], a[32:35], v[88:91]
    v_exp_f32 v44, v44
    v_mfma_f32_16x16x32_bf16 v[56:59], a[64:67], a[48:51], v[92:95]
    ds_read_b128 a[64:67], v4 offset:24576
    v_cvt_pk_bf16_f32 v69, v42, v43
    v_mfma_f32_16x16x32_bf16 v[48:51], a[68:71], a[36:39], v[48:51]
    v_exp_f32 v45, v45
    v_mfma_f32_16x16x32_bf16 v[56:59], a[68:71], a[52:55], v[56:59]
    ds_read_b128 a[68:71], v5 offset:24576
    v_cvt_pk_bf16_f32 v66, v36, v37
    v_mfma_f32_16x16x32_bf16 v[48:51], a[72:75], a[40:43], v[48:51]
    v_exp_f32 v46, v46
    v_mfma_f32_16x16x32_bf16 v[56:59], a[72:75], a[56:59], v[56:59]
    ds_read_b128 a[72:75], v6 offset:24576
    v_cvt_pk_bf16_f32 v67, v38, v39
    v_mfma_f32_16x16x32_bf16 v[48:51], a[76:79], a[44:47], v[48:51]
    v_exp_f32 v47, v47
    v_mfma_f32_16x16x32_bf16 v[56:59], a[76:79], a[60:63], v[56:59]
    ds_read_b128 a[76:79], v7 offset:24576
    v_cvt_pk_bf16_f32 v70, v44, v45
    v_mfma_f32_16x16x32_bf16 v[52:55], a[80:83], a[32:35], v[88:91]
    s_add_u32 s82, s82, 16384
    v_mfma_f32_16x16x32_bf16 v[60:63], a[80:83], a[48:51], v[92:95]
    ds_read_b128 a[80:83], v4 offset:28672
    v_cvt_pk_bf16_f32 v71, v46, v47
    v_mfma_f32_16x16x32_bf16 v[52:55], a[84:87], a[36:39], v[52:55]
    v_exp_f32 v48, v48
    v_mfma_f32_16x16x32_bf16 v[60:63], a[84:87], a[52:55], v[60:63]
    ds_read_b128 a[84:87], v5 offset:28672
    v_xor_b32 v22, 0, v122
    v_mfma_f32_16x16x32_bf16 v[52:55], a[88:91], a[40:43], v[52:55]
    v_exp_f32 v49, v49
    v_mfma_f32_16x16x32_bf16 v[60:63], a[88:91], a[56:59], v[60:63]
    ds_read_b128 a[88:91], v6 offset:28672
    v_xor_b32 v23, 64, v122
    v_mfma_f32_16x16x32_bf16 v[52:55], a[92:95], a[44:47], v[52:55]
    v_exp_f32 v50, v50
    v_mfma_f32_16x16x32_bf16 v[60:63], a[92:95], a[60:63], v[60:63]
    ds_read_b128 a[92:95], v7 offset:28672
    s_waitcnt lgkmcnt(8)
    v_mfma_f32_16x16x32_bf16 v[128:131], a[96:99], v[64:67], v[128:131]
    v_exp_f32 v51, v51
    v_mfma_f32_16x16x32_bf16 v[160:163], a[96:99], v[68:71], v[160:163]
    v_cvt_pk_bf16_f32 v72, v48, v49
    v_cvt_pk_bf16_f32 v73, v50, v51
    v_mfma_f32_16x16x32_bf16 v[132:135], a[100:103], v[64:67], v[132:135]
    v_exp_f32 v56, v56
    v_mfma_f32_16x16x32_bf16 v[164:167], a[100:103], v[68:71], v[164:167]
    s_waitcnt vmcnt(10)
    ds_read_b128 v[32:35], v121 offset:0
    v_mfma_f32_16x16x32_bf16 v[136:139], a[104:107], v[64:67], v[136:139]
    v_exp_f32 v57, v57
    v_mfma_f32_16x16x32_bf16 v[168:171], a[104:107], v[68:71], v[168:171]
    v_cvt_pk_bf16_f32 v76, v56, v57
    ds_read_b128 v[36:39], v121 offset:1024
    v_mfma_f32_16x16x32_bf16 v[140:143], a[108:111], v[64:67], v[140:143]
    v_exp_f32 v58, v58
    v_mfma_f32_16x16x32_bf16 v[172:175], a[108:111], v[68:71], v[172:175]
    ds_read_b128 v[40:43], v121 offset:2048
    ds_read_b128 v[44:47], v121 offset:3072
    v_mfma_f32_16x16x32_bf16 v[144:147], a[112:115], v[64:67], v[144:147]
    v_exp_f32 v59, v59
    v_mfma_f32_16x16x32_bf16 v[176:179], a[112:115], v[68:71], v[176:179]
    v_cvt_pk_bf16_f32 v77, v58, v59
    v_xor_b32 v24, 128, v122
    v_mfma_f32_16x16x32_bf16 v[148:151], a[116:119], v[64:67], v[148:151]
    v_exp_f32 v52, v52
    v_mfma_f32_16x16x32_bf16 v[180:183], a[116:119], v[68:71], v[180:183]
    ds_read_b64_tr_b16 v[48:49], v22 offset:0
    ds_read_b64_tr_b16 v[50:51], v22 offset:1024
    v_mfma_f32_16x16x32_bf16 v[152:155], a[120:123], v[64:67], v[152:155]
    v_exp_f32 v53, v53
    v_mfma_f32_16x16x32_bf16 v[184:187], a[120:123], v[68:71], v[184:187]
    ds_read_b64_tr_b16 v[56:57], v22 offset:8
    ds_read_b64_tr_b16 v[58:59], v22 offset:1032
    v_mfma_f32_16x16x32_bf16 v[156:159], a[124:127], v[64:67], v[156:159]
    v_exp_f32 v54, v54
    v_mfma_f32_16x16x32_bf16 v[188:191], a[124:127], v[68:71], v[188:191]
    v_xor_b32 v25, 192, v122
    v_mfma_f32_16x16x32_bf16 v[96:99], v[112:115], v[64:67], v[96:99]
    v_exp_f32 v55, v55
    v_mfma_f32_16x16x32_bf16 v[100:103], v[112:115], v[68:71], v[100:103]
    s_waitcnt lgkmcnt(2)
    v_mfma_f32_16x16x32_bf16 a[128:131], v[48:51], v[32:35], 0
    ds_read_b64_tr_b16 v[64:65], v23 offset:0
    ds_read_b64_tr_b16 v[66:67], v23 offset:1024
    v_mfma_f32_16x16x32_bf16 a[160:163], v[48:51], v[36:39], 0
    s_add_u32 m0, s24, 131072
    s_add_u32 s72, s70, 0
    v_mfma_f32_16x16x32_bf16 a[192:195], v[48:51], v[40:43], 0
    buffer_load_dwordx4 v18, s[32:35], s72 offen lds
    v_mfma_f32_16x16x32_bf16 a[224:227], v[48:51], v[44:47], 0
    s_waitcnt lgkmcnt(2)
    v_mfma_f32_16x16x32_bf16 a[132:135], v[56:59], v[32:35], 0
    ds_read_b64_tr_b16 v[68:69], v23 offset:8
    ds_read_b64_tr_b16 v[70:71], v23 offset:1032
    v_mfma_f32_16x16x32_bf16 a[164:167], v[56:59], v[36:39], 0
    v_mfma_f32_16x16x32_bf16 a[196:199], v[56:59], v[40:43], 0
    v_mfma_f32_16x16x32_bf16 a[228:231], v[56:59], v[44:47], 0
    s_waitcnt lgkmcnt(2)
    v_mfma_f32_16x16x32_bf16 a[136:139], v[64:67], v[32:35], 0
    ds_read_b64_tr_b16 v[48:49], v24 offset:0
    ds_read_b64_tr_b16 v[50:51], v24 offset:1024
    v_mfma_f32_16x16x32_bf16 a[168:171], v[64:67], v[36:39], 0
    s_add_u32 m0, s24, 132096
    s_add_u32 s72, s70, 16384
    v_mfma_f32_16x16x32_bf16 a[200:203], v[64:67], v[40:43], 0
    buffer_load_dwordx4 v18, s[32:35], s72 offen lds
    v_mfma_f32_16x16x32_bf16 a[232:235], v[64:67], v[44:47], 0
    s_waitcnt lgkmcnt(2)
    v_mfma_f32_16x16x32_bf16 a[140:143], v[68:71], v[32:35], 0
    ds_read_b64_tr_b16 v[56:57], v24 offset:8
    ds_read_b64_tr_b16 v[58:59], v24 offset:1032
    v_mfma_f32_16x16x32_bf16 a[172:175], v[68:71], v[36:39], 0
    v_mfma_f32_16x16x32_bf16 a[204:207], v[68:71], v[40:43], 0
    v_mfma_f32_16x16x32_bf16 a[236:239], v[68:71], v[44:47], 0
    s_waitcnt lgkmcnt(2)
    v_mfma_f32_16x16x32_bf16 a[144:147], v[48:51], v[32:35], 0
    ds_read_b64_tr_b16 v[64:65], v25 offset:0
    ds_read_b64_tr_b16 v[66:67], v25 offset:1024
    v_mfma_f32_16x16x32_bf16 a[176:179], v[48:51], v[36:39], 0
    s_add_u32 m0, s24, 133120
    s_add_u32 s72, s70, 32768
    v_mfma_f32_16x16x32_bf16 a[208:211], v[48:51], v[40:43], 0
    buffer_load_dwordx4 v18, s[32:35], s72 offen lds
    v_mfma_f32_16x16x32_bf16 a[240:243], v[48:51], v[44:47], 0
    s_waitcnt lgkmcnt(2)
    v_mfma_f32_16x16x32_bf16 a[148:151], v[56:59], v[32:35], 0
    ds_read_b64_tr_b16 v[68:69], v25 offset:8
    ds_read_b64_tr_b16 v[70:71], v25 offset:1032
    v_mfma_f32_16x16x32_bf16 a[180:183], v[56:59], v[36:39], 0
    v_mfma_f32_16x16x32_bf16 a[212:215], v[56:59], v[40:43], 0
    v_mfma_f32_16x16x32_bf16 a[244:247], v[56:59], v[44:47], 0
    s_waitcnt lgkmcnt(2)
    v_mfma_f32_16x16x32_bf16 a[152:155], v[64:67], v[32:35], 0
    s_add_u32 m0, s24, 134144
    s_add_u32 s72, s70, 49152
    v_mfma_f32_16x16x32_bf16 a[184:187], v[64:67], v[36:39], 0
    buffer_load_dwordx4 v18, s[32:35], s72 offen lds
    s_add_u32 s70, s70, 64
    v_mfma_f32_16x16x32_bf16 a[216:219], v[64:67], v[40:43], 0
    v_mfma_f32_16x16x32_bf16 a[248:251], v[64:67], v[44:47], 0
    s_waitcnt lgkmcnt(0)
    v_mfma_f32_16x16x32_bf16 a[156:159], v[68:71], v[32:35], 0
    v_mfma_f32_16x16x32_bf16 a[188:191], v[68:71], v[36:39], 0
    v_mfma_f32_16x16x32_bf16 a[220:223], v[68:71], v[40:43], 0
    v_mfma_f32_16x16x32_bf16 a[252:255], v[68:71], v[44:47], 0
    s_mov_b32 s27, 4
    s_branch L_loop1_s2
L_loop1:
    s_waitcnt vmcnt(12) lgkmcnt(0)
    s_barrier
    v_mfma_f32_16x16x32_bf16 v[32:35], a[64:67], a[0:3], v[80:83]
    v_exp_f32 v60, v60
    v_mfma_f32_16x16x32_bf16 v[40:43], a[64:67], a[16:19], v[84:87]
    v_cvt_pk_bf16_f32 v74, v52, v53
    s_lshr_b32 s74, s24, 1
    v_mfma_f32_16x16x32_bf16 v[32:35], a[68:71], a[4:7], v[32:35]
    v_exp_f32 v61, v61
    v_mfma_f32_16x16x32_bf16 v[40:43], a[68:71], a[20:23], v[40:43]
    v_cvt_pk_bf16_f32 v75, v54, v55
    v_cvt_pk_bf16_f32 v78, v60, v61
    v_mfma_f32_16x16x32_bf16 v[32:35], a[72:75], a[8:11], v[32:35]
    v_exp_f32 v62, v62
    v_mfma_f32_16x16x32_bf16 v[40:43], a[72:75], a[24:27], v[40:43]
    s_add_u32 m0, s74, 155648
    s_add_u32 s72, s71, 32768
    v_mfma_f32_16x16x32_bf16 v[32:35], a[76:79], a[12:15], v[32:35]
    v_exp_f32 v63, v63
    v_mfma_f32_16x16x32_bf16 v[40:43], a[76:79], a[28:31], v[40:43]
    v_cvt_pk_bf16_f32 v79, v62, v63
    buffer_load_dwordx4 v19, s[36:39], s71 offen lds
    v_mfma_f32_16x16x32_bf16 v[36:39], a[80:83], a[0:3], v[80:83]
    s_add_u32 m0, s74, 156672
    v_mfma_f32_16x16x32_bf16 v[44:47], a[80:83], a[16:19], v[84:87]
    s_add_u32 s71, s71, 262144
    v_mfma_f32_16x16x32_bf16 v[36:39], a[84:87], a[4:7], v[36:39]
    v_exp_f32 v32, v32
    v_mfma_f32_16x16x32_bf16 v[44:47], a[84:87], a[20:23], v[44:47]
    buffer_load_dwordx4 v19, s[36:39], s72 offen lds
    v_mfma_f32_16x16x32_bf16 v[36:39], a[88:91], a[8:11], v[36:39]
    v_exp_f32 v33, v33
    v_mfma_f32_16x16x32_bf16 v[44:47], a[88:91], a[24:27], v[44:47]
    v_cvt_pk_bf16_f32 v64, v32, v33
    s_add_u32 m0, s80, 65536
    v_mfma_f32_16x16x32_bf16 v[36:39], a[92:95], a[12:15], v[36:39]
    v_exp_f32 v34, v34
    v_mfma_f32_16x16x32_bf16 v[44:47], a[92:95], a[28:31], v[44:47]
    buffer_load_dwordx4 v20, s[12:15], s25 offen nt lds
    s_add_u32 m0, s80, 69632
    v_mfma_f32_16x16x32_bf16 v[192:195], a[96:99], v[72:75], v[192:195]
    v_exp_f32 v35, v35
    v_mfma_f32_16x16x32_bf16 v[224:227], a[96:99], v[76:79], v[224:227]
    ds_read_b64_tr_b16 a[96:97], v8 offset:16384
    ds_read_b64_tr_b16 a[98:99], v8 offset:20480
    v_mfma_f32_16x16x32_bf16 v[196:199], a[100:103], v[72:75], v[196:199]
    v_exp_f32 v40, v40
    v_mfma_f32_16x16x32_bf16 v[228:231], a[100:103], v[76:79], v[228:231]
    ds_read_b64_tr_b16 a[100:101], v9 offset:16384
    ds_read_b64_tr_b16 a[102:103], v9 offset:20480
    v_mfma_f32_16x16x32_bf16 v[200:203], a[104:107], v[72:75], v[200:203]
    v_exp_f32 v41, v41
    v_mfma_f32_16x16x32_bf16 v[232:235], a[104:107], v[76:79], v[232:235]
    ds_read_b64_tr_b16 a[104:105], v10 offset:16384
    ds_read_b64_tr_b16 a[106:107], v10 offset:20480
    v_mfma_f32_16x16x32_bf16 v[204:207], a[108:111], v[72:75], v[204:207]
    v_exp_f32 v42, v42
    v_mfma_f32_16x16x32_bf16 v[236:239], a[108:111], v[76:79], v[236:239]
    ds_read_b64_tr_b16 a[108:109], v11 offset:16384
    ds_read_b64_tr_b16 a[110:111], v11 offset:20480
    v_mfma_f32_16x16x32_bf16 v[208:211], a[112:115], v[72:75], v[208:211]
    v_exp_f32 v43, v43
    v_mfma_f32_16x16x32_bf16 v[240:243], a[112:115], v[76:79], v[240:243]
    ds_read_b64_tr_b16 a[112:113], v12 offset:16384
    ds_read_b64_tr_b16 a[114:115], v12 offset:20480
    v_mfma_f32_16x16x32_bf16 v[212:215], a[116:119], v[72:75], v[212:215]
    v_exp_f32 v36, v36
    v_mfma_f32_16x16x32_bf16 v[244:247], a[116:119], v[76:79], v[244:247]
    ds_read_b64_tr_b16 a[116:117], v13 offset:16384
    ds_read_b64_tr_b16 a[118:119], v13 offset:20480
    v_mfma_f32_16x16x32_bf16 v[216:219], a[120:123], v[72:75], v[216:219]
    v_exp_f32 v37, v37
    v_mfma_f32_16x16x32_bf16 v[248:251], a[120:123], v[76:79], v[248:251]
    ds_read_b64_tr_b16 a[120:121], v14 offset:16384
    ds_read_b64_tr_b16 a[122:123], v14 offset:20480
    v_mfma_f32_16x16x32_bf16 v[220:223], a[124:127], v[72:75], v[220:223]
    v_exp_f32 v38, v38
    v_mfma_f32_16x16x32_bf16 v[252:255], a[124:127], v[76:79], v[252:255]
    ds_read_b64_tr_b16 a[124:125], v15 offset:16384
    ds_read_b64_tr_b16 a[126:127], v15 offset:20480
    v_mfma_f32_16x16x32_bf16 v[104:107], v[112:115], v[72:75], v[104:107]
    v_exp_f32 v39, v39
    v_mfma_f32_16x16x32_bf16 v[108:111], v[112:115], v[76:79], v[108:111]
    v_cvt_pk_bf16_f32 v65, v34, v35
    v_cvt_pk_bf16_f32 v68, v40, v41
    v_mfma_f32_16x16x32_bf16 v[48:51], a[64:67], a[32:35], v[88:91]
    v_exp_f32 v44, v44
    v_mfma_f32_16x16x32_bf16 v[56:59], a[64:67], a[48:51], v[92:95]
    ds_read_b128 a[64:67], v4 offset:16384
    v_cvt_pk_bf16_f32 v69, v42, v43
    v_mfma_f32_16x16x32_bf16 v[48:51], a[68:71], a[36:39], v[48:51]
    v_exp_f32 v45, v45
    v_mfma_f32_16x16x32_bf16 v[56:59], a[68:71], a[52:55], v[56:59]
    ds_read_b128 a[68:71], v5 offset:16384
    v_cvt_pk_bf16_f32 v66, v36, v37
    v_mfma_f32_16x16x32_bf16 v[48:51], a[72:75], a[40:43], v[48:51]
    v_exp_f32 v46, v46
    v_mfma_f32_16x16x32_bf16 v[56:59], a[72:75], a[56:59], v[56:59]
    ds_read_b128 a[72:75], v6 offset:16384
    v_cvt_pk_bf16_f32 v67, v38, v39
    v_mfma_f32_16x16x32_bf16 v[48:51], a[76:79], a[44:47], v[48:51]
    v_exp_f32 v47, v47
    v_mfma_f32_16x16x32_bf16 v[56:59], a[76:79], a[60:63], v[56:59]
    ds_read_b128 a[76:79], v7 offset:16384
    v_cvt_pk_bf16_f32 v70, v44, v45
    v_mfma_f32_16x16x32_bf16 v[52:55], a[80:83], a[32:35], v[88:91]
    buffer_load_dwordx4 v21, s[12:15], s25 offen nt lds
    v_mfma_f32_16x16x32_bf16 v[60:63], a[80:83], a[48:51], v[92:95]
    ds_read_b128 a[80:83], v4 offset:20480
    v_cvt_pk_bf16_f32 v71, v46, v47
    v_mfma_f32_16x16x32_bf16 v[52:55], a[84:87], a[36:39], v[52:55]
    v_exp_f32 v48, v48
    v_mfma_f32_16x16x32_bf16 v[60:63], a[84:87], a[52:55], v[60:63]
    ds_read_b128 a[84:87], v5 offset:20480
    s_add_u32 m0, s80, 73728
    v_mfma_f32_16x16x32_bf16 v[52:55], a[88:91], a[40:43], v[52:55]
    v_exp_f32 v49, v49
    v_mfma_f32_16x16x32_bf16 v[60:63], a[88:91], a[56:59], v[60:63]
    ds_read_b128 a[88:91], v6 offset:20480
    buffer_load_dwordx4 v20, s[12:15], s81 offen nt lds
    v_mfma_f32_16x16x32_bf16 v[52:55], a[92:95], a[44:47], v[52:55]
    v_exp_f32 v50, v50
    v_mfma_f32_16x16x32_bf16 v[60:63], a[92:95], a[60:63], v[60:63]
    ds_read_b128 a[92:95], v7 offset:20480
    s_waitcnt lgkmcnt(8)
    v_mfma_f32_16x16x32_bf16 v[128:131], a[96:99], v[64:67], v[128:131]
    v_exp_f32 v51, v51
    v_mfma_f32_16x16x32_bf16 v[160:163], a[96:99], v[68:71], v[160:163]
    v_cvt_pk_bf16_f32 v72, v48, v49
    v_cvt_pk_bf16_f32 v73, v50, v51
    v_mfma_f32_16x16x32_bf16 v[132:135], a[100:103], v[64:67], v[132:135]
    v_exp_f32 v56, v56
    v_mfma_f32_16x16x32_bf16 v[164:167], a[100:103], v[68:71], v[164:167]
    s_add_u32 m0, s80, 77824
    v_mfma_f32_16x16x32_bf16 v[136:139], a[104:107], v[64:67], v[136:139]
    v_exp_f32 v57, v57
    v_mfma_f32_16x16x32_bf16 v[168:171], a[104:107], v[68:71], v[168:171]
    v_cvt_pk_bf16_f32 v76, v56, v57
    v_mfma_f32_16x16x32_bf16 v[140:143], a[108:111], v[64:67], v[140:143]
    v_exp_f32 v58, v58
    v_mfma_f32_16x16x32_bf16 v[172:175], a[108:111], v[68:71], v[172:175]
    buffer_load_dwordx4 v21, s[12:15], s81 offen nt lds
    v_mfma_f32_16x16x32_bf16 v[144:147], a[112:115], v[64:67], v[144:147]
    v_exp_f32 v59, v59
    v_mfma_f32_16x16x32_bf16 v[176:179], a[112:115], v[68:71], v[176:179]
    v_cvt_pk_bf16_f32 v77, v58, v59
    s_add_u32 s25, s25, 16384
    v_mfma_f32_16x16x32_bf16 v[148:151], a[116:119], v[64:67], v[148:151]
    v_exp_f32 v52, v52
    v_mfma_f32_16x16x32_bf16 v[180:183], a[116:119], v[68:71], v[180:183]
    s_add_u32 s81, s81, 16384
    s_add_u32 m0, s80, 0
    v_mfma_f32_16x16x32_bf16 v[152:155], a[120:123], v[64:67], v[152:155]
    v_exp_f32 v53, v53
    v_mfma_f32_16x16x32_bf16 v[184:187], a[120:123], v[68:71], v[184:187]
    buffer_load_dwordx4 v16, s[8:11], s26 offen nt lds
    v_mfma_f32_16x16x32_bf16 v[156:159], a[124:127], v[64:67], v[156:159]
    v_exp_f32 v54, v54
    v_mfma_f32_16x16x32_bf16 v[188:191], a[124:127], v[68:71], v[188:191]
    s_add_u32 m0, s80, 4096
    v_mfma_f32_16x16x32_bf16 v[96:99], v[112:115], v[64:67], v[96:99]
    v_exp_f32 v55, v55
    v_mfma_f32_16x16x32_bf16 v[100:103], v[112:115], v[68:71], v[100:103]
    s_waitcnt lgkmcnt(0)
    v_mfma_f32_16x16x32_bf16 v[32:35], a[64:67], a[0:3], v[80:83]
    v_exp_f32 v60, v60
    v_mfma_f32_16x16x32_bf16 v[40:43], a[64:67], a[16:19], v[84:87]
    v_cvt_pk_bf16_f32 v74, v52, v53
    v_mfma_f32_16x16x32_bf16 v[32:35], a[68:71], a[4:7], v[32:35]
    v_exp_f32 v61, v61
    v_mfma_f32_16x16x32_bf16 v[40:43], a[68:71], a[20:23], v[40:43]
    v_cvt_pk_bf16_f32 v75, v54, v55
    v_cvt_pk_bf16_f32 v78, v60, v61
    v_mfma_f32_16x16x32_bf16 v[32:35], a[72:75], a[8:11], v[32:35]
    v_exp_f32 v62, v62
    v_mfma_f32_16x16x32_bf16 v[40:43], a[72:75], a[24:27], v[40:43]
    buffer_load_dwordx4 v17, s[8:11], s26 offen nt lds
    v_mfma_f32_16x16x32_bf16 v[32:35], a[76:79], a[12:15], v[32:35]
    v_exp_f32 v63, v63
    v_mfma_f32_16x16x32_bf16 v[40:43], a[76:79], a[28:31], v[40:43]
    v_cvt_pk_bf16_f32 v79, v62, v63
    v_mfma_f32_16x16x32_bf16 v[36:39], a[80:83], a[0:3], v[80:83]
    v_mfma_f32_16x16x32_bf16 v[44:47], a[80:83], a[16:19], v[84:87]
    s_add_u32 m0, s80, 8192
    v_mfma_f32_16x16x32_bf16 v[36:39], a[84:87], a[4:7], v[36:39]
    v_exp_f32 v32, v32
    v_mfma_f32_16x16x32_bf16 v[44:47], a[84:87], a[20:23], v[44:47]
    buffer_load_dwordx4 v16, s[8:11], s82 offen nt lds
    v_mfma_f32_16x16x32_bf16 v[36:39], a[88:91], a[8:11], v[36:39]
    v_exp_f32 v33, v33
    v_mfma_f32_16x16x32_bf16 v[44:47], a[88:91], a[24:27], v[44:47]
    v_cvt_pk_bf16_f32 v64, v32, v33
    s_add_u32 m0, s80, 12288
    v_mfma_f32_16x16x32_bf16 v[36:39], a[92:95], a[12:15], v[36:39]
    v_exp_f32 v34, v34
    v_mfma_f32_16x16x32_bf16 v[44:47], a[92:95], a[28:31], v[44:47]
    buffer_load_dwordx4 v17, s[8:11], s82 offen nt lds
    s_add_u32 s26, s26, 16384
    v_mfma_f32_16x16x32_bf16 v[192:195], a[96:99], v[72:75], v[192:195]
    v_exp_f32 v35, v35
    v_mfma_f32_16x16x32_bf16 v[224:227], a[96:99], v[76:79], v[224:227]
    ds_read_b64_tr_b16 a[96:97], v8 offset:24576
    ds_read_b64_tr_b16 a[98:99], v8 offset:28672
    v_mfma_f32_16x16x32_bf16 v[196:199], a[100:103], v[72:75], v[196:199]
    v_exp_f32 v40, v40
    v_mfma_f32_16x16x32_bf16 v[228:231], a[100:103], v[76:79], v[228:231]
    ds_read_b64_tr_b16 a[100:101], v9 offset:24576
    ds_read_b64_tr_b16 a[102:103], v9 offset:28672
    v_mfma_f32_16x16x32_bf16 v[200:203], a[104:107], v[72:75], v[200:203]
    v_exp_f32 v41, v41
    v_mfma_f32_16x16x32_bf16 v[232:235], a[104:107], v[76:79], v[232:235]
    ds_read_b64_tr_b16 a[104:105], v10 offset:24576
    ds_read_b64_tr_b16 a[106:107], v10 offset:28672
    v_mfma_f32_16x16x32_bf16 v[204:207], a[108:111], v[72:75], v[204:207]
    v_exp_f32 v42, v42
    v_mfma_f32_16x16x32_bf16 v[236:239], a[108:111], v[76:79], v[236:239]
    ds_read_b64_tr_b16 a[108:109], v11 offset:24576
    ds_read_b64_tr_b16 a[110:111], v11 offset:28672
    v_mfma_f32_16x16x32_bf16 v[208:211], a[112:115], v[72:75], v[208:211]
    v_exp_f32 v43, v43
    v_mfma_f32_16x16x32_bf16 v[240:243], a[112:115], v[76:79], v[240:243]
    ds_read_b64_tr_b16 a[112:113], v12 offset:24576
    ds_read_b64_tr_b16 a[114:115], v12 offset:28672
    v_mfma_f32_16x16x32_bf16 v[212:215], a[116:119], v[72:75], v[212:215]
    v_exp_f32 v36, v36
    v_mfma_f32_16x16x32_bf16 v[244:247], a[116:119], v[76:79], v[244:247]
    ds_read_b64_tr_b16 a[116:117], v13 offset:24576
    ds_read_b64_tr_b16 a[118:119], v13 offset:28672
    v_mfma_f32_16x16x32_bf16 v[216:219], a[120:123], v[72:75], v[216:219]
    v_exp_f32 v37, v37
    v_mfma_f32_16x16x32_bf16 v[248:251], a[120:123], v[76:79], v[248:251]
    ds_read_b64_tr_b16 a[120:121], v14 offset:24576
    ds_read_b64_tr_b16 a[122:123], v14 offset:28672
    v_mfma_f32_16x16x32_bf16 v[220:223], a[124:127], v[72:75], v[220:223]
    v_exp_f32 v38, v38
    v_mfma_f32_16x16x32_bf16 v[252:255], a[124:127], v[76:79], v[252:255]
    ds_read_b64_tr_b16 a[124:125], v15 offset:24576
    ds_read_b64_tr_b16 a[126:127], v15 offset:28672
    v_mfma_f32_16x16x32_bf16 v[104:107], v[112:115], v[72:75], v[104:107]
    v_exp_f32 v39, v39
    v_mfma_f32_16x16x32_bf16 v[108:111], v[112:115], v[76:79], v[108:111]
    v_cvt_pk_bf16_f32 v65, v34, v35
    v_cvt_pk_bf16_f32 v68, v40, v41
    v_mfma_f32_16x16x32_bf16 v[48:51], a[64:67], a[32:35], v[88:91]
    v_exp_f32 v44, v44
    v_mfma_f32_16x16x32_bf16 v[56:59], a[64:67], a[48:51], v[92:95]
    ds_read_b128 a[64:67], v4 offset:24576
    v_cvt_pk_bf16_f32 v69, v42, v43
    v_mfma_f32_16x16x32_bf16 v[48:51], a[68:71], a[36:39], v[48:51]
    v_exp_f32 v45, v45
    v_mfma_f32_16x16x32_bf16 v[56:59], a[68:71], a[52:55], v[56:59]
    ds_read_b128 a[68:71], v5 offset:24576
    v_cvt_pk_bf16_f32 v66, v36, v37
    v_mfma_f32_16x16x32_bf16 v[48:51], a[72:75], a[40:43], v[48:51]
    v_exp_f32 v46, v46
    v_mfma_f32_16x16x32_bf16 v[56:59], a[72:75], a[56:59], v[56:59]
    ds_read_b128 a[72:75], v6 offset:24576
    v_cvt_pk_bf16_f32 v67, v38, v39
    v_mfma_f32_16x16x32_bf16 v[48:51], a[76:79], a[44:47], v[48:51]
    v_exp_f32 v47, v47
    v_mfma_f32_16x16x32_bf16 v[56:59], a[76:79], a[60:63], v[56:59]
    ds_read_b128 a[76:79], v7 offset:24576
    v_cvt_pk_bf16_f32 v70, v44, v45
    v_mfma_f32_16x16x32_bf16 v[52:55], a[80:83], a[32:35], v[88:91]
    s_add_u32 s82, s82, 16384
    v_mfma_f32_16x16x32_bf16 v[60:63], a[80:83], a[48:51], v[92:95]
    ds_read_b128 a[80:83], v4 offset:28672
    v_cvt_pk_bf16_f32 v71, v46, v47
    v_mfma_f32_16x16x32_bf16 v[52:55], a[84:87], a[36:39], v[52:55]
    v_exp_f32 v48, v48
    v_mfma_f32_16x16x32_bf16 v[60:63], a[84:87], a[52:55], v[60:63]
    ds_read_b128 a[84:87], v5 offset:28672
    v_xor_b32 v22, 0, v122
    v_mfma_f32_16x16x32_bf16 v[52:55], a[88:91], a[40:43], v[52:55]
    v_exp_f32 v49, v49
    v_mfma_f32_16x16x32_bf16 v[60:63], a[88:91], a[56:59], v[60:63]
    ds_read_b128 a[88:91], v6 offset:28672
    v_xor_b32 v23, 64, v122
    v_mfma_f32_16x16x32_bf16 v[52:55], a[92:95], a[44:47], v[52:55]
    v_exp_f32 v50, v50
    v_mfma_f32_16x16x32_bf16 v[60:63], a[92:95], a[60:63], v[60:63]
    ds_read_b128 a[92:95], v7 offset:28672
    s_waitcnt lgkmcnt(8)
    v_mfma_f32_16x16x32_bf16 v[128:131], a[96:99], v[64:67], v[128:131]
    v_exp_f32 v51, v51
    v_mfma_f32_16x16x32_bf16 v[160:163], a[96:99], v[68:71], v[160:163]
    v_cvt_pk_bf16_f32 v72, v48, v49
    v_cvt_pk_bf16_f32 v73, v50, v51
    v_mfma_f32_16x16x32_bf16 v[132:135], a[100:103], v[64:67], v[132:135]
    v_exp_f32 v56, v56
    v_mfma_f32_16x16x32_bf16 v[164:167], a[100:103], v[68:71], v[164:167]
    s_waitcnt vmcnt(10)
    ds_read_b128 v[32:35], v121 offset:0
    v_mfma_f32_16x16x32_bf16 v[136:139], a[104:107], v[64:67], v[136:139]
    v_exp_f32 v57, v57
    v_mfma_f32_16x16x32_bf16 v[168:171], a[104:107], v[68:71], v[168:171]
    v_cvt_pk_bf16_f32 v76, v56, v57
    ds_read_b128 v[36:39], v121 offset:1024
    v_mfma_f32_16x16x32_bf16 v[140:143], a[108:111], v[64:67], v[140:143]
    v_exp_f32 v58, v58
    v_mfma_f32_16x16x32_bf16 v[172:175], a[108:111], v[68:71], v[172:175]
    ds_read_b128 v[40:43], v121 offset:2048
    ds_read_b128 v[44:47], v121 offset:3072
    v_mfma_f32_16x16x32_bf16 v[144:147], a[112:115], v[64:67], v[144:147]
    v_exp_f32 v59, v59
    v_mfma_f32_16x16x32_bf16 v[176:179], a[112:115], v[68:71], v[176:179]
    v_cvt_pk_bf16_f32 v77, v58, v59
    v_xor_b32 v24, 128, v122
    v_mfma_f32_16x16x32_bf16 v[148:151], a[116:119], v[64:67], v[148:151]
    v_exp_f32 v52, v52
    v_mfma_f32_16x16x32_bf16 v[180:183], a[116:119], v[68:71], v[180:183]
    ds_read_b64_tr_b16 v[48:49], v22 offset:0
    ds_read_b64_tr_b16 v[50:51], v22 offset:1024
    v_mfma_f32_16x16x32_bf16 v[152:155], a[120:123], v[64:67], v[152:155]
    v_exp_f32 v53, v53
    v_mfma_f32_16x16x32_bf16 v[184:187], a[120:123], v[68:71], v[184:187]
    ds_read_b64_tr_b16 v[56:57], v22 offset:8
    ds_read_b64_tr_b16 v[58:59], v22 offset:1032
    v_mfma_f32_16x16x32_bf16 v[156:159], a[124:127], v[64:67], v[156:159]
    v_exp_f32 v54, v54
    v_mfma_f32_16x16x32_bf16 v[188:191], a[124:127], v[68:71], v[188:191]
    v_xor_b32 v25, 192, v122
    v_mfma_f32_16x16x32_bf16 v[96:99], v[112:115], v[64:67], v[96:99]
    v_exp_f32 v55, v55
    v_mfma_f32_16x16x32_bf16 v[100:103], v[112:115], v[68:71], v[100:103]
    s_waitcnt lgkmcnt(2)
    v_mfma_f32_16x16x32_bf16 a[128:131], v[48:51], v[32:35], a[128:131]
    ds_read_b64_tr_b16 v[64:65], v23 offset:0
    ds_read_b64_tr_b16 v[66:67], v23 offset:1024
    v_mfma_f32_16x16x32_bf16 a[160:163], v[48:51], v[36:39], a[160:163]
    s_add_u32 m0, s24, 131072
    s_add_u32 s72, s70, 0
    v_mfma_f32_16x16x32_bf16 a[192:195], v[48:51], v[40:43], a[192:195]
    buffer_load_dwordx4 v18, s[32:35], s72 offen lds
    v_mfma_f32_16x16x32_bf16 a[224:227], v[48:51], v[44:47], a[224:227]
    s_waitcnt lgkmcnt(2)
    v_mfma_f32_16x16x32_bf16 a[132:135], v[56:59], v[32:35], a[132:135]
    ds_read_b64_tr_b16 v[68:69], v23 offset:8
    ds_read_b64_tr_b16 v[70:71], v23 offset:1032
    v_mfma_f32_16x16x32_bf16 a[164:167], v[56:59], v[36:39], a[164:167]
    v_mfma_f32_16x16x32_bf16 a[196:199], v[56:59], v[40:43], a[196:199]
    v_mfma_f32_16x16x32_bf16 a[228:231], v[56:59], v[44:47], a[228:231]
    s_waitcnt lgkmcnt(2)
    v_mfma_f32_16x16x32_bf16 a[136:139], v[64:67], v[32:35], a[136:139]
    ds_read_b64_tr_b16 v[48:49], v24 offset:0
    ds_read_b64_tr_b16 v[50:51], v24 offset:1024
    v_mfma_f32_16x16x32_bf16 a[168:171], v[64:67], v[36:39], a[168:171]
    s_add_u32 m0, s24, 132096
    s_add_u32 s72, s70, 16384
    v_mfma_f32_16x16x32_bf16 a[200:203], v[64:67], v[40:43], a[200:203]
    buffer_load_dwordx4 v18, s[32:35], s72 offen lds
    v_mfma_f32_16x16x32_bf16 a[232:235], v[64:67], v[44:47], a[232:235]
    s_waitcnt lgkmcnt(2)
    v_mfma_f32_16x16x32_bf16 a[140:143], v[68:71], v[32:35], a[140:143]
    ds_read_b64_tr_b16 v[56:57], v24 offset:8
    ds_read_b64_tr_b16 v[58:59], v24 offset:1032
    v_mfma_f32_16x16x32_bf16 a[172:175], v[68:71], v[36:39], a[172:175]
    v_mfma_f32_16x16x32_bf16 a[204:207], v[68:71], v[40:43], a[204:207]
    v_mfma_f32_16x16x32_bf16 a[236:239], v[68:71], v[44:47], a[236:239]
    s_waitcnt lgkmcnt(2)
    v_mfma_f32_16x16x32_bf16 a[144:147], v[48:51], v[32:35], a[144:147]
    ds_read_b64_tr_b16 v[64:65], v25 offset:0
    ds_read_b64_tr_b16 v[66:67], v25 offset:1024
    v_mfma_f32_16x16x32_bf16 a[176:179], v[48:51], v[36:39], a[176:179]
    s_add_u32 m0, s24, 133120
    s_add_u32 s72, s70, 32768
    v_mfma_f32_16x16x32_bf16 a[208:211], v[48:51], v[40:43], a[208:211]
    buffer_load_dwordx4 v18, s[32:35], s72 offen lds
    v_mfma_f32_16x16x32_bf16 a[240:243], v[48:51], v[44:47], a[240:243]
    s_waitcnt lgkmcnt(2)
    v_mfma_f32_16x16x32_bf16 a[148:151], v[56:59], v[32:35], a[148:151]
    ds_read_b64_tr_b16 v[68:69], v25 offset:8
    ds_read_b64_tr_b16 v[70:71], v25 offset:1032
    v_mfma_f32_16x16x32_bf16 a[180:183], v[56:59], v[36:39], a[180:183]
    v_mfma_f32_16x16x32_bf16 a[212:215], v[56:59], v[40:43], a[212:215]
    v_mfma_f32_16x16x32_bf16 a[244:247], v[56:59], v[44:47], a[244:247]
    s_waitcnt lgkmcnt(2)
    v_mfma_f32_16x16x32_bf16 a[152:155], v[64:67], v[32:35], a[152:155]
    s_add_u32 m0, s24, 134144
    s_add_u32 s72, s70, 49152
    v_mfma_f32_16x16x32_bf16 a[184:187], v[64:67], v[36:39], a[184:187]
    buffer_load_dwordx4 v18, s[32:35], s72 offen lds
    s_add_u32 s70, s70, 64
    v_mfma_f32_16x16x32_bf16 a[216:219], v[64:67], v[40:43], a[216:219]
    v_mfma_f32_16x16x32_bf16 a[248:251], v[64:67], v[44:47], a[248:251]
    s_waitcnt lgkmcnt(0)
    v_mfma_f32_16x16x32_bf16 a[156:159], v[68:71], v[32:35], a[156:159]
    v_mfma_f32_16x16x32_bf16 a[188:191], v[68:71], v[36:39], a[188:191]
    v_mfma_f32_16x16x32_bf16 a[220:223], v[68:71], v[40:43], a[220:223]
    v_mfma_f32_16x16x32_bf16 a[252:255], v[68:71], v[44:47], a[252:255]
L_loop1_s2:
    s_waitcnt vmcnt(12) lgkmcnt(0)
    s_barrier
    v_mfma_f32_16x16x32_bf16 v[32:35], a[64:67], a[0:3], v[80:83]
    v_exp_f32 v60, v60
    v_mfma_f32_16x16x32_bf16 v[40:43], a[64:67], a[16:19], v[84:87]
    v_cvt_pk_bf16_f32 v74, v52, v53
    s_lshr_b32 s74, s24, 1
    v_mfma_f32_16x16x32_bf16 v[32:35], a[68:71], a[4:7], v[32:35]
    v_exp_f32 v61, v61
    v_mfma_f32_16x16x32_bf16 v[40:43], a[68:71], a[20:23], v[40:43]
    v_cvt_pk_bf16_f32 v75, v54, v55
    v_cvt_pk_bf16_f32 v78, v60, v61
    v_mfma_f32_16x16x32_bf16 v[32:35], a[72:75], a[8:11], v[32:35]
    v_exp_f32 v62, v62
    v_mfma_f32_16x16x32_bf16 v[40:43], a[72:75], a[24:27], v[40:43]
    s_add_u32 m0, s74, 147456
    s_add_u32 s72, s71, 32768
    v_mfma_f32_16x16x32_bf16 v[32:35], a[76:79], a[12:15], v[32:35]
    v_exp_f32 v63, v63
    v_mfma_f32_16x16x32_bf16 v[40:43], a[76:79], a[28:31], v[40:43]
    v_cvt_pk_bf16_f32 v79, v62, v63
    buffer_load_dwordx4 v19, s[36:39], s71 offen lds
    v_mfma_f32_16x16x32_bf16 v[36:39], a[80:83], a[0:3], v[80:83]
    s_add_u32 m0, s74, 148480
    v_mfma_f32_16x16x32_bf16 v[44:47], a[80:83], a[16:19], v[84:87]
    s_add_u32 s71, s71, 262144
    v_mfma_f32_16x16x32_bf16 v[36:39], a[84:87], a[4:7], v[36:39]
    v_exp_f32 v32, v32
    v_mfma_f32_16x16x32_bf16 v[44:47], a[84:87], a[20:23], v[44:47]
    buffer_load_dwordx4 v19, s[36:39], s72 offen lds
    v_mfma_f32_16x16x32_bf16 v[36:39], a[88:91], a[8:11], v[36:39]
    v_exp_f32 v33, v33
    v_mfma_f32_16x16x32_bf16 v[44:47], a[88:91], a[24:27], v[44:47]
    v_cvt_pk_bf16_f32 v64, v32, v33
    s_add_u32 m0, s80, 81920
    v_mfma_f32_16x16x32_bf16 v[36:39], a[92:95], a[12:15], v[36:39]
    v_exp_f32 v34, v34
    v_mfma_f32_16x16x32_bf16 v[44:47], a[92:95], a[28:31], v[44:47]
    buffer_load_dwordx4 v20, s[12:15], s25 offen nt lds
    s_add_u32 m0, s80, 86016
    v_mfma_f32_16x16x32_bf16 v[192:195], a[96:99], v[72:75], v[192:195]
    v_exp_f32 v35, v35
    v_mfma_f32_16x16x32_bf16 v[224:227], a[96:99], v[76:79], v[224:227]
    ds_read_b64_tr_b16 a[96:97], v8 offset:32768
    ds_read_b64_tr_b16 a[98:99], v8 offset:36864
    v_mfma_f32_16x16x32_bf16 v[196:199], a[100:103], v[72:75], v[196:199]
    v_exp_f32 v40, v40
    v_mfma_f32_16x16x32_bf16 v[228:231], a[100:103], v[76:79], v[228:231]
    ds_read_b64_tr_b16 a[100:101], v9 offset:32768
    ds_read_b64_tr_b16 a[102:103], v9 offset:36864
    v_mfma_f32_16x16x32_bf16 v[200:203], a[104:107], v[72:75], v[200:203]
    v_exp_f32 v41, v41
    v_mfma_f32_16x16x32_bf16 v[232:235], a[104:107], v[76:79], v[232:235]
    ds_read_b64_tr_b16 a[104:105], v10 offset:32768
    ds_read_b64_tr_b16 a[106:107], v10 offset:36864
    v_mfma_f32_16x16x32_bf16 v[204:207], a[108:111], v[72:75], v[204:207]
    v_exp_f32 v42, v42
    v_mfma_f32_16x16x32_bf16 v[236:239], a[108:111], v[76:79], v[236:239]
    ds_read_b64_tr_b16 a[108:109], v11 offset:32768
    ds_read_b64_tr_b16 a[110:111], v11 offset:36864
    v_mfma_f32_16x16x32_bf16 v[208:211], a[112:115], v[72:75], v[208:211]
    v_exp_f32 v43, v43
    v_mfma_f32_16x16x32_bf16 v[240:243], a[112:115], v[76:79], v[240:243]
    ds_read_b64_tr_b16 a[112:113], v12 offset:32768
    ds_read_b64_tr_b16 a[114:115], v12 offset:36864
    v_mfma_f32_16x16x32_bf16 v[212:215], a[116:119], v[72:75], v[212:215]
    v_exp_f32 v36, v36
    v_mfma_f32_16x16x32_bf16 v[244:247], a[116:119], v[76:79], v[244:247]
    ds_read_b64_tr_b16 a[116:117], v13 offset:32768
    ds_read_b64_tr_b16 a[118:119], v13 offset:36864
    v_mfma_f32_16x16x32_bf16 v[216:219], a[120:123], v[72:75], v[216:219]
    v_exp_f32 v37, v37
    v_mfma_f32_16x16x32_bf16 v[248:251], a[120:123], v[76:79], v[248:251]
    ds_read_b64_tr_b16 a[120:121], v14 offset:32768
    ds_read_b64_tr_b16 a[122:123], v14 offset:36864
    v_mfma_f32_16x16x32_bf16 v[220:223], a[124:127], v[72:75], v[220:223]
    v_exp_f32 v38, v38
    v_mfma_f32_16x16x32_bf16 v[252:255], a[124:127], v[76:79], v[252:255]
    ds_read_b64_tr_b16 a[124:125], v15 offset:32768
    ds_read_b64_tr_b16 a[126:127], v15 offset:36864
    v_mfma_f32_16x16x32_bf16 v[104:107], v[112:115], v[72:75], v[104:107]
    v_exp_f32 v39, v39
    v_mfma_f32_16x16x32_bf16 v[108:111], v[112:115], v[76:79], v[108:111]
    v_cvt_pk_bf16_f32 v65, v34, v35
    v_cvt_pk_bf16_f32 v68, v40, v41
    v_mfma_f32_16x16x32_bf16 v[48:51], a[64:67], a[32:35], v[88:91]
    v_exp_f32 v44, v44
    v_mfma_f32_16x16x32_bf16 v[56:59], a[64:67], a[48:51], v[92:95]
    ds_read_b128 a[64:67], v4 offset:32768
    v_cvt_pk_bf16_f32 v69, v42, v43
    v_mfma_f32_16x16x32_bf16 v[48:51], a[68:71], a[36:39], v[48:51]
    v_exp_f32 v45, v45
    v_mfma_f32_16x16x32_bf16 v[56:59], a[68:71], a[52:55], v[56:59]
    ds_read_b128 a[68:71], v5 offset:32768
    v_cvt_pk_bf16_f32 v66, v36, v37
    v_mfma_f32_16x16x32_bf16 v[48:51], a[72:75], a[40:43], v[48:51]
    v_exp_f32 v46, v46
    v_mfma_f32_16x16x32_bf16 v[56:59], a[72:75], a[56:59], v[56:59]
    ds_read_b128 a[72:75], v6 offset:32768
    v_cvt_pk_bf16_f32 v67, v38, v39
    v_mfma_f32_16x16x32_bf16 v[48:51], a[76:79], a[44:47], v[48:51]
    v_exp_f32 v47, v47
    v_mfma_f32_16x16x32_bf16 v[56:59], a[76:79], a[60:63], v[56:59]
    ds_read_b128 a[76:79], v7 offset:32768
    v_cvt_pk_bf16_f32 v70, v44, v45
    v_mfma_f32_16x16x32_bf16 v[52:55], a[80:83], a[32:35], v[88:91]
    buffer_load_dwordx4 v21, s[12:15], s25 offen nt lds
    v_mfma_f32_16x16x32_bf16 v[60:63], a[80:83], a[48:51], v[92:95]
    ds_read_b128 a[80:83], v4 offset:36864
    v_cvt_pk_bf16_f32 v71, v46, v47
    v_mfma_f32_16x16x32_bf16 v[52:55], a[84:87], a[36:39], v[52:55]
    v_exp_f32 v48, v48
    v_mfma_f32_16x16x32_bf16 v[60:63], a[84:87], a[52:55], v[60:63]
    ds_read_b128 a[84:87], v5 offset:36864
    s_add_u32 m0, s80, 90112
    v_mfma_f32_16x16x32_bf16 v[52:55], a[88:91], a[40:43], v[52:55]
    v_exp_f32 v49, v49
    v_mfma_f32_16x16x32_bf16 v[60:63], a[88:91], a[56:59], v[60:63]
    ds_read_b128 a[88:91], v6 offset:36864
    buffer_load_dwordx4 v20, s[12:15], s81 offen nt lds
    v_mfma_f32_16x16x32_bf16 v[52:55], a[92:95], a[44:47], v[52:55]
    v_exp_f32 v50, v50
    v_mfma_f32_16x16x32_bf16 v[60:63], a[92:95], a[60:63], v[60:63]
    ds_read_b128 a[92:95], v7 offset:36864
    s_waitcnt lgkmcnt(8)
    v_mfma_f32_16x16x32_bf16 v[128:131], a[96:99], v[64:67], v[128:131]
    v_exp_f32 v51, v51
    v_mfma_f32_16x16x32_bf16 v[160:163], a[96:99], v[68:71], v[160:163]
    v_cvt_pk_bf16_f32 v72, v48, v49
    v_cvt_pk_bf16_f32 v73, v50, v51
    v_mfma_f32_16x16x32_bf16 v[132:135], a[100:103], v[64:67], v[132:135]
    v_exp_f32 v56, v56
    v_mfma_f32_16x16x32_bf16 v[164:167], a[100:103], v[68:71], v[164:167]
    s_add_u32 m0, s80, 94208
    v_mfma_f32_16x16x32_bf16 v[136:139], a[104:107], v[64:67], v[136:139]
    v_exp_f32 v57, v57
    v_mfma_f32_16x16x32_bf16 v[168:171], a[104:107], v[68:71], v[168:171]
    v_cvt_pk_bf16_f32 v76, v56, v57
    v_mfma_f32_16x16x32_bf16 v[140:143], a[108:111], v[64:67], v[140:143]
    v_exp_f32 v58, v58
    v_mfma_f32_16x16x32_bf16 v[172:175], a[108:111], v[68:71], v[172:175]
    buffer_load_dwordx4 v21, s[12:15], s81 offen nt lds
    v_mfma_f32_16x16x32_bf16 v[144:147], a[112:115], v[64:67], v[144:147]
    v_exp_f32 v59, v59
    v_mfma_f32_16x16x32_bf16 v[176:179], a[112:115], v[68:71], v[176:179]
    v_cvt_pk_bf16_f32 v77, v58, v59
    s_add_u32 s25, s25, 16384
    v_mfma_f32_16x16x32_bf16 v[148:151], a[116:119], v[64:67], v[148:151]
    v_exp_f32 v52, v52
    v_mfma_f32_16x16x32_bf16 v[180:183], a[116:119], v[68:71], v[180:183]
    s_add_u32 s81, s81, 16384
    s_add_u32 m0, s80, 16384
    v_mfma_f32_16x16x32_bf16 v[152:155], a[120:123], v[64:67], v[152:155]
    v_exp_f32 v53, v53
    v_mfma_f32_16x16x32_bf16 v[184:187], a[120:123], v[68:71], v[184:187]
    buffer_load_dwordx4 v16, s[8:11], s26 offen nt lds
    v_mfma_f32_16x16x32_bf16 v[156:159], a[124:127], v[64:67], v[156:159]
    v_exp_f32 v54, v54
    v_mfma_f32_16x16x32_bf16 v[188:191], a[124:127], v[68:71], v[188:191]
    s_add_u32 m0, s80, 20480
    v_mfma_f32_16x16x32_bf16 v[96:99], v[112:115], v[64:67], v[96:99]
    v_exp_f32 v55, v55
    v_mfma_f32_16x16x32_bf16 v[100:103], v[112:115], v[68:71], v[100:103]
    s_waitcnt lgkmcnt(0)
    v_mfma_f32_16x16x32_bf16 v[32:35], a[64:67], a[0:3], v[80:83]
    v_exp_f32 v60, v60
    v_mfma_f32_16x16x32_bf16 v[40:43], a[64:67], a[16:19], v[84:87]
    v_cvt_pk_bf16_f32 v74, v52, v53
    v_mfma_f32_16x16x32_bf16 v[32:35], a[68:71], a[4:7], v[32:35]
    v_exp_f32 v61, v61
    v_mfma_f32_16x16x32_bf16 v[40:43], a[68:71], a[20:23], v[40:43]
    v_cvt_pk_bf16_f32 v75, v54, v55
    v_cvt_pk_bf16_f32 v78, v60, v61
    v_mfma_f32_16x16x32_bf16 v[32:35], a[72:75], a[8:11], v[32:35]
    v_exp_f32 v62, v62
    v_mfma_f32_16x16x32_bf16 v[40:43], a[72:75], a[24:27], v[40:43]
    buffer_load_dwordx4 v17, s[8:11], s26 offen nt lds
    v_mfma_f32_16x16x32_bf16 v[32:35], a[76:79], a[12:15], v[32:35]
    v_exp_f32 v63, v63
    v_mfma_f32_16x16x32_bf16 v[40:43], a[76:79], a[28:31], v[40:43]
    v_cvt_pk_bf16_f32 v79, v62, v63
    v_mfma_f32_16x16x32_bf16 v[36:39], a[80:83], a[0:3], v[80:83]
    v_mfma_f32_16x16x32_bf16 v[44:47], a[80:83], a[16:19], v[84:87]
    s_add_u32 m0, s80, 24576
    v_mfma_f32_16x16x32_bf16 v[36:39], a[84:87], a[4:7], v[36:39]
    v_exp_f32 v32, v32
    v_mfma_f32_16x16x32_bf16 v[44:47], a[84:87], a[20:23], v[44:47]
    buffer_load_dwordx4 v16, s[8:11], s82 offen nt lds
    v_mfma_f32_16x16x32_bf16 v[36:39], a[88:91], a[8:11], v[36:39]
    v_exp_f32 v33, v33
    v_mfma_f32_16x16x32_bf16 v[44:47], a[88:91], a[24:27], v[44:47]
    v_cvt_pk_bf16_f32 v64, v32, v33
    s_add_u32 m0, s80, 28672
    v_mfma_f32_16x16x32_bf16 v[36:39], a[92:95], a[12:15], v[36:39]
    v_exp_f32 v34, v34
    v_mfma_f32_16x16x32_bf16 v[44:47], a[92:95], a[28:31], v[44:47]
    buffer_load_dwordx4 v17, s[8:11], s82 offen nt lds
    s_add_u32 s26, s26, 16384
    v_mfma_f32_16x16x32_bf16 v[192:195], a[96:99], v[72:75], v[192:195]
    v_exp_f32 v35, v35
    v_mfma_f32_16x16x32_bf16 v[224:227], a[96:99], v[76:79], v[224:227]
    ds_read_b64_tr_b16 a[96:97], v8 offset:40960
    ds_read_b64_tr_b16 a[98:99], v8 offset:45056
    v_mfma_f32_16x16x32_bf16 v[196:199], a[100:103], v[72:75], v[196:199]
    v_exp_f32 v40, v40
    v_mfma_f32_16x16x32_bf16 v[228:231], a[100:103], v[76:79], v[228:231]
    ds_read_b64_tr_b16 a[100:101], v9 offset:40960
    ds_read_b64_tr_b16 a[102:103], v9 offset:45056
    v_mfma_f32_16x16x32_bf16 v[200:203], a[104:107], v[72:75], v[200:203]
    v_exp_f32 v41, v41
    v_mfma_f32_16x16x32_bf16 v[232:235], a[104:107], v[76:79], v[232:235]
    ds_read_b64_tr_b16 a[104:105], v10 offset:40960
    ds_read_b64_tr_b16 a[106:107], v10 offset:45056
    v_mfma_f32_16x16x32_bf16 v[204:207], a[108:111], v[72:75], v[204:207]
    v_exp_f32 v42, v42
    v_mfma_f32_16x16x32_bf16 v[236:239], a[108:111], v[76:79], v[236:239]
    ds_read_b64_tr_b16 a[108:109], v11 offset:40960
    ds_read_b64_tr_b16 a[110:111], v11 offset:45056
    v_mfma_f32_16x16x32_bf16 v[208:211], a[112:115], v[72:75], v[208:211]
    v_exp_f32 v43, v43
    v_mfma_f32_16x16x32_bf16 v[240:243], a[112:115], v[76:79], v[240:243]
    ds_read_b64_tr_b16 a[112:113], v12 offset:40960
    ds_read_b64_tr_b16 a[114:115], v12 offset:45056
    v_mfma_f32_16x16x32_bf16 v[212:215], a[116:119], v[72:75], v[212:215]
    v_exp_f32 v36, v36
    v_mfma_f32_16x16x32_bf16 v[244:247], a[116:119], v[76:79], v[244:247]
    ds_read_b64_tr_b16 a[116:117], v13 offset:40960
    ds_read_b64_tr_b16 a[118:119], v13 offset:45056
    v_mfma_f32_16x16x32_bf16 v[216:219], a[120:123], v[72:75], v[216:219]
    v_exp_f32 v37, v37
    v_mfma_f32_16x16x32_bf16 v[248:251], a[120:123], v[76:79], v[248:251]
    ds_read_b64_tr_b16 a[120:121], v14 offset:40960
    ds_read_b64_tr_b16 a[122:123], v14 offset:45056
    v_mfma_f32_16x16x32_bf16 v[220:223], a[124:127], v[72:75], v[220:223]
    v_exp_f32 v38, v38
    v_mfma_f32_16x16x32_bf16 v[252:255], a[124:127], v[76:79], v[252:255]
    ds_read_b64_tr_b16 a[124:125], v15 offset:40960
    ds_read_b64_tr_b16 a[126:127], v15 offset:45056
    v_mfma_f32_16x16x32_bf16 v[104:107], v[112:115], v[72:75], v[104:107]
    v_exp_f32 v39, v39
    v_mfma_f32_16x16x32_bf16 v[108:111], v[112:115], v[76:79], v[108:111]
    v_cvt_pk_bf16_f32 v65, v34, v35
    v_cvt_pk_bf16_f32 v68, v40, v41
    v_mfma_f32_16x16x32_bf16 v[48:51], a[64:67], a[32:35], v[88:91]
    v_exp_f32 v44, v44
    v_mfma_f32_16x16x32_bf16 v[56:59], a[64:67], a[48:51], v[92:95]
    ds_read_b128 a[64:67], v4 offset:40960
    v_cvt_pk_bf16_f32 v69, v42, v43
    v_mfma_f32_16x16x32_bf16 v[48:51], a[68:71], a[36:39], v[48:51]
    v_exp_f32 v45, v45
    v_mfma_f32_16x16x32_bf16 v[56:59], a[68:71], a[52:55], v[56:59]
    ds_read_b128 a[68:71], v5 offset:40960
    v_cvt_pk_bf16_f32 v66, v36, v37
    v_mfma_f32_16x16x32_bf16 v[48:51], a[72:75], a[40:43], v[48:51]
    v_exp_f32 v46, v46
    v_mfma_f32_16x16x32_bf16 v[56:59], a[72:75], a[56:59], v[56:59]
    ds_read_b128 a[72:75], v6 offset:40960
    v_cvt_pk_bf16_f32 v67, v38, v39
    v_mfma_f32_16x16x32_bf16 v[48:51], a[76:79], a[44:47], v[48:51]
    v_exp_f32 v47, v47
    v_mfma_f32_16x16x32_bf16 v[56:59], a[76:79], a[60:63], v[56:59]
    ds_read_b128 a[76:79], v7 offset:40960
    v_cvt_pk_bf16_f32 v70, v44, v45
    v_mfma_f32_16x16x32_bf16 v[52:55], a[80:83], a[32:35], v[88:91]
    s_add_u32 s82, s82, 16384
    v_mfma_f32_16x16x32_bf16 v[60:63], a[80:83], a[48:51], v[92:95]
    ds_read_b128 a[80:83], v4 offset:45056
    v_cvt_pk_bf16_f32 v71, v46, v47
    v_mfma_f32_16x16x32_bf16 v[52:55], a[84:87], a[36:39], v[52:55]
    v_exp_f32 v48, v48
    v_mfma_f32_16x16x32_bf16 v[60:63], a[84:87], a[52:55], v[60:63]
    ds_read_b128 a[84:87], v5 offset:45056
    v_xor_b32 v22, 0, v122
    v_mfma_f32_16x16x32_bf16 v[52:55], a[88:91], a[40:43], v[52:55]
    v_exp_f32 v49, v49
    v_mfma_f32_16x16x32_bf16 v[60:63], a[88:91], a[56:59], v[60:63]
    ds_read_b128 a[88:91], v6 offset:45056
    v_xor_b32 v23, 64, v122
    v_mfma_f32_16x16x32_bf16 v[52:55], a[92:95], a[44:47], v[52:55]
    v_exp_f32 v50, v50
    v_mfma_f32_16x16x32_bf16 v[60:63], a[92:95], a[60:63], v[60:63]
    ds_read_b128 a[92:95], v7 offset:45056
    s_waitcnt lgkmcnt(8)
    v_mfma_f32_16x16x32_bf16 v[128:131], a[96:99], v[64:67], v[128:131]
    v_exp_f32 v51, v51
    v_mfma_f32_16x16x32_bf16 v[160:163], a[96:99], v[68:71], v[160:163]
    v_cvt_pk_bf16_f32 v72, v48, v49
    v_cvt_pk_bf16_f32 v73, v50, v51
    v_mfma_f32_16x16x32_bf16 v[132:135], a[100:103], v[64:67], v[132:135]
    v_exp_f32 v56, v56
    v_mfma_f32_16x16x32_bf16 v[164:167], a[100:103], v[68:71], v[164:167]
    s_waitcnt vmcnt(10)
    ds_read_b128 v[32:35], v121 offset:0
    v_mfma_f32_16x16x32_bf16 v[136:139], a[104:107], v[64:67], v[136:139]
    v_exp_f32 v57, v57
    v_mfma_f32_16x16x32_bf16 v[168:171], a[104:107], v[68:71], v[168:171]
    v_cvt_pk_bf16_f32 v76, v56, v57
    ds_read_b128 v[36:39], v121 offset:1024
    v_mfma_f32_16x16x32_bf16 v[140:143], a[108:111], v[64:67], v[140:143]
    v_exp_f32 v58, v58
    v_mfma_f32_16x16x32_bf16 v[172:175], a[108:111], v[68:71], v[172:175]
    ds_read_b128 v[40:43], v121 offset:2048
    ds_read_b128 v[44:47], v121 offset:3072
    v_mfma_f32_16x16x32_bf16 v[144:147], a[112:115], v[64:67], v[144:147]
    v_exp_f32 v59, v59
    v_mfma_f32_16x16x32_bf16 v[176:179], a[112:115], v[68:71], v[176:179]
    v_cvt_pk_bf16_f32 v77, v58, v59
    v_xor_b32 v24, 128, v122
    v_mfma_f32_16x16x32_bf16 v[148:151], a[116:119], v[64:67], v[148:151]
    v_exp_f32 v52, v52
    v_mfma_f32_16x16x32_bf16 v[180:183], a[116:119], v[68:71], v[180:183]
    ds_read_b64_tr_b16 v[48:49], v22 offset:8192
    ds_read_b64_tr_b16 v[50:51], v22 offset:9216
    v_mfma_f32_16x16x32_bf16 v[152:155], a[120:123], v[64:67], v[152:155]
    v_exp_f32 v53, v53
    v_mfma_f32_16x16x32_bf16 v[184:187], a[120:123], v[68:71], v[184:187]
    ds_read_b64_tr_b16 v[56:57], v22 offset:8200
    ds_read_b64_tr_b16 v[58:59], v22 offset:9224
    v_mfma_f32_16x16x32_bf16 v[156:159], a[124:127], v[64:67], v[156:159]
    v_exp_f32 v54, v54
    v_mfma_f32_16x16x32_bf16 v[188:191], a[124:127], v[68:71], v[188:191]
    v_xor_b32 v25, 192, v122
    v_mfma_f32_16x16x32_bf16 v[96:99], v[112:115], v[64:67], v[96:99]
    v_exp_f32 v55, v55
    v_mfma_f32_16x16x32_bf16 v[100:103], v[112:115], v[68:71], v[100:103]
    s_waitcnt lgkmcnt(2)
    v_mfma_f32_16x16x32_bf16 a[128:131], v[48:51], v[32:35], a[128:131]
    ds_read_b64_tr_b16 v[64:65], v23 offset:8192
    ds_read_b64_tr_b16 v[66:67], v23 offset:9216
    v_mfma_f32_16x16x32_bf16 a[160:163], v[48:51], v[36:39], a[160:163]
    s_add_u32 m0, s24, 131072
    s_add_u32 s72, s70, 0
    v_mfma_f32_16x16x32_bf16 a[192:195], v[48:51], v[40:43], a[192:195]
    buffer_load_dwordx4 v18, s[32:35], s72 offen lds
    v_mfma_f32_16x16x32_bf16 a[224:227], v[48:51], v[44:47], a[224:227]
    s_waitcnt lgkmcnt(2)
    v_mfma_f32_16x16x32_bf16 a[132:135], v[56:59], v[32:35], a[132:135]
    ds_read_b64_tr_b16 v[68:69], v23 offset:8200
    ds_read_b64_tr_b16 v[70:71], v23 offset:9224
    v_mfma_f32_16x16x32_bf16 a[164:167], v[56:59], v[36:39], a[164:167]
    v_mfma_f32_16x16x32_bf16 a[196:199], v[56:59], v[40:43], a[196:199]
    v_mfma_f32_16x16x32_bf16 a[228:231], v[56:59], v[44:47], a[228:231]
    s_waitcnt lgkmcnt(2)
    v_mfma_f32_16x16x32_bf16 a[136:139], v[64:67], v[32:35], a[136:139]
    ds_read_b64_tr_b16 v[48:49], v24 offset:8192
    ds_read_b64_tr_b16 v[50:51], v24 offset:9216
    v_mfma_f32_16x16x32_bf16 a[168:171], v[64:67], v[36:39], a[168:171]
    s_add_u32 m0, s24, 132096
    s_add_u32 s72, s70, 16384
    v_mfma_f32_16x16x32_bf16 a[200:203], v[64:67], v[40:43], a[200:203]
    buffer_load_dwordx4 v18, s[32:35], s72 offen lds
    v_mfma_f32_16x16x32_bf16 a[232:235], v[64:67], v[44:47], a[232:235]
    s_waitcnt lgkmcnt(2)
    v_mfma_f32_16x16x32_bf16 a[140:143], v[68:71], v[32:35], a[140:143]
    ds_read_b64_tr_b16 v[56:57], v24 offset:8200
    ds_read_b64_tr_b16 v[58:59], v24 offset:9224
    v_mfma_f32_16x16x32_bf16 a[172:175], v[68:71], v[36:39], a[172:175]
    v_mfma_f32_16x16x32_bf16 a[204:207], v[68:71], v[40:43], a[204:207]
    v_mfma_f32_16x16x32_bf16 a[236:239], v[68:71], v[44:47], a[236:239]
    s_waitcnt lgkmcnt(2)
    v_mfma_f32_16x16x32_bf16 a[144:147], v[48:51], v[32:35], a[144:147]
    ds_read_b64_tr_b16 v[64:65], v25 offset:8192
    ds_read_b64_tr_b16 v[66:67], v25 offset:9216
    v_mfma_f32_16x16x32_bf16 a[176:179], v[48:51], v[36:39], a[176:179]
    s_add_u32 m0, s24, 133120
    s_add_u32 s72, s70, 32768
    v_mfma_f32_16x16x32_bf16 a[208:211], v[48:51], v[40:43], a[208:211]
    buffer_load_dwordx4 v18, s[32:35], s72 offen lds
    v_mfma_f32_16x16x32_bf16 a[240:243], v[48:51], v[44:47], a[240:243]
    s_waitcnt lgkmcnt(2)
    v_mfma_f32_16x16x32_bf16 a[148:151], v[56:59], v[32:35], a[148:151]
    ds_read_b64_tr_b16 v[68:69], v25 offset:8200
    ds_read_b64_tr_b16 v[70:71], v25 offset:9224
    v_mfma_f32_16x16x32_bf16 a[180:183], v[56:59], v[36:39], a[180:183]
    v_mfma_f32_16x16x32_bf16 a[212:215], v[56:59], v[40:43], a[212:215]
    v_mfma_f32_16x16x32_bf16 a[244:247], v[56:59], v[44:47], a[244:247]
    s_waitcnt lgkmcnt(2)
    v_mfma_f32_16x16x32_bf16 a[152:155], v[64:67], v[32:35], a[152:155]
    s_add_u32 m0, s24, 134144
    s_add_u32 s72, s70, 49152
    v_mfma_f32_16x16x32_bf16 a[184:187], v[64:67], v[36:39], a[184:187]
    buffer_load_dwordx4 v18, s[32:35], s72 offen lds
    s_add_u32 s70, s70, 64
    v_mfma_f32_16x16x32_bf16 a[216:219], v[64:67], v[40:43], a[216:219]
    v_mfma_f32_16x16x32_bf16 a[248:251], v[64:67], v[44:47], a[248:251]
    s_waitcnt lgkmcnt(0)
    v_mfma_f32_16x16x32_bf16 a[156:159], v[68:71], v[32:35], a[156:159]
    v_mfma_f32_16x16x32_bf16 a[188:191], v[68:71], v[36:39], a[188:191]
    v_mfma_f32_16x16x32_bf16 a[220:223], v[68:71], v[40:43], a[220:223]
    v_mfma_f32_16x16x32_bf16 a[252:255], v[68:71], v[44:47], a[252:255]
    s_waitcnt vmcnt(12) lgkmcnt(0)
    s_barrier
    v_mfma_f32_16x16x32_bf16 v[32:35], a[64:67], a[0:3], v[80:83]
    v_exp_f32 v60, v60
    v_mfma_f32_16x16x32_bf16 v[40:43], a[64:67], a[16:19], v[84:87]
    v_cvt_pk_bf16_f32 v74, v52, v53
    s_lshr_b32 s74, s24, 1
    v_mfma_f32_16x16x32_bf16 v[32:35], a[68:71], a[4:7], v[32:35]
    v_exp_f32 v61, v61
    v_mfma_f32_16x16x32_bf16 v[40:43], a[68:71], a[20:23], v[40:43]
    v_cvt_pk_bf16_f32 v75, v54, v55
    v_cvt_pk_bf16_f32 v78, v60, v61
    v_mfma_f32_16x16x32_bf16 v[32:35], a[72:75], a[8:11], v[32:35]
    v_exp_f32 v62, v62
    v_mfma_f32_16x16x32_bf16 v[40:43], a[72:75], a[24:27], v[40:43]
    s_add_u32 m0, s74, 155648
    s_add_u32 s72, s71, 32768
    v_mfma_f32_16x16x32_bf16 v[32:35], a[76:79], a[12:15], v[32:35]
    v_exp_f32 v63, v63
    v_mfma_f32_16x16x32_bf16 v[40:43], a[76:79], a[28:31], v[40:43]
    v_cvt_pk_bf16_f32 v79, v62, v63
    buffer_load_dwordx4 v19, s[36:39], s71 offen lds
    v_mfma_f32_16x16x32_bf16 v[36:39], a[80:83], a[0:3], v[80:83]
    s_add_u32 m0, s74, 156672
    v_mfma_f32_16x16x32_bf16 v[44:47], a[80:83], a[16:19], v[84:87]
    s_add_u32 s71, s71, 262144
    v_mfma_f32_16x16x32_bf16 v[36:39], a[84:87], a[4:7], v[36:39]
    v_exp_f32 v32, v32
    v_mfma_f32_16x16x32_bf16 v[44:47], a[84:87], a[20:23], v[44:47]
    buffer_load_dwordx4 v19, s[36:39], s72 offen lds
    v_mfma_f32_16x16x32_bf16 v[36:39], a[88:91], a[8:11], v[36:39]
    v_exp_f32 v33, v33
    v_mfma_f32_16x16x32_bf16 v[44:47], a[88:91], a[24:27], v[44:47]
    v_cvt_pk_bf16_f32 v64, v32, v33
    s_add_u32 m0, s80, 98304
    v_mfma_f32_16x16x32_bf16 v[36:39], a[92:95], a[12:15], v[36:39]
    v_exp_f32 v34, v34
    v_mfma_f32_16x16x32_bf16 v[44:47], a[92:95], a[28:31], v[44:47]
    buffer_load_dwordx4 v20, s[12:15], s25 offen nt lds
    s_add_u32 m0, s80, 102400
    v_mfma_f32_16x16x32_bf16 v[192:195], a[96:99], v[72:75], v[192:195]
    v_exp_f32 v35, v35
    v_mfma_f32_16x16x32_bf16 v[224:227], a[96:99], v[76:79], v[224:227]
    ds_read_b64_tr_b16 a[96:97], v8 offset:49152
    ds_read_b64_tr_b16 a[98:99], v8 offset:53248
    v_mfma_f32_16x16x32_bf16 v[196:199], a[100:103], v[72:75], v[196:199]
    v_exp_f32 v40, v40
    v_mfma_f32_16x16x32_bf16 v[228:231], a[100:103], v[76:79], v[228:231]
    ds_read_b64_tr_b16 a[100:101], v9 offset:49152
    ds_read_b64_tr_b16 a[102:103], v9 offset:53248
    v_mfma_f32_16x16x32_bf16 v[200:203], a[104:107], v[72:75], v[200:203]
    v_exp_f32 v41, v41
    v_mfma_f32_16x16x32_bf16 v[232:235], a[104:107], v[76:79], v[232:235]
    ds_read_b64_tr_b16 a[104:105], v10 offset:49152
    ds_read_b64_tr_b16 a[106:107], v10 offset:53248
    v_mfma_f32_16x16x32_bf16 v[204:207], a[108:111], v[72:75], v[204:207]
    v_exp_f32 v42, v42
    v_mfma_f32_16x16x32_bf16 v[236:239], a[108:111], v[76:79], v[236:239]
    ds_read_b64_tr_b16 a[108:109], v11 offset:49152
    ds_read_b64_tr_b16 a[110:111], v11 offset:53248
    v_mfma_f32_16x16x32_bf16 v[208:211], a[112:115], v[72:75], v[208:211]
    v_exp_f32 v43, v43
    v_mfma_f32_16x16x32_bf16 v[240:243], a[112:115], v[76:79], v[240:243]
    ds_read_b64_tr_b16 a[112:113], v12 offset:49152
    ds_read_b64_tr_b16 a[114:115], v12 offset:53248
    v_mfma_f32_16x16x32_bf16 v[212:215], a[116:119], v[72:75], v[212:215]
    v_exp_f32 v36, v36
    v_mfma_f32_16x16x32_bf16 v[244:247], a[116:119], v[76:79], v[244:247]
    ds_read_b64_tr_b16 a[116:117], v13 offset:49152
    ds_read_b64_tr_b16 a[118:119], v13 offset:53248
    v_mfma_f32_16x16x32_bf16 v[216:219], a[120:123], v[72:75], v[216:219]
    v_exp_f32 v37, v37
    v_mfma_f32_16x16x32_bf16 v[248:251], a[120:123], v[76:79], v[248:251]
    ds_read_b64_tr_b16 a[120:121], v14 offset:49152
    ds_read_b64_tr_b16 a[122:123], v14 offset:53248
    v_mfma_f32_16x16x32_bf16 v[220:223], a[124:127], v[72:75], v[220:223]
    v_exp_f32 v38, v38
    v_mfma_f32_16x16x32_bf16 v[252:255], a[124:127], v[76:79], v[252:255]
    ds_read_b64_tr_b16 a[124:125], v15 offset:49152
    ds_read_b64_tr_b16 a[126:127], v15 offset:53248
    v_mfma_f32_16x16x32_bf16 v[104:107], v[112:115], v[72:75], v[104:107]
    v_exp_f32 v39, v39
    v_mfma_f32_16x16x32_bf16 v[108:111], v[112:115], v[76:79], v[108:111]
    v_cvt_pk_bf16_f32 v65, v34, v35
    v_cvt_pk_bf16_f32 v68, v40, v41
    v_mfma_f32_16x16x32_bf16 v[48:51], a[64:67], a[32:35], v[88:91]
    v_exp_f32 v44, v44
    v_mfma_f32_16x16x32_bf16 v[56:59], a[64:67], a[48:51], v[92:95]
    ds_read_b128 a[64:67], v4 offset:49152
    v_cvt_pk_bf16_f32 v69, v42, v43
    v_mfma_f32_16x16x32_bf16 v[48:51], a[68:71], a[36:39], v[48:51]
    v_exp_f32 v45, v45
    v_mfma_f32_16x16x32_bf16 v[56:59], a[68:71], a[52:55], v[56:59]
    ds_read_b128 a[68:71], v5 offset:49152
    v_cvt_pk_bf16_f32 v66, v36, v37
    v_mfma_f32_16x16x32_bf16 v[48:51], a[72:75], a[40:43], v[48:51]
    v_exp_f32 v46, v46
    v_mfma_f32_16x16x32_bf16 v[56:59], a[72:75], a[56:59], v[56:59]
    ds_read_b128 a[72:75], v6 offset:49152
    v_cvt_pk_bf16_f32 v67, v38, v39
    v_mfma_f32_16x16x32_bf16 v[48:51], a[76:79], a[44:47], v[48:51]
    v_exp_f32 v47, v47
    v_mfma_f32_16x16x32_bf16 v[56:59], a[76:79], a[60:63], v[56:59]
    ds_read_b128 a[76:79], v7 offset:49152
    v_cvt_pk_bf16_f32 v70, v44, v45
    v_mfma_f32_16x16x32_bf16 v[52:55], a[80:83], a[32:35], v[88:91]
    buffer_load_dwordx4 v21, s[12:15], s25 offen nt lds
    v_mfma_f32_16x16x32_bf16 v[60:63], a[80:83], a[48:51], v[92:95]
    ds_read_b128 a[80:83], v4 offset:53248
    v_cvt_pk_bf16_f32 v71, v46, v47
    v_mfma_f32_16x16x32_bf16 v[52:55], a[84:87], a[36:39], v[52:55]
    v_exp_f32 v48, v48
    v_mfma_f32_16x16x32_bf16 v[60:63], a[84:87], a[52:55], v[60:63]
    ds_read_b128 a[84:87], v5 offset:53248
    s_add_u32 m0, s80, 106496
    v_mfma_f32_16x16x32_bf16 v[52:55], a[88:91], a[40:43], v[52:55]
    v_exp_f32 v49, v49
    v_mfma_f32_16x16x32_bf16 v[60:63], a[88:91], a[56:59], v[60:63]
    ds_read_b128 a[88:91], v6 offset:53248
    buffer_load_dwordx4 v20, s[12:15], s81 offen nt lds
    v_mfma_f32_16x16x32_bf16 v[52:55], a[92:95], a[44:47], v[52:55]
    v_exp_f32 v50, v50
    v_mfma_f32_16x16x32_bf16 v[60:63], a[92:95], a[60:63], v[60:63]
    ds_read_b128 a[92:95], v7 offset:53248
    s_waitcnt lgkmcnt(8)
    v_mfma_f32_16x16x32_bf16 v[128:131], a[96:99], v[64:67], v[128:131]
    v_exp_f32 v51, v51
    v_mfma_f32_16x16x32_bf16 v[160:163], a[96:99], v[68:71], v[160:163]
    v_cvt_pk_bf16_f32 v72, v48, v49
    v_cvt_pk_bf16_f32 v73, v50, v51
    v_mfma_f32_16x16x32_bf16 v[132:135], a[100:103], v[64:67], v[132:135]
    v_exp_f32 v56, v56
    v_mfma_f32_16x16x32_bf16 v[164:167], a[100:103], v[68:71], v[164:167]
    s_add_u32 m0, s80, 110592
    v_mfma_f32_16x16x32_bf16 v[136:139], a[104:107], v[64:67], v[136:139]
    v_exp_f32 v57, v57
    v_mfma_f32_16x16x32_bf16 v[168:171], a[104:107], v[68:71], v[168:171]
    v_cvt_pk_bf16_f32 v76, v56, v57
    v_mfma_f32_16x16x32_bf16 v[140:143], a[108:111], v[64:67], v[140:143]
    v_exp_f32 v58, v58
    v_mfma_f32_16x16x32_bf16 v[172:175], a[108:111], v[68:71], v[172:175]
    buffer_load_dwordx4 v21, s[12:15], s81 offen nt lds
    v_mfma_f32_16x16x32_bf16 v[144:147], a[112:115], v[64:67], v[144:147]
    v_exp_f32 v59, v59
    v_mfma_f32_16x16x32_bf16 v[176:179], a[112:115], v[68:71], v[176:179]
    v_cvt_pk_bf16_f32 v77, v58, v59
    s_add_u32 s25, s25, 16384
    v_mfma_f32_16x16x32_bf16 v[148:151], a[116:119], v[64:67], v[148:151]
    v_exp_f32 v52, v52
    v_mfma_f32_16x16x32_bf16 v[180:183], a[116:119], v[68:71], v[180:183]
    s_add_u32 s81, s81, 16384
    s_add_u32 m0, s80, 32768
    v_mfma_f32_16x16x32_bf16 v[152:155], a[120:123], v[64:67], v[152:155]
    v_exp_f32 v53, v53
    v_mfma_f32_16x16x32_bf16 v[184:187], a[120:123], v[68:71], v[184:187]
    buffer_load_dwordx4 v16, s[8:11], s26 offen nt lds
    v_mfma_f32_16x16x32_bf16 v[156:159], a[124:127], v[64:67], v[156:159]
    v_exp_f32 v54, v54
    v_mfma_f32_16x16x32_bf16 v[188:191], a[124:127], v[68:71], v[188:191]
    s_add_u32 m0, s80, 36864
    v_mfma_f32_16x16x32_bf16 v[96:99], v[112:115], v[64:67], v[96:99]
    v_exp_f32 v55, v55
    v_mfma_f32_16x16x32_bf16 v[100:103], v[112:115], v[68:71], v[100:103]
    s_waitcnt lgkmcnt(0)
    v_mfma_f32_16x16x32_bf16 v[32:35], a[64:67], a[0:3], v[80:83]
    v_exp_f32 v60, v60
    v_mfma_f32_16x16x32_bf16 v[40:43], a[64:67], a[16:19], v[84:87]
    v_cvt_pk_bf16_f32 v74, v52, v53
    v_mfma_f32_16x16x32_bf16 v[32:35], a[68:71], a[4:7], v[32:35]
    v_exp_f32 v61, v61
    v_mfma_f32_16x16x32_bf16 v[40:43], a[68:71], a[20:23], v[40:43]
    v_cvt_pk_bf16_f32 v75, v54, v55
    v_cvt_pk_bf16_f32 v78, v60, v61
    v_mfma_f32_16x16x32_bf16 v[32:35], a[72:75], a[8:11], v[32:35]
    v_exp_f32 v62, v62
    v_mfma_f32_16x16x32_bf16 v[40:43], a[72:75], a[24:27], v[40:43]
    buffer_load_dwordx4 v17, s[8:11], s26 offen nt lds
    v_mfma_f32_16x16x32_bf16 v[32:35], a[76:79], a[12:15], v[32:35]
    v_exp_f32 v63, v63
    v_mfma_f32_16x16x32_bf16 v[40:43], a[76:79], a[28:31], v[40:43]
    v_cvt_pk_bf16_f32 v79, v62, v63
    v_mfma_f32_16x16x32_bf16 v[36:39], a[80:83], a[0:3], v[80:83]
    v_mfma_f32_16x16x32_bf16 v[44:47], a[80:83], a[16:19], v[84:87]
    s_add_u32 m0, s80, 40960
    v_mfma_f32_16x16x32_bf16 v[36:39], a[84:87], a[4:7], v[36:39]
    v_exp_f32 v32, v32
    v_mfma_f32_16x16x32_bf16 v[44:47], a[84:87], a[20:23], v[44:47]
    buffer_load_dwordx4 v16, s[8:11], s82 offen nt lds
    v_mfma_f32_16x16x32_bf16 v[36:39], a[88:91], a[8:11], v[36:39]
    v_exp_f32 v33, v33
    v_mfma_f32_16x16x32_bf16 v[44:47], a[88:91], a[24:27], v[44:47]
    v_cvt_pk_bf16_f32 v64, v32, v33
    s_add_u32 m0, s80, 45056
    v_mfma_f32_16x16x32_bf16 v[36:39], a[92:95], a[12:15], v[36:39]
    v_exp_f32 v34, v34
    v_mfma_f32_16x16x32_bf16 v[44:47], a[92:95], a[28:31], v[44:47]
    buffer_load_dwordx4 v17, s[8:11], s82 offen nt lds
    s_add_u32 s26, s26, 16384
    v_mfma_f32_16x16x32_bf16 v[192:195], a[96:99], v[72:75], v[192:195]
    v_exp_f32 v35, v35
    v_mfma_f32_16x16x32_bf16 v[224:227], a[96:99], v[76:79], v[224:227]
    ds_read_b64_tr_b16 a[96:97], v8 offset:57344
    ds_read_b64_tr_b16 a[98:99], v8 offset:61440
    v_mfma_f32_16x16x32_bf16 v[196:199], a[100:103], v[72:75], v[196:199]
    v_exp_f32 v40, v40
    v_mfma_f32_16x16x32_bf16 v[228:231], a[100:103], v[76:79], v[228:231]
    ds_read_b64_tr_b16 a[100:101], v9 offset:57344
    ds_read_b64_tr_b16 a[102:103], v9 offset:61440
    v_mfma_f32_16x16x32_bf16 v[200:203], a[104:107], v[72:75], v[200:203]
    v_exp_f32 v41, v41
    v_mfma_f32_16x16x32_bf16 v[232:235], a[104:107], v[76:79], v[232:235]
    ds_read_b64_tr_b16 a[104:105], v10 offset:57344
    ds_read_b64_tr_b16 a[106:107], v10 offset:61440
    v_mfma_f32_16x16x32_bf16 v[204:207], a[108:111], v[72:75], v[204:207]
    v_exp_f32 v42, v42
    v_mfma_f32_16x16x32_bf16 v[236:239], a[108:111], v[76:79], v[236:239]
    ds_read_b64_tr_b16 a[108:109], v11 offset:57344
    ds_read_b64_tr_b16 a[110:111], v11 offset:61440
    v_mfma_f32_16x16x32_bf16 v[208:211], a[112:115], v[72:75], v[208:211]
    v_exp_f32 v43, v43
    v_mfma_f32_16x16x32_bf16 v[240:243], a[112:115], v[76:79], v[240:243]
    ds_read_b64_tr_b16 a[112:113], v12 offset:57344
    ds_read_b64_tr_b16 a[114:115], v12 offset:61440
    v_mfma_f32_16x16x32_bf16 v[212:215], a[116:119], v[72:75], v[212:215]
    v_exp_f32 v36, v36
    v_mfma_f32_16x16x32_bf16 v[244:247], a[116:119], v[76:79], v[244:247]
    ds_read_b64_tr_b16 a[116:117], v13 offset:57344
    ds_read_b64_tr_b16 a[118:119], v13 offset:61440
    v_mfma_f32_16x16x32_bf16 v[216:219], a[120:123], v[72:75], v[216:219]
    v_exp_f32 v37, v37
    v_mfma_f32_16x16x32_bf16 v[248:251], a[120:123], v[76:79], v[248:251]
    ds_read_b64_tr_b16 a[120:121], v14 offset:57344
    ds_read_b64_tr_b16 a[122:123], v14 offset:61440
    v_mfma_f32_16x16x32_bf16 v[220:223], a[124:127], v[72:75], v[220:223]
    v_exp_f32 v38, v38
    v_mfma_f32_16x16x32_bf16 v[252:255], a[124:127], v[76:79], v[252:255]
    ds_read_b64_tr_b16 a[124:125], v15 offset:57344
    ds_read_b64_tr_b16 a[126:127], v15 offset:61440
    v_mfma_f32_16x16x32_bf16 v[104:107], v[112:115], v[72:75], v[104:107]
    v_exp_f32 v39, v39
    v_mfma_f32_16x16x32_bf16 v[108:111], v[112:115], v[76:79], v[108:111]
    v_cvt_pk_bf16_f32 v65, v34, v35
    v_cvt_pk_bf16_f32 v68, v40, v41
    v_mfma_f32_16x16x32_bf16 v[48:51], a[64:67], a[32:35], v[88:91]
    v_exp_f32 v44, v44
    v_mfma_f32_16x16x32_bf16 v[56:59], a[64:67], a[48:51], v[92:95]
    ds_read_b128 a[64:67], v4 offset:57344
    v_cvt_pk_bf16_f32 v69, v42, v43
    v_mfma_f32_16x16x32_bf16 v[48:51], a[68:71], a[36:39], v[48:51]
    v_exp_f32 v45, v45
    v_mfma_f32_16x16x32_bf16 v[56:59], a[68:71], a[52:55], v[56:59]
    ds_read_b128 a[68:71], v5 offset:57344
    v_cvt_pk_bf16_f32 v66, v36, v37
    v_mfma_f32_16x16x32_bf16 v[48:51], a[72:75], a[40:43], v[48:51]
    v_exp_f32 v46, v46
    v_mfma_f32_16x16x32_bf16 v[56:59], a[72:75], a[56:59], v[56:59]
    ds_read_b128 a[72:75], v6 offset:57344
    v_cvt_pk_bf16_f32 v67, v38, v39
    v_mfma_f32_16x16x32_bf16 v[48:51], a[76:79], a[44:47], v[48:51]
    v_exp_f32 v47, v47
    v_mfma_f32_16x16x32_bf16 v[56:59], a[76:79], a[60:63], v[56:59]
    ds_read_b128 a[76:79], v7 offset:57344
    v_cvt_pk_bf16_f32 v70, v44, v45
    v_mfma_f32_16x16x32_bf16 v[52:55], a[80:83], a[32:35], v[88:91]
    s_add_u32 s82, s82, 16384
    v_mfma_f32_16x16x32_bf16 v[60:63], a[80:83], a[48:51], v[92:95]
    ds_read_b128 a[80:83], v4 offset:61440
    v_cvt_pk_bf16_f32 v71, v46, v47
    v_mfma_f32_16x16x32_bf16 v[52:55], a[84:87], a[36:39], v[52:55]
    v_exp_f32 v48, v48
    v_mfma_f32_16x16x32_bf16 v[60:63], a[84:87], a[52:55], v[60:63]
    ds_read_b128 a[84:87], v5 offset:61440
    v_xor_b32 v22, 0, v122
    v_mfma_f32_16x16x32_bf16 v[52:55], a[88:91], a[40:43], v[52:55]
    v_exp_f32 v49, v49
    v_mfma_f32_16x16x32_bf16 v[60:63], a[88:91], a[56:59], v[60:63]
    ds_read_b128 a[88:91], v6 offset:61440
    v_xor_b32 v23, 64, v122
    v_mfma_f32_16x16x32_bf16 v[52:55], a[92:95], a[44:47], v[52:55]
    v_exp_f32 v50, v50
    v_mfma_f32_16x16x32_bf16 v[60:63], a[92:95], a[60:63], v[60:63]
    ds_read_b128 a[92:95], v7 offset:61440
    s_waitcnt lgkmcnt(8)
    v_mfma_f32_16x16x32_bf16 v[128:131], a[96:99], v[64:67], v[128:131]
    v_exp_f32 v51, v51
    v_mfma_f32_16x16x32_bf16 v[160:163], a[96:99], v[68:71], v[160:163]
    v_cvt_pk_bf16_f32 v72, v48, v49
    v_cvt_pk_bf16_f32 v73, v50, v51
    v_mfma_f32_16x16x32_bf16 v[132:135], a[100:103], v[64:67], v[132:135]
    v_exp_f32 v56, v56
    v_mfma_f32_16x16x32_bf16 v[164:167], a[100:103], v[68:71], v[164:167]
    s_waitcnt vmcnt(10)
    ds_read_b128 v[32:35], v121 offset:0
    v_mfma_f32_16x16x32_bf16 v[136:139], a[104:107], v[64:67], v[136:139]
    v_exp_f32 v57, v57
    v_mfma_f32_16x16x32_bf16 v[168:171], a[104:107], v[68:71], v[168:171]
    v_cvt_pk_bf16_f32 v76, v56, v57
    ds_read_b128 v[36:39], v121 offset:1024
    v_mfma_f32_16x16x32_bf16 v[140:143], a[108:111], v[64:67], v[140:143]
    v_exp_f32 v58, v58
    v_mfma_f32_16x16x32_bf16 v[172:175], a[108:111], v[68:71], v[172:175]
    ds_read_b128 v[40:43], v121 offset:2048
    ds_read_b128 v[44:47], v121 offset:3072
    v_mfma_f32_16x16x32_bf16 v[144:147], a[112:115], v[64:67], v[144:147]
    v_exp_f32 v59, v59
    v_mfma_f32_16x16x32_bf16 v[176:179], a[112:115], v[68:71], v[176:179]
    v_cvt_pk_bf16_f32 v77, v58, v59
    v_xor_b32 v24, 128, v122
    v_mfma_f32_16x16x32_bf16 v[148:151], a[116:119], v[64:67], v[148:151]
    v_exp_f32 v52, v52
    v_mfma_f32_16x16x32_bf16 v[180:183], a[116:119], v[68:71], v[180:183]
    ds_read_b64_tr_b16 v[48:49], v22 offset:0
    ds_read_b64_tr_b16 v[50:51], v22 offset:1024
    v_mfma_f32_16x16x32_bf16 v[152:155], a[120:123], v[64:67], v[152:155]
    v_exp_f32 v53, v53
    v_mfma_f32_16x16x32_bf16 v[184:187], a[120:123], v[68:71], v[184:187]
    ds_read_b64_tr_b16 v[56:57], v22 offset:8
    ds_read_b64_tr_b16 v[58:59], v22 offset:1032
    v_mfma_f32_16x16x32_bf16 v[156:159], a[124:127], v[64:67], v[156:159]
    v_exp_f32 v54, v54
    v_mfma_f32_16x16x32_bf16 v[188:191], a[124:127], v[68:71], v[188:191]
    v_xor_b32 v25, 192, v122
    v_mfma_f32_16x16x32_bf16 v[96:99], v[112:115], v[64:67], v[96:99]
    v_exp_f32 v55, v55
    v_mfma_f32_16x16x32_bf16 v[100:103], v[112:115], v[68:71], v[100:103]
    s_waitcnt lgkmcnt(2)
    v_mfma_f32_16x16x32_bf16 a[128:131], v[48:51], v[32:35], a[128:131]
    ds_read_b64_tr_b16 v[64:65], v23 offset:0
    ds_read_b64_tr_b16 v[66:67], v23 offset:1024
    v_mfma_f32_16x16x32_bf16 a[160:163], v[48:51], v[36:39], a[160:163]
    s_add_u32 m0, s24, 131072
    s_add_u32 s72, s70, 0
    v_mfma_f32_16x16x32_bf16 a[192:195], v[48:51], v[40:43], a[192:195]
    buffer_load_dwordx4 v18, s[32:35], s72 offen lds
    v_mfma_f32_16x16x32_bf16 a[224:227], v[48:51], v[44:47], a[224:227]
    s_waitcnt lgkmcnt(2)
    v_mfma_f32_16x16x32_bf16 a[132:135], v[56:59], v[32:35], a[132:135]
    ds_read_b64_tr_b16 v[68:69], v23 offset:8
    ds_read_b64_tr_b16 v[70:71], v23 offset:1032
    v_mfma_f32_16x16x32_bf16 a[164:167], v[56:59], v[36:39], a[164:167]
    v_mfma_f32_16x16x32_bf16 a[196:199], v[56:59], v[40:43], a[196:199]
    v_mfma_f32_16x16x32_bf16 a[228:231], v[56:59], v[44:47], a[228:231]
    s_waitcnt lgkmcnt(2)
    v_mfma_f32_16x16x32_bf16 a[136:139], v[64:67], v[32:35], a[136:139]
    ds_read_b64_tr_b16 v[48:49], v24 offset:0
    ds_read_b64_tr_b16 v[50:51], v24 offset:1024
    v_mfma_f32_16x16x32_bf16 a[168:171], v[64:67], v[36:39], a[168:171]
    s_add_u32 m0, s24, 132096
    s_add_u32 s72, s70, 16384
    v_mfma_f32_16x16x32_bf16 a[200:203], v[64:67], v[40:43], a[200:203]
    buffer_load_dwordx4 v18, s[32:35], s72 offen lds
    v_mfma_f32_16x16x32_bf16 a[232:235], v[64:67], v[44:47], a[232:235]
    s_waitcnt lgkmcnt(2)
    v_mfma_f32_16x16x32_bf16 a[140:143], v[68:71], v[32:35], a[140:143]
    ds_read_b64_tr_b16 v[56:57], v24 offset:8
    ds_read_b64_tr_b16 v[58:59], v24 offset:1032
    v_mfma_f32_16x16x32_bf16 a[172:175], v[68:71], v[36:39], a[172:175]
    v_mfma_f32_16x16x32_bf16 a[204:207], v[68:71], v[40:43], a[204:207]
    v_mfma_f32_16x16x32_bf16 a[236:239], v[68:71], v[44:47], a[236:239]
    s_waitcnt lgkmcnt(2)
    v_mfma_f32_16x16x32_bf16 a[144:147], v[48:51], v[32:35], a[144:147]
    ds_read_b64_tr_b16 v[64:65], v25 offset:0
    ds_read_b64_tr_b16 v[66:67], v25 offset:1024
    v_mfma_f32_16x16x32_bf16 a[176:179], v[48:51], v[36:39], a[176:179]
    s_add_u32 m0, s24, 133120
    s_add_u32 s72, s70, 32768
    v_mfma_f32_16x16x32_bf16 a[208:211], v[48:51], v[40:43], a[208:211]
    buffer_load_dwordx4 v18, s[32:35], s72 offen lds
    v_mfma_f32_16x16x32_bf16 a[240:243], v[48:51], v[44:47], a[240:243]
    s_waitcnt lgkmcnt(2)
    v_mfma_f32_16x16x32_bf16 a[148:151], v[56:59], v[32:35], a[148:151]
    ds_read_b64_tr_b16 v[68:69], v25 offset:8
    ds_read_b64_tr_b16 v[70:71], v25 offset:1032
    v_mfma_f32_16x16x32_bf16 a[180:183], v[56:59], v[36:39], a[180:183]
    v_mfma_f32_16x16x32_bf16 a[212:215], v[56:59], v[40:43], a[212:215]
    v_mfma_f32_16x16x32_bf16 a[244:247], v[56:59], v[44:47], a[244:247]
    s_waitcnt lgkmcnt(2)
    v_mfma_f32_16x16x32_bf16 a[152:155], v[64:67], v[32:35], a[152:155]
    s_add_u32 m0, s24, 134144
    s_add_u32 s72, s70, 49152
    v_mfma_f32_16x16x32_bf16 a[184:187], v[64:67], v[36:39], a[184:187]
    buffer_load_dwordx4 v18, s[32:35], s72 offen lds
    s_add_u32 s70, s70, 64
    v_mfma_f32_16x16x32_bf16 a[216:219], v[64:67], v[40:43], a[216:219]
    v_mfma_f32_16x16x32_bf16 a[248:251], v[64:67], v[44:47], a[248:251]
    s_waitcnt lgkmcnt(0)
    v_mfma_f32_16x16x32_bf16 a[156:159], v[68:71], v[32:35], a[156:159]
    v_mfma_f32_16x16x32_bf16 a[188:191], v[68:71], v[36:39], a[188:191]
    v_mfma_f32_16x16x32_bf16 a[220:223], v[68:71], v[40:43], a[220:223]
    v_mfma_f32_16x16x32_bf16 a[252:255], v[68:71], v[44:47], a[252:255]
    s_sub_u32 s27, s27, 1
    s_cmp_eq_u32 s27, 0
    s_cbranch_scc1 L_loop1_end
    s_waitcnt vmcnt(12) lgkmcnt(0)
    s_barrier
    v_mfma_f32_16x16x32_bf16 v[32:35], a[64:67], a[0:3], v[80:83]
    v_exp_f32 v60, v60
    v_mfma_f32_16x16x32_bf16 v[40:43], a[64:67], a[16:19], v[84:87]
    v_cvt_pk_bf16_f32 v74, v52, v53
    s_lshr_b32 s74, s24, 1
    v_mfma_f32_16x16x32_bf16 v[32:35], a[68:71], a[4:7], v[32:35]
    v_exp_f32 v61, v61
    v_mfma_f32_16x16x32_bf16 v[40:43], a[68:71], a[20:23], v[40:43]
    v_cvt_pk_bf16_f32 v75, v54, v55
    v_cvt_pk_bf16_f32 v78, v60, v61
    v_mfma_f32_16x16x32_bf16 v[32:35], a[72:75], a[8:11], v[32:35]
    v_exp_f32 v62, v62
    v_mfma_f32_16x16x32_bf16 v[40:43], a[72:75], a[24:27], v[40:43]
    s_add_u32 m0, s74, 147456
    s_add_u32 s72, s71, 32768
    v_mfma_f32_16x16x32_bf16 v[32:35], a[76:79], a[12:15], v[32:35]
    v_exp_f32 v63, v63
    v_mfma_f32_16x16x32_bf16 v[40:43], a[76:79], a[28:31], v[40:43]
    v_cvt_pk_bf16_f32 v79, v62, v63
    buffer_load_dwordx4 v19, s[36:39], s71 offen lds
    v_mfma_f32_16x16x32_bf16 v[36:39], a[80:83], a[0:3], v[80:83]
    s_add_u32 m0, s74, 148480
    v_mfma_f32_16x16x32_bf16 v[44:47], a[80:83], a[16:19], v[84:87]
    s_add_u32 s71, s71, 262144
    v_mfma_f32_16x16x32_bf16 v[36:39], a[84:87], a[4:7], v[36:39]
    v_exp_f32 v32, v32
    v_mfma_f32_16x16x32_bf16 v[44:47], a[84:87], a[20:23], v[44:47]
    buffer_load_dwordx4 v19, s[36:39], s72 offen lds
    v_mfma_f32_16x16x32_bf16 v[36:39], a[88:91], a[8:11], v[36:39]
    v_exp_f32 v33, v33
    v_mfma_f32_16x16x32_bf16 v[44:47], a[88:91], a[24:27], v[44:47]
    v_cvt_pk_bf16_f32 v64, v32, v33
    s_add_u32 m0, s80, 114688
    v_mfma_f32_16x16x32_bf16 v[36:39], a[92:95], a[12:15], v[36:39]
    v_exp_f32 v34, v34
    v_mfma_f32_16x16x32_bf16 v[44:47], a[92:95], a[28:31], v[44:47]
    buffer_load_dwordx4 v20, s[12:15], s25 offen nt lds
    s_add_u32 m0, s80, 118784
    v_mfma_f32_16x16x32_bf16 v[192:195], a[96:99], v[72:75], v[192:195]
    v_exp_f32 v35, v35
    v_mfma_f32_16x16x32_bf16 v[224:227], a[96:99], v[76:79], v[224:227]
    ds_read_b64_tr_b16 a[96:97], v8 offset:0
    ds_read_b64_tr_b16 a[98:99], v8 offset:4096
    v_mfma_f32_16x16x32_bf16 v[196:199], a[100:103], v[72:75], v[196:199]
    v_exp_f32 v40, v40
    v_mfma_f32_16x16x32_bf16 v[228:231], a[100:103], v[76:79], v[228:231]
    ds_read_b64_tr_b16 a[100:101], v9 offset:0
    ds_read_b64_tr_b16 a[102:103], v9 offset:4096
    v_mfma_f32_16x16x32_bf16 v[200:203], a[104:107], v[72:75], v[200:203]
    v_exp_f32 v41, v41
    v_mfma_f32_16x16x32_bf16 v[232:235], a[104:107], v[76:79], v[232:235]
    ds_read_b64_tr_b16 a[104:105], v10 offset:0
    ds_read_b64_tr_b16 a[106:107], v10 offset:4096
    v_mfma_f32_16x16x32_bf16 v[204:207], a[108:111], v[72:75], v[204:207]
    v_exp_f32 v42, v42
    v_mfma_f32_16x16x32_bf16 v[236:239], a[108:111], v[76:79], v[236:239]
    ds_read_b64_tr_b16 a[108:109], v11 offset:0
    ds_read_b64_tr_b16 a[110:111], v11 offset:4096
    v_mfma_f32_16x16x32_bf16 v[208:211], a[112:115], v[72:75], v[208:211]
    v_exp_f32 v43, v43
    v_mfma_f32_16x16x32_bf16 v[240:243], a[112:115], v[76:79], v[240:243]
    ds_read_b64_tr_b16 a[112:113], v12 offset:0
    ds_read_b64_tr_b16 a[114:115], v12 offset:4096
    v_mfma_f32_16x16x32_bf16 v[212:215], a[116:119], v[72:75], v[212:215]
    v_exp_f32 v36, v36
    v_mfma_f32_16x16x32_bf16 v[244:247], a[116:119], v[76:79], v[244:247]
    ds_read_b64_tr_b16 a[116:117], v13 offset:0
    ds_read_b64_tr_b16 a[118:119], v13 offset:4096
    v_mfma_f32_16x16x32_bf16 v[216:219], a[120:123], v[72:75], v[216:219]
    v_exp_f32 v37, v37
    v_mfma_f32_16x16x32_bf16 v[248:251], a[120:123], v[76:79], v[248:251]
    ds_read_b64_tr_b16 a[120:121], v14 offset:0
    ds_read_b64_tr_b16 a[122:123], v14 offset:4096
    v_mfma_f32_16x16x32_bf16 v[220:223], a[124:127], v[72:75], v[220:223]
    v_exp_f32 v38, v38
    v_mfma_f32_16x16x32_bf16 v[252:255], a[124:127], v[76:79], v[252:255]
    ds_read_b64_tr_b16 a[124:125], v15 offset:0
    ds_read_b64_tr_b16 a[126:127], v15 offset:4096
    v_mfma_f32_16x16x32_bf16 v[104:107], v[112:115], v[72:75], v[104:107]
    v_exp_f32 v39, v39
    v_mfma_f32_16x16x32_bf16 v[108:111], v[112:115], v[76:79], v[108:111]
    v_cvt_pk_bf16_f32 v65, v34, v35
    v_cvt_pk_bf16_f32 v68, v40, v41
    v_mfma_f32_16x16x32_bf16 v[48:51], a[64:67], a[32:35], v[88:91]
    v_exp_f32 v44, v44
    v_mfma_f32_16x16x32_bf16 v[56:59], a[64:67], a[48:51], v[92:95]
    ds_read_b128 a[64:67], v4 offset:0
    v_cvt_pk_bf16_f32 v69, v42, v43
    v_mfma_f32_16x16x32_bf16 v[48:51], a[68:71], a[36:39], v[48:51]
    v_exp_f32 v45, v45
    v_mfma_f32_16x16x32_bf16 v[56:59], a[68:71], a[52:55], v[56:59]
    ds_read_b128 a[68:71], v5 offset:0
    v_cvt_pk_bf16_f32 v66, v36, v37
    v_mfma_f32_16x16x32_bf16 v[48:51], a[72:75], a[40:43], v[48:51]
    v_exp_f32 v46, v46
    v_mfma_f32_16x16x32_bf16 v[56:59], a[72:75], a[56:59], v[56:59]
    ds_read_b128 a[72:75], v6 offset:0
    v_cvt_pk_bf16_f32 v67, v38, v39
    v_mfma_f32_16x16x32_bf16 v[48:51], a[76:79], a[44:47], v[48:51]
    v_exp_f32 v47, v47
    v_mfma_f32_16x16x32_bf16 v[56:59], a[76:79], a[60:63], v[56:59]
    ds_read_b128 a[76:79], v7 offset:0
    v_cvt_pk_bf16_f32 v70, v44, v45
    v_mfma_f32_16x16x32_bf16 v[52:55], a[80:83], a[32:35], v[88:91]
    buffer_load_dwordx4 v21, s[12:15], s25 offen nt lds
    v_mfma_f32_16x16x32_bf16 v[60:63], a[80:83], a[48:51], v[92:95]
    ds_read_b128 a[80:83], v4 offset:4096
    v_cvt_pk_bf16_f32 v71, v46, v47
    v_mfma_f32_16x16x32_bf16 v[52:55], a[84:87], a[36:39], v[52:55]
    v_exp_f32 v48, v48
    v_mfma_f32_16x16x32_bf16 v[60:63], a[84:87], a[52:55], v[60:63]
    ds_read_b128 a[84:87], v5 offset:4096
    s_add_u32 m0, s80, 122880
    v_mfma_f32_16x16x32_bf16 v[52:55], a[88:91], a[40:43], v[52:55]
    v_exp_f32 v49, v49
    v_mfma_f32_16x16x32_bf16 v[60:63], a[88:91], a[56:59], v[60:63]
    ds_read_b128 a[88:91], v6 offset:4096
    buffer_load_dwordx4 v20, s[12:15], s81 offen nt lds
    v_mfma_f32_16x16x32_bf16 v[52:55], a[92:95], a[44:47], v[52:55]
    v_exp_f32 v50, v50
    v_mfma_f32_16x16x32_bf16 v[60:63], a[92:95], a[60:63], v[60:63]
    ds_read_b128 a[92:95], v7 offset:4096
    s_waitcnt lgkmcnt(8)
    v_mfma_f32_16x16x32_bf16 v[128:131], a[96:99], v[64:67], v[128:131]
    v_exp_f32 v51, v51
    v_mfma_f32_16x16x32_bf16 v[160:163], a[96:99], v[68:71], v[160:163]
    v_cvt_pk_bf16_f32 v72, v48, v49
    v_cvt_pk_bf16_f32 v73, v50, v51
    v_mfma_f32_16x16x32_bf16 v[132:135], a[100:103], v[64:67], v[132:135]
    v_exp_f32 v56, v56
    v_mfma_f32_16x16x32_bf16 v[164:167], a[100:103], v[68:71], v[164:167]
    s_add_u32 m0, s80, 126976
    v_mfma_f32_16x16x32_bf16 v[136:139], a[104:107], v[64:67], v[136:139]
    v_exp_f32 v57, v57
    v_mfma_f32_16x16x32_bf16 v[168:171], a[104:107], v[68:71], v[168:171]
    v_cvt_pk_bf16_f32 v76, v56, v57
    v_mfma_f32_16x16x32_bf16 v[140:143], a[108:111], v[64:67], v[140:143]
    v_exp_f32 v58, v58
    v_mfma_f32_16x16x32_bf16 v[172:175], a[108:111], v[68:71], v[172:175]
    buffer_load_dwordx4 v21, s[12:15], s81 offen nt lds
    v_mfma_f32_16x16x32_bf16 v[144:147], a[112:115], v[64:67], v[144:147]
    v_exp_f32 v59, v59
    v_mfma_f32_16x16x32_bf16 v[176:179], a[112:115], v[68:71], v[176:179]
    v_cvt_pk_bf16_f32 v77, v58, v59
    s_add_u32 s25, s25, 16384
    v_mfma_f32_16x16x32_bf16 v[148:151], a[116:119], v[64:67], v[148:151]
    v_exp_f32 v52, v52
    v_mfma_f32_16x16x32_bf16 v[180:183], a[116:119], v[68:71], v[180:183]
    s_add_u32 s81, s81, 16384
    s_add_u32 m0, s80, 49152
    v_mfma_f32_16x16x32_bf16 v[152:155], a[120:123], v[64:67], v[152:155]
    v_exp_f32 v53, v53
    v_mfma_f32_16x16x32_bf16 v[184:187], a[120:123], v[68:71], v[184:187]
    buffer_load_dwordx4 v16, s[8:11], s26 offen nt lds
    v_mfma_f32_16x16x32_bf16 v[156:159], a[124:127], v[64:67], v[156:159]
    v_exp_f32 v54, v54
    v_mfma_f32_16x16x32_bf16 v[188:191], a[124:127], v[68:71], v[188:191]
    s_add_u32 m0, s80, 53248
    v_mfma_f32_16x16x32_bf16 v[96:99], v[112:115], v[64:67], v[96:99]
    v_exp_f32 v55, v55
    v_mfma_f32_16x16x32_bf16 v[100:103], v[112:115], v[68:71], v[100:103]
    s_waitcnt lgkmcnt(0)
    v_mfma_f32_16x16x32_bf16 v[32:35], a[64:67], a[0:3], v[80:83]
    v_exp_f32 v60, v60
    v_mfma_f32_16x16x32_bf16 v[40:43], a[64:67], a[16:19], v[84:87]
    v_cvt_pk_bf16_f32 v74, v52, v53
    v_mfma_f32_16x16x32_bf16 v[32:35], a[68:71], a[4:7], v[32:35]
    v_exp_f32 v61, v61
    v_mfma_f32_16x16x32_bf16 v[40:43], a[68:71], a[20:23], v[40:43]
    v_cvt_pk_bf16_f32 v75, v54, v55
    v_cvt_pk_bf16_f32 v78, v60, v61
    v_mfma_f32_16x16x32_bf16 v[32:35], a[72:75], a[8:11], v[32:35]
    v_exp_f32 v62, v62
    v_mfma_f32_16x16x32_bf16 v[40:43], a[72:75], a[24:27], v[40:43]
    buffer_load_dwordx4 v17, s[8:11], s26 offen nt lds
    v_mfma_f32_16x16x32_bf16 v[32:35], a[76:79], a[12:15], v[32:35]
    v_exp_f32 v63, v63
    v_mfma_f32_16x16x32_bf16 v[40:43], a[76:79], a[28:31], v[40:43]
    v_cvt_pk_bf16_f32 v79, v62, v63
    v_mfma_f32_16x16x32_bf16 v[36:39], a[80:83], a[0:3], v[80:83]
    v_mfma_f32_16x16x32_bf16 v[44:47], a[80:83], a[16:19], v[84:87]
    s_add_u32 m0, s80, 57344
    v_mfma_f32_16x16x32_bf16 v[36:39], a[84:87], a[4:7], v[36:39]
    v_exp_f32 v32, v32
    v_mfma_f32_16x16x32_bf16 v[44:47], a[84:87], a[20:23], v[44:47]
    buffer_load_dwordx4 v16, s[8:11], s82 offen nt lds
    v_mfma_f32_16x16x32_bf16 v[36:39], a[88:91], a[8:11], v[36:39]
    v_exp_f32 v33, v33
    v_mfma_f32_16x16x32_bf16 v[44:47], a[88:91], a[24:27], v[44:47]
    v_cvt_pk_bf16_f32 v64, v32, v33
    s_add_u32 m0, s80, 61440
    v_mfma_f32_16x16x32_bf16 v[36:39], a[92:95], a[12:15], v[36:39]
    v_exp_f32 v34, v34
    v_mfma_f32_16x16x32_bf16 v[44:47], a[92:95], a[28:31], v[44:47]
    buffer_load_dwordx4 v17, s[8:11], s82 offen nt lds
    s_add_u32 s26, s26, 16384
    v_mfma_f32_16x16x32_bf16 v[192:195], a[96:99], v[72:75], v[192:195]
    v_exp_f32 v35, v35
    v_mfma_f32_16x16x32_bf16 v[224:227], a[96:99], v[76:79], v[224:227]
    ds_read_b64_tr_b16 a[96:97], v8 offset:8192
    ds_read_b64_tr_b16 a[98:99], v8 offset:12288
    v_mfma_f32_16x16x32_bf16 v[196:199], a[100:103], v[72:75], v[196:199]
    v_exp_f32 v40, v40
    v_mfma_f32_16x16x32_bf16 v[228:231], a[100:103], v[76:79], v[228:231]
    ds_read_b64_tr_b16 a[100:101], v9 offset:8192
    ds_read_b64_tr_b16 a[102:103], v9 offset:12288
    v_mfma_f32_16x16x32_bf16 v[200:203], a[104:107], v[72:75], v[200:203]
    v_exp_f32 v41, v41
    v_mfma_f32_16x16x32_bf16 v[232:235], a[104:107], v[76:79], v[232:235]
    ds_read_b64_tr_b16 a[104:105], v10 offset:8192
    ds_read_b64_tr_b16 a[106:107], v10 offset:12288
    v_mfma_f32_16x16x32_bf16 v[204:207], a[108:111], v[72:75], v[204:207]
    v_exp_f32 v42, v42
    v_mfma_f32_16x16x32_bf16 v[236:239], a[108:111], v[76:79], v[236:239]
    ds_read_b64_tr_b16 a[108:109], v11 offset:8192
    ds_read_b64_tr_b16 a[110:111], v11 offset:12288
    v_mfma_f32_16x16x32_bf16 v[208:211], a[112:115], v[72:75], v[208:211]
    v_exp_f32 v43, v43
    v_mfma_f32_16x16x32_bf16 v[240:243], a[112:115], v[76:79], v[240:243]
    ds_read_b64_tr_b16 a[112:113], v12 offset:8192
    ds_read_b64_tr_b16 a[114:115], v12 offset:12288
    v_mfma_f32_16x16x32_bf16 v[212:215], a[116:119], v[72:75], v[212:215]
    v_exp_f32 v36, v36
    v_mfma_f32_16x16x32_bf16 v[244:247], a[116:119], v[76:79], v[244:247]
    ds_read_b64_tr_b16 a[116:117], v13 offset:8192
    ds_read_b64_tr_b16 a[118:119], v13 offset:12288
    v_mfma_f32_16x16x32_bf16 v[216:219], a[120:123], v[72:75], v[216:219]
    v_exp_f32 v37, v37
    v_mfma_f32_16x16x32_bf16 v[248:251], a[120:123], v[76:79], v[248:251]
    ds_read_b64_tr_b16 a[120:121], v14 offset:8192
    ds_read_b64_tr_b16 a[122:123], v14 offset:12288
    v_mfma_f32_16x16x32_bf16 v[220:223], a[124:127], v[72:75], v[220:223]
    v_exp_f32 v38, v38
    v_mfma_f32_16x16x32_bf16 v[252:255], a[124:127], v[76:79], v[252:255]
    ds_read_b64_tr_b16 a[124:125], v15 offset:8192
    ds_read_b64_tr_b16 a[126:127], v15 offset:12288
    v_mfma_f32_16x16x32_bf16 v[104:107], v[112:115], v[72:75], v[104:107]
    v_exp_f32 v39, v39
    v_mfma_f32_16x16x32_bf16 v[108:111], v[112:115], v[76:79], v[108:111]
    v_cvt_pk_bf16_f32 v65, v34, v35
    v_cvt_pk_bf16_f32 v68, v40, v41
    v_mfma_f32_16x16x32_bf16 v[48:51], a[64:67], a[32:35], v[88:91]
    v_exp_f32 v44, v44
    v_mfma_f32_16x16x32_bf16 v[56:59], a[64:67], a[48:51], v[92:95]
    ds_read_b128 a[64:67], v4 offset:8192
    v_cvt_pk_bf16_f32 v69, v42, v43
    v_mfma_f32_16x16x32_bf16 v[48:51], a[68:71], a[36:39], v[48:51]
    v_exp_f32 v45, v45
    v_mfma_f32_16x16x32_bf16 v[56:59], a[68:71], a[52:55], v[56:59]
    ds_read_b128 a[68:71], v5 offset:8192
    v_cvt_pk_bf16_f32 v66, v36, v37
    v_mfma_f32_16x16x32_bf16 v[48:51], a[72:75], a[40:43], v[48:51]
    v_exp_f32 v46, v46
    v_mfma_f32_16x16x32_bf16 v[56:59], a[72:75], a[56:59], v[56:59]
    ds_read_b128 a[72:75], v6 offset:8192
    v_cvt_pk_bf16_f32 v67, v38, v39
    v_mfma_f32_16x16x32_bf16 v[48:51], a[76:79], a[44:47], v[48:51]
    v_exp_f32 v47, v47
    v_mfma_f32_16x16x32_bf16 v[56:59], a[76:79], a[60:63], v[56:59]
    ds_read_b128 a[76:79], v7 offset:8192
    v_cvt_pk_bf16_f32 v70, v44, v45
    v_mfma_f32_16x16x32_bf16 v[52:55], a[80:83], a[32:35], v[88:91]
    s_add_u32 s82, s82, 16384
    v_mfma_f32_16x16x32_bf16 v[60:63], a[80:83], a[48:51], v[92:95]
    ds_read_b128 a[80:83], v4 offset:12288
    v_cvt_pk_bf16_f32 v71, v46, v47
    v_mfma_f32_16x16x32_bf16 v[52:55], a[84:87], a[36:39], v[52:55]
    v_exp_f32 v48, v48
    v_mfma_f32_16x16x32_bf16 v[60:63], a[84:87], a[52:55], v[60:63]
    ds_read_b128 a[84:87], v5 offset:12288
    v_xor_b32 v22, 0, v122
    v_mfma_f32_16x16x32_bf16 v[52:55], a[88:91], a[40:43], v[52:55]
    v_exp_f32 v49, v49
    v_mfma_f32_16x16x32_bf16 v[60:63], a[88:91], a[56:59], v[60:63]
    ds_read_b128 a[88:91], v6 offset:12288
    v_xor_b32 v23, 64, v122
    v_mfma_f32_16x16x32_bf16 v[52:55], a[92:95], a[44:47], v[52:55]
    v_exp_f32 v50, v50
    v_mfma_f32_16x16x32_bf16 v[60:63], a[92:95], a[60:63], v[60:63]
    ds_read_b128 a[92:95], v7 offset:12288
    s_waitcnt lgkmcnt(8)
    v_mfma_f32_16x16x32_bf16 v[128:131], a[96:99], v[64:67], v[128:131]
    v_exp_f32 v51, v51
    v_mfma_f32_16x16x32_bf16 v[160:163], a[96:99], v[68:71], v[160:163]
    v_cvt_pk_bf16_f32 v72, v48, v49
    v_cvt_pk_bf16_f32 v73, v50, v51
    v_mfma_f32_16x16x32_bf16 v[132:135], a[100:103], v[64:67], v[132:135]
    v_exp_f32 v56, v56
    v_mfma_f32_16x16x32_bf16 v[164:167], a[100:103], v[68:71], v[164:167]
    s_waitcnt vmcnt(10)
    ds_read_b128 v[32:35], v121 offset:0
    v_mfma_f32_16x16x32_bf16 v[136:139], a[104:107], v[64:67], v[136:139]
    v_exp_f32 v57, v57
    v_mfma_f32_16x16x32_bf16 v[168:171], a[104:107], v[68:71], v[168:171]
    v_cvt_pk_bf16_f32 v76, v56, v57
    ds_read_b128 v[36:39], v121 offset:1024
    v_mfma_f32_16x16x32_bf16 v[140:143], a[108:111], v[64:67], v[140:143]
    v_exp_f32 v58, v58
    v_mfma_f32_16x16x32_bf16 v[172:175], a[108:111], v[68:71], v[172:175]
    ds_read_b128 v[40:43], v121 offset:2048
    ds_read_b128 v[44:47], v121 offset:3072
    v_mfma_f32_16x16x32_bf16 v[144:147], a[112:115], v[64:67], v[144:147]
    v_exp_f32 v59, v59
    v_mfma_f32_16x16x32_bf16 v[176:179], a[112:115], v[68:71], v[176:179]
    v_cvt_pk_bf16_f32 v77, v58, v59
    v_xor_b32 v24, 128, v122
    v_mfma_f32_16x16x32_bf16 v[148:151], a[116:119], v[64:67], v[148:151]
    v_exp_f32 v52, v52
    v_mfma_f32_16x16x32_bf16 v[180:183], a[116:119], v[68:71], v[180:183]
    ds_read_b64_tr_b16 v[48:49], v22 offset:8192
    ds_read_b64_tr_b16 v[50:51], v22 offset:9216
    v_mfma_f32_16x16x32_bf16 v[152:155], a[120:123], v[64:67], v[152:155]
    v_exp_f32 v53, v53
    v_mfma_f32_16x16x32_bf16 v[184:187], a[120:123], v[68:71], v[184:187]
    ds_read_b64_tr_b16 v[56:57], v22 offset:8200
    ds_read_b64_tr_b16 v[58:59], v22 offset:9224
    v_mfma_f32_16x16x32_bf16 v[156:159], a[124:127], v[64:67], v[156:159]
    v_exp_f32 v54, v54
    v_mfma_f32_16x16x32_bf16 v[188:191], a[124:127], v[68:71], v[188:191]
    v_xor_b32 v25, 192, v122
    v_mfma_f32_16x16x32_bf16 v[96:99], v[112:115], v[64:67], v[96:99]
    v_exp_f32 v55, v55
    v_mfma_f32_16x16x32_bf16 v[100:103], v[112:115], v[68:71], v[100:103]
    s_waitcnt lgkmcnt(2)
    v_mfma_f32_16x16x32_bf16 a[128:131], v[48:51], v[32:35], a[128:131]
    ds_read_b64_tr_b16 v[64:65], v23 offset:8192
    ds_read_b64_tr_b16 v[66:67], v23 offset:9216
    v_mfma_f32_16x16x32_bf16 a[160:163], v[48:51], v[36:39], a[160:163]
    s_add_u32 m0, s24, 131072
    s_add_u32 s72, s70, 0
    v_mfma_f32_16x16x32_bf16 a[192:195], v[48:51], v[40:43], a[192:195]
    buffer_load_dwordx4 v18, s[32:35], s72 offen lds
    v_mfma_f32_16x16x32_bf16 a[224:227], v[48:51], v[44:47], a[224:227]
    s_waitcnt lgkmcnt(2)
    v_mfma_f32_16x16x32_bf16 a[132:135], v[56:59], v[32:35], a[132:135]
    ds_read_b64_tr_b16 v[68:69], v23 offset:8200
    ds_read_b64_tr_b16 v[70:71], v23 offset:9224
    v_mfma_f32_16x16x32_bf16 a[164:167], v[56:59], v[36:39], a[164:167]
    v_mfma_f32_16x16x32_bf16 a[196:199], v[56:59], v[40:43], a[196:199]
    v_mfma_f32_16x16x32_bf16 a[228:231], v[56:59], v[44:47], a[228:231]
    s_waitcnt lgkmcnt(2)
    v_mfma_f32_16x16x32_bf16 a[136:139], v[64:67], v[32:35], a[136:139]
    ds_read_b64_tr_b16 v[48:49], v24 offset:8192
    ds_read_b64_tr_b16 v[50:51], v24 offset:9216
    v_mfma_f32_16x16x32_bf16 a[168:171], v[64:67], v[36:39], a[168:171]
    s_add_u32 m0, s24, 132096
    s_add_u32 s72, s70, 16384
    v_mfma_f32_16x16x32_bf16 a[200:203], v[64:67], v[40:43], a[200:203]
    buffer_load_dwordx4 v18, s[32:35], s72 offen lds
    v_mfma_f32_16x16x32_bf16 a[232:235], v[64:67], v[44:47], a[232:235]
    s_waitcnt lgkmcnt(2)
    v_mfma_f32_16x16x32_bf16 a[140:143], v[68:71], v[32:35], a[140:143]
    ds_read_b64_tr_b16 v[56:57], v24 offset:8200
    ds_read_b64_tr_b16 v[58:59], v24 offset:9224
    v_mfma_f32_16x16x32_bf16 a[172:175], v[68:71], v[36:39], a[172:175]
    v_mfma_f32_16x16x32_bf16 a[204:207], v[68:71], v[40:43], a[204:207]
    v_mfma_f32_16x16x32_bf16 a[236:239], v[68:71], v[44:47], a[236:239]
    s_waitcnt lgkmcnt(2)
    v_mfma_f32_16x16x32_bf16 a[144:147], v[48:51], v[32:35], a[144:147]
    ds_read_b64_tr_b16 v[64:65], v25 offset:8192
    ds_read_b64_tr_b16 v[66:67], v25 offset:9216
    v_mfma_f32_16x16x32_bf16 a[176:179], v[48:51], v[36:39], a[176:179]
    s_add_u32 m0, s24, 133120
    s_add_u32 s72, s70, 32768
    v_mfma_f32_16x16x32_bf16 a[208:211], v[48:51], v[40:43], a[208:211]
    buffer_load_dwordx4 v18, s[32:35], s72 offen lds
    v_mfma_f32_16x16x32_bf16 a[240:243], v[48:51], v[44:47], a[240:243]
    s_waitcnt lgkmcnt(2)
    v_mfma_f32_16x16x32_bf16 a[148:151], v[56:59], v[32:35], a[148:151]
    ds_read_b64_tr_b16 v[68:69], v25 offset:8200
    ds_read_b64_tr_b16 v[70:71], v25 offset:9224
    v_mfma_f32_16x16x32_bf16 a[180:183], v[56:59], v[36:39], a[180:183]
    v_mfma_f32_16x16x32_bf16 a[212:215], v[56:59], v[40:43], a[212:215]
    v_mfma_f32_16x16x32_bf16 a[244:247], v[56:59], v[44:47], a[244:247]
    s_waitcnt lgkmcnt(2)
    v_mfma_f32_16x16x32_bf16 a[152:155], v[64:67], v[32:35], a[152:155]
    s_add_u32 m0, s24, 134144
    s_add_u32 s72, s70, 49152
    v_mfma_f32_16x16x32_bf16 a[184:187], v[64:67], v[36:39], a[184:187]
    buffer_load_dwordx4 v18, s[32:35], s72 offen lds
    s_add_u32 s70, s70, 64
    v_mfma_f32_16x16x32_bf16 a[216:219], v[64:67], v[40:43], a[216:219]
    v_mfma_f32_16x16x32_bf16 a[248:251], v[64:67], v[44:47], a[248:251]
    s_waitcnt lgkmcnt(0)
    v_mfma_f32_16x16x32_bf16 a[156:159], v[68:71], v[32:35], a[156:159]
    v_mfma_f32_16x16x32_bf16 a[188:191], v[68:71], v[36:39], a[188:191]
    v_mfma_f32_16x16x32_bf16 a[220:223], v[68:71], v[40:43], a[220:223]
    v_mfma_f32_16x16x32_bf16 a[252:255], v[68:71], v[44:47], a[252:255]
    s_branch L_loop1
L_loop1_end:
    v_exp_f32 v60, v60
    v_exp_f32 v61, v61
    v_exp_f32 v62, v62
    v_exp_f32 v63, v63
    v_cvt_pk_bf16_f32 v74, v52, v53
    v_cvt_pk_bf16_f32 v75, v54, v55
    v_cvt_pk_bf16_f32 v78, v60, v61
    v_cvt_pk_bf16_f32 v79, v62, v63
    s_nop 1
    v_mfma_f32_16x16x32_bf16 v[192:195], a[96:99], v[72:75], v[192:195]
    v_mfma_f32_16x16x32_bf16 v[224:227], a[96:99], v[76:79], v[224:227]
    v_mfma_f32_16x16x32_bf16 v[196:199], a[100:103], v[72:75], v[196:199]
    v_mfma_f32_16x16x32_bf16 v[228:231], a[100:103], v[76:79], v[228:231]
    v_mfma_f32_16x16x32_bf16 v[200:203], a[104:107], v[72:75], v[200:203]
    v_mfma_f32_16x16x32_bf16 v[232:235], a[104:107], v[76:79], v[232:235]
    v_mfma_f32_16x16x32_bf16 v[204:207], a[108:111], v[72:75], v[204:207]
    v_mfma_f32_16x16x32_bf16 v[236:239], a[108:111], v[76:79], v[236:239]
    v_mfma_f32_16x16x32_bf16 v[208:211], a[112:115], v[72:75], v[208:211]
    v_mfma_f32_16x16x32_bf16 v[240:243], a[112:115], v[76:79], v[240:243]
    v_mfma_f32_16x16x32_bf16 v[212:215], a[116:119], v[72:75], v[212:215]
    v_mfma_f32_16x16x32_bf16 v[244:247], a[116:119], v[76:79], v[244:247]
    v_mfma_f32_16x16x32_bf16 v[216:219], a[120:123], v[72:75], v[216:219]
    v_mfma_f32_16x16x32_bf16 v[248:251], a[120:123], v[76:79], v[248:251]
    v_mfma_f32_16x16x32_bf16 v[220:223], a[124:127], v[72:75], v[220:223]
    v_mfma_f32_16x16x32_bf16 v[252:255], a[124:127], v[76:79], v[252:255]
    v_mfma_f32_16x16x32_bf16 v[104:107], v[112:115], v[72:75], v[104:107]
    v_mfma_f32_16x16x32_bf16 v[108:111], v[112:115], v[76:79], v[108:111]
    s_nop 7
    v_mov_b32 v30, 0x4e800000
    v_cmp_nlt_f32 vcc, v96, v30
    s_or_b64 s[88:89], s[88:89], vcc
    v_cmp_nlt_f32 vcc, v100, v30
    s_or_b64 s[88:89], s[88:89], vcc
    v_cmp_nlt_f32 vcc, v104, v30
    s_or_b64 s[88:89], s[88:89], vcc
    v_cmp_nlt_f32 vcc, v108, v30
    s_or_b64 s[88:89], s[88:89], vcc
    v_rcp_f32 v22, v96
    v_rcp_f32 v24, v100
    v_rcp_f32 v26, v104
    v_rcp_f32 v28, v108
    v_pk_mul_f32 v[128:129], v[128:129], v[22:23] op_sel_hi:[1,0]
    v_pk_mul_f32 v[130:131], v[130:131], v[22:23] op_sel_hi:[1,0]
    v_pk_mul_f32 v[132:133], v[132:133], v[22:23] op_sel_hi:[1,0]
    v_pk_mul_f32 v[134:135], v[134:135], v[22:23] op_sel_hi:[1,0]
    v_cvt_pk_bf16_f32 v128, v128, v129
    v_cvt_pk_bf16_f32 v129, v130, v131
    v_cvt_pk_bf16_f32 v130, v132, v133
    v_cvt_pk_bf16_f32 v131, v134, v135
    v_pk_mul_f32 v[136:137], v[136:137], v[22:23] op_sel_hi:[1,0]
    v_pk_mul_f32 v[138:139], v[138:139], v[22:23] op_sel_hi:[1,0]
    v_pk_mul_f32 v[140:141], v[140:141], v[22:23] op_sel_hi:[1,0]
    v_pk_mul_f32 v[142:143], v[142:143], v[22:23] op_sel_hi:[1,0]
    v_cvt_pk_bf16_f32 v136, v136, v137
    v_cvt_pk_bf16_f32 v137, v138, v139
    v_cvt_pk_bf16_f32 v138, v140, v141
    v_cvt_pk_bf16_f32 v139, v142, v143
    v_pk_mul_f32 v[144:145], v[144:145], v[22:23] op_sel_hi:[1,0]
    v_pk_mul_f32 v[146:147], v[146:147], v[22:23] op_sel_hi:[1,0]
    v_pk_mul_f32 v[148:149], v[148:149], v[22:23] op_sel_hi:[1,0]
    v_pk_mul_f32 v[150:151], v[150:151], v[22:23] op_sel_hi:[1,0]
    v_cvt_pk_bf16_f32 v144, v144, v145
    v_cvt_pk_bf16_f32 v145, v146, v147
    v_cvt_pk_bf16_f32 v146, v148, v149
    v_cvt_pk_bf16_f32 v147, v150, v151
    v_pk_mul_f32 v[152:153], v[152:153], v[22:23] op_sel_hi:[1,0]
    v_pk_mul_f32 v[154:155], v[154:155], v[22:23] op_sel_hi:[1,0]
    v_pk_mul_f32 v[156:157], v[156:157], v[22:23] op_sel_hi:[1,0]
    v_pk_mul_f32 v[158:159], v[158:159], v[22:23] op_sel_hi:[1,0]
    v_cvt_pk_bf16_f32 v152, v152, v153
    v_cvt_pk_bf16_f32 v153, v154, v155
    v_cvt_pk_bf16_f32 v154, v156, v157
    v_cvt_pk_bf16_f32 v155, v158, v159
    v_pk_mul_f32 v[160:161], v[160:161], v[24:25] op_sel_hi:[1,0]
    v_pk_mul_f32 v[162:163], v[162:163], v[24:25] op_sel_hi:[1,0]
    v_pk_mul_f32 v[164:165], v[164:165], v[24:25] op_sel_hi:[1,0]
    v_pk_mul_f32 v[166:167], v[166:167], v[24:25] op_sel_hi:[1,0]
    v_cvt_pk_bf16_f32 v160, v160, v161
    v_cvt_pk_bf16_f32 v161, v162, v163
    v_cvt_pk_bf16_f32 v162, v164, v165
    v_cvt_pk_bf16_f32 v163, v166, v167
    v_pk_mul_f32 v[168:169], v[168:169], v[24:25] op_sel_hi:[1,0]
    v_pk_mul_f32 v[170:171], v[170:171], v[24:25] op_sel_hi:[1,0]
    v_pk_mul_f32 v[172:173], v[172:173], v[24:25] op_sel_hi:[1,0]
    v_pk_mul_f32 v[174:175], v[174:175], v[24:25] op_sel_hi:[1,0]
    v_cvt_pk_bf16_f32 v168, v168, v169
    v_cvt_pk_bf16_f32 v169, v170, v171
    v_cvt_pk_bf16_f32 v170, v172, v173
    v_cvt_pk_bf16_f32 v171, v174, v175
    v_pk_mul_f32 v[176:177], v[176:177], v[24:25] op_sel_hi:[1,0]
    v_pk_mul_f32 v[178:179], v[178:179], v[24:25] op_sel_hi:[1,0]
    v_pk_mul_f32 v[180:181], v[180:181], v[24:25] op_sel_hi:[1,0]
    v_pk_mul_f32 v[182:183], v[182:183], v[24:25] op_sel_hi:[1,0]
    v_cvt_pk_bf16_f32 v176, v176, v177
    v_cvt_pk_bf16_f32 v177, v178, v179
    v_cvt_pk_bf16_f32 v178, v180, v181
    v_cvt_pk_bf16_f32 v179, v182, v183
    v_pk_mul_f32 v[184:185], v[184:185], v[24:25] op_sel_hi:[1,0]
    v_pk_mul_f32 v[186:187], v[186:187], v[24:25] op_sel_hi:[1,0]
    v_pk_mul_f32 v[188:189], v[188:189], v[24:25] op_sel_hi:[1,0]
    v_pk_mul_f32 v[190:191], v[190:191], v[24:25] op_sel_hi:[1,0]
    v_cvt_pk_bf16_f32 v184, v184, v185
    v_cvt_pk_bf16_f32 v185, v186, v187
    v_cvt_pk_bf16_f32 v186, v188, v189
    v_cvt_pk_bf16_f32 v187, v190, v191
    v_pk_mul_f32 v[192:193], v[192:193], v[26:27] op_sel_hi:[1,0]
    v_pk_mul_f32 v[194:195], v[194:195], v[26:27] op_sel_hi:[1,0]
    v_pk_mul_f32 v[196:197], v[196:197], v[26:27] op_sel_hi:[1,0]
    v_pk_mul_f32 v[198:199], v[198:199], v[26:27] op_sel_hi:[1,0]
    v_cvt_pk_bf16_f32 v192, v192, v193
    v_cvt_pk_bf16_f32 v193, v194, v195
    v_cvt_pk_bf16_f32 v194, v196, v197
    v_cvt_pk_bf16_f32 v195, v198, v199
    v_pk_mul_f32 v[200:201], v[200:201], v[26:27] op_sel_hi:[1,0]
    v_pk_mul_f32 v[202:203], v[202:203], v[26:27] op_sel_hi:[1,0]
    v_pk_mul_f32 v[204:205], v[204:205], v[26:27] op_sel_hi:[1,0]
    v_pk_mul_f32 v[206:207], v[206:207], v[26:27] op_sel_hi:[1,0]
    v_cvt_pk_bf16_f32 v200, v200, v201
    v_cvt_pk_bf16_f32 v201, v202, v203
    v_cvt_pk_bf16_f32 v202, v204, v205
    v_cvt_pk_bf16_f32 v203, v206, v207
    v_pk_mul_f32 v[208:209], v[208:209], v[26:27] op_sel_hi:[1,0]
    v_pk_mul_f32 v[210:211], v[210:211], v[26:27] op_sel_hi:[1,0]
    v_pk_mul_f32 v[212:213], v[212:213], v[26:27] op_sel_hi:[1,0]
    v_pk_mul_f32 v[214:215], v[214:215], v[26:27] op_sel_hi:[1,0]
    v_cvt_pk_bf16_f32 v208, v208, v209
    v_cvt_pk_bf16_f32 v209, v210, v211
    v_cvt_pk_bf16_f32 v210, v212, v213
    v_cvt_pk_bf16_f32 v211, v214, v215
    v_pk_mul_f32 v[216:217], v[216:217], v[26:27] op_sel_hi:[1,0]
    v_pk_mul_f32 v[218:219], v[218:219], v[26:27] op_sel_hi:[1,0]
    v_pk_mul_f32 v[220:221], v[220:221], v[26:27] op_sel_hi:[1,0]
    v_pk_mul_f32 v[222:223], v[222:223], v[26:27] op_sel_hi:[1,0]
    v_cvt_pk_bf16_f32 v216, v216, v217
    v_cvt_pk_bf16_f32 v217, v218, v219
    v_cvt_pk_bf16_f32 v218, v220, v221
    v_cvt_pk_bf16_f32 v219, v222, v223
    v_pk_mul_f32 v[224:225], v[224:225], v[28:29] op_sel_hi:[1,0]
    v_pk_mul_f32 v[226:227], v[226:227], v[28:29] op_sel_hi:[1,0]
    v_pk_mul_f32 v[228:229], v[228:229], v[28:29] op_sel_hi:[1,0]
    v_pk_mul_f32 v[230:231], v[230:231], v[28:29] op_sel_hi:[1,0]
    v_cvt_pk_bf16_f32 v224, v224, v225
    v_cvt_pk_bf16_f32 v225, v226, v227
    v_cvt_pk_bf16_f32 v226, v228, v229
    v_cvt_pk_bf16_f32 v227, v230, v231
    v_pk_mul_f32 v[232:233], v[232:233], v[28:29] op_sel_hi:[1,0]
    v_pk_mul_f32 v[234:235], v[234:235], v[28:29] op_sel_hi:[1,0]
    v_pk_mul_f32 v[236:237], v[236:237], v[28:29] op_sel_hi:[1,0]
    v_pk_mul_f32 v[238:239], v[238:239], v[28:29] op_sel_hi:[1,0]
    v_cvt_pk_bf16_f32 v232, v232, v233
    v_cvt_pk_bf16_f32 v233, v234, v235
    v_cvt_pk_bf16_f32 v234, v236, v237
    v_cvt_pk_bf16_f32 v235, v238, v239
    v_pk_mul_f32 v[240:241], v[240:241], v[28:29] op_sel_hi:[1,0]
    v_pk_mul_f32 v[242:243], v[242:243], v[28:29] op_sel_hi:[1,0]
    v_pk_mul_f32 v[244:245], v[244:245], v[28:29] op_sel_hi:[1,0]
    v_pk_mul_f32 v[246:247], v[246:247], v[28:29] op_sel_hi:[1,0]
    v_cvt_pk_bf16_f32 v240, v240, v241
    v_cvt_pk_bf16_f32 v241, v242, v243
    v_cvt_pk_bf16_f32 v242, v244, v245
    v_cvt_pk_bf16_f32 v243, v246, v247
    v_pk_mul_f32 v[248:249], v[248:249], v[28:29] op_sel_hi:[1,0]
    v_pk_mul_f32 v[250:251], v[250:251], v[28:29] op_sel_hi:[1,0]
    v_pk_mul_f32 v[252:253], v[252:253], v[28:29] op_sel_hi:[1,0]
    v_pk_mul_f32 v[254:255], v[254:255], v[28:29] op_sel_hi:[1,0]
    v_cvt_pk_bf16_f32 v248, v248, v249
    v_cvt_pk_bf16_f32 v249, v250, v251
    v_cvt_pk_bf16_f32 v250, v252, v253
    v_cvt_pk_bf16_f32 v251, v254, v255
    s_waitcnt vmcnt(0) lgkmcnt(0)
    s_barrier
    s_cmp_lg_u64 s[88:89], 0
    s_cselect_b32 s3, 1, 0
    v_mov_b32 v23, s3
    v_lshlrev_b32 v25, 2, v2
    v_add_u32 v25, 155632, v25
    ds_write_b32 v25, v23
    s_waitcnt lgkmcnt(0)
    v_xor_b32 v22, 0, v122
    v_xor_b32 v23, 64, v122
    v_xor_b32 v24, 128, v122
    v_xor_b32 v25, 192, v122
    ds_read_b128 v[32:35], v121 offset:0
    ds_read_b128 v[36:39], v121 offset:1024
    ds_read_b128 v[40:43], v121 offset:2048
    ds_read_b128 v[44:47], v121 offset:3072
    ds_read_b64_tr_b16 v[48:49], v22 offset:8192
    ds_read_b64_tr_b16 v[50:51], v22 offset:9216
    ds_read_b64_tr_b16 v[56:57], v22 offset:8200
    ds_read_b64_tr_b16 v[58:59], v22 offset:9224
    s_waitcnt lgkmcnt(2)
    v_mfma_f32_16x16x32_bf16 a[128:131], v[48:51], v[32:35], a[128:131]
    ds_read_b64_tr_b16 v[64:65], v23 offset:8192
    ds_read_b64_tr_b16 v[66:67], v23 offset:9216
    v_mfma_f32_16x16x32_bf16 a[160:163], v[48:51], v[36:39], a[160:163]
    v_mfma_f32_16x16x32_bf16 a[192:195], v[48:51], v[40:43], a[192:195]
    v_mfma_f32_16x16x32_bf16 a[224:227], v[48:51], v[44:47], a[224:227]
    s_waitcnt lgkmcnt(2)
    v_mfma_f32_16x16x32_bf16 a[132:135], v[56:59], v[32:35], a[132:135]
    ds_read_b64_tr_b16 v[68:69], v23 offset:8200
    ds_read_b64_tr_b16 v[70:71], v23 offset:9224
    v_mfma_f32_16x16x32_bf16 a[164:167], v[56:59], v[36:39], a[164:167]
    v_mfma_f32_16x16x32_bf16 a[196:199], v[56:59], v[40:43], a[196:199]
    v_mfma_f32_16x16x32_bf16 a[228:231], v[56:59], v[44:47], a[228:231]
    s_waitcnt lgkmcnt(2)
    v_mfma_f32_16x16x32_bf16 a[136:139], v[64:67], v[32:35], a[136:139]
    ds_read_b64_tr_b16 v[48:49], v24 offset:8192
    ds_read_b64_tr_b16 v[50:51], v24 offset:9216
    v_mfma_f32_16x16x32_bf16 a[168:171], v[64:67], v[36:39], a[168:171]
    v_mfma_f32_16x16x32_bf16 a[200:203], v[64:67], v[40:43], a[200:203]
    v_mfma_f32_16x16x32_bf16 a[232:235], v[64:67], v[44:47], a[232:235]
    s_waitcnt lgkmcnt(2)
    v_mfma_f32_16x16x32_bf16 a[140:143], v[68:71], v[32:35], a[140:143]
    ds_read_b64_tr_b16 v[56:57], v24 offset:8200
    ds_read_b64_tr_b16 v[58:59], v24 offset:9224
    v_mfma_f32_16x16x32_bf16 a[172:175], v[68:71], v[36:39], a[172:175]
    v_mfma_f32_16x16x32_bf16 a[204:207], v[68:71], v[40:43], a[204:207]
    v_mfma_f32_16x16x32_bf16 a[236:239], v[68:71], v[44:47], a[236:239]
    s_waitcnt lgkmcnt(2)
    v_mfma_f32_16x16x32_bf16 a[144:147], v[48:51], v[32:35], a[144:147]
    ds_read_b64_tr_b16 v[64:65], v25 offset:8192
    ds_read_b64_tr_b16 v[66:67], v25 offset:9216
    v_mfma_f32_16x16x32_bf16 a[176:179], v[48:51], v[36:39], a[176:179]
    v_mfma_f32_16x16x32_bf16 a[208:211], v[48:51], v[40:43], a[208:211]
    v_mfma_f32_16x16x32_bf16 a[240:243], v[48:51], v[44:47], a[240:243]
    s_waitcnt lgkmcnt(2)
    v_mfma_f32_16x16x32_bf16 a[148:151], v[56:59], v[32:35], a[148:151]
    ds_read_b64_tr_b16 v[68:69], v25 offset:8200
    ds_read_b64_tr_b16 v[70:71], v25 offset:9224
    v_mfma_f32_16x16x32_bf16 a[180:183], v[56:59], v[36:39], a[180:183]
    v_mfma_f32_16x16x32_bf16 a[212:215], v[56:59], v[40:43], a[212:215]
    v_mfma_f32_16x16x32_bf16 a[244:247], v[56:59], v[44:47], a[244:247]
    s_waitcnt lgkmcnt(2)
    v_mfma_f32_16x16x32_bf16 a[152:155], v[64:67], v[32:35], a[152:155]
    v_mfma_f32_16x16x32_bf16 a[184:187], v[64:67], v[36:39], a[184:187]
    v_mfma_f32_16x16x32_bf16 a[216:219], v[64:67], v[40:43], a[216:219]
    v_mfma_f32_16x16x32_bf16 a[248:251], v[64:67], v[44:47], a[248:251]
    s_waitcnt lgkmcnt(0)
    v_mfma_f32_16x16x32_bf16 a[156:159], v[68:71], v[32:35], a[156:159]
    v_mfma_f32_16x16x32_bf16 a[188:191], v[68:71], v[36:39], a[188:191]
    v_mfma_f32_16x16x32_bf16 a[220:223], v[68:71], v[40:43], a[220:223]
    v_mfma_f32_16x16x32_bf16 a[252:255], v[68:71], v[44:47], a[252:255]
    s_nop 7
    s_mov_b32 s78, s29
    s_add_u32 s29, s29, 4096
    s_mov_b32 s28, 1
    s_lshl_b32 s3, s2, 14
    v_lshlrev_b32 v29, 12, v2
    v_lshl_add_u32 v29, v1, 6, v29
    v_add_u32 v29, s3, v29
    global_load_dword v31, v29, s[84:85]
    v_accvgpr_read_b32 v32, a128
    v_accvgpr_read_b32 v33, a129
    v_accvgpr_read_b32 v34, a130
    v_accvgpr_read_b32 v35, a131
    v_accvgpr_read_b32 v36, a132
    v_accvgpr_read_b32 v37, a133
    v_accvgpr_read_b32 v38, a134
    v_accvgpr_read_b32 v39, a135
    v_pk_mul_f32 v[32:33], v[32:33], v[120:121] op_sel_hi:[1,0]
    v_pk_mul_f32 v[34:35], v[34:35], v[120:121] op_sel_hi:[1,0]
    v_pk_mul_f32 v[36:37], v[36:37], v[120:121] op_sel_hi:[1,0]
    v_pk_mul_f32 v[38:39], v[38:39], v[120:121] op_sel_hi:[1,0]
    v_cvt_pk_bf16_f32 v32, v32, v33
    v_cvt_pk_bf16_f32 v33, v34, v35
    v_cvt_pk_bf16_f32 v34, v36, v37
    v_cvt_pk_bf16_f32 v35, v38, v39
    v_accvgpr_write_b32 a0, v32
    v_accvgpr_write_b32 a1, v33
    v_accvgpr_write_b32 a2, v34
    v_accvgpr_write_b32 a3, v35
    v_accvgpr_read_b32 v40, a136
    v_accvgpr_read_b32 v41, a137
    v_accvgpr_read_b32 v42, a138
    v_accvgpr_read_b32 v43, a139
    v_accvgpr_read_b32 v44, a140
    v_accvgpr_read_b32 v45, a141
    v_accvgpr_read_b32 v46, a142
    v_accvgpr_read_b32 v47, a143
    v_pk_mul_f32 v[40:41], v[40:41], v[120:121] op_sel_hi:[1,0]
    v_pk_mul_f32 v[42:43], v[42:43], v[120:121] op_sel_hi:[1,0]
    v_pk_mul_f32 v[44:45], v[44:45], v[120:121] op_sel_hi:[1,0]
    v_pk_mul_f32 v[46:47], v[46:47], v[120:121] op_sel_hi:[1,0]
    v_cvt_pk_bf16_f32 v40, v40, v41
    v_cvt_pk_bf16_f32 v41, v42, v43
    v_cvt_pk_bf16_f32 v42, v44, v45
    v_cvt_pk_bf16_f32 v43, v46, v47
    v_accvgpr_write_b32 a4, v40
    v_accvgpr_write_b32 a5, v41
    v_accvgpr_write_b32 a6, v42
    v_accvgpr_write_b32 a7, v43
    v_accvgpr_read_b32 v32, a144
    v_accvgpr_read_b32 v33, a145
    v_accvgpr_read_b32 v34, a146
    v_accvgpr_read_b32 v35, a147
    v_accvgpr_read_b32 v36, a148
    v_accvgpr_read_b32 v37, a149
    v_accvgpr_read_b32 v38, a150
    v_accvgpr_read_b32 v39, a151
    v_pk_mul_f32 v[32:33], v[32:33], v[120:121] op_sel_hi:[1,0]
    v_pk_mul_f32 v[34:35], v[34:35], v[120:121] op_sel_hi:[1,0]
    v_pk_mul_f32 v[36:37], v[36:37], v[120:121] op_sel_hi:[1,0]
    v_pk_mul_f32 v[38:39], v[38:39], v[120:121] op_sel_hi:[1,0]
    v_cvt_pk_bf16_f32 v32, v32, v33
    v_cvt_pk_bf16_f32 v33, v34, v35
    v_cvt_pk_bf16_f32 v34, v36, v37
    v_cvt_pk_bf16_f32 v35, v38, v39
    v_accvgpr_write_b32 a8, v32
    v_accvgpr_write_b32 a9, v33
    v_accvgpr_write_b32 a10, v34
    v_accvgpr_write_b32 a11, v35
    v_accvgpr_read_b32 v40, a152
    v_accvgpr_read_b32 v41, a153
    v_accvgpr_read_b32 v42, a154
    v_accvgpr_read_b32 v43, a155
    v_accvgpr_read_b32 v44, a156
    v_accvgpr_read_b32 v45, a157
    v_accvgpr_read_b32 v46, a158
    v_accvgpr_read_b32 v47, a159
    v_pk_mul_f32 v[40:41], v[40:41], v[120:121] op_sel_hi:[1,0]
    v_pk_mul_f32 v[42:43], v[42:43], v[120:121] op_sel_hi:[1,0]
    v_pk_mul_f32 v[44:45], v[44:45], v[120:121] op_sel_hi:[1,0]
    v_pk_mul_f32 v[46:47], v[46:47], v[120:121] op_sel_hi:[1,0]
    v_cvt_pk_bf16_f32 v40, v40, v41
    v_cvt_pk_bf16_f32 v41, v42, v43
    v_cvt_pk_bf16_f32 v42, v44, v45
    v_cvt_pk_bf16_f32 v43, v46, v47
    v_accvgpr_write_b32 a12, v40
    v_accvgpr_write_b32 a13, v41
    v_accvgpr_write_b32 a14, v42
    v_accvgpr_write_b32 a15, v43
    v_accvgpr_read_b32 v32, a160
    v_accvgpr_read_b32 v33, a161
    v_accvgpr_read_b32 v34, a162
    v_accvgpr_read_b32 v35, a163
    v_accvgpr_read_b32 v36, a164
    v_accvgpr_read_b32 v37, a165
    v_accvgpr_read_b32 v38, a166
    v_accvgpr_read_b32 v39, a167
    v_pk_mul_f32 v[32:33], v[32:33], v[120:121] op_sel_hi:[1,0]
    v_pk_mul_f32 v[34:35], v[34:35], v[120:121] op_sel_hi:[1,0]
    v_pk_mul_f32 v[36:37], v[36:37], v[120:121] op_sel_hi:[1,0]
    v_pk_mul_f32 v[38:39], v[38:39], v[120:121] op_sel_hi:[1,0]
    v_cvt_pk_bf16_f32 v32, v32, v33
    v_cvt_pk_bf16_f32 v33, v34, v35
    v_cvt_pk_bf16_f32 v34, v36, v37
    v_cvt_pk_bf16_f32 v35, v38, v39
    v_accvgpr_write_b32 a16, v32
    v_accvgpr_write_b32 a17, v33
    v_accvgpr_write_b32 a18, v34
    v_accvgpr_write_b32 a19, v35
    v_accvgpr_read_b32 v40, a168
    v_accvgpr_read_b32 v41, a169
    v_accvgpr_read_b32 v42, a170
    v_accvgpr_read_b32 v43, a171
    v_accvgpr_read_b32 v44, a172
    v_accvgpr_read_b32 v45, a173
    v_accvgpr_read_b32 v46, a174
    v_accvgpr_read_b32 v47, a175
    v_pk_mul_f32 v[40:41], v[40:41], v[120:121] op_sel_hi:[1,0]
    v_pk_mul_f32 v[42:43], v[42:43], v[120:121] op_sel_hi:[1,0]
    v_pk_mul_f32 v[44:45], v[44:45], v[120:121] op_sel_hi:[1,0]
    v_pk_mul_f32 v[46:47], v[46:47], v[120:121] op_sel_hi:[1,0]
    v_cvt_pk_bf16_f32 v40, v40, v41
    v_cvt_pk_bf16_f32 v41, v42, v43
    v_cvt_pk_bf16_f32 v42, v44, v45
    v_cvt_pk_bf16_f32 v43, v46, v47
    v_accvgpr_write_b32 a20, v40
    v_accvgpr_write_b32 a21, v41
    v_accvgpr_write_b32 a22, v42
    v_accvgpr_write_b32 a23, v43
    v_accvgpr_read_b32 v32, a176
    v_accvgpr_read_b32 v33, a177
    v_accvgpr_read_b32 v34, a178
    v_accvgpr_read_b32 v35, a179
    v_accvgpr_read_b32 v36, a180
    v_accvgpr_read_b32 v37, a181
    v_accvgpr_read_b32 v38, a182
    v_accvgpr_read_b32 v39, a183
    v_pk_mul_f32 v[32:33], v[32:33], v[120:121] op_sel_hi:[1,0]
    v_pk_mul_f32 v[34:35], v[34:35], v[120:121] op_sel_hi:[1,0]
    v_pk_mul_f32 v[36:37], v[36:37], v[120:121] op_sel_hi:[1,0]
    v_pk_mul_f32 v[38:39], v[38:39], v[120:121] op_sel_hi:[1,0]
    v_cvt_pk_bf16_f32 v32, v32, v33
    v_cvt_pk_bf16_f32 v33, v34, v35
    v_cvt_pk_bf16_f32 v34, v36, v37
    v_cvt_pk_bf16_f32 v35, v38, v39
    v_accvgpr_write_b32 a24, v32
    v_accvgpr_write_b32 a25, v33
    v_accvgpr_write_b32 a26, v34
    v_accvgpr_write_b32 a27, v35
    v_accvgpr_read_b32 v40, a184
    v_accvgpr_read_b32 v41, a185
    v_accvgpr_read_b32 v42, a186
    v_accvgpr_read_b32 v43, a187
    v_accvgpr_read_b32 v44, a188
    v_accvgpr_read_b32 v45, a189
    v_accvgpr_read_b32 v46, a190
    v_accvgpr_read_b32 v47, a191
    v_pk_mul_f32 v[40:41], v[40:41], v[120:121] op_sel_hi:[1,0]
    v_pk_mul_f32 v[42:43], v[42:43], v[120:121] op_sel_hi:[1,0]
    v_pk_mul_f32 v[44:45], v[44:45], v[120:121] op_sel_hi:[1,0]
    v_pk_mul_f32 v[46:47], v[46:47], v[120:121] op_sel_hi:[1,0]
    v_cvt_pk_bf16_f32 v40, v40, v41
    v_cvt_pk_bf16_f32 v41, v42, v43
    v_cvt_pk_bf16_f32 v42, v44, v45
    v_cvt_pk_bf16_f32 v43, v46, v47
    v_accvgpr_write_b32 a28, v40
    v_accvgpr_write_b32 a29, v41
    v_accvgpr_write_b32 a30, v42
    v_accvgpr_write_b32 a31, v43
    v_accvgpr_read_b32 v32, a192
    v_accvgpr_read_b32 v33, a193
    v_accvgpr_read_b32 v34, a194
    v_accvgpr_read_b32 v35, a195
    v_accvgpr_read_b32 v36, a196
    v_accvgpr_read_b32 v37, a197
    v_accvgpr_read_b32 v38, a198
    v_accvgpr_read_b32 v39, a199
    v_pk_mul_f32 v[32:33], v[32:33], v[120:121] op_sel_hi:[1,0]
    v_pk_mul_f32 v[34:35], v[34:35], v[120:121] op_sel_hi:[1,0]
    v_pk_mul_f32 v[36:37], v[36:37], v[120:121] op_sel_hi:[1,0]
    v_pk_mul_f32 v[38:39], v[38:39], v[120:121] op_sel_hi:[1,0]
    v_cvt_pk_bf16_f32 v32, v32, v33
    v_cvt_pk_bf16_f32 v33, v34, v35
    v_cvt_pk_bf16_f32 v34, v36, v37
    v_cvt_pk_bf16_f32 v35, v38, v39
    v_accvgpr_write_b32 a32, v32
    v_accvgpr_write_b32 a33, v33
    v_accvgpr_write_b32 a34, v34
    v_accvgpr_write_b32 a35, v35
    v_accvgpr_read_b32 v40, a200
    v_accvgpr_read_b32 v41, a201
    v_accvgpr_read_b32 v42, a202
    v_accvgpr_read_b32 v43, a203
    v_accvgpr_read_b32 v44, a204
    v_accvgpr_read_b32 v45, a205
    v_accvgpr_read_b32 v46, a206
    v_accvgpr_read_b32 v47, a207
    v_pk_mul_f32 v[40:41], v[40:41], v[120:121] op_sel_hi:[1,0]
    v_pk_mul_f32 v[42:43], v[42:43], v[120:121] op_sel_hi:[1,0]
    v_pk_mul_f32 v[44:45], v[44:45], v[120:121] op_sel_hi:[1,0]
    v_pk_mul_f32 v[46:47], v[46:47], v[120:121] op_sel_hi:[1,0]
    v_cvt_pk_bf16_f32 v40, v40, v41
    v_cvt_pk_bf16_f32 v41, v42, v43
    v_cvt_pk_bf16_f32 v42, v44, v45
    v_cvt_pk_bf16_f32 v43, v46, v47
    v_accvgpr_write_b32 a36, v40
    v_accvgpr_write_b32 a37, v41
    v_accvgpr_write_b32 a38, v42
    v_accvgpr_write_b32 a39, v43
    v_accvgpr_read_b32 v32, a208
    v_accvgpr_read_b32 v33, a209
    v_accvgpr_read_b32 v34, a210
    v_accvgpr_read_b32 v35, a211
    v_accvgpr_read_b32 v36, a212
    v_accvgpr_read_b32 v37, a213
    v_accvgpr_read_b32 v38, a214
    v_accvgpr_read_b32 v39, a215
    v_pk_mul_f32 v[32:33], v[32:33], v[120:121] op_sel_hi:[1,0]
    v_pk_mul_f32 v[34:35], v[34:35], v[120:121] op_sel_hi:[1,0]
    v_pk_mul_f32 v[36:37], v[36:37], v[120:121] op_sel_hi:[1,0]
    v_pk_mul_f32 v[38:39], v[38:39], v[120:121] op_sel_hi:[1,0]
    v_cvt_pk_bf16_f32 v32, v32, v33
    v_cvt_pk_bf16_f32 v33, v34, v35
    v_cvt_pk_bf16_f32 v34, v36, v37
    v_cvt_pk_bf16_f32 v35, v38, v39
    v_accvgpr_write_b32 a40, v32
    v_accvgpr_write_b32 a41, v33
    v_accvgpr_write_b32 a42, v34
    v_accvgpr_write_b32 a43, v35
    v_accvgpr_read_b32 v40, a216
    v_accvgpr_read_b32 v41, a217
    v_accvgpr_read_b32 v42, a218
    v_accvgpr_read_b32 v43, a219
    v_accvgpr_read_b32 v44, a220
    v_accvgpr_read_b32 v45, a221
    v_accvgpr_read_b32 v46, a222
    v_accvgpr_read_b32 v47, a223
    v_pk_mul_f32 v[40:41], v[40:41], v[120:121] op_sel_hi:[1,0]
    v_pk_mul_f32 v[42:43], v[42:43], v[120:121] op_sel_hi:[1,0]
    v_pk_mul_f32 v[44:45], v[44:45], v[120:121] op_sel_hi:[1,0]
    v_pk_mul_f32 v[46:47], v[46:47], v[120:121] op_sel_hi:[1,0]
    v_cvt_pk_bf16_f32 v40, v40, v41
    v_cvt_pk_bf16_f32 v41, v42, v43
    v_cvt_pk_bf16_f32 v42, v44, v45
    v_cvt_pk_bf16_f32 v43, v46, v47
    v_accvgpr_write_b32 a44, v40
    v_accvgpr_write_b32 a45, v41
    v_accvgpr_write_b32 a46, v42
    v_accvgpr_write_b32 a47, v43
    v_accvgpr_read_b32 v32, a224
    v_accvgpr_read_b32 v33, a225
    v_accvgpr_read_b32 v34, a226
    v_accvgpr_read_b32 v35, a227
    v_accvgpr_read_b32 v36, a228
    v_accvgpr_read_b32 v37, a229
    v_accvgpr_read_b32 v38, a230
    v_accvgpr_read_b32 v39, a231
    v_pk_mul_f32 v[32:33], v[32:33], v[120:121] op_sel_hi:[1,0]
    v_pk_mul_f32 v[34:35], v[34:35], v[120:121] op_sel_hi:[1,0]
    v_pk_mul_f32 v[36:37], v[36:37], v[120:121] op_sel_hi:[1,0]
    v_pk_mul_f32 v[38:39], v[38:39], v[120:121] op_sel_hi:[1,0]
    v_cvt_pk_bf16_f32 v32, v32, v33
    v_cvt_pk_bf16_f32 v33, v34, v35
    v_cvt_pk_bf16_f32 v34, v36, v37
    v_cvt_pk_bf16_f32 v35, v38, v39
    v_accvgpr_write_b32 a48, v32
    v_accvgpr_write_b32 a49, v33
    v_accvgpr_write_b32 a50, v34
    v_accvgpr_write_b32 a51, v35
    v_accvgpr_read_b32 v40, a232
    v_accvgpr_read_b32 v41, a233
    v_accvgpr_read_b32 v42, a234
    v_accvgpr_read_b32 v43, a235
    v_accvgpr_read_b32 v44, a236
    v_accvgpr_read_b32 v45, a237
    v_accvgpr_read_b32 v46, a238
    v_accvgpr_read_b32 v47, a239
    v_pk_mul_f32 v[40:41], v[40:41], v[120:121] op_sel_hi:[1,0]
    v_pk_mul_f32 v[42:43], v[42:43], v[120:121] op_sel_hi:[1,0]
    v_pk_mul_f32 v[44:45], v[44:45], v[120:121] op_sel_hi:[1,0]
    v_pk_mul_f32 v[46:47], v[46:47], v[120:121] op_sel_hi:[1,0]
    v_cvt_pk_bf16_f32 v40, v40, v41
    v_cvt_pk_bf16_f32 v41, v42, v43
    v_cvt_pk_bf16_f32 v42, v44, v45
    v_cvt_pk_bf16_f32 v43, v46, v47
    v_accvgpr_write_b32 a52, v40
    v_accvgpr_write_b32 a53, v41
    v_accvgpr_write_b32 a54, v42
    v_accvgpr_write_b32 a55, v43
    v_accvgpr_read_b32 v32, a240
    v_accvgpr_read_b32 v33, a241
    v_accvgpr_read_b32 v34, a242
    v_accvgpr_read_b32 v35, a243
    v_accvgpr_read_b32 v36, a244
    v_accvgpr_read_b32 v37, a245
    v_accvgpr_read_b32 v38, a246
    v_accvgpr_read_b32 v39, a247
    v_pk_mul_f32 v[32:33], v[32:33], v[120:121] op_sel_hi:[1,0]
    v_pk_mul_f32 v[34:35], v[34:35], v[120:121] op_sel_hi:[1,0]
    v_pk_mul_f32 v[36:37], v[36:37], v[120:121] op_sel_hi:[1,0]
    v_pk_mul_f32 v[38:39], v[38:39], v[120:121] op_sel_hi:[1,0]
    v_cvt_pk_bf16_f32 v32, v32, v33
    v_cvt_pk_bf16_f32 v33, v34, v35
    v_cvt_pk_bf16_f32 v34, v36, v37
    v_cvt_pk_bf16_f32 v35, v38, v39
    v_accvgpr_write_b32 a56, v32
    v_accvgpr_write_b32 a57, v33
    v_accvgpr_write_b32 a58, v34
    v_accvgpr_write_b32 a59, v35
    v_accvgpr_read_b32 v40, a248
    v_accvgpr_read_b32 v41, a249
    v_accvgpr_read_b32 v42, a250
    v_accvgpr_read_b32 v43, a251
    v_accvgpr_read_b32 v44, a252
    v_accvgpr_read_b32 v45, a253
    v_accvgpr_read_b32 v46, a254
    v_accvgpr_read_b32 v47, a255
    v_pk_mul_f32 v[40:41], v[40:41], v[120:121] op_sel_hi:[1,0]
    v_pk_mul_f32 v[42:43], v[42:43], v[120:121] op_sel_hi:[1,0]
    v_pk_mul_f32 v[44:45], v[44:45], v[120:121] op_sel_hi:[1,0]
    v_pk_mul_f32 v[46:47], v[46:47], v[120:121] op_sel_hi:[1,0]
    v_cvt_pk_bf16_f32 v40, v40, v41
    v_cvt_pk_bf16_f32 v41, v42, v43
    v_cvt_pk_bf16_f32 v42, v44, v45
    v_cvt_pk_bf16_f32 v43, v46, v47
    v_accvgpr_write_b32 a60, v40
    v_accvgpr_write_b32 a61, v41
    v_accvgpr_write_b32 a62, v42
    v_accvgpr_write_b32 a63, v43
    v_accvgpr_write_b32 a128, v128
    v_accvgpr_write_b32 a129, v129
    v_accvgpr_write_b32 a130, v130
    v_accvgpr_write_b32 a131, v131
    v_accvgpr_write_b32 a132, v136
    v_accvgpr_write_b32 a133, v137
    v_accvgpr_write_b32 a134, v138
    v_accvgpr_write_b32 a135, v139
    v_accvgpr_write_b32 a136, v144
    v_accvgpr_write_b32 a137, v145
    v_accvgpr_write_b32 a138, v146
    v_accvgpr_write_b32 a139, v147
    v_accvgpr_write_b32 a140, v152
    v_accvgpr_write_b32 a141, v153
    v_accvgpr_write_b32 a142, v154
    v_accvgpr_write_b32 a143, v155
    v_accvgpr_write_b32 a144, v160
    v_accvgpr_write_b32 a145, v161
    v_accvgpr_write_b32 a146, v162
    v_accvgpr_write_b32 a147, v163
    v_accvgpr_write_b32 a148, v168
    v_accvgpr_write_b32 a149, v169
    v_accvgpr_write_b32 a150, v170
    v_accvgpr_write_b32 a151, v171
    v_accvgpr_write_b32 a152, v176
    v_accvgpr_write_b32 a153, v177
    v_accvgpr_write_b32 a154, v178
    v_accvgpr_write_b32 a155, v179
    v_accvgpr_write_b32 a156, v184
    v_accvgpr_write_b32 a157, v185
    v_accvgpr_write_b32 a158, v186
    v_accvgpr_write_b32 a159, v187
    v_accvgpr_write_b32 a160, v192
    v_accvgpr_write_b32 a161, v193
    v_accvgpr_write_b32 a162, v194
    v_accvgpr_write_b32 a163, v195
    v_accvgpr_write_b32 a164, v200
    v_accvgpr_write_b32 a165, v201
    v_accvgpr_write_b32 a166, v202
    v_accvgpr_write_b32 a167, v203
    v_accvgpr_write_b32 a168, v208
    v_accvgpr_write_b32 a169, v209
    v_accvgpr_write_b32 a170, v210
    v_accvgpr_write_b32 a171, v211
    v_accvgpr_write_b32 a172, v216
    v_accvgpr_write_b32 a173, v217
    v_accvgpr_write_b32 a174, v218
    v_accvgpr_write_b32 a175, v219
    v_accvgpr_write_b32 a176, v224
    v_accvgpr_write_b32 a177, v225
    v_accvgpr_write_b32 a178, v226
    v_accvgpr_write_b32 a179, v227
    v_accvgpr_write_b32 a180, v232
    v_accvgpr_write_b32 a181, v233
    v_accvgpr_write_b32 a182, v234
    v_accvgpr_write_b32 a183, v235
    v_accvgpr_write_b32 a184, v240
    v_accvgpr_write_b32 a185, v241
    v_accvgpr_write_b32 a186, v242
    v_accvgpr_write_b32 a187, v243
    v_accvgpr_write_b32 a188, v248
    v_accvgpr_write_b32 a189, v249
    v_accvgpr_write_b32 a190, v250
    v_accvgpr_write_b32 a191, v251
    s_cmp_eq_u32 s87, 0
    s_cbranch_scc1 L_nopre1
    v_bfe_u32 v28, v0, 4, 2
    v_lshlrev_b32 v23, 3, v2
    v_add_u32 v23, 0, v23
    v_add_u32 v23, v23, v28
    v_and_b32 v24, 15, v23
    v_xor_b32 v24, v24, v3
    v_lshlrev_b32 v24, 4, v24
    v_subrev_u32 v23, 0, v23
    v_lshl_add_u32 v29, v23, 8, v24
    v_lshlrev_b32 v23, 3, v2
    v_add_u32 v23, 4, v23
    v_add_u32 v23, v23, v28
    v_and_b32 v24, 15, v23
    v_xor_b32 v24, v24, v3
    v_lshlrev_b32 v24, 4, v24
    v_subrev_u32 v23, 4, v23
    v_lshl_add_u32 v30, v23, 8, v24
    v_add_u32 v24, 0x20000, v4
    v_add_u32 v25, 0x20000, v5
    v_add_u32 v26, 0x20000, v6
    v_add_u32 v27, 0x20000, v7
    v_mov_b32 v124, 0xff800000
    v_mov_b32 v125, 0xff800000
    v_mov_b32 v126, 0xff800000
    v_mov_b32 v127, 0xff800000
    s_lshl_b32 s90, s28, 18
    s_mov_b32 s91, 32
    s_waitcnt vmcnt(0) lgkmcnt(0)
    s_barrier
L_pre1:
    s_lshr_b32 s3, s24, 1
    s_add_u32 m0, s3, 0x20000
    s_nop 0
    buffer_load_dwordx4 v29, s[8:11], s90 offen offset:0 lds
    buffer_load_dwordx4 v30, s[8:11], s90 offen offset:1024 lds
    s_add_u32 s90, s90, 8192
    s_waitcnt vmcnt(0)
    s_barrier
    ds_read_b128 a[64:67], v24 offset:0
    ds_read_b128 a[68:71], v25 offset:0
    ds_read_b128 a[72:75], v26 offset:0
    ds_read_b128 a[76:79], v27 offset:0
    ds_read_b128 a[80:83], v24 offset:4096
    ds_read_b128 a[84:87], v25 offset:4096
    ds_read_b128 a[88:91], v26 offset:4096
    ds_read_b128 a[92:95], v27 offset:4096
    s_waitcnt lgkmcnt(0)
    s_barrier
    v_mfma_f32_16x16x32_bf16 v[32:35], a[64:67], a[0:3], 0
    v_mfma_f32_16x16x32_bf16 v[40:43], a[64:67], a[16:19], 0
    v_mfma_f32_16x16x32_bf16 v[32:35], a[68:71], a[4:7], v[32:35]
    v_mfma_f32_16x16x32_bf16 v[40:43], a[68:71], a[20:23], v[40:43]
    v_mfma_f32_16x16x32_bf16 v[32:35], a[72:75], a[8:11], v[32:35]
    v_mfma_f32_16x16x32_bf16 v[40:43], a[72:75], a[24:27], v[40:43]
    v_mfma_f32_16x16x32_bf16 v[32:35], a[76:79], a[12:15], v[32:35]
    v_mfma_f32_16x16x32_bf16 v[40:43], a[76:79], a[28:31], v[40:43]
    v_mfma_f32_16x16x32_bf16 v[36:39], a[80:83], a[0:3], 0
    v_mfma_f32_16x16x32_bf16 v[44:47], a[80:83], a[16:19], 0
    v_mfma_f32_16x16x32_bf16 v[36:39], a[84:87], a[4:7], v[36:39]
    v_mfma_f32_16x16x32_bf16 v[44:47], a[84:87], a[20:23], v[44:47]
    v_mfma_f32_16x16x32_bf16 v[36:39], a[88:91], a[8:11], v[36:39]
    v_mfma_f32_16x16x32_bf16 v[44:47], a[88:91], a[24:27], v[44:47]
    v_mfma_f32_16x16x32_bf16 v[36:39], a[92:95], a[12:15], v[36:39]
    v_mfma_f32_16x16x32_bf16 v[44:47], a[92:95], a[28:31], v[44:47]
    v_mfma_f32_16x16x32_bf16 v[48:51], a[64:67], a[32:35], 0
    v_mfma_f32_16x16x32_bf16 v[56:59], a[64:67], a[48:51], 0
    v_mfma_f32_16x16x32_bf16 v[48:51], a[68:71], a[36:39], v[48:51]
    v_mfma_f32_16x16x32_bf16 v[56:59], a[68:71], a[52:55], v[56:59]
    v_mfma_f32_16x16x32_bf16 v[48:51], a[72:75], a[40:43], v[48:51]
    v_mfma_f32_16x16x32_bf16 v[56:59], a[72:75], a[56:59], v[56:59]
    v_mfma_f32_16x16x32_bf16 v[48:51], a[76:79], a[44:47], v[48:51]
    v_mfma_f32_16x16x32_bf16 v[56:59], a[76:79], a[60:63], v[56:59]
    v_mfma_f32_16x16x32_bf16 v[52:55], a[80:83], a[32:35], 0
    v_mfma_f32_16x16x32_bf16 v[60:63], a[80:83], a[48:51], 0
    v_mfma_f32_16x16x32_bf16 v[52:55], a[84:87], a[36:39], v[52:55]
    v_mfma_f32_16x16x32_bf16 v[60:63], a[84:87], a[52:55], v[60:63]
    v_mfma_f32_16x16x32_bf16 v[52:55], a[88:91], a[40:43], v[52:55]
    v_mfma_f32_16x16x32_bf16 v[60:63], a[88:91], a[56:59], v[60:63]
    v_mfma_f32_16x16x32_bf16 v[52:55], a[92:95], a[44:47], v[52:55]
    v_mfma_f32_16x16x32_bf16 v[60:63], a[92:95], a[60:63], v[60:63]
    s_nop 7
    v_max3_f32 v124, v124, v32, v33
    v_max3_f32 v124, v124, v34, v35
    v_max3_f32 v124, v124, v36, v37
    v_max3_f32 v124, v124, v38, v39
    v_max3_f32 v125, v125, v40, v41
    v_max3_f32 v125, v125, v42, v43
    v_max3_f32 v125, v125, v44, v45
    v_max3_f32 v125, v125, v46, v47
    v_max3_f32 v126, v126, v48, v49
    v_max3_f32 v126, v126, v50, v51
    v_max3_f32 v126, v126, v52, v53
    v_max3_f32 v126, v126, v54, v55
    v_max3_f32 v127, v127, v56, v57
    v_max3_f32 v127, v127, v58, v59
    v_max3_f32 v127, v127, v60, v61
    v_max3_f32 v127, v127, v62, v63
    s_sub_u32 s91, s91, 1
    s_cmp_lg_u32 s91, 0
    s_cbranch_scc1 L_pre1
    v_mov_b32 v22, v124
    v_mov_b32 v23, v125
    v_mov_b32 v24, v126
    v_mov_b32 v25, v127
    v_mov_b32 v26, v22
    v_mov_b32 v27, v23
    v_mov_b32 v28, v24
    v_mov_b32 v29, v25
    s_nop 1
    v_permlane16_swap_b32 v22, v26
    v_permlane16_swap_b32 v23, v27
    v_permlane16_swap_b32 v24, v28
    v_permlane16_swap_b32 v25, v29
    s_nop 1
    v_max_f32 v22, v22, v26
    v_max_f32 v23, v23, v27
    v_max_f32 v24, v24, v28
    v_max_f32 v25, v25, v29
    v_mov_b32 v26, v22
    v_mov_b32 v27, v23
    v_mov_b32 v28, v24
    v_mov_b32 v29, v25
    s_nop 1
    v_permlane32_swap_b32 v22, v26
    v_permlane32_swap_b32 v23, v27
    v_permlane32_swap_b32 v24, v28
    v_permlane32_swap_b32 v25, v29
    s_nop 1
    v_max_f32 v22, v22, v26
    v_max_f32 v23, v23, v27
    v_max_f32 v24, v24, v28
    v_max_f32 v25, v25, v29
    v_mov_b32 v124, v22
    v_mov_b32 v125, v23
    v_mov_b32 v126, v24
    v_mov_b32 v127, v25
    ds_read_b128 a[64:67], v4 offset:57344
    ds_read_b128 a[68:71], v5 offset:57344
    ds_read_b128 a[72:75], v6 offset:57344
    ds_read_b128 a[76:79], v7 offset:57344
    ds_read_b128 a[80:83], v4 offset:61440
    ds_read_b128 a[84:87], v5 offset:61440
    ds_read_b128 a[88:91], v6 offset:61440
    ds_read_b128 a[92:95], v7 offset:61440
L_nopre1:
    s_waitcnt vmcnt(17) lgkmcnt(0)
    s_barrier
    v_mfma_f32_16x16x32_bf16 v[32:35], a[64:67], a[0:3], 0
    ds_read_b64_tr_b16 a[96:97], v8 offset:0
    s_add_u32 m0, s80, 114688
    v_mfma_f32_16x16x32_bf16 v[40:43], a[64:67], a[16:19], 0
    ds_read_b64_tr_b16 a[98:99], v8 offset:4096
    v_mfma_f32_16x16x32_bf16 v[32:35], a[68:71], a[4:7], v[32:35]
    ds_read_b64_tr_b16 a[100:101], v9 offset:0
    buffer_load_dwordx4 v20, s[12:15], s25 offen nt lds
    v_mfma_f32_16x16x32_bf16 v[40:43], a[68:71], a[20:23], v[40:43]
    ds_read_b64_tr_b16 a[102:103], v9 offset:4096
    v_mfma_f32_16x16x32_bf16 v[32:35], a[72:75], a[8:11], v[32:35]
    ds_read_b64_tr_b16 a[104:105], v10 offset:0
    s_add_u32 m0, s80, 118784
    v_mfma_f32_16x16x32_bf16 v[40:43], a[72:75], a[24:27], v[40:43]
    ds_read_b64_tr_b16 a[106:107], v10 offset:4096
    v_mfma_f32_16x16x32_bf16 v[32:35], a[76:79], a[12:15], v[32:35]
    ds_read_b64_tr_b16 a[108:109], v11 offset:0
    buffer_load_dwordx4 v21, s[12:15], s25 offen nt lds
    v_mfma_f32_16x16x32_bf16 v[40:43], a[76:79], a[28:31], v[40:43]
    ds_read_b64_tr_b16 a[110:111], v11 offset:4096
    v_mfma_f32_16x16x32_bf16 v[36:39], a[80:83], a[0:3], 0
    ds_read_b64_tr_b16 a[112:113], v12 offset:0
    s_add_u32 m0, s80, 122880
    v_mfma_f32_16x16x32_bf16 v[44:47], a[80:83], a[16:19], 0
    ds_read_b64_tr_b16 a[114:115], v12 offset:4096
    v_mfma_f32_16x16x32_bf16 v[36:39], a[84:87], a[4:7], v[36:39]
    ds_read_b64_tr_b16 a[116:117], v13 offset:0
    buffer_load_dwordx4 v20, s[12:15], s81 offen nt lds
    v_mfma_f32_16x16x32_bf16 v[44:47], a[84:87], a[20:23], v[44:47]
    ds_read_b64_tr_b16 a[118:119], v13 offset:4096
    v_mfma_f32_16x16x32_bf16 v[36:39], a[88:91], a[8:11], v[36:39]
    ds_read_b64_tr_b16 a[120:121], v14 offset:0
    s_add_u32 m0, s80, 126976
    v_mfma_f32_16x16x32_bf16 v[44:47], a[88:91], a[24:27], v[44:47]
    ds_read_b64_tr_b16 a[122:123], v14 offset:4096
    v_mfma_f32_16x16x32_bf16 v[36:39], a[92:95], a[12:15], v[36:39]
    ds_read_b64_tr_b16 a[124:125], v15 offset:0
    buffer_load_dwordx4 v21, s[12:15], s81 offen nt lds
    v_mfma_f32_16x16x32_bf16 v[44:47], a[92:95], a[28:31], v[44:47]
    ds_read_b64_tr_b16 a[126:127], v15 offset:4096
    v_mfma_f32_16x16x32_bf16 v[48:51], a[64:67], a[32:35], 0
    s_add_u32 s25, s25, 16384
    v_mfma_f32_16x16x32_bf16 v[56:59], a[64:67], a[48:51], 0
    ds_read_b128 a[64:67], v4 offset:0
    v_mfma_f32_16x16x32_bf16 v[48:51], a[68:71], a[36:39], v[48:51]
    s_add_u32 s81, s81, 16384
    v_mfma_f32_16x16x32_bf16 v[56:59], a[68:71], a[52:55], v[56:59]
    ds_read_b128 a[68:71], v5 offset:0
    v_mfma_f32_16x16x32_bf16 v[48:51], a[72:75], a[40:43], v[48:51]
    s_add_u32 m0, s80, 49152
    v_mfma_f32_16x16x32_bf16 v[56:59], a[72:75], a[56:59], v[56:59]
    ds_read_b128 a[72:75], v6 offset:0
    v_mfma_f32_16x16x32_bf16 v[48:51], a[76:79], a[44:47], v[48:51]
    buffer_load_dwordx4 v16, s[8:11], s26 offen nt lds
    v_mfma_f32_16x16x32_bf16 v[56:59], a[76:79], a[60:63], v[56:59]
    ds_read_b128 a[76:79], v7 offset:0
    v_mfma_f32_16x16x32_bf16 v[52:55], a[80:83], a[32:35], 0
    s_add_u32 m0, s80, 53248
    v_mfma_f32_16x16x32_bf16 v[60:63], a[80:83], a[48:51], 0
    ds_read_b128 a[80:83], v4 offset:4096
    v_mfma_f32_16x16x32_bf16 v[52:55], a[84:87], a[36:39], v[52:55]
    buffer_load_dwordx4 v17, s[8:11], s26 offen nt lds
    v_mfma_f32_16x16x32_bf16 v[60:63], a[84:87], a[52:55], v[60:63]
    ds_read_b128 a[84:87], v5 offset:4096
    v_mfma_f32_16x16x32_bf16 v[52:55], a[88:91], a[40:43], v[52:55]
    v_mfma_f32_16x16x32_bf16 v[60:63], a[88:91], a[56:59], v[60:63]
    ds_read_b128 a[88:91], v6 offset:4096
    v_mfma_f32_16x16x32_bf16 v[52:55], a[92:95], a[44:47], v[52:55]
    v_mfma_f32_16x16x32_bf16 v[60:63], a[92:95], a[60:63], v[60:63]
    ds_read_b128 a[92:95], v7 offset:4096
    s_nop 7
    s_cmp_eq_u32 s87, 0
    s_cbranch_scc0 L_usepre2
    v_max3_f32 v22, v32, v33, v34
    v_max3_f32 v26, v35, v36, v37
    v_max3_f32 v22, v22, v38, v39
    v_max_f32 v22, v22, v26
    v_max3_f32 v23, v40, v41, v42
    v_max3_f32 v27, v43, v44, v45
    v_max3_f32 v23, v23, v46, v47
    v_max_f32 v23, v23, v27
    v_max3_f32 v24, v48, v49, v50
    v_max3_f32 v28, v51, v52, v53
    v_max3_f32 v24, v24, v54, v55
    v_max_f32 v24, v24, v28
    v_max3_f32 v25, v56, v57, v58
    v_max3_f32 v29, v59, v60, v61
    v_max3_f32 v25, v25, v62, v63
    v_max_f32 v25, v25, v29
    v_mov_b32 v26, v22
    v_mov_b32 v27, v23
    v_mov_b32 v28, v24
    v_mov_b32 v29, v25
    s_nop 1
    v_permlane16_swap_b32 v22, v26
    v_permlane16_swap_b32 v23, v27
    v_permlane16_swap_b32 v24, v28
    v_permlane16_swap_b32 v25, v29
    s_nop 1
    v_max_f32 v22, v22, v26
    v_max_f32 v23, v23, v27
    v_max_f32 v24, v24, v28
    v_max_f32 v25, v25, v29
    v_mov_b32 v26, v22
    v_mov_b32 v27, v23
    v_mov_b32 v28, v24
    v_mov_b32 v29, v25
    s_nop 1
    v_permlane32_swap_b32 v22, v26
    v_permlane32_swap_b32 v23, v27
    v_permlane32_swap_b32 v24, v28
    v_permlane32_swap_b32 v25, v29
    s_nop 1
    v_max_f32 v22, v22, v26
    v_max_f32 v23, v23, v27
    v_max_f32 v24, v24, v28
    v_max_f32 v25, v25, v29
    s_branch L_havem2
L_usepre2:
    v_mov_b32 v22, v124
    v_mov_b32 v23, v125
    v_mov_b32 v24, v126
    v_mov_b32 v25, v127
L_havem2:
    v_sub_f32 v80, 0, v22
    v_sub_f32 v81, 0, v22
    v_sub_f32 v82, 0, v22
    v_sub_f32 v83, 0, v22
    v_sub_f32 v84, 0, v23
    v_sub_f32 v85, 0, v23
    v_sub_f32 v86, 0, v23
    v_sub_f32 v87, 0, v23
    v_sub_f32 v88, 0, v24
    v_sub_f32 v89, 0, v24
    v_sub_f32 v90, 0, v24
    v_sub_f32 v91, 0, v24
    v_sub_f32 v92, 0, v25
    v_sub_f32 v93, 0, v25
    v_sub_f32 v94, 0, v25
    v_sub_f32 v95, 0, v25
    v_sub_f32 v32, v32, v22
    v_sub_f32 v33, v33, v22
    v_sub_f32 v34, v34, v22
    v_sub_f32 v35, v35, v22
    v_sub_f32 v36, v36, v22
    v_sub_f32 v37, v37, v22
    v_sub_f32 v38, v38, v22
    v_sub_f32 v39, v39, v22
    v_sub_f32 v40, v40, v23
    v_sub_f32 v41, v41, v23
    v_sub_f32 v42, v42, v23
    v_sub_f32 v43, v43, v23
    v_sub_f32 v44, v44, v23
    v_sub_f32 v45, v45, v23
    v_sub_f32 v46, v46, v23
    v_sub_f32 v47, v47, v23
    v_sub_f32 v48, v48, v24
    v_sub_f32 v49, v49, v24
    v_sub_f32 v50, v50, v24
    v_sub_f32 v51, v51, v24
    v_sub_f32 v52, v52, v24
    v_sub_f32 v53, v53, v24
    v_sub_f32 v54, v54, v24
    v_sub_f32 v55, v55, v24
    v_sub_f32 v56, v56, v25
    v_sub_f32 v57, v57, v25
    v_sub_f32 v58, v58, v25
    v_sub_f32 v59, v59, v25
    v_sub_f32 v60, v60, v25
    v_sub_f32 v61, v61, v25
    v_sub_f32 v62, v62, v25
    v_sub_f32 v63, v63, v25
    v_exp_f32 v32, v32
    v_exp_f32 v33, v33
    v_exp_f32 v34, v34
    v_exp_f32 v35, v35
    v_exp_f32 v36, v36
    v_exp_f32 v37, v37
    v_exp_f32 v38, v38
    v_exp_f32 v39, v39
    v_exp_f32 v40, v40
    v_exp_f32 v41, v41
    v_exp_f32 v42, v42
    v_exp_f32 v43, v43
    v_exp_f32 v44, v44
    v_exp_f32 v45, v45
    v_exp_f32 v46, v46
    v_exp_f32 v47, v47
    s_nop 0
    v_cvt_pk_bf16_f32 v64, v32, v33
    v_cvt_pk_bf16_f32 v65, v34, v35
    v_cvt_pk_bf16_f32 v66, v36, v37
    v_cvt_pk_bf16_f32 v67, v38, v39
    v_cvt_pk_bf16_f32 v68, v40, v41
    v_cvt_pk_bf16_f32 v69, v42, v43
    v_cvt_pk_bf16_f32 v70, v44, v45
    v_cvt_pk_bf16_f32 v71, v46, v47
    s_waitcnt lgkmcnt(8)
    v_mfma_f32_16x16x32_bf16 v[128:131], a[96:99], v[64:67], 0
    v_exp_f32 v48, v48
    v_mfma_f32_16x16x32_bf16 v[160:163], a[96:99], v[68:71], 0
    v_exp_f32 v49, v49
    v_mfma_f32_16x16x32_bf16 v[132:135], a[100:103], v[64:67], 0
    v_exp_f32 v50, v50
    v_mfma_f32_16x16x32_bf16 v[164:167], a[100:103], v[68:71], 0
    v_exp_f32 v51, v51
    v_mfma_f32_16x16x32_bf16 v[136:139], a[104:107], v[64:67], 0
    v_exp_f32 v56, v56
    v_mfma_f32_16x16x32_bf16 v[168:171], a[104:107], v[68:71], 0
    v_exp_f32 v57, v57
    v_mfma_f32_16x16x32_bf16 v[140:143], a[108:111], v[64:67], 0
    v_exp_f32 v58, v58
    v_mfma_f32_16x16x32_bf16 v[172:175], a[108:111], v[68:71], 0
    v_exp_f32 v59, v59
    v_mfma_f32_16x16x32_bf16 v[144:147], a[112:115], v[64:67], 0
    v_exp_f32 v52, v52
    v_mfma_f32_16x16x32_bf16 v[176:179], a[112:115], v[68:71], 0
    v_exp_f32 v53, v53
    v_mfma_f32_16x16x32_bf16 v[148:151], a[116:119], v[64:67], 0
    v_exp_f32 v54, v54
    v_mfma_f32_16x16x32_bf16 v[180:183], a[116:119], v[68:71], 0
    v_exp_f32 v55, v55
    v_mfma_f32_16x16x32_bf16 v[152:155], a[120:123], v[64:67], 0
    v_cvt_pk_bf16_f32 v72, v48, v49
    v_cvt_pk_bf16_f32 v73, v50, v51
    v_mfma_f32_16x16x32_bf16 v[184:187], a[120:123], v[68:71], 0
    v_cvt_pk_bf16_f32 v76, v56, v57
    v_cvt_pk_bf16_f32 v77, v58, v59
    v_mfma_f32_16x16x32_bf16 v[156:159], a[124:127], v[64:67], 0
    v_mfma_f32_16x16x32_bf16 v[188:191], a[124:127], v[68:71], 0
    v_mfma_f32_16x16x32_bf16 v[96:99], v[112:115], v[64:67], 0
    v_mfma_f32_16x16x32_bf16 v[100:103], v[112:115], v[68:71], 0
    s_waitcnt lgkmcnt(0)
    v_mfma_f32_16x16x32_bf16 v[32:35], a[64:67], a[0:3], v[80:83]
    v_exp_f32 v60, v60
    v_mfma_f32_16x16x32_bf16 v[40:43], a[64:67], a[16:19], v[84:87]
    v_cvt_pk_bf16_f32 v74, v52, v53
    s_add_u32 m0, s80, 57344
    v_mfma_f32_16x16x32_bf16 v[32:35], a[68:71], a[4:7], v[32:35]
    v_exp_f32 v61, v61
    v_mfma_f32_16x16x32_bf16 v[40:43], a[68:71], a[20:23], v[40:43]
    v_cvt_pk_bf16_f32 v75, v54, v55
    v_cvt_pk_bf16_f32 v78, v60, v61
    v_mfma_f32_16x16x32_bf16 v[32:35], a[72:75], a[8:11], v[32:35]
    v_exp_f32 v62, v62
    v_mfma_f32_16x16x32_bf16 v[40:43], a[72:75], a[24:27], v[40:43]
    buffer_load_dwordx4 v16, s[8:11], s82 offen nt lds
    v_mfma_f32_16x16x32_bf16 v[32:35], a[76:79], a[12:15], v[32:35]
    v_exp_f32 v63, v63
    v_mfma_f32_16x16x32_bf16 v[40:43], a[76:79], a[28:31], v[40:43]
    v_cvt_pk_bf16_f32 v79, v62, v63
    v_mfma_f32_16x16x32_bf16 v[36:39], a[80:83], a[0:3], v[80:83]
    v_mfma_f32_16x16x32_bf16 v[44:47], a[80:83], a[16:19], v[84:87]
    s_add_u32 m0, s80, 61440
    v_mfma_f32_16x16x32_bf16 v[36:39], a[84:87], a[4:7], v[36:39]
    v_exp_f32 v32, v32
    v_mfma_f32_16x16x32_bf16 v[44:47], a[84:87], a[20:23], v[44:47]
    buffer_load_dwordx4 v17, s[8:11], s82 offen nt lds
    v_mfma_f32_16x16x32_bf16 v[36:39], a[88:91], a[8:11], v[36:39]
    v_exp_f32 v33, v33
    v_mfma_f32_16x16x32_bf16 v[44:47], a[88:91], a[24:27], v[44:47]
    v_cvt_pk_bf16_f32 v64, v32, v33
    s_add_u32 s26, s26, 16384
    v_mfma_f32_16x16x32_bf16 v[36:39], a[92:95], a[12:15], v[36:39]
    v_exp_f32 v34, v34
    v_mfma_f32_16x16x32_bf16 v[44:47], a[92:95], a[28:31], v[44:47]
    s_add_u32 s82, s82, 16384
    v_mfma_f32_16x16x32_bf16 v[192:195], a[96:99], v[72:75], 0
    v_exp_f32 v35, v35
    v_mfma_f32_16x16x32_bf16 v[224:227], a[96:99], v[76:79], 0
    ds_read_b64_tr_b16 a[96:97], v8 offset:8192
    ds_read_b64_tr_b16 a[98:99], v8 offset:12288
    v_mfma_f32_16x16x32_bf16 v[196:199], a[100:103], v[72:75], 0
    v_exp_f32 v40, v40
    v_mfma_f32_16x16x32_bf16 v[228:231], a[100:103], v[76:79], 0
    ds_read_b64_tr_b16 a[100:101], v9 offset:8192
    ds_read_b64_tr_b16 a[102:103], v9 offset:12288
    v_mfma_f32_16x16x32_bf16 v[200:203], a[104:107], v[72:75], 0
    v_exp_f32 v41, v41
    v_mfma_f32_16x16x32_bf16 v[232:235], a[104:107], v[76:79], 0
    ds_read_b64_tr_b16 a[104:105], v10 offset:8192
    ds_read_b64_tr_b16 a[106:107], v10 offset:12288
    v_mfma_f32_16x16x32_bf16 v[204:207], a[108:111], v[72:75], 0
    v_exp_f32 v42, v42
    v_mfma_f32_16x16x32_bf16 v[236:239], a[108:111], v[76:79], 0
    ds_read_b64_tr_b16 a[108:109], v11 offset:8192
    ds_read_b64_tr_b16 a[110:111], v11 offset:12288
    v_mfma_f32_16x16x32_bf16 v[208:211], a[112:115], v[72:75], 0
    v_exp_f32 v43, v43
    v_mfma_f32_16x16x32_bf16 v[240:243], a[112:115], v[76:79], 0
    ds_read_b64_tr_b16 a[112:113], v12 offset:8192
    ds_read_b64_tr_b16 a[114:115], v12 offset:12288
    v_mfma_f32_16x16x32_bf16 v[212:215], a[116:119], v[72:75], 0
    v_exp_f32 v36, v36
    v_mfma_f32_16x16x32_bf16 v[244:247], a[116:119], v[76:79], 0
    ds_read_b64_tr_b16 a[116:117], v13 offset:8192
    ds_read_b64_tr_b16 a[118:119], v13 offset:12288
    v_mfma_f32_16x16x32_bf16 v[216:219], a[120:123], v[72:75], 0
    v_exp_f32 v37, v37
    v_mfma_f32_16x16x32_bf16 v[248:251], a[120:123], v[76:79], 0
    ds_read_b64_tr_b16 a[120:121], v14 offset:8192
    ds_read_b64_tr_b16 a[122:123], v14 offset:12288
    v_mfma_f32_16x16x32_bf16 v[220:223], a[124:127], v[72:75], 0
    v_exp_f32 v38, v38
    v_mfma_f32_16x16x32_bf16 v[252:255], a[124:127], v[76:79], 0
    ds_read_b64_tr_b16 a[124:125], v15 offset:8192
    ds_read_b64_tr_b16 a[126:127], v15 offset:12288
    v_mfma_f32_16x16x32_bf16 v[104:107], v[112:115], v[72:75], 0
    v_exp_f32 v39, v39
    v_mfma_f32_16x16x32_bf16 v[108:111], v[112:115], v[76:79], 0
    v_cvt_pk_bf16_f32 v65, v34, v35
    v_cvt_pk_bf16_f32 v68, v40, v41
    v_mfma_f32_16x16x32_bf16 v[48:51], a[64:67], a[32:35], v[88:91]
    v_exp_f32 v44, v44
    v_mfma_f32_16x16x32_bf16 v[56:59], a[64:67], a[48:51], v[92:95]
    ds_read_b128 a[64:67], v4 offset:8192
    v_cvt_pk_bf16_f32 v69, v42, v43
    v_mfma_f32_16x16x32_bf16 v[48:51], a[68:71], a[36:39], v[48:51]
    v_exp_f32 v45, v45
    v_mfma_f32_16x16x32_bf16 v[56:59], a[68:71], a[52:55], v[56:59]
    ds_read_b128 a[68:71], v5 offset:8192
    v_cvt_pk_bf16_f32 v66, v36, v37
    v_mfma_f32_16x16x32_bf16 v[48:51], a[72:75], a[40:43], v[48:51]
    v_exp_f32 v46, v46
    v_mfma_f32_16x16x32_bf16 v[56:59], a[72:75], a[56:59], v[56:59]
    ds_read_b128 a[72:75], v6 offset:8192
    v_cvt_pk_bf16_f32 v67, v38, v39
    v_mfma_f32_16x16x32_bf16 v[48:51], a[76:79], a[44:47], v[48:51]
    v_exp_f32 v47, v47
    v_mfma_f32_16x16x32_bf16 v[56:59], a[76:79], a[60:63], v[56:59]
    ds_read_b128 a[76:79], v7 offset:8192
    v_cvt_pk_bf16_f32 v70, v44, v45
    v_mfma_f32_16x16x32_bf16 v[52:55], a[80:83], a[32:35], v[88:91]
    buffer_store_dwordx4 a[128:131], v116, s[16:19], s78 offen offset:0 sc1
    v_mfma_f32_16x16x32_bf16 v[60:63], a[80:83], a[48:51], v[92:95]
    ds_read_b128 a[80:83], v4 offset:12288
    v_cvt_pk_bf16_f32 v71, v46, v47
    v_mfma_f32_16x16x32_bf16 v[52:55], a[84:87], a[36:39], v[52:55]
    v_exp_f32 v48, v48
    v_mfma_f32_16x16x32_bf16 v[60:63], a[84:87], a[52:55], v[60:63]
    ds_read_b128 a[84:87], v5 offset:12288
    v_mfma_f32_16x16x32_bf16 v[52:55], a[88:91], a[40:43], v[52:55]
    v_exp_f32 v49, v49
    v_mfma_f32_16x16x32_bf16 v[60:63], a[88:91], a[56:59], v[60:63]
    ds_read_b128 a[88:91], v6 offset:12288
    v_mfma_f32_16x16x32_bf16 v[52:55], a[92:95], a[44:47], v[52:55]
    v_exp_f32 v50, v50
    v_mfma_f32_16x16x32_bf16 v[60:63], a[92:95], a[60:63], v[60:63]
    ds_read_b128 a[92:95], v7 offset:12288
    s_waitcnt lgkmcnt(8)
    v_mfma_f32_16x16x32_bf16 v[128:131], a[96:99], v[64:67], v[128:131]
    v_exp_f32 v51, v51
    v_mfma_f32_16x16x32_bf16 v[160:163], a[96:99], v[68:71], v[160:163]
    v_cvt_pk_bf16_f32 v72, v48, v49
    v_cvt_pk_bf16_f32 v73, v50, v51
    v_mfma_f32_16x16x32_bf16 v[132:135], a[100:103], v[64:67], v[132:135]
    v_exp_f32 v56, v56
    v_mfma_f32_16x16x32_bf16 v[164:167], a[100:103], v[68:71], v[164:167]
    v_mfma_f32_16x16x32_bf16 v[136:139], a[104:107], v[64:67], v[136:139]
    v_exp_f32 v57, v57
    v_mfma_f32_16x16x32_bf16 v[168:171], a[104:107], v[68:71], v[168:171]
    v_cvt_pk_bf16_f32 v76, v56, v57
    v_mfma_f32_16x16x32_bf16 v[140:143], a[108:111], v[64:67], v[140:143]
    v_exp_f32 v58, v58
    v_mfma_f32_16x16x32_bf16 v[172:175], a[108:111], v[68:71], v[172:175]
    v_mfma_f32_16x16x32_bf16 v[144:147], a[112:115], v[64:67], v[144:147]
    v_exp_f32 v59, v59
    v_mfma_f32_16x16x32_bf16 v[176:179], a[112:115], v[68:71], v[176:179]
    v_cvt_pk_bf16_f32 v77, v58, v59
    v_mfma_f32_16x16x32_bf16 v[148:151], a[116:119], v[64:67], v[148:151]
    v_exp_f32 v52, v52
    v_mfma_f32_16x16x32_bf16 v[180:183], a[116:119], v[68:71], v[180:183]
    buffer_store_dwordx4 a[132:135], v116, s[16:19], s78 offen offset:1024 sc1
    v_mfma_f32_16x16x32_bf16 v[152:155], a[120:123], v[64:67], v[152:155]
    v_exp_f32 v53, v53
    v_mfma_f32_16x16x32_bf16 v[184:187], a[120:123], v[68:71], v[184:187]
    v_mfma_f32_16x16x32_bf16 v[156:159], a[124:127], v[64:67], v[156:159]
    v_exp_f32 v54, v54
    v_mfma_f32_16x16x32_bf16 v[188:191], a[124:127], v[68:71], v[188:191]
    v_mfma_f32_16x16x32_bf16 v[96:99], v[112:115], v[64:67], v[96:99]
    v_exp_f32 v55, v55
    v_mfma_f32_16x16x32_bf16 v[100:103], v[112:115], v[68:71], v[100:103]
    s_waitcnt vmcnt(19) lgkmcnt(0)
    s_barrier
    v_mfma_f32_16x16x32_bf16 v[32:35], a[64:67], a[0:3], v[80:83]
    v_exp_f32 v60, v60
    v_mfma_f32_16x16x32_bf16 v[40:43], a[64:67], a[16:19], v[84:87]
    v_cvt_pk_bf16_f32 v74, v52, v53
    s_add_u32 m0, s80, 65536
    v_mfma_f32_16x16x32_bf16 v[32:35], a[68:71], a[4:7], v[32:35]
    v_exp_f32 v61, v61
    v_mfma_f32_16x16x32_bf16 v[40:43], a[68:71], a[20:23], v[40:43]
    v_cvt_pk_bf16_f32 v75, v54, v55
    v_cvt_pk_bf16_f32 v78, v60, v61
    v_mfma_f32_16x16x32_bf16 v[32:35], a[72:75], a[8:11], v[32:35]
    v_exp_f32 v62, v62
    v_mfma_f32_16x16x32_bf16 v[40:43], a[72:75], a[24:27], v[40:43]
    buffer_load_dwordx4 v20, s[12:15], s25 offen nt lds
    v_mfma_f32_16x16x32_bf16 v[32:35], a[76:79], a[12:15], v[32:35]
    v_exp_f32 v63, v63
    v_mfma_f32_16x16x32_bf16 v[40:43], a[76:79], a[28:31], v[40:43]
    v_cvt_pk_bf16_f32 v79, v62, v63
    v_mfma_f32_16x16x32_bf16 v[36:39], a[80:83], a[0:3], v[80:83]
    v_mfma_f32_16x16x32_bf16 v[44:47], a[80:83], a[16:19], v[84:87]
    s_add_u32 m0, s80, 69632
    v_mfma_f32_16x16x32_bf16 v[36:39], a[84:87], a[4:7], v[36:39]
    v_exp_f32 v32, v32
    v_mfma_f32_16x16x32_bf16 v[44:47], a[84:87], a[20:23], v[44:47]
    buffer_load_dwordx4 v21, s[12:15], s25 offen nt lds
    v_mfma_f32_16x16x32_bf16 v[36:39], a[88:91], a[8:11], v[36:39]
    v_exp_f32 v33, v33
    v_mfma_f32_16x16x32_bf16 v[44:47], a[88:91], a[24:27], v[44:47]
    v_cvt_pk_bf16_f32 v64, v32, v33
    v_mfma_f32_16x16x32_bf16 v[36:39], a[92:95], a[12:15], v[36:39]
    v_exp_f32 v34, v34
    v_mfma_f32_16x16x32_bf16 v[44:47], a[92:95], a[28:31], v[44:47]
    s_add_u32 m0, s80, 73728
    buffer_store_dwordx4 a[136:139], v116, s[16:19], s78 offen offset:2048 sc1
    v_mfma_f32_16x16x32_bf16 v[192:195], a[96:99], v[72:75], v[192:195]
    v_exp_f32 v35, v35
    v_mfma_f32_16x16x32_bf16 v[224:227], a[96:99], v[76:79], v[224:227]
    ds_read_b64_tr_b16 a[96:97], v8 offset:16384
    ds_read_b64_tr_b16 a[98:99], v8 offset:20480
    v_mfma_f32_16x16x32_bf16 v[196:199], a[100:103], v[72:75], v[196:199]
    v_exp_f32 v40, v40
    v_mfma_f32_16x16x32_bf16 v[228:231], a[100:103], v[76:79], v[228:231]
    ds_read_b64_tr_b16 a[100:101], v9 offset:16384
    ds_read_b64_tr_b16 a[102:103], v9 offset:20480
    v_mfma_f32_16x16x32_bf16 v[200:203], a[104:107], v[72:75], v[200:203]
    v_exp_f32 v41, v41
    v_mfma_f32_16x16x32_bf16 v[232:235], a[104:107], v[76:79], v[232:235]
    ds_read_b64_tr_b16 a[104:105], v10 offset:16384
    ds_read_b64_tr_b16 a[106:107], v10 offset:20480
    v_mfma_f32_16x16x32_bf16 v[204:207], a[108:111], v[72:75], v[204:207]
    v_exp_f32 v42, v42
    v_mfma_f32_16x16x32_bf16 v[236:239], a[108:111], v[76:79], v[236:239]
    ds_read_b64_tr_b16 a[108:109], v11 offset:16384
    ds_read_b64_tr_b16 a[110:111], v11 offset:20480
    v_mfma_f32_16x16x32_bf16 v[208:211], a[112:115], v[72:75], v[208:211]
    v_exp_f32 v43, v43
    v_mfma_f32_16x16x32_bf16 v[240:243], a[112:115], v[76:79], v[240:243]
    ds_read_b64_tr_b16 a[112:113], v12 offset:16384
    ds_read_b64_tr_b16 a[114:115], v12 offset:20480
    v_mfma_f32_16x16x32_bf16 v[212:215], a[116:119], v[72:75], v[212:215]
    v_exp_f32 v36, v36
    v_mfma_f32_16x16x32_bf16 v[244:247], a[116:119], v[76:79], v[244:247]
    ds_read_b64_tr_b16 a[116:117], v13 offset:16384
    ds_read_b64_tr_b16 a[118:119], v13 offset:20480
    v_mfma_f32_16x16x32_bf16 v[216:219], a[120:123], v[72:75], v[216:219]
    v_exp_f32 v37, v37
    v_mfma_f32_16x16x32_bf16 v[248:251], a[120:123], v[76:79], v[248:251]
    ds_read_b64_tr_b16 a[120:121], v14 offset:16384
    ds_read_b64_tr_b16 a[122:123], v14 offset:20480
    v_mfma_f32_16x16x32_bf16 v[220:223], a[124:127], v[72:75], v[220:223]
    v_exp_f32 v38, v38
    v_mfma_f32_16x16x32_bf16 v[252:255], a[124:127], v[76:79], v[252:255]
    ds_read_b64_tr_b16 a[124:125], v15 offset:16384
    ds_read_b64_tr_b16 a[126:127], v15 offset:20480
    v_mfma_f32_16x16x32_bf16 v[104:107], v[112:115], v[72:75], v[104:107]
    v_exp_f32 v39, v39
    v_mfma_f32_16x16x32_bf16 v[108:111], v[112:115], v[76:79], v[108:111]
    v_cvt_pk_bf16_f32 v65, v34, v35
    v_cvt_pk_bf16_f32 v68, v40, v41
    v_mfma_f32_16x16x32_bf16 v[48:51], a[64:67], a[32:35], v[88:91]
    v_exp_f32 v44, v44
    v_mfma_f32_16x16x32_bf16 v[56:59], a[64:67], a[48:51], v[92:95]
    ds_read_b128 a[64:67], v4 offset:16384
    v_cvt_pk_bf16_f32 v69, v42, v43
    v_mfma_f32_16x16x32_bf16 v[48:51], a[68:71], a[36:39], v[48:51]
    v_exp_f32 v45, v45
    v_mfma_f32_16x16x32_bf16 v[56:59], a[68:71], a[52:55], v[56:59]
    ds_read_b128 a[68:71], v5 offset:16384
    v_cvt_pk_bf16_f32 v66, v36, v37
    v_mfma_f32_16x16x32_bf16 v[48:51], a[72:75], a[40:43], v[48:51]
    v_exp_f32 v46, v46
    v_mfma_f32_16x16x32_bf16 v[56:59], a[72:75], a[56:59], v[56:59]
    ds_read_b128 a[72:75], v6 offset:16384
    v_cvt_pk_bf16_f32 v67, v38, v39
    v_mfma_f32_16x16x32_bf16 v[48:51], a[76:79], a[44:47], v[48:51]
    v_exp_f32 v47, v47
    v_mfma_f32_16x16x32_bf16 v[56:59], a[76:79], a[60:63], v[56:59]
    ds_read_b128 a[76:79], v7 offset:16384
    v_cvt_pk_bf16_f32 v70, v44, v45
    v_mfma_f32_16x16x32_bf16 v[52:55], a[80:83], a[32:35], v[88:91]
    buffer_load_dwordx4 v20, s[12:15], s81 offen nt lds
    v_mfma_f32_16x16x32_bf16 v[60:63], a[80:83], a[48:51], v[92:95]
    ds_read_b128 a[80:83], v4 offset:20480
    v_cvt_pk_bf16_f32 v71, v46, v47
    v_mfma_f32_16x16x32_bf16 v[52:55], a[84:87], a[36:39], v[52:55]
    v_exp_f32 v48, v48
    v_mfma_f32_16x16x32_bf16 v[60:63], a[84:87], a[52:55], v[60:63]
    ds_read_b128 a[84:87], v5 offset:20480
    s_add_u32 m0, s80, 77824
    v_mfma_f32_16x16x32_bf16 v[52:55], a[88:91], a[40:43], v[52:55]
    v_exp_f32 v49, v49
    v_mfma_f32_16x16x32_bf16 v[60:63], a[88:91], a[56:59], v[60:63]
    ds_read_b128 a[88:91], v6 offset:20480
    buffer_load_dwordx4 v21, s[12:15], s81 offen nt lds
    v_mfma_f32_16x16x32_bf16 v[52:55], a[92:95], a[44:47], v[52:55]
    v_exp_f32 v50, v50
    v_mfma_f32_16x16x32_bf16 v[60:63], a[92:95], a[60:63], v[60:63]
    ds_read_b128 a[92:95], v7 offset:20480
    s_waitcnt lgkmcnt(8)
    v_mfma_f32_16x16x32_bf16 v[128:131], a[96:99], v[64:67], v[128:131]
    v_exp_f32 v51, v51
    v_mfma_f32_16x16x32_bf16 v[160:163], a[96:99], v[68:71], v[160:163]
    v_cvt_pk_bf16_f32 v72, v48, v49
    v_cvt_pk_bf16_f32 v73, v50, v51
    v_mfma_f32_16x16x32_bf16 v[132:135], a[100:103], v[64:67], v[132:135]
    v_exp_f32 v56, v56
    v_mfma_f32_16x16x32_bf16 v[164:167], a[100:103], v[68:71], v[164:167]
    s_add_u32 s25, s25, 16384
    s_add_u32 s81, s81, 16384
    buffer_store_dwordx4 a[140:143], v116, s[16:19], s78 offen offset:3072 sc1
    v_mfma_f32_16x16x32_bf16 v[136:139], a[104:107], v[64:67], v[136:139]
    v_exp_f32 v57, v57
    v_mfma_f32_16x16x32_bf16 v[168:171], a[104:107], v[68:71], v[168:171]
    v_cvt_pk_bf16_f32 v76, v56, v57
    s_add_u32 m0, s80, 0
    v_mfma_f32_16x16x32_bf16 v[140:143], a[108:111], v[64:67], v[140:143]
    v_exp_f32 v58, v58
    v_mfma_f32_16x16x32_bf16 v[172:175], a[108:111], v[68:71], v[172:175]
    buffer_load_dwordx4 v16, s[8:11], s26 offen nt lds
    v_mfma_f32_16x16x32_bf16 v[144:147], a[112:115], v[64:67], v[144:147]
    v_exp_f32 v59, v59
    v_mfma_f32_16x16x32_bf16 v[176:179], a[112:115], v[68:71], v[176:179]
    v_cvt_pk_bf16_f32 v77, v58, v59
    v_mfma_f32_16x16x32_bf16 v[148:151], a[116:119], v[64:67], v[148:151]
    v_exp_f32 v52, v52
    v_mfma_f32_16x16x32_bf16 v[180:183], a[116:119], v[68:71], v[180:183]
    s_add_u32 m0, s80, 4096
    v_mfma_f32_16x16x32_bf16 v[152:155], a[120:123], v[64:67], v[152:155]
    v_exp_f32 v53, v53
    v_mfma_f32_16x16x32_bf16 v[184:187], a[120:123], v[68:71], v[184:187]
    buffer_load_dwordx4 v17, s[8:11], s26 offen nt lds
    v_mfma_f32_16x16x32_bf16 v[156:159], a[124:127], v[64:67], v[156:159]
    v_exp_f32 v54, v54
    v_mfma_f32_16x16x32_bf16 v[188:191], a[124:127], v[68:71], v[188:191]
    v_mfma_f32_16x16x32_bf16 v[96:99], v[112:115], v[64:67], v[96:99]
    v_exp_f32 v55, v55
    v_mfma_f32_16x16x32_bf16 v[100:103], v[112:115], v[68:71], v[100:103]
    s_waitcnt lgkmcnt(0)
    v_mfma_f32_16x16x32_bf16 v[32:35], a[64:67], a[0:3], v[80:83]
    v_exp_f32 v60, v60
    v_mfma_f32_16x16x32_bf16 v[40:43], a[64:67], a[16:19], v[84:87]
    v_cvt_pk_bf16_f32 v74, v52, v53
    s_add_u32 m0, s80, 8192
    v_mfma_f32_16x16x32_bf16 v[32:35], a[68:71], a[4:7], v[32:35]
    v_exp_f32 v61, v61
    v_mfma_f32_16x16x32_bf16 v[40:43], a[68:71], a[20:23], v[40:43]
    v_cvt_pk_bf16_f32 v75, v54, v55
    v_cvt_pk_bf16_f32 v78, v60, v61
    v_mfma_f32_16x16x32_bf16 v[32:35], a[72:75], a[8:11], v[32:35]
    v_exp_f32 v62, v62
    v_mfma_f32_16x16x32_bf16 v[40:43], a[72:75], a[24:27], v[40:43]
    buffer_load_dwordx4 v16, s[8:11], s82 offen nt lds
    v_mfma_f32_16x16x32_bf16 v[32:35], a[76:79], a[12:15], v[32:35]
    v_exp_f32 v63, v63
    v_mfma_f32_16x16x32_bf16 v[40:43], a[76:79], a[28:31], v[40:43]
    v_cvt_pk_bf16_f32 v79, v62, v63
    v_mfma_f32_16x16x32_bf16 v[36:39], a[80:83], a[0:3], v[80:83]
    v_mfma_f32_16x16x32_bf16 v[44:47], a[80:83], a[16:19], v[84:87]
    s_add_u32 m0, s80, 12288
    v_mfma_f32_16x16x32_bf16 v[36:39], a[84:87], a[4:7], v[36:39]
    v_exp_f32 v32, v32
    v_mfma_f32_16x16x32_bf16 v[44:47], a[84:87], a[20:23], v[44:47]
    buffer_load_dwordx4 v17, s[8:11], s82 offen nt lds
    v_mfma_f32_16x16x32_bf16 v[36:39], a[88:91], a[8:11], v[36:39]
    v_exp_f32 v33, v33
    v_mfma_f32_16x16x32_bf16 v[44:47], a[88:91], a[24:27], v[44:47]
    v_cvt_pk_bf16_f32 v64, v32, v33
    s_add_u32 s26, s26, 16384
    v_mfma_f32_16x16x32_bf16 v[36:39], a[92:95], a[12:15], v[36:39]
    v_exp_f32 v34, v34
    v_mfma_f32_16x16x32_bf16 v[44:47], a[92:95], a[28:31], v[44:47]
    s_add_u32 s82, s82, 16384
    v_mfma_f32_16x16x32_bf16 v[192:195], a[96:99], v[72:75], v[192:195]
    v_exp_f32 v35, v35
    v_mfma_f32_16x16x32_bf16 v[224:227], a[96:99], v[76:79], v[224:227]
    ds_read_b64_tr_b16 a[96:97], v8 offset:24576
    ds_read_b64_tr_b16 a[98:99], v8 offset:28672
    v_mfma_f32_16x16x32_bf16 v[196:199], a[100:103], v[72:75], v[196:199]
    v_exp_f32 v40, v40
    v_mfma_f32_16x16x32_bf16 v[228:231], a[100:103], v[76:79], v[228:231]
    ds_read_b64_tr_b16 a[100:101], v9 offset:24576
    ds_read_b64_tr_b16 a[102:103], v9 offset:28672
    v_mfma_f32_16x16x32_bf16 v[200:203], a[104:107], v[72:75], v[200:203]
    v_exp_f32 v41, v41
    v_mfma_f32_16x16x32_bf16 v[232:235], a[104:107], v[76:79], v[232:235]
    ds_read_b64_tr_b16 a[104:105], v10 offset:24576
    ds_read_b64_tr_b16 a[106:107], v10 offset:28672
    v_mfma_f32_16x16x32_bf16 v[204:207], a[108:111], v[72:75], v[204:207]
    v_exp_f32 v42, v42
    v_mfma_f32_16x16x32_bf16 v[236:239], a[108:111], v[76:79], v[236:239]
    ds_read_b64_tr_b16 a[108:109], v11 offset:24576
    ds_read_b64_tr_b16 a[110:111], v11 offset:28672
    v_mfma_f32_16x16x32_bf16 v[208:211], a[112:115], v[72:75], v[208:211]
    v_exp_f32 v43, v43
    v_mfma_f32_16x16x32_bf16 v[240:243], a[112:115], v[76:79], v[240:243]
    ds_read_b64_tr_b16 a[112:113], v12 offset:24576
    ds_read_b64_tr_b16 a[114:115], v12 offset:28672
    v_mfma_f32_16x16x32_bf16 v[212:215], a[116:119], v[72:75], v[212:215]
    v_exp_f32 v36, v36
    v_mfma_f32_16x16x32_bf16 v[244:247], a[116:119], v[76:79], v[244:247]
    ds_read_b64_tr_b16 a[116:117], v13 offset:24576
    ds_read_b64_tr_b16 a[118:119], v13 offset:28672
    v_mfma_f32_16x16x32_bf16 v[216:219], a[120:123], v[72:75], v[216:219]
    v_exp_f32 v37, v37
    v_mfma_f32_16x16x32_bf16 v[248:251], a[120:123], v[76:79], v[248:251]
    ds_read_b64_tr_b16 a[120:121], v14 offset:24576
    ds_read_b64_tr_b16 a[122:123], v14 offset:28672
    v_mfma_f32_16x16x32_bf16 v[220:223], a[124:127], v[72:75], v[220:223]
    v_exp_f32 v38, v38
    v_mfma_f32_16x16x32_bf16 v[252:255], a[124:127], v[76:79], v[252:255]
    ds_read_b64_tr_b16 a[124:125], v15 offset:24576
    ds_read_b64_tr_b16 a[126:127], v15 offset:28672
    v_mfma_f32_16x16x32_bf16 v[104:107], v[112:115], v[72:75], v[104:107]
    v_exp_f32 v39, v39
    v_mfma_f32_16x16x32_bf16 v[108:111], v[112:115], v[76:79], v[108:111]
    v_cvt_pk_bf16_f32 v65, v34, v35
    v_cvt_pk_bf16_f32 v68, v40, v41
    v_mfma_f32_16x16x32_bf16 v[48:51], a[64:67], a[32:35], v[88:91]
    v_exp_f32 v44, v44
    v_mfma_f32_16x16x32_bf16 v[56:59], a[64:67], a[48:51], v[92:95]
    ds_read_b128 a[64:67], v4 offset:24576
    v_cvt_pk_bf16_f32 v69, v42, v43
    v_mfma_f32_16x16x32_bf16 v[48:51], a[68:71], a[36:39], v[48:51]
    v_exp_f32 v45, v45
    v_mfma_f32_16x16x32_bf16 v[56:59], a[68:71], a[52:55], v[56:59]
    ds_read_b128 a[68:71], v5 offset:24576
    v_cvt_pk_bf16_f32 v66, v36, v37
    v_mfma_f32_16x16x32_bf16 v[48:51], a[72:75], a[40:43], v[48:51]
    v_exp_f32 v46, v46
    v_mfma_f32_16x16x32_bf16 v[56:59], a[72:75], a[56:59], v[56:59]
    ds_read_b128 a[72:75], v6 offset:24576
    v_cvt_pk_bf16_f32 v67, v38, v39
    v_mfma_f32_16x16x32_bf16 v[48:51], a[76:79], a[44:47], v[48:51]
    v_exp_f32 v47, v47
    v_mfma_f32_16x16x32_bf16 v[56:59], a[76:79], a[60:63], v[56:59]
    ds_read_b128 a[76:79], v7 offset:24576
    v_cvt_pk_bf16_f32 v70, v44, v45
    v_mfma_f32_16x16x32_bf16 v[52:55], a[80:83], a[32:35], v[88:91]
    buffer_store_dwordx4 a[144:147], v117, s[16:19], s78 offen offset:0 sc1
    v_mfma_f32_16x16x32_bf16 v[60:63], a[80:83], a[48:51], v[92:95]
    ds_read_b128 a[80:83], v4 offset:28672
    v_cvt_pk_bf16_f32 v71, v46, v47
    v_mfma_f32_16x16x32_bf16 v[52:55], a[84:87], a[36:39], v[52:55]
    v_exp_f32 v48, v48
    v_mfma_f32_16x16x32_bf16 v[60:63], a[84:87], a[52:55], v[60:63]
    ds_read_b128 a[84:87], v5 offset:28672
    v_mfma_f32_16x16x32_bf16 v[52:55], a[88:91], a[40:43], v[52:55]
    v_exp_f32 v49, v49
    v_mfma_f32_16x16x32_bf16 v[60:63], a[88:91], a[56:59], v[60:63]
    ds_read_b128 a[88:91], v6 offset:28672
    v_mfma_f32_16x16x32_bf16 v[52:55], a[92:95], a[44:47], v[52:55]
    v_exp_f32 v50, v50
    v_mfma_f32_16x16x32_bf16 v[60:63], a[92:95], a[60:63], v[60:63]
    ds_read_b128 a[92:95], v7 offset:28672
    s_waitcnt lgkmcnt(8)
    v_mfma_f32_16x16x32_bf16 v[128:131], a[96:99], v[64:67], v[128:131]
    v_exp_f32 v51, v51
    v_mfma_f32_16x16x32_bf16 v[160:163], a[96:99], v[68:71], v[160:163]
    v_cvt_pk_bf16_f32 v72, v48, v49
    v_cvt_pk_bf16_f32 v73, v50, v51
    v_mfma_f32_16x16x32_bf16 v[132:135], a[100:103], v[64:67], v[132:135]
    v_exp_f32 v56, v56
    v_mfma_f32_16x16x32_bf16 v[164:167], a[100:103], v[68:71], v[164:167]
    v_mfma_f32_16x16x32_bf16 v[136:139], a[104:107], v[64:67], v[136:139]
    v_exp_f32 v57, v57
    v_mfma_f32_16x16x32_bf16 v[168:171], a[104:107], v[68:71], v[168:171]
    v_cvt_pk_bf16_f32 v76, v56, v57
    v_mfma_f32_16x16x32_bf16 v[140:143], a[108:111], v[64:67], v[140:143]
    v_exp_f32 v58, v58
    v_mfma_f32_16x16x32_bf16 v[172:175], a[108:111], v[68:71], v[172:175]
    v_mfma_f32_16x16x32_bf16 v[144:147], a[112:115], v[64:67], v[144:147]
    v_exp_f32 v59, v59
    v_mfma_f32_16x16x32_bf16 v[176:179], a[112:115], v[68:71], v[176:179]
    v_cvt_pk_bf16_f32 v77, v58, v59
    v_mfma_f32_16x16x32_bf16 v[148:151], a[116:119], v[64:67], v[148:151]
    v_exp_f32 v52, v52
    v_mfma_f32_16x16x32_bf16 v[180:183], a[116:119], v[68:71], v[180:183]
    v_mfma_f32_16x16x32_bf16 v[152:155], a[120:123], v[64:67], v[152:155]
    v_exp_f32 v53, v53
    v_mfma_f32_16x16x32_bf16 v[184:187], a[120:123], v[68:71], v[184:187]
    v_mfma_f32_16x16x32_bf16 v[156:159], a[124:127], v[64:67], v[156:159]
    v_exp_f32 v54, v54
    v_mfma_f32_16x16x32_bf16 v[188:191], a[124:127], v[68:71], v[188:191]
    v_mfma_f32_16x16x32_bf16 v[96:99], v[112:115], v[64:67], v[96:99]
    v_exp_f32 v55, v55
    v_mfma_f32_16x16x32_bf16 v[100:103], v[112:115], v[68:71], v[100:103]
    s_waitcnt vmcnt(22) lgkmcnt(0)
    s_barrier
    v_mfma_f32_16x16x32_bf16 v[32:35], a[64:67], a[0:3], v[80:83]
    v_exp_f32 v60, v60
    v_mfma_f32_16x16x32_bf16 v[40:43], a[64:67], a[16:19], v[84:87]
    v_cvt_pk_bf16_f32 v74, v52, v53
    s_add_u32 m0, s80, 81920
    v_mfma_f32_16x16x32_bf16 v[32:35], a[68:71], a[4:7], v[32:35]
    v_exp_f32 v61, v61
    v_mfma_f32_16x16x32_bf16 v[40:43], a[68:71], a[20:23], v[40:43]
    v_cvt_pk_bf16_f32 v75, v54, v55
    v_cvt_pk_bf16_f32 v78, v60, v61
    v_mfma_f32_16x16x32_bf16 v[32:35], a[72:75], a[8:11], v[32:35]
    v_exp_f32 v62, v62
    v_mfma_f32_16x16x32_bf16 v[40:43], a[72:75], a[24:27], v[40:43]
    buffer_load_dwordx4 v20, s[12:15], s25 offen nt lds
    v_mfma_f32_16x16x32_bf16 v[32:35], a[76:79], a[12:15], v[32:35]
    v_exp_f32 v63, v63
    v_mfma_f32_16x16x32_bf16 v[40:43], a[76:79], a[28:31], v[40:43]
    v_cvt_pk_bf16_f32 v79, v62, v63
    v_mfma_f32_16x16x32_bf16 v[36:39], a[80:83], a[0:3], v[80:83]
    v_mfma_f32_16x16x32_bf16 v[44:47], a[80:83], a[16:19], v[84:87]
    s_add_u32 m0, s80, 86016
    v_mfma_f32_16x16x32_bf16 v[36:39], a[84:87], a[4:7], v[36:39]
    v_exp_f32 v32, v32
    v_mfma_f32_16x16x32_bf16 v[44:47], a[84:87], a[20:23], v[44:47]
    buffer_load_dwordx4 v21, s[12:15], s25 offen nt lds
    v_mfma_f32_16x16x32_bf16 v[36:39], a[88:91], a[8:11], v[36:39]
    v_exp_f32 v33, v33
    v_mfma_f32_16x16x32_bf16 v[44:47], a[88:91], a[24:27], v[44:47]
    v_cvt_pk_bf16_f32 v64, v32, v33
    v_mfma_f32_16x16x32_bf16 v[36:39], a[92:95], a[12:15], v[36:39]
    v_exp_f32 v34, v34
    v_mfma_f32_16x16x32_bf16 v[44:47], a[92:95], a[28:31], v[44:47]
    s_add_u32 m0, s80, 90112
    buffer_store_dwordx4 a[148:151], v117, s[16:19], s78 offen offset:1024 sc1
    v_mfma_f32_16x16x32_bf16 v[192:195], a[96:99], v[72:75], v[192:195]
    v_exp_f32 v35, v35
    v_mfma_f32_16x16x32_bf16 v[224:227], a[96:99], v[76:79], v[224:227]
    ds_read_b64_tr_b16 a[96:97], v8 offset:32768
    ds_read_b64_tr_b16 a[98:99], v8 offset:36864
    v_mfma_f32_16x16x32_bf16 v[196:199], a[100:103], v[72:75], v[196:199]
    v_exp_f32 v40, v40
    v_mfma_f32_16x16x32_bf16 v[228:231], a[100:103], v[76:79], v[228:231]
    ds_read_b64_tr_b16 a[100:101], v9 offset:32768
    ds_read_b64_tr_b16 a[102:103], v9 offset:36864
    v_mfma_f32_16x16x32_bf16 v[200:203], a[104:107], v[72:75], v[200:203]
    v_exp_f32 v41, v41
    v_mfma_f32_16x16x32_bf16 v[232:235], a[104:107], v[76:79], v[232:235]
    ds_read_b64_tr_b16 a[104:105], v10 offset:32768
    ds_read_b64_tr_b16 a[106:107], v10 offset:36864
    v_mfma_f32_16x16x32_bf16 v[204:207], a[108:111], v[72:75], v[204:207]
    v_exp_f32 v42, v42
    v_mfma_f32_16x16x32_bf16 v[236:239], a[108:111], v[76:79], v[236:239]
    ds_read_b64_tr_b16 a[108:109], v11 offset:32768
    ds_read_b64_tr_b16 a[110:111], v11 offset:36864
    v_mfma_f32_16x16x32_bf16 v[208:211], a[112:115], v[72:75], v[208:211]
    v_exp_f32 v43, v43
    v_mfma_f32_16x16x32_bf16 v[240:243], a[112:115], v[76:79], v[240:243]
    ds_read_b64_tr_b16 a[112:113], v12 offset:32768
    ds_read_b64_tr_b16 a[114:115], v12 offset:36864
    v_mfma_f32_16x16x32_bf16 v[212:215], a[116:119], v[72:75], v[212:215]
    v_exp_f32 v36, v36
    v_mfma_f32_16x16x32_bf16 v[244:247], a[116:119], v[76:79], v[244:247]
    ds_read_b64_tr_b16 a[116:117], v13 offset:32768
    ds_read_b64_tr_b16 a[118:119], v13 offset:36864
    v_mfma_f32_16x16x32_bf16 v[216:219], a[120:123], v[72:75], v[216:219]
    v_exp_f32 v37, v37
    v_mfma_f32_16x16x32_bf16 v[248:251], a[120:123], v[76:79], v[248:251]
    ds_read_b64_tr_b16 a[120:121], v14 offset:32768
    ds_read_b64_tr_b16 a[122:123], v14 offset:36864
    v_mfma_f32_16x16x32_bf16 v[220:223], a[124:127], v[72:75], v[220:223]
    v_exp_f32 v38, v38
    v_mfma_f32_16x16x32_bf16 v[252:255], a[124:127], v[76:79], v[252:255]
    ds_read_b64_tr_b16 a[124:125], v15 offset:32768
    ds_read_b64_tr_b16 a[126:127], v15 offset:36864
    v_mfma_f32_16x16x32_bf16 v[104:107], v[112:115], v[72:75], v[104:107]
    v_exp_f32 v39, v39
    v_mfma_f32_16x16x32_bf16 v[108:111], v[112:115], v[76:79], v[108:111]
    v_cvt_pk_bf16_f32 v65, v34, v35
    v_cvt_pk_bf16_f32 v68, v40, v41
    v_mfma_f32_16x16x32_bf16 v[48:51], a[64:67], a[32:35], v[88:91]
    v_exp_f32 v44, v44
    v_mfma_f32_16x16x32_bf16 v[56:59], a[64:67], a[48:51], v[92:95]
    ds_read_b128 a[64:67], v4 offset:32768
    v_cvt_pk_bf16_f32 v69, v42, v43
    v_mfma_f32_16x16x32_bf16 v[48:51], a[68:71], a[36:39], v[48:51]
    v_exp_f32 v45, v45
    v_mfma_f32_16x16x32_bf16 v[56:59], a[68:71], a[52:55], v[56:59]
    ds_read_b128 a[68:71], v5 offset:32768
    v_cvt_pk_bf16_f32 v66, v36, v37
    v_mfma_f32_16x16x32_bf16 v[48:51], a[72:75], a[40:43], v[48:51]
    v_exp_f32 v46, v46
    v_mfma_f32_16x16x32_bf16 v[56:59], a[72:75], a[56:59], v[56:59]
    ds_read_b128 a[72:75], v6 offset:32768
    v_cvt_pk_bf16_f32 v67, v38, v39
    v_mfma_f32_16x16x32_bf16 v[48:51], a[76:79], a[44:47], v[48:51]
    v_exp_f32 v47, v47
    v_mfma_f32_16x16x32_bf16 v[56:59], a[76:79], a[60:63], v[56:59]
    ds_read_b128 a[76:79], v7 offset:32768
    v_cvt_pk_bf16_f32 v70, v44, v45
    v_mfma_f32_16x16x32_bf16 v[52:55], a[80:83], a[32:35], v[88:91]
    buffer_load_dwordx4 v20, s[12:15], s81 offen nt lds
    v_mfma_f32_16x16x32_bf16 v[60:63], a[80:83], a[48:51], v[92:95]
    ds_read_b128 a[80:83], v4 offset:36864
    v_cvt_pk_bf16_f32 v71, v46, v47
    v_mfma_f32_16x16x32_bf16 v[52:55], a[84:87], a[36:39], v[52:55]
    v_exp_f32 v48, v48
    v_mfma_f32_16x16x32_bf16 v[60:63], a[84:87], a[52:55], v[60:63]
    ds_read_b128 a[84:87], v5 offset:36864
    s_add_u32 m0, s80, 94208
    v_mfma_f32_16x16x32_bf16 v[52:55], a[88:91], a[40:43], v[52:55]
    v_exp_f32 v49, v49
    v_mfma_f32_16x16x32_bf16 v[60:63], a[88:91], a[56:59], v[60:63]
    ds_read_b128 a[88:91], v6 offset:36864
    buffer_load_dwordx4 v21, s[12:15], s81 offen nt lds
    v_mfma_f32_16x16x32_bf16 v[52:55], a[92:95], a[44:47], v[52:55]
    v_exp_f32 v50, v50
    v_mfma_f32_16x16x32_bf16 v[60:63], a[92:95], a[60:63], v[60:63]
    ds_read_b128 a[92:95], v7 offset:36864
    s_waitcnt lgkmcnt(8)
    v_mfma_f32_16x16x32_bf16 v[128:131], a[96:99], v[64:67], v[128:131]
    v_exp_f32 v51, v51
    v_mfma_f32_16x16x32_bf16 v[160:163], a[96:99], v[68:71], v[160:163]
    v_cvt_pk_bf16_f32 v72, v48, v49
    v_cvt_pk_bf16_f32 v73, v50, v51
    v_mfma_f32_16x16x32_bf16 v[132:135], a[100:103], v[64:67], v[132:135]
    v_exp_f32 v56, v56
    v_mfma_f32_16x16x32_bf16 v[164:167], a[100:103], v[68:71], v[164:167]
    s_add_u32 s25, s25, 16384
    s_add_u32 s81, s81, 16384
    buffer_store_dwordx4 a[152:155], v117, s[16:19], s78 offen offset:2048 sc1
    v_mfma_f32_16x16x32_bf16 v[136:139], a[104:107], v[64:67], v[136:139]
    v_exp_f32 v57, v57
    v_mfma_f32_16x16x32_bf16 v[168:171], a[104:107], v[68:71], v[168:171]
    v_cvt_pk_bf16_f32 v76, v56, v57
    s_add_u32 m0, s80, 16384
    v_mfma_f32_16x16x32_bf16 v[140:143], a[108:111], v[64:67], v[140:143]
    v_exp_f32 v58, v58
    v_mfma_f32_16x16x32_bf16 v[172:175], a[108:111], v[68:71], v[172:175]
    buffer_load_dwordx4 v16, s[8:11], s26 offen nt lds
    v_mfma_f32_16x16x32_bf16 v[144:147], a[112:115], v[64:67], v[144:147]
    v_exp_f32 v59, v59
    v_mfma_f32_16x16x32_bf16 v[176:179], a[112:115], v[68:71], v[176:179]
    v_cvt_pk_bf16_f32 v77, v58, v59
    v_mfma_f32_16x16x32_bf16 v[148:151], a[116:119], v[64:67], v[148:151]
    v_exp_f32 v52, v52
    v_mfma_f32_16x16x32_bf16 v[180:183], a[116:119], v[68:71], v[180:183]
    s_add_u32 m0, s80, 20480
    v_mfma_f32_16x16x32_bf16 v[152:155], a[120:123], v[64:67], v[152:155]
    v_exp_f32 v53, v53
    v_mfma_f32_16x16x32_bf16 v[184:187], a[120:123], v[68:71], v[184:187]
    buffer_load_dwordx4 v17, s[8:11], s26 offen nt lds
    v_mfma_f32_16x16x32_bf16 v[156:159], a[124:127], v[64:67], v[156:159]
    v_exp_f32 v54, v54
    v_mfma_f32_16x16x32_bf16 v[188:191], a[124:127], v[68:71], v[188:191]
    v_mfma_f32_16x16x32_bf16 v[96:99], v[112:115], v[64:67], v[96:99]
    v_exp_f32 v55, v55
    v_mfma_f32_16x16x32_bf16 v[100:103], v[112:115], v[68:71], v[100:103]
    s_waitcnt lgkmcnt(0)
    v_mfma_f32_16x16x32_bf16 v[32:35], a[64:67], a[0:3], v[80:83]
    v_exp_f32 v60, v60
    v_mfma_f32_16x16x32_bf16 v[40:43], a[64:67], a[16:19], v[84:87]
    v_cvt_pk_bf16_f32 v74, v52, v53
    s_add_u32 m0, s80, 24576
    v_mfma_f32_16x16x32_bf16 v[32:35], a[68:71], a[4:7], v[32:35]
    v_exp_f32 v61, v61
    v_mfma_f32_16x16x32_bf16 v[40:43], a[68:71], a[20:23], v[40:43]
    v_cvt_pk_bf16_f32 v75, v54, v55
    v_cvt_pk_bf16_f32 v78, v60, v61
    v_mfma_f32_16x16x32_bf16 v[32:35], a[72:75], a[8:11], v[32:35]
    v_exp_f32 v62, v62
    v_mfma_f32_16x16x32_bf16 v[40:43], a[72:75], a[24:27], v[40:43]
    buffer_load_dwordx4 v16, s[8:11], s82 offen nt lds
    v_mfma_f32_16x16x32_bf16 v[32:35], a[76:79], a[12:15], v[32:35]
    v_exp_f32 v63, v63
    v_mfma_f32_16x16x32_bf16 v[40:43], a[76:79], a[28:31], v[40:43]
    v_cvt_pk_bf16_f32 v79, v62, v63
    v_mfma_f32_16x16x32_bf16 v[36:39], a[80:83], a[0:3], v[80:83]
    v_mfma_f32_16x16x32_bf16 v[44:47], a[80:83], a[16:19], v[84:87]
    s_add_u32 m0, s80, 28672
    v_mfma_f32_16x16x32_bf16 v[36:39], a[84:87], a[4:7], v[36:39]
    v_exp_f32 v32, v32
    v_mfma_f32_16x16x32_bf16 v[44:47], a[84:87], a[20:23], v[44:47]
    buffer_load_dwordx4 v17, s[8:11], s82 offen nt lds
    v_mfma_f32_16x16x32_bf16 v[36:39], a[88:91], a[8:11], v[36:39]
    v_exp_f32 v33, v33
    v_mfma_f32_16x16x32_bf16 v[44:47], a[88:91], a[24:27], v[44:47]
    v_cvt_pk_bf16_f32 v64, v32, v33
    s_add_u32 s26, s26, 16384
    v_mfma_f32_16x16x32_bf16 v[36:39], a[92:95], a[12:15], v[36:39]
    v_exp_f32 v34, v34
    v_mfma_f32_16x16x32_bf16 v[44:47], a[92:95], a[28:31], v[44:47]
    s_add_u32 s82, s82, 16384
    v_mfma_f32_16x16x32_bf16 v[192:195], a[96:99], v[72:75], v[192:195]
    v_exp_f32 v35, v35
    v_mfma_f32_16x16x32_bf16 v[224:227], a[96:99], v[76:79], v[224:227]
    ds_read_b64_tr_b16 a[96:97], v8 offset:40960
    ds_read_b64_tr_b16 a[98:99], v8 offset:45056
    v_mfma_f32_16x16x32_bf16 v[196:199], a[100:103], v[72:75], v[196:199]
    v_exp_f32 v40, v40
    v_mfma_f32_16x16x32_bf16 v[228:231], a[100:103], v[76:79], v[228:231]
    ds_read_b64_tr_b16 a[100:101], v9 offset:40960
    ds_read_b64_tr_b16 a[102:103], v9 offset:45056
    v_mfma_f32_16x16x32_bf16 v[200:203], a[104:107], v[72:75], v[200:203]
    v_exp_f32 v41, v41
    v_mfma_f32_16x16x32_bf16 v[232:235], a[104:107], v[76:79], v[232:235]
    ds_read_b64_tr_b16 a[104:105], v10 offset:40960
    ds_read_b64_tr_b16 a[106:107], v10 offset:45056
    v_mfma_f32_16x16x32_bf16 v[204:207], a[108:111], v[72:75], v[204:207]
    v_exp_f32 v42, v42
    v_mfma_f32_16x16x32_bf16 v[236:239], a[108:111], v[76:79], v[236:239]
    ds_read_b64_tr_b16 a[108:109], v11 offset:40960
    ds_read_b64_tr_b16 a[110:111], v11 offset:45056
    v_mfma_f32_16x16x32_bf16 v[208:211], a[112:115], v[72:75], v[208:211]
    v_exp_f32 v43, v43
    v_mfma_f32_16x16x32_bf16 v[240:243], a[112:115], v[76:79], v[240:243]
    ds_read_b64_tr_b16 a[112:113], v12 offset:40960
    ds_read_b64_tr_b16 a[114:115], v12 offset:45056
    v_mfma_f32_16x16x32_bf16 v[212:215], a[116:119], v[72:75], v[212:215]
    v_exp_f32 v36, v36
    v_mfma_f32_16x16x32_bf16 v[244:247], a[116:119], v[76:79], v[244:247]
    ds_read_b64_tr_b16 a[116:117], v13 offset:40960
    ds_read_b64_tr_b16 a[118:119], v13 offset:45056
    v_mfma_f32_16x16x32_bf16 v[216:219], a[120:123], v[72:75], v[216:219]
    v_exp_f32 v37, v37
    v_mfma_f32_16x16x32_bf16 v[248:251], a[120:123], v[76:79], v[248:251]
    ds_read_b64_tr_b16 a[120:121], v14 offset:40960
    ds_read_b64_tr_b16 a[122:123], v14 offset:45056
    v_mfma_f32_16x16x32_bf16 v[220:223], a[124:127], v[72:75], v[220:223]
    v_exp_f32 v38, v38
    v_mfma_f32_16x16x32_bf16 v[252:255], a[124:127], v[76:79], v[252:255]
    ds_read_b64_tr_b16 a[124:125], v15 offset:40960
    ds_read_b64_tr_b16 a[126:127], v15 offset:45056
    v_mfma_f32_16x16x32_bf16 v[104:107], v[112:115], v[72:75], v[104:107]
    v_exp_f32 v39, v39
    v_mfma_f32_16x16x32_bf16 v[108:111], v[112:115], v[76:79], v[108:111]
    v_cvt_pk_bf16_f32 v65, v34, v35
    v_cvt_pk_bf16_f32 v68, v40, v41
    v_mfma_f32_16x16x32_bf16 v[48:51], a[64:67], a[32:35], v[88:91]
    v_exp_f32 v44, v44
    v_mfma_f32_16x16x32_bf16 v[56:59], a[64:67], a[48:51], v[92:95]
    ds_read_b128 a[64:67], v4 offset:40960
    v_cvt_pk_bf16_f32 v69, v42, v43
    v_mfma_f32_16x16x32_bf16 v[48:51], a[68:71], a[36:39], v[48:51]
    v_exp_f32 v45, v45
    v_mfma_f32_16x16x32_bf16 v[56:59], a[68:71], a[52:55], v[56:59]
    ds_read_b128 a[68:71], v5 offset:40960
    v_cvt_pk_bf16_f32 v66, v36, v37
    v_mfma_f32_16x16x32_bf16 v[48:51], a[72:75], a[40:43], v[48:51]
    v_exp_f32 v46, v46
    v_mfma_f32_16x16x32_bf16 v[56:59], a[72:75], a[56:59], v[56:59]
    ds_read_b128 a[72:75], v6 offset:40960
    v_cvt_pk_bf16_f32 v67, v38, v39
    v_mfma_f32_16x16x32_bf16 v[48:51], a[76:79], a[44:47], v[48:51]
    v_exp_f32 v47, v47
    v_mfma_f32_16x16x32_bf16 v[56:59], a[76:79], a[60:63], v[56:59]
    ds_read_b128 a[76:79], v7 offset:40960
    v_cvt_pk_bf16_f32 v70, v44, v45
    v_mfma_f32_16x16x32_bf16 v[52:55], a[80:83], a[32:35], v[88:91]
    buffer_store_dwordx4 a[156:159], v117, s[16:19], s78 offen offset:3072 sc1
    v_mfma_f32_16x16x32_bf16 v[60:63], a[80:83], a[48:51], v[92:95]
    ds_read_b128 a[80:83], v4 offset:45056
    v_cvt_pk_bf16_f32 v71, v46, v47
    v_mfma_f32_16x16x32_bf16 v[52:55], a[84:87], a[36:39], v[52:55]
    v_exp_f32 v48, v48
    v_mfma_f32_16x16x32_bf16 v[60:63], a[84:87], a[52:55], v[60:63]
    ds_read_b128 a[84:87], v5 offset:45056
    v_mfma_f32_16x16x32_bf16 v[52:55], a[88:91], a[40:43], v[52:55]
    v_exp_f32 v49, v49
    v_mfma_f32_16x16x32_bf16 v[60:63], a[88:91], a[56:59], v[60:63]
    ds_read_b128 a[88:91], v6 offset:45056
    v_mfma_f32_16x16x32_bf16 v[52:55], a[92:95], a[44:47], v[52:55]
    v_exp_f32 v50, v50
    v_mfma_f32_16x16x32_bf16 v[60:63], a[92:95], a[60:63], v[60:63]
    ds_read_b128 a[92:95], v7 offset:45056
    s_waitcnt lgkmcnt(8)
    v_mfma_f32_16x16x32_bf16 v[128:131], a[96:99], v[64:67], v[128:131]
    v_exp_f32 v51, v51
    v_mfma_f32_16x16x32_bf16 v[160:163], a[96:99], v[68:71], v[160:163]
    v_cvt_pk_bf16_f32 v72, v48, v49
    v_cvt_pk_bf16_f32 v73, v50, v51
    v_mfma_f32_16x16x32_bf16 v[132:135], a[100:103], v[64:67], v[132:135]
    v_exp_f32 v56, v56
    v_mfma_f32_16x16x32_bf16 v[164:167], a[100:103], v[68:71], v[164:167]
    v_mfma_f32_16x16x32_bf16 v[136:139], a[104:107], v[64:67], v[136:139]
    v_exp_f32 v57, v57
    v_mfma_f32_16x16x32_bf16 v[168:171], a[104:107], v[68:71], v[168:171]
    v_cvt_pk_bf16_f32 v76, v56, v57
    v_mfma_f32_16x16x32_bf16 v[140:143], a[108:111], v[64:67], v[140:143]
    v_exp_f32 v58, v58
    v_mfma_f32_16x16x32_bf16 v[172:175], a[108:111], v[68:71], v[172:175]
    v_mfma_f32_16x16x32_bf16 v[144:147], a[112:115], v[64:67], v[144:147]
    v_exp_f32 v59, v59
    v_mfma_f32_16x16x32_bf16 v[176:179], a[112:115], v[68:71], v[176:179]
    v_cvt_pk_bf16_f32 v77, v58, v59
    v_mfma_f32_16x16x32_bf16 v[148:151], a[116:119], v[64:67], v[148:151]
    v_exp_f32 v52, v52
    v_mfma_f32_16x16x32_bf16 v[180:183], a[116:119], v[68:71], v[180:183]
    v_mfma_f32_16x16x32_bf16 v[152:155], a[120:123], v[64:67], v[152:155]
    v_exp_f32 v53, v53
    v_mfma_f32_16x16x32_bf16 v[184:187], a[120:123], v[68:71], v[184:187]
    v_mfma_f32_16x16x32_bf16 v[156:159], a[124:127], v[64:67], v[156:159]
    v_exp_f32 v54, v54
    v_mfma_f32_16x16x32_bf16 v[188:191], a[124:127], v[68:71], v[188:191]
    v_mfma_f32_16x16x32_bf16 v[96:99], v[112:115], v[64:67], v[96:99]
    v_exp_f32 v55, v55
    v_mfma_f32_16x16x32_bf16 v[100:103], v[112:115], v[68:71], v[100:103]
    s_waitcnt vmcnt(24) lgkmcnt(0)
    s_barrier
    v_mfma_f32_16x16x32_bf16 v[32:35], a[64:67], a[0:3], v[80:83]
    v_exp_f32 v60, v60
    v_mfma_f32_16x16x32_bf16 v[40:43], a[64:67], a[16:19], v[84:87]
    v_cvt_pk_bf16_f32 v74, v52, v53
    s_add_u32 m0, s80, 98304
    v_mfma_f32_16x16x32_bf16 v[32:35], a[68:71], a[4:7], v[32:35]
    v_exp_f32 v61, v61
    v_mfma_f32_16x16x32_bf16 v[40:43], a[68:71], a[20:23], v[40:43]
    v_cvt_pk_bf16_f32 v75, v54, v55
    v_cvt_pk_bf16_f32 v78, v60, v61
    v_mfma_f32_16x16x32_bf16 v[32:35], a[72:75], a[8:11], v[32:35]
    v_exp_f32 v62, v62
    v_mfma_f32_16x16x32_bf16 v[40:43], a[72:75], a[24:27], v[40:43]
    buffer_load_dwordx4 v20, s[12:15], s25 offen nt lds
    v_mfma_f32_16x16x32_bf16 v[32:35], a[76:79], a[12:15], v[32:35]
    v_exp_f32 v63, v63
    v_mfma_f32_16x16x32_bf16 v[40:43], a[76:79], a[28:31], v[40:43]
    v_cvt_pk_bf16_f32 v79, v62, v63
    v_mfma_f32_16x16x32_bf16 v[36:39], a[80:83], a[0:3], v[80:83]
    v_mfma_f32_16x16x32_bf16 v[44:47], a[80:83], a[16:19], v[84:87]
    s_add_u32 m0, s80, 102400
    v_mfma_f32_16x16x32_bf16 v[36:39], a[84:87], a[4:7], v[36:39]
    v_exp_f32 v32, v32
    v_mfma_f32_16x16x32_bf16 v[44:47], a[84:87], a[20:23], v[44:47]
    buffer_load_dwordx4 v21, s[12:15], s25 offen nt lds
    v_mfma_f32_16x16x32_bf16 v[36:39], a[88:91], a[8:11], v[36:39]
    v_exp_f32 v33, v33
    v_mfma_f32_16x16x32_bf16 v[44:47], a[88:91], a[24:27], v[44:47]
    v_cvt_pk_bf16_f32 v64, v32, v33
    v_mfma_f32_16x16x32_bf16 v[36:39], a[92:95], a[12:15], v[36:39]
    v_exp_f32 v34, v34
    v_mfma_f32_16x16x32_bf16 v[44:47], a[92:95], a[28:31], v[44:47]
    s_add_u32 m0, s80, 106496
    v_mfma_f32_16x16x32_bf16 v[192:195], a[96:99], v[72:75], v[192:195]
    v_exp_f32 v35, v35
    buffer_store_dwordx4 a[160:163], v118, s[16:19], s78 offen offset:0 sc1
    v_mfma_f32_16x16x32_bf16 v[224:227], a[96:99], v[76:79], v[224:227]
    ds_read_b64_tr_b16 a[96:97], v8 offset:49152
    ds_read_b64_tr_b16 a[98:99], v8 offset:53248
    v_mfma_f32_16x16x32_bf16 v[196:199], a[100:103], v[72:75], v[196:199]
    v_exp_f32 v40, v40
    v_mfma_f32_16x16x32_bf16 v[228:231], a[100:103], v[76:79], v[228:231]
    ds_read_b64_tr_b16 a[100:101], v9 offset:49152
    ds_read_b64_tr_b16 a[102:103], v9 offset:53248
    v_mfma_f32_16x16x32_bf16 v[200:203], a[104:107], v[72:75], v[200:203]
    v_exp_f32 v41, v41
    v_mfma_f32_16x16x32_bf16 v[232:235], a[104:107], v[76:79], v[232:235]
    ds_read_b64_tr_b16 a[104:105], v10 offset:49152
    ds_read_b64_tr_b16 a[106:107], v10 offset:53248
    v_mfma_f32_16x16x32_bf16 v[204:207], a[108:111], v[72:75], v[204:207]
    v_exp_f32 v42, v42
    v_mfma_f32_16x16x32_bf16 v[236:239], a[108:111], v[76:79], v[236:239]
    ds_read_b64_tr_b16 a[108:109], v11 offset:49152
    ds_read_b64_tr_b16 a[110:111], v11 offset:53248
    v_mfma_f32_16x16x32_bf16 v[208:211], a[112:115], v[72:75], v[208:211]
    v_exp_f32 v43, v43
    v_mfma_f32_16x16x32_bf16 v[240:243], a[112:115], v[76:79], v[240:243]
    ds_read_b64_tr_b16 a[112:113], v12 offset:49152
    ds_read_b64_tr_b16 a[114:115], v12 offset:53248
    v_mfma_f32_16x16x32_bf16 v[212:215], a[116:119], v[72:75], v[212:215]
    v_exp_f32 v36, v36
    v_mfma_f32_16x16x32_bf16 v[244:247], a[116:119], v[76:79], v[244:247]
    ds_read_b64_tr_b16 a[116:117], v13 offset:49152
    ds_read_b64_tr_b16 a[118:119], v13 offset:53248
    v_mfma_f32_16x16x32_bf16 v[216:219], a[120:123], v[72:75], v[216:219]
    v_exp_f32 v37, v37
    v_mfma_f32_16x16x32_bf16 v[248:251], a[120:123], v[76:79], v[248:251]
    ds_read_b64_tr_b16 a[120:121], v14 offset:49152
    ds_read_b64_tr_b16 a[122:123], v14 offset:53248
    v_mfma_f32_16x16x32_bf16 v[220:223], a[124:127], v[72:75], v[220:223]
    v_exp_f32 v38, v38
    v_mfma_f32_16x16x32_bf16 v[252:255], a[124:127], v[76:79], v[252:255]
    ds_read_b64_tr_b16 a[124:125], v15 offset:49152
    ds_read_b64_tr_b16 a[126:127], v15 offset:53248
    v_mfma_f32_16x16x32_bf16 v[104:107], v[112:115], v[72:75], v[104:107]
    v_exp_f32 v39, v39
    v_mfma_f32_16x16x32_bf16 v[108:111], v[112:115], v[76:79], v[108:111]
    v_cvt_pk_bf16_f32 v65, v34, v35
    v_cvt_pk_bf16_f32 v68, v40, v41
    v_mfma_f32_16x16x32_bf16 v[48:51], a[64:67], a[32:35], v[88:91]
    v_exp_f32 v44, v44
    v_mfma_f32_16x16x32_bf16 v[56:59], a[64:67], a[48:51], v[92:95]
    ds_read_b128 a[64:67], v4 offset:49152
    v_cvt_pk_bf16_f32 v69, v42, v43
    v_mfma_f32_16x16x32_bf16 v[48:51], a[68:71], a[36:39], v[48:51]
    v_exp_f32 v45, v45
    v_mfma_f32_16x16x32_bf16 v[56:59], a[68:71], a[52:55], v[56:59]
    ds_read_b128 a[68:71], v5 offset:49152
    v_cvt_pk_bf16_f32 v66, v36, v37
    v_mfma_f32_16x16x32_bf16 v[48:51], a[72:75], a[40:43], v[48:51]
    v_exp_f32 v46, v46
    v_mfma_f32_16x16x32_bf16 v[56:59], a[72:75], a[56:59], v[56:59]
    ds_read_b128 a[72:75], v6 offset:49152
    v_cvt_pk_bf16_f32 v67, v38, v39
    v_mfma_f32_16x16x32_bf16 v[48:51], a[76:79], a[44:47], v[48:51]
    v_exp_f32 v47, v47
    v_mfma_f32_16x16x32_bf16 v[56:59], a[76:79], a[60:63], v[56:59]
    ds_read_b128 a[76:79], v7 offset:49152
    v_cvt_pk_bf16_f32 v70, v44, v45
    v_mfma_f32_16x16x32_bf16 v[52:55], a[80:83], a[32:35], v[88:91]
    buffer_load_dwordx4 v20, s[12:15], s81 offen nt lds
    v_mfma_f32_16x16x32_bf16 v[60:63], a[80:83], a[48:51], v[92:95]
    ds_read_b128 a[80:83], v4 offset:53248
    v_cvt_pk_bf16_f32 v71, v46, v47
    v_mfma_f32_16x16x32_bf16 v[52:55], a[84:87], a[36:39], v[52:55]
    v_exp_f32 v48, v48
    v_mfma_f32_16x16x32_bf16 v[60:63], a[84:87], a[52:55], v[60:63]
    ds_read_b128 a[84:87], v5 offset:53248
    s_add_u32 m0, s80, 110592
    v_mfma_f32_16x16x32_bf16 v[52:55], a[88:91], a[40:43], v[52:55]
    v_exp_f32 v49, v49
    v_mfma_f32_16x16x32_bf16 v[60:63], a[88:91], a[56:59], v[60:63]
    ds_read_b128 a[88:91], v6 offset:53248
    buffer_load_dwordx4 v21, s[12:15], s81 offen nt lds
    v_mfma_f32_16x16x32_bf16 v[52:55], a[92:95], a[44:47], v[52:55]
    v_exp_f32 v50, v50
    v_mfma_f32_16x16x32_bf16 v[60:63], a[92:95], a[60:63], v[60:63]
    ds_read_b128 a[92:95], v7 offset:53248
    s_waitcnt lgkmcnt(8)
    v_mfma_f32_16x16x32_bf16 v[128:131], a[96:99], v[64:67], v[128:131]
    v_exp_f32 v51, v51
    v_mfma_f32_16x16x32_bf16 v[160:163], a[96:99], v[68:71], v[160:163]
    v_cvt_pk_bf16_f32 v72, v48, v49
    v_cvt_pk_bf16_f32 v73, v50, v51
    v_mfma_f32_16x16x32_bf16 v[132:135], a[100:103], v[64:67], v[132:135]
    v_exp_f32 v56, v56
    v_mfma_f32_16x16x32_bf16 v[164:167], a[100:103], v[68:71], v[164:167]
    s_add_u32 s25, s25, 16384
    s_add_u32 s81, s81, 16384
    v_mfma_f32_16x16x32_bf16 v[136:139], a[104:107], v[64:67], v[136:139]
    v_exp_f32 v57, v57
    v_mfma_f32_16x16x32_bf16 v[168:171], a[104:107], v[68:71], v[168:171]
    v_cvt_pk_bf16_f32 v76, v56, v57
    s_add_u32 m0, s80, 32768
    v_mfma_f32_16x16x32_bf16 v[140:143], a[108:111], v[64:67], v[140:143]
    v_exp_f32 v58, v58
    v_mfma_f32_16x16x32_bf16 v[172:175], a[108:111], v[68:71], v[172:175]
    buffer_load_dwordx4 v16, s[8:11], s26 offen nt lds
    v_mfma_f32_16x16x32_bf16 v[144:147], a[112:115], v[64:67], v[144:147]
    v_exp_f32 v59, v59
    v_mfma_f32_16x16x32_bf16 v[176:179], a[112:115], v[68:71], v[176:179]
    v_cvt_pk_bf16_f32 v77, v58, v59
    v_mfma_f32_16x16x32_bf16 v[148:151], a[116:119], v[64:67], v[148:151]
    v_exp_f32 v52, v52
    v_mfma_f32_16x16x32_bf16 v[180:183], a[116:119], v[68:71], v[180:183]
    s_add_u32 m0, s80, 36864
    v_mfma_f32_16x16x32_bf16 v[152:155], a[120:123], v[64:67], v[152:155]
    v_exp_f32 v53, v53
    v_mfma_f32_16x16x32_bf16 v[184:187], a[120:123], v[68:71], v[184:187]
    buffer_load_dwordx4 v17, s[8:11], s26 offen nt lds
    v_mfma_f32_16x16x32_bf16 v[156:159], a[124:127], v[64:67], v[156:159]
    v_exp_f32 v54, v54
    v_mfma_f32_16x16x32_bf16 v[188:191], a[124:127], v[68:71], v[188:191]
    v_mfma_f32_16x16x32_bf16 v[96:99], v[112:115], v[64:67], v[96:99]
    v_exp_f32 v55, v55
    v_mfma_f32_16x16x32_bf16 v[100:103], v[112:115], v[68:71], v[100:103]
    s_waitcnt lgkmcnt(0)
    v_mfma_f32_16x16x32_bf16 v[32:35], a[64:67], a[0:3], v[80:83]
    v_exp_f32 v60, v60
    v_mfma_f32_16x16x32_bf16 v[40:43], a[64:67], a[16:19], v[84:87]
    v_cvt_pk_bf16_f32 v74, v52, v53
    s_add_u32 m0, s80, 40960
    v_mfma_f32_16x16x32_bf16 v[32:35], a[68:71], a[4:7], v[32:35]
    v_exp_f32 v61, v61
    v_mfma_f32_16x16x32_bf16 v[40:43], a[68:71], a[20:23], v[40:43]
    v_cvt_pk_bf16_f32 v75, v54, v55
    v_cvt_pk_bf16_f32 v78, v60, v61
    v_mfma_f32_16x16x32_bf16 v[32:35], a[72:75], a[8:11], v[32:35]
    v_exp_f32 v62, v62
    v_mfma_f32_16x16x32_bf16 v[40:43], a[72:75], a[24:27], v[40:43]
    buffer_load_dwordx4 v16, s[8:11], s82 offen nt lds
    v_mfma_f32_16x16x32_bf16 v[32:35], a[76:79], a[12:15], v[32:35]
    v_exp_f32 v63, v63
    v_mfma_f32_16x16x32_bf16 v[40:43], a[76:79], a[28:31], v[40:43]
    v_cvt_pk_bf16_f32 v79, v62, v63
    v_mfma_f32_16x16x32_bf16 v[36:39], a[80:83], a[0:3], v[80:83]
    v_mfma_f32_16x16x32_bf16 v[44:47], a[80:83], a[16:19], v[84:87]
    s_add_u32 m0, s80, 45056
    v_mfma_f32_16x16x32_bf16 v[36:39], a[84:87], a[4:7], v[36:39]
    v_exp_f32 v32, v32
    v_mfma_f32_16x16x32_bf16 v[44:47], a[84:87], a[20:23], v[44:47]
    buffer_load_dwordx4 v17, s[8:11], s82 offen nt lds
    v_mfma_f32_16x16x32_bf16 v[36:39], a[88:91], a[8:11], v[36:39]
    v_exp_f32 v33, v33
    v_mfma_f32_16x16x32_bf16 v[44:47], a[88:91], a[24:27], v[44:47]
    v_cvt_pk_bf16_f32 v64, v32, v33
    s_add_u32 s26, s26, 16384
    v_mfma_f32_16x16x32_bf16 v[36:39], a[92:95], a[12:15], v[36:39]
    v_exp_f32 v34, v34
    v_mfma_f32_16x16x32_bf16 v[44:47], a[92:95], a[28:31], v[44:47]
    s_add_u32 s82, s82, 16384
    v_mfma_f32_16x16x32_bf16 v[192:195], a[96:99], v[72:75], v[192:195]
    v_exp_f32 v35, v35
    v_mfma_f32_16x16x32_bf16 v[224:227], a[96:99], v[76:79], v[224:227]
    ds_read_b64_tr_b16 a[96:97], v8 offset:57344
    ds_read_b64_tr_b16 a[98:99], v8 offset:61440
    v_mfma_f32_16x16x32_bf16 v[196:199], a[100:103], v[72:75], v[196:199]
    v_exp_f32 v40, v40
    v_mfma_f32_16x16x32_bf16 v[228:231], a[100:103], v[76:79], v[228:231]
    ds_read_b64_tr_b16 a[100:101], v9 offset:57344
    ds_read_b64_tr_b16 a[102:103], v9 offset:61440
    v_mfma_f32_16x16x32_bf16 v[200:203], a[104:107], v[72:75], v[200:203]
    v_exp_f32 v41, v41
    v_mfma_f32_16x16x32_bf16 v[232:235], a[104:107], v[76:79], v[232:235]
    ds_read_b64_tr_b16 a[104:105], v10 offset:57344
    ds_read_b64_tr_b16 a[106:107], v10 offset:61440
    v_mfma_f32_16x16x32_bf16 v[204:207], a[108:111], v[72:75], v[204:207]
    v_exp_f32 v42, v42
    v_mfma_f32_16x16x32_bf16 v[236:239], a[108:111], v[76:79], v[236:239]
    ds_read_b64_tr_b16 a[108:109], v11 offset:57344
    ds_read_b64_tr_b16 a[110:111], v11 offset:61440
    v_mfma_f32_16x16x32_bf16 v[208:211], a[112:115], v[72:75], v[208:211]
    v_exp_f32 v43, v43
    v_mfma_f32_16x16x32_bf16 v[240:243], a[112:115], v[76:79], v[240:243]
    ds_read_b64_tr_b16 a[112:113], v12 offset:57344
    ds_read_b64_tr_b16 a[114:115], v12 offset:61440
    v_mfma_f32_16x16x32_bf16 v[212:215], a[116:119], v[72:75], v[212:215]
    v_exp_f32 v36, v36
    v_mfma_f32_16x16x32_bf16 v[244:247], a[116:119], v[76:79], v[244:247]
    ds_read_b64_tr_b16 a[116:117], v13 offset:57344
    ds_read_b64_tr_b16 a[118:119], v13 offset:61440
    v_mfma_f32_16x16x32_bf16 v[216:219], a[120:123], v[72:75], v[216:219]
    v_exp_f32 v37, v37
    v_mfma_f32_16x16x32_bf16 v[248:251], a[120:123], v[76:79], v[248:251]
    ds_read_b64_tr_b16 a[120:121], v14 offset:57344
    ds_read_b64_tr_b16 a[122:123], v14 offset:61440
    v_mfma_f32_16x16x32_bf16 v[220:223], a[124:127], v[72:75], v[220:223]
    v_exp_f32 v38, v38
    v_mfma_f32_16x16x32_bf16 v[252:255], a[124:127], v[76:79], v[252:255]
    ds_read_b64_tr_b16 a[124:125], v15 offset:57344
    ds_read_b64_tr_b16 a[126:127], v15 offset:61440
    v_mfma_f32_16x16x32_bf16 v[104:107], v[112:115], v[72:75], v[104:107]
    v_exp_f32 v39, v39
    v_mfma_f32_16x16x32_bf16 v[108:111], v[112:115], v[76:79], v[108:111]
    v_cvt_pk_bf16_f32 v65, v34, v35
    v_cvt_pk_bf16_f32 v68, v40, v41
    v_mfma_f32_16x16x32_bf16 v[48:51], a[64:67], a[32:35], v[88:91]
    v_exp_f32 v44, v44
    v_mfma_f32_16x16x32_bf16 v[56:59], a[64:67], a[48:51], v[92:95]
    ds_read_b128 a[64:67], v4 offset:57344
    v_cvt_pk_bf16_f32 v69, v42, v43
    v_mfma_f32_16x16x32_bf16 v[48:51], a[68:71], a[36:39], v[48:51]
    v_exp_f32 v45, v45
    v_mfma_f32_16x16x32_bf16 v[56:59], a[68:71], a[52:55], v[56:59]
    ds_read_b128 a[68:71], v5 offset:57344
    v_cvt_pk_bf16_f32 v66, v36, v37
    v_mfma_f32_16x16x32_bf16 v[48:51], a[72:75], a[40:43], v[48:51]
    v_exp_f32 v46, v46
    v_mfma_f32_16x16x32_bf16 v[56:59], a[72:75], a[56:59], v[56:59]
    ds_read_b128 a[72:75], v6 offset:57344
    v_cvt_pk_bf16_f32 v67, v38, v39
    v_mfma_f32_16x16x32_bf16 v[48:51], a[76:79], a[44:47], v[48:51]
    v_exp_f32 v47, v47
    v_mfma_f32_16x16x32_bf16 v[56:59], a[76:79], a[60:63], v[56:59]
    ds_read_b128 a[76:79], v7 offset:57344
    v_cvt_pk_bf16_f32 v70, v44, v45
    v_mfma_f32_16x16x32_bf16 v[52:55], a[80:83], a[32:35], v[88:91]
    buffer_store_dwordx4 a[164:167], v118, s[16:19], s78 offen offset:1024 sc1
    v_mfma_f32_16x16x32_bf16 v[60:63], a[80:83], a[48:51], v[92:95]
    ds_read_b128 a[80:83], v4 offset:61440
    v_cvt_pk_bf16_f32 v71, v46, v47
    v_mfma_f32_16x16x32_bf16 v[52:55], a[84:87], a[36:39], v[52:55]
    v_exp_f32 v48, v48
    v_mfma_f32_16x16x32_bf16 v[60:63], a[84:87], a[52:55], v[60:63]
    ds_read_b128 a[84:87], v5 offset:61440
    v_mfma_f32_16x16x32_bf16 v[52:55], a[88:91], a[40:43], v[52:55]
    v_exp_f32 v49, v49
    v_mfma_f32_16x16x32_bf16 v[60:63], a[88:91], a[56:59], v[60:63]
    ds_read_b128 a[88:91], v6 offset:61440
    v_mfma_f32_16x16x32_bf16 v[52:55], a[92:95], a[44:47], v[52:55]
    v_exp_f32 v50, v50
    v_mfma_f32_16x16x32_bf16 v[60:63], a[92:95], a[60:63], v[60:63]
    ds_read_b128 a[92:95], v7 offset:61440
    s_waitcnt lgkmcnt(8)
    v_mfma_f32_16x16x32_bf16 v[128:131], a[96:99], v[64:67], v[128:131]
    v_exp_f32 v51, v51
    v_mfma_f32_16x16x32_bf16 v[160:163], a[96:99], v[68:71], v[160:163]
    v_cvt_pk_bf16_f32 v72, v48, v49
    v_cvt_pk_bf16_f32 v73, v50, v51
    v_mfma_f32_16x16x32_bf16 v[132:135], a[100:103], v[64:67], v[132:135]
    v_exp_f32 v56, v56
    v_mfma_f32_16x16x32_bf16 v[164:167], a[100:103], v[68:71], v[164:167]
    v_mfma_f32_16x16x32_bf16 v[136:139], a[104:107], v[64:67], v[136:139]
    v_exp_f32 v57, v57
    v_mfma_f32_16x16x32_bf16 v[168:171], a[104:107], v[68:71], v[168:171]
    v_cvt_pk_bf16_f32 v76, v56, v57
    v_mfma_f32_16x16x32_bf16 v[140:143], a[108:111], v[64:67], v[140:143]
    v_exp_f32 v58, v58
    v_mfma_f32_16x16x32_bf16 v[172:175], a[108:111], v[68:71], v[172:175]
    v_mfma_f32_16x16x32_bf16 v[144:147], a[112:115], v[64:67], v[144:147]
    v_exp_f32 v59, v59
    v_mfma_f32_16x16x32_bf16 v[176:179], a[112:115], v[68:71], v[176:179]
    v_cvt_pk_bf16_f32 v77, v58, v59
    v_mfma_f32_16x16x32_bf16 v[148:151], a[116:119], v[64:67], v[148:151]
    v_exp_f32 v52, v52
    v_mfma_f32_16x16x32_bf16 v[180:183], a[116:119], v[68:71], v[180:183]
    v_mfma_f32_16x16x32_bf16 v[152:155], a[120:123], v[64:67], v[152:155]
    v_exp_f32 v53, v53
    v_mfma_f32_16x16x32_bf16 v[184:187], a[120:123], v[68:71], v[184:187]
    v_mfma_f32_16x16x32_bf16 v[156:159], a[124:127], v[64:67], v[156:159]
    v_exp_f32 v54, v54
    v_mfma_f32_16x16x32_bf16 v[188:191], a[124:127], v[68:71], v[188:191]
    v_mfma_f32_16x16x32_bf16 v[96:99], v[112:115], v[64:67], v[96:99]
    v_exp_f32 v55, v55
    v_mfma_f32_16x16x32_bf16 v[100:103], v[112:115], v[68:71], v[100:103]
    s_waitcnt vmcnt(22) lgkmcnt(0)
    s_barrier
    v_mfma_f32_16x16x32_bf16 v[32:35], a[64:67], a[0:3], v[80:83]
    v_exp_f32 v60, v60
    v_mfma_f32_16x16x32_bf16 v[40:43], a[64:67], a[16:19], v[84:87]
    v_cvt_pk_bf16_f32 v74, v52, v53
    s_add_u32 m0, s80, 114688
    v_mfma_f32_16x16x32_bf16 v[32:35], a[68:71], a[4:7], v[32:35]
    v_exp_f32 v61, v61
    v_mfma_f32_16x16x32_bf16 v[40:43], a[68:71], a[20:23], v[40:43]
    v_cvt_pk_bf16_f32 v75, v54, v55
    v_cvt_pk_bf16_f32 v78, v60, v61
    v_mfma_f32_16x16x32_bf16 v[32:35], a[72:75], a[8:11], v[32:35]
    v_exp_f32 v62, v62
    v_mfma_f32_16x16x32_bf16 v[40:43], a[72:75], a[24:27], v[40:43]
    buffer_load_dwordx4 v20, s[12:15], s25 offen nt lds
    v_mfma_f32_16x16x32_bf16 v[32:35], a[76:79], a[12:15], v[32:35]
    v_exp_f32 v63, v63
    v_mfma_f32_16x16x32_bf16 v[40:43], a[76:79], a[28:31], v[40:43]
    v_cvt_pk_bf16_f32 v79, v62, v63
    v_mfma_f32_16x16x32_bf16 v[36:39], a[80:83], a[0:3], v[80:83]
    v_mfma_f32_16x16x32_bf16 v[44:47], a[80:83], a[16:19], v[84:87]
    s_add_u32 m0, s80, 118784
    v_mfma_f32_16x16x32_bf16 v[36:39], a[84:87], a[4:7], v[36:39]
    v_exp_f32 v32, v32
    v_mfma_f32_16x16x32_bf16 v[44:47], a[84:87], a[20:23], v[44:47]
    buffer_load_dwordx4 v21, s[12:15], s25 offen nt lds
    v_mfma_f32_16x16x32_bf16 v[36:39], a[88:91], a[8:11], v[36:39]
    v_exp_f32 v33, v33
    v_mfma_f32_16x16x32_bf16 v[44:47], a[88:91], a[24:27], v[44:47]
    v_cvt_pk_bf16_f32 v64, v32, v33
    v_mfma_f32_16x16x32_bf16 v[36:39], a[92:95], a[12:15], v[36:39]
    v_exp_f32 v34, v34
    v_mfma_f32_16x16x32_bf16 v[44:47], a[92:95], a[28:31], v[44:47]
    s_add_u32 m0, s80, 122880
    v_mfma_f32_16x16x32_bf16 v[192:195], a[96:99], v[72:75], v[192:195]
    v_exp_f32 v35, v35
    buffer_store_dwordx4 a[168:171], v118, s[16:19], s78 offen offset:2048 sc1
    v_mfma_f32_16x16x32_bf16 v[224:227], a[96:99], v[76:79], v[224:227]
    ds_read_b64_tr_b16 a[96:97], v8 offset:0
    ds_read_b64_tr_b16 a[98:99], v8 offset:4096
    v_mfma_f32_16x16x32_bf16 v[196:199], a[100:103], v[72:75], v[196:199]
    v_exp_f32 v40, v40
    v_mfma_f32_16x16x32_bf16 v[228:231], a[100:103], v[76:79], v[228:231]
    ds_read_b64_tr_b16 a[100:101], v9 offset:0
    ds_read_b64_tr_b16 a[102:103], v9 offset:4096
    v_mfma_f32_16x16x32_bf16 v[200:203], a[104:107], v[72:75], v[200:203]
    v_exp_f32 v41, v41
    v_mfma_f32_16x16x32_bf16 v[232:235], a[104:107], v[76:79], v[232:235]
    ds_read_b64_tr_b16 a[104:105], v10 offset:0
    ds_read_b64_tr_b16 a[106:107], v10 offset:4096
    v_mfma_f32_16x16x32_bf16 v[204:207], a[108:111], v[72:75], v[204:207]
    v_exp_f32 v42, v42
    v_mfma_f32_16x16x32_bf16 v[236:239], a[108:111], v[76:79], v[236:239]
    ds_read_b64_tr_b16 a[108:109], v11 offset:0
    ds_read_b64_tr_b16 a[110:111], v11 offset:4096
    v_mfma_f32_16x16x32_bf16 v[208:211], a[112:115], v[72:75], v[208:211]
    v_exp_f32 v43, v43
    v_mfma_f32_16x16x32_bf16 v[240:243], a[112:115], v[76:79], v[240:243]
    ds_read_b64_tr_b16 a[112:113], v12 offset:0
    ds_read_b64_tr_b16 a[114:115], v12 offset:4096
    v_mfma_f32_16x16x32_bf16 v[212:215], a[116:119], v[72:75], v[212:215]
    v_exp_f32 v36, v36
    v_mfma_f32_16x16x32_bf16 v[244:247], a[116:119], v[76:79], v[244:247]
    ds_read_b64_tr_b16 a[116:117], v13 offset:0
    ds_read_b64_tr_b16 a[118:119], v13 offset:4096
    v_mfma_f32_16x16x32_bf16 v[216:219], a[120:123], v[72:75], v[216:219]
    v_exp_f32 v37, v37
    v_mfma_f32_16x16x32_bf16 v[248:251], a[120:123], v[76:79], v[248:251]
    ds_read_b64_tr_b16 a[120:121], v14 offset:0
    ds_read_b64_tr_b16 a[122:123], v14 offset:4096
    v_mfma_f32_16x16x32_bf16 v[220:223], a[124:127], v[72:75], v[220:223]
    v_exp_f32 v38, v38
    v_mfma_f32_16x16x32_bf16 v[252:255], a[124:127], v[76:79], v[252:255]
    ds_read_b64_tr_b16 a[124:125], v15 offset:0
    ds_read_b64_tr_b16 a[126:127], v15 offset:4096
    v_mfma_f32_16x16x32_bf16 v[104:107], v[112:115], v[72:75], v[104:107]
    v_exp_f32 v39, v39
    v_mfma_f32_16x16x32_bf16 v[108:111], v[112:115], v[76:79], v[108:111]
    v_cvt_pk_bf16_f32 v65, v34, v35
    v_cvt_pk_bf16_f32 v68, v40, v41
    v_mfma_f32_16x16x32_bf16 v[48:51], a[64:67], a[32:35], v[88:91]
    v_exp_f32 v44, v44
    v_mfma_f32_16x16x32_bf16 v[56:59], a[64:67], a[48:51], v[92:95]
    ds_read_b128 a[64:67], v4 offset:0
    v_cvt_pk_bf16_f32 v69, v42, v43
    v_mfma_f32_16x16x32_bf16 v[48:51], a[68:71], a[36:39], v[48:51]
    v_exp_f32 v45, v45
    v_mfma_f32_16x16x32_bf16 v[56:59], a[68:71], a[52:55], v[56:59]
    ds_read_b128 a[68:71], v5 offset:0
    v_cvt_pk_bf16_f32 v66, v36, v37
    v_mfma_f32_16x16x32_bf16 v[48:51], a[72:75], a[40:43], v[48:51]
    v_exp_f32 v46, v46
    v_mfma_f32_16x16x32_bf16 v[56:59], a[72:75], a[56:59], v[56:59]
    ds_read_b128 a[72:75], v6 offset:0
    v_cvt_pk_bf16_f32 v67, v38, v39
    v_mfma_f32_16x16x32_bf16 v[48:51], a[76:79], a[44:47], v[48:51]
    v_exp_f32 v47, v47
    v_mfma_f32_16x16x32_bf16 v[56:59], a[76:79], a[60:63], v[56:59]
    ds_read_b128 a[76:79], v7 offset:0
    v_cvt_pk_bf16_f32 v70, v44, v45
    v_mfma_f32_16x16x32_bf16 v[52:55], a[80:83], a[32:35], v[88:91]
    buffer_load_dwordx4 v20, s[12:15], s81 offen nt lds
    v_mfma_f32_16x16x32_bf16 v[60:63], a[80:83], a[48:51], v[92:95]
    ds_read_b128 a[80:83], v4 offset:4096
    v_cvt_pk_bf16_f32 v71, v46, v47
    v_mfma_f32_16x16x32_bf16 v[52:55], a[84:87], a[36:39], v[52:55]
    v_exp_f32 v48, v48
    v_mfma_f32_16x16x32_bf16 v[60:63], a[84:87], a[52:55], v[60:63]
    ds_read_b128 a[84:87], v5 offset:4096
    s_add_u32 m0, s80, 126976
    v_mfma_f32_16x16x32_bf16 v[52:55], a[88:91], a[40:43], v[52:55]
    v_exp_f32 v49, v49
    v_mfma_f32_16x16x32_bf16 v[60:63], a[88:91], a[56:59], v[60:63]
    ds_read_b128 a[88:91], v6 offset:4096
    buffer_load_dwordx4 v21, s[12:15], s81 offen nt lds
    v_mfma_f32_16x16x32_bf16 v[52:55], a[92:95], a[44:47], v[52:55]
    v_exp_f32 v50, v50
    v_mfma_f32_16x16x32_bf16 v[60:63], a[92:95], a[60:63], v[60:63]
    ds_read_b128 a[92:95], v7 offset:4096
    s_waitcnt lgkmcnt(8)
    v_mfma_f32_16x16x32_bf16 v[128:131], a[96:99], v[64:67], v[128:131]
    v_exp_f32 v51, v51
    v_mfma_f32_16x16x32_bf16 v[160:163], a[96:99], v[68:71], v[160:163]
    v_cvt_pk_bf16_f32 v72, v48, v49
    v_cvt_pk_bf16_f32 v73, v50, v51
    v_mfma_f32_16x16x32_bf16 v[132:135], a[100:103], v[64:67], v[132:135]
    v_exp_f32 v56, v56
    v_mfma_f32_16x16x32_bf16 v[164:167], a[100:103], v[68:71], v[164:167]
    s_add_u32 s25, s25, 16384
    s_add_u32 s81, s81, 16384
    v_mfma_f32_16x16x32_bf16 v[136:139], a[104:107], v[64:67], v[136:139]
    v_exp_f32 v57, v57
    v_mfma_f32_16x16x32_bf16 v[168:171], a[104:107], v[68:71], v[168:171]
    v_cvt_pk_bf16_f32 v76, v56, v57
    s_add_u32 m0, s80, 49152
    v_mfma_f32_16x16x32_bf16 v[140:143], a[108:111], v[64:67], v[140:143]
    v_exp_f32 v58, v58
    v_mfma_f32_16x16x32_bf16 v[172:175], a[108:111], v[68:71], v[172:175]
    buffer_load_dwordx4 v16, s[8:11], s26 offen nt lds
    v_mfma_f32_16x16x32_bf16 v[144:147], a[112:115], v[64:67], v[144:147]
    v_exp_f32 v59, v59
    v_mfma_f32_16x16x32_bf16 v[176:179], a[112:115], v[68:71], v[176:179]
    v_cvt_pk_bf16_f32 v77, v58, v59
    v_mfma_f32_16x16x32_bf16 v[148:151], a[116:119], v[64:67], v[148:151]
    v_exp_f32 v52, v52
    v_mfma_f32_16x16x32_bf16 v[180:183], a[116:119], v[68:71], v[180:183]
    s_add_u32 m0, s80, 53248
    v_mfma_f32_16x16x32_bf16 v[152:155], a[120:123], v[64:67], v[152:155]
    v_exp_f32 v53, v53
    v_mfma_f32_16x16x32_bf16 v[184:187], a[120:123], v[68:71], v[184:187]
    buffer_load_dwordx4 v17, s[8:11], s26 offen nt lds
    v_mfma_f32_16x16x32_bf16 v[156:159], a[124:127], v[64:67], v[156:159]
    v_exp_f32 v54, v54
    v_mfma_f32_16x16x32_bf16 v[188:191], a[124:127], v[68:71], v[188:191]
    v_mfma_f32_16x16x32_bf16 v[96:99], v[112:115], v[64:67], v[96:99]
    v_exp_f32 v55, v55
    v_mfma_f32_16x16x32_bf16 v[100:103], v[112:115], v[68:71], v[100:103]
    s_waitcnt lgkmcnt(0)
    v_mfma_f32_16x16x32_bf16 v[32:35], a[64:67], a[0:3], v[80:83]
    v_exp_f32 v60, v60
    v_mfma_f32_16x16x32_bf16 v[40:43], a[64:67], a[16:19], v[84:87]
    v_cvt_pk_bf16_f32 v74, v52, v53
    s_add_u32 m0, s80, 57344
    v_mfma_f32_16x16x32_bf16 v[32:35], a[68:71], a[4:7], v[32:35]
    v_exp_f32 v61, v61
    v_mfma_f32_16x16x32_bf16 v[40:43], a[68:71], a[20:23], v[40:43]
    v_cvt_pk_bf16_f32 v75, v54, v55
    v_cvt_pk_bf16_f32 v78, v60, v61
    v_mfma_f32_16x16x32_bf16 v[32:35], a[72:75], a[8:11], v[32:35]
    v_exp_f32 v62, v62
    v_mfma_f32_16x16x32_bf16 v[40:43], a[72:75], a[24:27], v[40:43]
    buffer_load_dwordx4 v16, s[8:11], s82 offen nt lds
    v_mfma_f32_16x16x32_bf16 v[32:35], a[76:79], a[12:15], v[32:35]
    v_exp_f32 v63, v63
    v_mfma_f32_16x16x32_bf16 v[40:43], a[76:79], a[28:31], v[40:43]
    v_cvt_pk_bf16_f32 v79, v62, v63
    v_mfma_f32_16x16x32_bf16 v[36:39], a[80:83], a[0:3], v[80:83]
    v_mfma_f32_16x16x32_bf16 v[44:47], a[80:83], a[16:19], v[84:87]
    s_add_u32 m0, s80, 61440
    v_mfma_f32_16x16x32_bf16 v[36:39], a[84:87], a[4:7], v[36:39]
    v_exp_f32 v32, v32
    v_mfma_f32_16x16x32_bf16 v[44:47], a[84:87], a[20:23], v[44:47]
    buffer_load_dwordx4 v17, s[8:11], s82 offen nt lds
    v_mfma_f32_16x16x32_bf16 v[36:39], a[88:91], a[8:11], v[36:39]
    v_exp_f32 v33, v33
    v_mfma_f32_16x16x32_bf16 v[44:47], a[88:91], a[24:27], v[44:47]
    v_cvt_pk_bf16_f32 v64, v32, v33
    s_add_u32 s26, s26, 16384
    v_mfma_f32_16x16x32_bf16 v[36:39], a[92:95], a[12:15], v[36:39]
    v_exp_f32 v34, v34
    v_mfma_f32_16x16x32_bf16 v[44:47], a[92:95], a[28:31], v[44:47]
    s_add_u32 s82, s82, 16384
    v_mfma_f32_16x16x32_bf16 v[192:195], a[96:99], v[72:75], v[192:195]
    v_exp_f32 v35, v35
    v_mfma_f32_16x16x32_bf16 v[224:227], a[96:99], v[76:79], v[224:227]
    ds_read_b64_tr_b16 a[96:97], v8 offset:8192
    ds_read_b64_tr_b16 a[98:99], v8 offset:12288
    v_mfma_f32_16x16x32_bf16 v[196:199], a[100:103], v[72:75], v[196:199]
    v_exp_f32 v40, v40
    v_mfma_f32_16x16x32_bf16 v[228:231], a[100:103], v[76:79], v[228:231]
    ds_read_b64_tr_b16 a[100:101], v9 offset:8192
    ds_read_b64_tr_b16 a[102:103], v9 offset:12288
    v_mfma_f32_16x16x32_bf16 v[200:203], a[104:107], v[72:75], v[200:203]
    v_exp_f32 v41, v41
    v_mfma_f32_16x16x32_bf16 v[232:235], a[104:107], v[76:79], v[232:235]
    ds_read_b64_tr_b16 a[104:105], v10 offset:8192
    ds_read_b64_tr_b16 a[106:107], v10 offset:12288
    v_mfma_f32_16x16x32_bf16 v[204:207], a[108:111], v[72:75], v[204:207]
    v_exp_f32 v42, v42
    v_mfma_f32_16x16x32_bf16 v[236:239], a[108:111], v[76:79], v[236:239]
    ds_read_b64_tr_b16 a[108:109], v11 offset:8192
    ds_read_b64_tr_b16 a[110:111], v11 offset:12288
    v_mfma_f32_16x16x32_bf16 v[208:211], a[112:115], v[72:75], v[208:211]
    v_exp_f32 v43, v43
    v_mfma_f32_16x16x32_bf16 v[240:243], a[112:115], v[76:79], v[240:243]
    ds_read_b64_tr_b16 a[112:113], v12 offset:8192
    ds_read_b64_tr_b16 a[114:115], v12 offset:12288
    v_mfma_f32_16x16x32_bf16 v[212:215], a[116:119], v[72:75], v[212:215]
    v_exp_f32 v36, v36
    v_mfma_f32_16x16x32_bf16 v[244:247], a[116:119], v[76:79], v[244:247]
    ds_read_b64_tr_b16 a[116:117], v13 offset:8192
    ds_read_b64_tr_b16 a[118:119], v13 offset:12288
    v_mfma_f32_16x16x32_bf16 v[216:219], a[120:123], v[72:75], v[216:219]
    v_exp_f32 v37, v37
    v_mfma_f32_16x16x32_bf16 v[248:251], a[120:123], v[76:79], v[248:251]
    ds_read_b64_tr_b16 a[120:121], v14 offset:8192
    ds_read_b64_tr_b16 a[122:123], v14 offset:12288
    v_mfma_f32_16x16x32_bf16 v[220:223], a[124:127], v[72:75], v[220:223]
    v_exp_f32 v38, v38
    v_mfma_f32_16x16x32_bf16 v[252:255], a[124:127], v[76:79], v[252:255]
    ds_read_b64_tr_b16 a[124:125], v15 offset:8192
    ds_read_b64_tr_b16 a[126:127], v15 offset:12288
    v_mfma_f32_16x16x32_bf16 v[104:107], v[112:115], v[72:75], v[104:107]
    v_exp_f32 v39, v39
    v_mfma_f32_16x16x32_bf16 v[108:111], v[112:115], v[76:79], v[108:111]
    v_cvt_pk_bf16_f32 v65, v34, v35
    v_cvt_pk_bf16_f32 v68, v40, v41
    v_mfma_f32_16x16x32_bf16 v[48:51], a[64:67], a[32:35], v[88:91]
    v_exp_f32 v44, v44
    v_mfma_f32_16x16x32_bf16 v[56:59], a[64:67], a[48:51], v[92:95]
    ds_read_b128 a[64:67], v4 offset:8192
    v_cvt_pk_bf16_f32 v69, v42, v43
    v_mfma_f32_16x16x32_bf16 v[48:51], a[68:71], a[36:39], v[48:51]
    v_exp_f32 v45, v45
    v_mfma_f32_16x16x32_bf16 v[56:59], a[68:71], a[52:55], v[56:59]
    ds_read_b128 a[68:71], v5 offset:8192
    v_cvt_pk_bf16_f32 v66, v36, v37
    v_mfma_f32_16x16x32_bf16 v[48:51], a[72:75], a[40:43], v[48:51]
    v_exp_f32 v46, v46
    v_mfma_f32_16x16x32_bf16 v[56:59], a[72:75], a[56:59], v[56:59]
    ds_read_b128 a[72:75], v6 offset:8192
    v_cvt_pk_bf16_f32 v67, v38, v39
    v_mfma_f32_16x16x32_bf16 v[48:51], a[76:79], a[44:47], v[48:51]
    v_exp_f32 v47, v47
    v_mfma_f32_16x16x32_bf16 v[56:59], a[76:79], a[60:63], v[56:59]
    ds_read_b128 a[76:79], v7 offset:8192
    v_cvt_pk_bf16_f32 v70, v44, v45
    v_mfma_f32_16x16x32_bf16 v[52:55], a[80:83], a[32:35], v[88:91]
    buffer_store_dwordx4 a[172:175], v118, s[16:19], s78 offen offset:3072 sc1
    v_mfma_f32_16x16x32_bf16 v[60:63], a[80:83], a[48:51], v[92:95]
    ds_read_b128 a[80:83], v4 offset:12288
    v_cvt_pk_bf16_f32 v71, v46, v47
    v_mfma_f32_16x16x32_bf16 v[52:55], a[84:87], a[36:39], v[52:55]
    v_exp_f32 v48, v48
    v_mfma_f32_16x16x32_bf16 v[60:63], a[84:87], a[52:55], v[60:63]
    ds_read_b128 a[84:87], v5 offset:12288
    v_mfma_f32_16x16x32_bf16 v[52:55], a[88:91], a[40:43], v[52:55]
    v_exp_f32 v49, v49
    v_mfma_f32_16x16x32_bf16 v[60:63], a[88:91], a[56:59], v[60:63]
    ds_read_b128 a[88:91], v6 offset:12288
    v_mfma_f32_16x16x32_bf16 v[52:55], a[92:95], a[44:47], v[52:55]
    v_exp_f32 v50, v50
    v_mfma_f32_16x16x32_bf16 v[60:63], a[92:95], a[60:63], v[60:63]
    ds_read_b128 a[92:95], v7 offset:12288
    s_waitcnt lgkmcnt(8)
    v_mfma_f32_16x16x32_bf16 v[128:131], a[96:99], v[64:67], v[128:131]
    v_exp_f32 v51, v51
    v_mfma_f32_16x16x32_bf16 v[160:163], a[96:99], v[68:71], v[160:163]
    v_cvt_pk_bf16_f32 v72, v48, v49
    v_cvt_pk_bf16_f32 v73, v50, v51
    v_mfma_f32_16x16x32_bf16 v[132:135], a[100:103], v[64:67], v[132:135]
    v_exp_f32 v56, v56
    v_mfma_f32_16x16x32_bf16 v[164:167], a[100:103], v[68:71], v[164:167]
    v_mfma_f32_16x16x32_bf16 v[136:139], a[104:107], v[64:67], v[136:139]
    v_exp_f32 v57, v57
    v_mfma_f32_16x16x32_bf16 v[168:171], a[104:107], v[68:71], v[168:171]
    v_cvt_pk_bf16_f32 v76, v56, v57
    v_mfma_f32_16x16x32_bf16 v[140:143], a[108:111], v[64:67], v[140:143]
    v_exp_f32 v58, v58
    v_mfma_f32_16x16x32_bf16 v[172:175], a[108:111], v[68:71], v[172:175]
    v_mfma_f32_16x16x32_bf16 v[144:147], a[112:115], v[64:67], v[144:147]
    v_exp_f32 v59, v59
    v_mfma_f32_16x16x32_bf16 v[176:179], a[112:115], v[68:71], v[176:179]
    v_cvt_pk_bf16_f32 v77, v58, v59
    v_mfma_f32_16x16x32_bf16 v[148:151], a[116:119], v[64:67], v[148:151]
    v_exp_f32 v52, v52
    v_mfma_f32_16x16x32_bf16 v[180:183], a[116:119], v[68:71], v[180:183]
    v_mfma_f32_16x16x32_bf16 v[152:155], a[120:123], v[64:67], v[152:155]
    v_exp_f32 v53, v53
    v_mfma_f32_16x16x32_bf16 v[184:187], a[120:123], v[68:71], v[184:187]
    v_mfma_f32_16x16x32_bf16 v[156:159], a[124:127], v[64:67], v[156:159]
    v_exp_f32 v54, v54
    v_mfma_f32_16x16x32_bf16 v[188:191], a[124:127], v[68:71], v[188:191]
    v_mfma_f32_16x16x32_bf16 v[96:99], v[112:115], v[64:67], v[96:99]
    v_exp_f32 v55, v55
    v_mfma_f32_16x16x32_bf16 v[100:103], v[112:115], v[68:71], v[100:103]
    s_waitcnt vmcnt(21) lgkmcnt(0)
    s_barrier
    v_mfma_f32_16x16x32_bf16 v[32:35], a[64:67], a[0:3], v[80:83]
    v_exp_f32 v60, v60
    v_mfma_f32_16x16x32_bf16 v[40:43], a[64:67], a[16:19], v[84:87]
    v_cvt_pk_bf16_f32 v74, v52, v53
    s_add_u32 m0, s80, 65536
    v_mfma_f32_16x16x32_bf16 v[32:35], a[68:71], a[4:7], v[32:35]
    v_exp_f32 v61, v61
    v_mfma_f32_16x16x32_bf16 v[40:43], a[68:71], a[20:23], v[40:43]
    v_cvt_pk_bf16_f32 v75, v54, v55
    v_cvt_pk_bf16_f32 v78, v60, v61
    v_mfma_f32_16x16x32_bf16 v[32:35], a[72:75], a[8:11], v[32:35]
    v_exp_f32 v62, v62
    v_mfma_f32_16x16x32_bf16 v[40:43], a[72:75], a[24:27], v[40:43]
    buffer_load_dwordx4 v20, s[12:15], s25 offen nt lds
    v_mfma_f32_16x16x32_bf16 v[32:35], a[76:79], a[12:15], v[32:35]
    v_exp_f32 v63, v63
    v_mfma_f32_16x16x32_bf16 v[40:43], a[76:79], a[28:31], v[40:43]
    v_cvt_pk_bf16_f32 v79, v62, v63
    v_mfma_f32_16x16x32_bf16 v[36:39], a[80:83], a[0:3], v[80:83]
    v_mfma_f32_16x16x32_bf16 v[44:47], a[80:83], a[16:19], v[84:87]
    s_add_u32 m0, s80, 69632
    v_mfma_f32_16x16x32_bf16 v[36:39], a[84:87], a[4:7], v[36:39]
    v_exp_f32 v32, v32
    v_mfma_f32_16x16x32_bf16 v[44:47], a[84:87], a[20:23], v[44:47]
    buffer_load_dwordx4 v21, s[12:15], s25 offen nt lds
    v_mfma_f32_16x16x32_bf16 v[36:39], a[88:91], a[8:11], v[36:39]
    v_exp_f32 v33, v33
    v_mfma_f32_16x16x32_bf16 v[44:47], a[88:91], a[24:27], v[44:47]
    v_cvt_pk_bf16_f32 v64, v32, v33
    v_mfma_f32_16x16x32_bf16 v[36:39], a[92:95], a[12:15], v[36:39]
    v_exp_f32 v34, v34
    v_mfma_f32_16x16x32_bf16 v[44:47], a[92:95], a[28:31], v[44:47]
    s_add_u32 m0, s80, 73728
    v_mfma_f32_16x16x32_bf16 v[192:195], a[96:99], v[72:75], v[192:195]
    v_exp_f32 v35, v35
    buffer_store_dwordx4 a[176:179], v119, s[16:19], s78 offen offset:0 sc1
    v_mfma_f32_16x16x32_bf16 v[224:227], a[96:99], v[76:79], v[224:227]
    ds_read_b64_tr_b16 a[96:97], v8 offset:16384
    ds_read_b64_tr_b16 a[98:99], v8 offset:20480
    v_mfma_f32_16x16x32_bf16 v[196:199], a[100:103], v[72:75], v[196:199]
    v_exp_f32 v40, v40
    v_mfma_f32_16x16x32_bf16 v[228:231], a[100:103], v[76:79], v[228:231]
    ds_read_b64_tr_b16 a[100:101], v9 offset:16384
    ds_read_b64_tr_b16 a[102:103], v9 offset:20480
    v_mfma_f32_16x16x32_bf16 v[200:203], a[104:107], v[72:75], v[200:203]
    v_exp_f32 v41, v41
    v_mfma_f32_16x16x32_bf16 v[232:235], a[104:107], v[76:79], v[232:235]
    ds_read_b64_tr_b16 a[104:105], v10 offset:16384
    ds_read_b64_tr_b16 a[106:107], v10 offset:20480
    v_mfma_f32_16x16x32_bf16 v[204:207], a[108:111], v[72:75], v[204:207]
    v_exp_f32 v42, v42
    v_mfma_f32_16x16x32_bf16 v[236:239], a[108:111], v[76:79], v[236:239]
    ds_read_b64_tr_b16 a[108:109], v11 offset:16384
    ds_read_b64_tr_b16 a[110:111], v11 offset:20480
    v_mfma_f32_16x16x32_bf16 v[208:211], a[112:115], v[72:75], v[208:211]
    v_exp_f32 v43, v43
    v_mfma_f32_16x16x32_bf16 v[240:243], a[112:115], v[76:79], v[240:243]
    ds_read_b64_tr_b16 a[112:113], v12 offset:16384
    ds_read_b64_tr_b16 a[114:115], v12 offset:20480
    v_mfma_f32_16x16x32_bf16 v[212:215], a[116:119], v[72:75], v[212:215]
    v_exp_f32 v36, v36
    v_mfma_f32_16x16x32_bf16 v[244:247], a[116:119], v[76:79], v[244:247]
    ds_read_b64_tr_b16 a[116:117], v13 offset:16384
    ds_read_b64_tr_b16 a[118:119], v13 offset:20480
    v_mfma_f32_16x16x32_bf16 v[216:219], a[120:123], v[72:75], v[216:219]
    v_exp_f32 v37, v37
    v_mfma_f32_16x16x32_bf16 v[248:251], a[120:123], v[76:79], v[248:251]
    ds_read_b64_tr_b16 a[120:121], v14 offset:16384
    ds_read_b64_tr_b16 a[122:123], v14 offset:20480
    v_mfma_f32_16x16x32_bf16 v[220:223], a[124:127], v[72:75], v[220:223]
    v_exp_f32 v38, v38
    v_mfma_f32_16x16x32_bf16 v[252:255], a[124:127], v[76:79], v[252:255]
    ds_read_b64_tr_b16 a[124:125], v15 offset:16384
    ds_read_b64_tr_b16 a[126:127], v15 offset:20480
    v_mfma_f32_16x16x32_bf16 v[104:107], v[112:115], v[72:75], v[104:107]
    v_exp_f32 v39, v39
    v_mfma_f32_16x16x32_bf16 v[108:111], v[112:115], v[76:79], v[108:111]
    v_cvt_pk_bf16_f32 v65, v34, v35
    v_cvt_pk_bf16_f32 v68, v40, v41
    v_mfma_f32_16x16x32_bf16 v[48:51], a[64:67], a[32:35], v[88:91]
    v_exp_f32 v44, v44
    v_mfma_f32_16x16x32_bf16 v[56:59], a[64:67], a[48:51], v[92:95]
    ds_read_b128 a[64:67], v4 offset:16384
    v_cvt_pk_bf16_f32 v69, v42, v43
    v_mfma_f32_16x16x32_bf16 v[48:51], a[68:71], a[36:39], v[48:51]
    v_exp_f32 v45, v45
    v_mfma_f32_16x16x32_bf16 v[56:59], a[68:71], a[52:55], v[56:59]
    ds_read_b128 a[68:71], v5 offset:16384
    v_cvt_pk_bf16_f32 v66, v36, v37
    v_mfma_f32_16x16x32_bf16 v[48:51], a[72:75], a[40:43], v[48:51]
    v_exp_f32 v46, v46
    v_mfma_f32_16x16x32_bf16 v[56:59], a[72:75], a[56:59], v[56:59]
    ds_read_b128 a[72:75], v6 offset:16384
    v_cvt_pk_bf16_f32 v67, v38, v39
    v_mfma_f32_16x16x32_bf16 v[48:51], a[76:79], a[44:47], v[48:51]
    v_exp_f32 v47, v47
    v_mfma_f32_16x16x32_bf16 v[56:59], a[76:79], a[60:63], v[56:59]
    ds_read_b128 a[76:79], v7 offset:16384
    v_cvt_pk_bf16_f32 v70, v44, v45
    v_mfma_f32_16x16x32_bf16 v[52:55], a[80:83], a[32:35], v[88:91]
    buffer_load_dwordx4 v20, s[12:15], s81 offen nt lds
    v_mfma_f32_16x16x32_bf16 v[60:63], a[80:83], a[48:51], v[92:95]
    ds_read_b128 a[80:83], v4 offset:20480
    v_cvt_pk_bf16_f32 v71, v46, v47
    v_mfma_f32_16x16x32_bf16 v[52:55], a[84:87], a[36:39], v[52:55]
    v_exp_f32 v48, v48
    v_mfma_f32_16x16x32_bf16 v[60:63], a[84:87], a[52:55], v[60:63]
    ds_read_b128 a[84:87], v5 offset:20480
    s_add_u32 m0, s80, 77824
    v_mfma_f32_16x16x32_bf16 v[52:55], a[88:91], a[40:43], v[52:55]
    v_exp_f32 v49, v49
    v_mfma_f32_16x16x32_bf16 v[60:63], a[88:91], a[56:59], v[60:63]
    ds_read_b128 a[88:91], v6 offset:20480
    buffer_load_dwordx4 v21, s[12:15], s81 offen nt lds
    v_mfma_f32_16x16x32_bf16 v[52:55], a[92:95], a[44:47], v[52:55]
    v_exp_f32 v50, v50
    v_mfma_f32_16x16x32_bf16 v[60:63], a[92:95], a[60:63], v[60:63]
    ds_read_b128 a[92:95], v7 offset:20480
    s_waitcnt lgkmcnt(8)
    v_mfma_f32_16x16x32_bf16 v[128:131], a[96:99], v[64:67], v[128:131]
    v_exp_f32 v51, v51
    v_mfma_f32_16x16x32_bf16 v[160:163], a[96:99], v[68:71], v[160:163]
    v_cvt_pk_bf16_f32 v72, v48, v49
    v_cvt_pk_bf16_f32 v73, v50, v51
    v_mfma_f32_16x16x32_bf16 v[132:135], a[100:103], v[64:67], v[132:135]
    v_exp_f32 v56, v56
    v_mfma_f32_16x16x32_bf16 v[164:167], a[100:103], v[68:71], v[164:167]
    s_add_u32 s25, s25, 16384
    s_add_u32 s81, s81, 16384
    v_mfma_f32_16x16x32_bf16 v[136:139], a[104:107], v[64:67], v[136:139]
    v_exp_f32 v57, v57
    v_mfma_f32_16x16x32_bf16 v[168:171], a[104:107], v[68:71], v[168:171]
    v_cvt_pk_bf16_f32 v76, v56, v57
    s_add_u32 m0, s80, 0
    v_mfma_f32_16x16x32_bf16 v[140:143], a[108:111], v[64:67], v[140:143]
    v_exp_f32 v58, v58
    v_mfma_f32_16x16x32_bf16 v[172:175], a[108:111], v[68:71], v[172:175]
    buffer_load_dwordx4 v16, s[8:11], s26 offen nt lds
    v_mfma_f32_16x16x32_bf16 v[144:147], a[112:115], v[64:67], v[144:147]
    v_exp_f32 v59, v59
    v_mfma_f32_16x16x32_bf16 v[176:179], a[112:115], v[68:71], v[176:179]
    v_cvt_pk_bf16_f32 v77, v58, v59
    v_mfma_f32_16x16x32_bf16 v[148:151], a[116:119], v[64:67], v[148:151]
    v_exp_f32 v52, v52
    v_mfma_f32_16x16x32_bf16 v[180:183], a[116:119], v[68:71], v[180:183]
    s_add_u32 m0, s80, 4096
    v_mfma_f32_16x16x32_bf16 v[152:155], a[120:123], v[64:67], v[152:155]
    v_exp_f32 v53, v53
    v_mfma_f32_16x16x32_bf16 v[184:187], a[120:123], v[68:71], v[184:187]
    buffer_load_dwordx4 v17, s[8:11], s26 offen nt lds
    v_mfma_f32_16x16x32_bf16 v[156:159], a[124:127], v[64:67], v[156:159]
    v_exp_f32 v54, v54
    v_mfma_f32_16x16x32_bf16 v[188:191], a[124:127], v[68:71], v[188:191]
    v_mfma_f32_16x16x32_bf16 v[96:99], v[112:115], v[64:67], v[96:99]
    v_exp_f32 v55, v55
    v_mfma_f32_16x16x32_bf16 v[100:103], v[112:115], v[68:71], v[100:103]
    s_waitcnt lgkmcnt(0)
    v_mfma_f32_16x16x32_bf16 v[32:35], a[64:67], a[0:3], v[80:83]
    v_exp_f32 v60, v60
    v_mfma_f32_16x16x32_bf16 v[40:43], a[64:67], a[16:19], v[84:87]
    v_cvt_pk_bf16_f32 v74, v52, v53
    s_add_u32 m0, s80, 8192
    v_mfma_f32_16x16x32_bf16 v[32:35], a[68:71], a[4:7], v[32:35]
    v_exp_f32 v61, v61
    v_mfma_f32_16x16x32_bf16 v[40:43], a[68:71], a[20:23], v[40:43]
    v_cvt_pk_bf16_f32 v75, v54, v55
    v_cvt_pk_bf16_f32 v78, v60, v61
    v_mfma_f32_16x16x32_bf16 v[32:35], a[72:75], a[8:11], v[32:35]
    v_exp_f32 v62, v62
    v_mfma_f32_16x16x32_bf16 v[40:43], a[72:75], a[24:27], v[40:43]
    buffer_load_dwordx4 v16, s[8:11], s82 offen nt lds
    v_mfma_f32_16x16x32_bf16 v[32:35], a[76:79], a[12:15], v[32:35]
    v_exp_f32 v63, v63
    v_mfma_f32_16x16x32_bf16 v[40:43], a[76:79], a[28:31], v[40:43]
    v_cvt_pk_bf16_f32 v79, v62, v63
    v_mfma_f32_16x16x32_bf16 v[36:39], a[80:83], a[0:3], v[80:83]
    v_mfma_f32_16x16x32_bf16 v[44:47], a[80:83], a[16:19], v[84:87]
    s_add_u32 m0, s80, 12288
    v_mfma_f32_16x16x32_bf16 v[36:39], a[84:87], a[4:7], v[36:39]
    v_exp_f32 v32, v32
    v_mfma_f32_16x16x32_bf16 v[44:47], a[84:87], a[20:23], v[44:47]
    buffer_load_dwordx4 v17, s[8:11], s82 offen nt lds
    v_mfma_f32_16x16x32_bf16 v[36:39], a[88:91], a[8:11], v[36:39]
    v_exp_f32 v33, v33
    v_mfma_f32_16x16x32_bf16 v[44:47], a[88:91], a[24:27], v[44:47]
    v_cvt_pk_bf16_f32 v64, v32, v33
    s_add_u32 s26, s26, 16384
    v_mfma_f32_16x16x32_bf16 v[36:39], a[92:95], a[12:15], v[36:39]
    v_exp_f32 v34, v34
    v_mfma_f32_16x16x32_bf16 v[44:47], a[92:95], a[28:31], v[44:47]
    s_add_u32 s82, s82, 16384
    v_mfma_f32_16x16x32_bf16 v[192:195], a[96:99], v[72:75], v[192:195]
    v_exp_f32 v35, v35
    v_mfma_f32_16x16x32_bf16 v[224:227], a[96:99], v[76:79], v[224:227]
    ds_read_b64_tr_b16 a[96:97], v8 offset:24576
    ds_read_b64_tr_b16 a[98:99], v8 offset:28672
    v_mfma_f32_16x16x32_bf16 v[196:199], a[100:103], v[72:75], v[196:199]
    v_exp_f32 v40, v40
    v_mfma_f32_16x16x32_bf16 v[228:231], a[100:103], v[76:79], v[228:231]
    ds_read_b64_tr_b16 a[100:101], v9 offset:24576
    ds_read_b64_tr_b16 a[102:103], v9 offset:28672
    v_mfma_f32_16x16x32_bf16 v[200:203], a[104:107], v[72:75], v[200:203]
    v_exp_f32 v41, v41
    v_mfma_f32_16x16x32_bf16 v[232:235], a[104:107], v[76:79], v[232:235]
    ds_read_b64_tr_b16 a[104:105], v10 offset:24576
    ds_read_b64_tr_b16 a[106:107], v10 offset:28672
    v_mfma_f32_16x16x32_bf16 v[204:207], a[108:111], v[72:75], v[204:207]
    v_exp_f32 v42, v42
    v_mfma_f32_16x16x32_bf16 v[236:239], a[108:111], v[76:79], v[236:239]
    ds_read_b64_tr_b16 a[108:109], v11 offset:24576
    ds_read_b64_tr_b16 a[110:111], v11 offset:28672
    v_mfma_f32_16x16x32_bf16 v[208:211], a[112:115], v[72:75], v[208:211]
    v_exp_f32 v43, v43
    v_mfma_f32_16x16x32_bf16 v[240:243], a[112:115], v[76:79], v[240:243]
    ds_read_b64_tr_b16 a[112:113], v12 offset:24576
    ds_read_b64_tr_b16 a[114:115], v12 offset:28672
    v_mfma_f32_16x16x32_bf16 v[212:215], a[116:119], v[72:75], v[212:215]
    v_exp_f32 v36, v36
    v_mfma_f32_16x16x32_bf16 v[244:247], a[116:119], v[76:79], v[244:247]
    ds_read_b64_tr_b16 a[116:117], v13 offset:24576
    ds_read_b64_tr_b16 a[118:119], v13 offset:28672
    v_mfma_f32_16x16x32_bf16 v[216:219], a[120:123], v[72:75], v[216:219]
    v_exp_f32 v37, v37
    v_mfma_f32_16x16x32_bf16 v[248:251], a[120:123], v[76:79], v[248:251]
    ds_read_b64_tr_b16 a[120:121], v14 offset:24576
    ds_read_b64_tr_b16 a[122:123], v14 offset:28672
    v_mfma_f32_16x16x32_bf16 v[220:223], a[124:127], v[72:75], v[220:223]
    v_exp_f32 v38, v38
    v_mfma_f32_16x16x32_bf16 v[252:255], a[124:127], v[76:79], v[252:255]
    ds_read_b64_tr_b16 a[124:125], v15 offset:24576
    ds_read_b64_tr_b16 a[126:127], v15 offset:28672
    v_mfma_f32_16x16x32_bf16 v[104:107], v[112:115], v[72:75], v[104:107]
    v_exp_f32 v39, v39
    v_mfma_f32_16x16x32_bf16 v[108:111], v[112:115], v[76:79], v[108:111]
    v_cvt_pk_bf16_f32 v65, v34, v35
    v_cvt_pk_bf16_f32 v68, v40, v41
    v_mfma_f32_16x16x32_bf16 v[48:51], a[64:67], a[32:35], v[88:91]
    v_exp_f32 v44, v44
    v_mfma_f32_16x16x32_bf16 v[56:59], a[64:67], a[48:51], v[92:95]
    ds_read_b128 a[64:67], v4 offset:24576
    v_cvt_pk_bf16_f32 v69, v42, v43
    v_mfma_f32_16x16x32_bf16 v[48:51], a[68:71], a[36:39], v[48:51]
    v_exp_f32 v45, v45
    v_mfma_f32_16x16x32_bf16 v[56:59], a[68:71], a[52:55], v[56:59]
    ds_read_b128 a[68:71], v5 offset:24576
    v_cvt_pk_bf16_f32 v66, v36, v37
    v_mfma_f32_16x16x32_bf16 v[48:51], a[72:75], a[40:43], v[48:51]
    v_exp_f32 v46, v46
    v_mfma_f32_16x16x32_bf16 v[56:59], a[72:75], a[56:59], v[56:59]
    ds_read_b128 a[72:75], v6 offset:24576
    v_cvt_pk_bf16_f32 v67, v38, v39
    v_mfma_f32_16x16x32_bf16 v[48:51], a[76:79], a[44:47], v[48:51]
    v_exp_f32 v47, v47
    v_mfma_f32_16x16x32_bf16 v[56:59], a[76:79], a[60:63], v[56:59]
    ds_read_b128 a[76:79], v7 offset:24576
    v_cvt_pk_bf16_f32 v70, v44, v45
    v_mfma_f32_16x16x32_bf16 v[52:55], a[80:83], a[32:35], v[88:91]
    buffer_store_dwordx4 a[180:183], v119, s[16:19], s78 offen offset:1024 sc1
    v_mfma_f32_16x16x32_bf16 v[60:63], a[80:83], a[48:51], v[92:95]
    ds_read_b128 a[80:83], v4 offset:28672
    v_cvt_pk_bf16_f32 v71, v46, v47
    v_mfma_f32_16x16x32_bf16 v[52:55], a[84:87], a[36:39], v[52:55]
    v_exp_f32 v48, v48
    v_mfma_f32_16x16x32_bf16 v[60:63], a[84:87], a[52:55], v[60:63]
    ds_read_b128 a[84:87], v5 offset:28672
    v_mfma_f32_16x16x32_bf16 v[52:55], a[88:91], a[40:43], v[52:55]
    v_exp_f32 v49, v49
    v_mfma_f32_16x16x32_bf16 v[60:63], a[88:91], a[56:59], v[60:63]
    ds_read_b128 a[88:91], v6 offset:28672
    v_mfma_f32_16x16x32_bf16 v[52:55], a[92:95], a[44:47], v[52:55]
    v_exp_f32 v50, v50
    v_mfma_f32_16x16x32_bf16 v[60:63], a[92:95], a[60:63], v[60:63]
    ds_read_b128 a[92:95], v7 offset:28672
    s_waitcnt lgkmcnt(8)
    v_mfma_f32_16x16x32_bf16 v[128:131], a[96:99], v[64:67], v[128:131]
    v_exp_f32 v51, v51
    v_mfma_f32_16x16x32_bf16 v[160:163], a[96:99], v[68:71], v[160:163]
    v_cvt_pk_bf16_f32 v72, v48, v49
    v_cvt_pk_bf16_f32 v73, v50, v51
    v_mfma_f32_16x16x32_bf16 v[132:135], a[100:103], v[64:67], v[132:135]
    v_exp_f32 v56, v56
    v_mfma_f32_16x16x32_bf16 v[164:167], a[100:103], v[68:71], v[164:167]
    v_mfma_f32_16x16x32_bf16 v[136:139], a[104:107], v[64:67], v[136:139]
    v_exp_f32 v57, v57
    v_mfma_f32_16x16x32_bf16 v[168:171], a[104:107], v[68:71], v[168:171]
    v_cvt_pk_bf16_f32 v76, v56, v57
    v_mfma_f32_16x16x32_bf16 v[140:143], a[108:111], v[64:67], v[140:143]
    v_exp_f32 v58, v58
    v_mfma_f32_16x16x32_bf16 v[172:175], a[108:111], v[68:71], v[172:175]
    v_mfma_f32_16x16x32_bf16 v[144:147], a[112:115], v[64:67], v[144:147]
    v_exp_f32 v59, v59
    v_mfma_f32_16x16x32_bf16 v[176:179], a[112:115], v[68:71], v[176:179]
    v_cvt_pk_bf16_f32 v77, v58, v59
    v_mfma_f32_16x16x32_bf16 v[148:151], a[116:119], v[64:67], v[148:151]
    v_exp_f32 v52, v52
    v_mfma_f32_16x16x32_bf16 v[180:183], a[116:119], v[68:71], v[180:183]
    v_mfma_f32_16x16x32_bf16 v[152:155], a[120:123], v[64:67], v[152:155]
    v_exp_f32 v53, v53
    v_mfma_f32_16x16x32_bf16 v[184:187], a[120:123], v[68:71], v[184:187]
    v_mfma_f32_16x16x32_bf16 v[156:159], a[124:127], v[64:67], v[156:159]
    v_exp_f32 v54, v54
    v_mfma_f32_16x16x32_bf16 v[188:191], a[124:127], v[68:71], v[188:191]
    v_mfma_f32_16x16x32_bf16 v[96:99], v[112:115], v[64:67], v[96:99]
    v_exp_f32 v55, v55
    v_mfma_f32_16x16x32_bf16 v[100:103], v[112:115], v[68:71], v[100:103]
    s_waitcnt vmcnt(21) lgkmcnt(0)
    s_barrier
    v_mfma_f32_16x16x32_bf16 v[32:35], a[64:67], a[0:3], v[80:83]
    v_exp_f32 v60, v60
    v_mfma_f32_16x16x32_bf16 v[40:43], a[64:67], a[16:19], v[84:87]
    v_cvt_pk_bf16_f32 v74, v52, v53
    s_add_u32 m0, s80, 81920
    v_mfma_f32_16x16x32_bf16 v[32:35], a[68:71], a[4:7], v[32:35]
    v_exp_f32 v61, v61
    v_mfma_f32_16x16x32_bf16 v[40:43], a[68:71], a[20:23], v[40:43]
    v_cvt_pk_bf16_f32 v75, v54, v55
    v_cvt_pk_bf16_f32 v78, v60, v61
    v_mfma_f32_16x16x32_bf16 v[32:35], a[72:75], a[8:11], v[32:35]
    v_exp_f32 v62, v62
    v_mfma_f32_16x16x32_bf16 v[40:43], a[72:75], a[24:27], v[40:43]
    buffer_load_dwordx4 v20, s[12:15], s25 offen nt lds
    v_mfma_f32_16x16x32_bf16 v[32:35], a[76:79], a[12:15], v[32:35]
    v_exp_f32 v63, v63
    v_mfma_f32_16x16x32_bf16 v[40:43], a[76:79], a[28:31], v[40:43]
    v_cvt_pk_bf16_f32 v79, v62, v63
    v_mfma_f32_16x16x32_bf16 v[36:39], a[80:83], a[0:3], v[80:83]
    v_mfma_f32_16x16x32_bf16 v[44:47], a[80:83], a[16:19], v[84:87]
    s_add_u32 m0, s80, 86016
    v_mfma_f32_16x16x32_bf16 v[36:39], a[84:87], a[4:7], v[36:39]
    v_exp_f32 v32, v32
    v_mfma_f32_16x16x32_bf16 v[44:47], a[84:87], a[20:23], v[44:47]
    buffer_load_dwordx4 v21, s[12:15], s25 offen nt lds
    v_mfma_f32_16x16x32_bf16 v[36:39], a[88:91], a[8:11], v[36:39]
    v_exp_f32 v33, v33
    v_mfma_f32_16x16x32_bf16 v[44:47], a[88:91], a[24:27], v[44:47]
    v_cvt_pk_bf16_f32 v64, v32, v33
    v_mfma_f32_16x16x32_bf16 v[36:39], a[92:95], a[12:15], v[36:39]
    v_exp_f32 v34, v34
    v_mfma_f32_16x16x32_bf16 v[44:47], a[92:95], a[28:31], v[44:47]
    s_add_u32 m0, s80, 90112
    v_mfma_f32_16x16x32_bf16 v[192:195], a[96:99], v[72:75], v[192:195]
    v_exp_f32 v35, v35
    buffer_store_dwordx4 a[184:187], v119, s[16:19], s78 offen offset:2048 sc1
    v_mfma_f32_16x16x32_bf16 v[224:227], a[96:99], v[76:79], v[224:227]
    ds_read_b64_tr_b16 a[96:97], v8 offset:32768
    ds_read_b64_tr_b16 a[98:99], v8 offset:36864
    v_mfma_f32_16x16x32_bf16 v[196:199], a[100:103], v[72:75], v[196:199]
    v_exp_f32 v40, v40
    v_mfma_f32_16x16x32_bf16 v[228:231], a[100:103], v[76:79], v[228:231]
    ds_read_b64_tr_b16 a[100:101], v9 offset:32768
    ds_read_b64_tr_b16 a[102:103], v9 offset:36864
    v_mfma_f32_16x16x32_bf16 v[200:203], a[104:107], v[72:75], v[200:203]
    v_exp_f32 v41, v41
    v_mfma_f32_16x16x32_bf16 v[232:235], a[104:107], v[76:79], v[232:235]
    ds_read_b64_tr_b16 a[104:105], v10 offset:32768
    ds_read_b64_tr_b16 a[106:107], v10 offset:36864
    v_mfma_f32_16x16x32_bf16 v[204:207], a[108:111], v[72:75], v[204:207]
    v_exp_f32 v42, v42
    v_mfma_f32_16x16x32_bf16 v[236:239], a[108:111], v[76:79], v[236:239]
    ds_read_b64_tr_b16 a[108:109], v11 offset:32768
    ds_read_b64_tr_b16 a[110:111], v11 offset:36864
    v_mfma_f32_16x16x32_bf16 v[208:211], a[112:115], v[72:75], v[208:211]
    v_exp_f32 v43, v43
    v_mfma_f32_16x16x32_bf16 v[240:243], a[112:115], v[76:79], v[240:243]
    ds_read_b64_tr_b16 a[112:113], v12 offset:32768
    ds_read_b64_tr_b16 a[114:115], v12 offset:36864
    v_mfma_f32_16x16x32_bf16 v[212:215], a[116:119], v[72:75], v[212:215]
    v_exp_f32 v36, v36
    v_mfma_f32_16x16x32_bf16 v[244:247], a[116:119], v[76:79], v[244:247]
    ds_read_b64_tr_b16 a[116:117], v13 offset:32768
    ds_read_b64_tr_b16 a[118:119], v13 offset:36864
    v_mfma_f32_16x16x32_bf16 v[216:219], a[120:123], v[72:75], v[216:219]
    v_exp_f32 v37, v37
    v_mfma_f32_16x16x32_bf16 v[248:251], a[120:123], v[76:79], v[248:251]
    ds_read_b64_tr_b16 a[120:121], v14 offset:32768
    ds_read_b64_tr_b16 a[122:123], v14 offset:36864
    v_mfma_f32_16x16x32_bf16 v[220:223], a[124:127], v[72:75], v[220:223]
    v_exp_f32 v38, v38
    v_mfma_f32_16x16x32_bf16 v[252:255], a[124:127], v[76:79], v[252:255]
    ds_read_b64_tr_b16 a[124:125], v15 offset:32768
    ds_read_b64_tr_b16 a[126:127], v15 offset:36864
    v_mfma_f32_16x16x32_bf16 v[104:107], v[112:115], v[72:75], v[104:107]
    v_exp_f32 v39, v39
    v_mfma_f32_16x16x32_bf16 v[108:111], v[112:115], v[76:79], v[108:111]
    v_cvt_pk_bf16_f32 v65, v34, v35
    v_cvt_pk_bf16_f32 v68, v40, v41
    v_mfma_f32_16x16x32_bf16 v[48:51], a[64:67], a[32:35], v[88:91]
    v_exp_f32 v44, v44
    v_mfma_f32_16x16x32_bf16 v[56:59], a[64:67], a[48:51], v[92:95]
    ds_read_b128 a[64:67], v4 offset:32768
    v_cvt_pk_bf16_f32 v69, v42, v43
    v_mfma_f32_16x16x32_bf16 v[48:51], a[68:71], a[36:39], v[48:51]
    v_exp_f32 v45, v45
    v_mfma_f32_16x16x32_bf16 v[56:59], a[68:71], a[52:55], v[56:59]
    ds_read_b128 a[68:71], v5 offset:32768
    v_cvt_pk_bf16_f32 v66, v36, v37
    v_mfma_f32_16x16x32_bf16 v[48:51], a[72:75], a[40:43], v[48:51]
    v_exp_f32 v46, v46
    v_mfma_f32_16x16x32_bf16 v[56:59], a[72:75], a[56:59], v[56:59]
    ds_read_b128 a[72:75], v6 offset:32768
    v_cvt_pk_bf16_f32 v67, v38, v39
    v_mfma_f32_16x16x32_bf16 v[48:51], a[76:79], a[44:47], v[48:51]
    v_exp_f32 v47, v47
    v_mfma_f32_16x16x32_bf16 v[56:59], a[76:79], a[60:63], v[56:59]
    ds_read_b128 a[76:79], v7 offset:32768
    v_cvt_pk_bf16_f32 v70, v44, v45
    v_mfma_f32_16x16x32_bf16 v[52:55], a[80:83], a[32:35], v[88:91]
    buffer_load_dwordx4 v20, s[12:15], s81 offen nt lds
    v_mfma_f32_16x16x32_bf16 v[60:63], a[80:83], a[48:51], v[92:95]
    ds_read_b128 a[80:83], v4 offset:36864
    v_cvt_pk_bf16_f32 v71, v46, v47
    v_mfma_f32_16x16x32_bf16 v[52:55], a[84:87], a[36:39], v[52:55]
    v_exp_f32 v48, v48
    v_mfma_f32_16x16x32_bf16 v[60:63], a[84:87], a[52:55], v[60:63]
    ds_read_b128 a[84:87], v5 offset:36864
    s_add_u32 m0, s80, 94208
    v_mfma_f32_16x16x32_bf16 v[52:55], a[88:91], a[40:43], v[52:55]
    v_exp_f32 v49, v49
    v_mfma_f32_16x16x32_bf16 v[60:63], a[88:91], a[56:59], v[60:63]
    ds_read_b128 a[88:91], v6 offset:36864
    buffer_load_dwordx4 v21, s[12:15], s81 offen nt lds
    v_mfma_f32_16x16x32_bf16 v[52:55], a[92:95], a[44:47], v[52:55]
    v_exp_f32 v50, v50
    v_mfma_f32_16x16x32_bf16 v[60:63], a[92:95], a[60:63], v[60:63]
    ds_read_b128 a[92:95], v7 offset:36864
    s_waitcnt lgkmcnt(8)
    v_mfma_f32_16x16x32_bf16 v[128:131], a[96:99], v[64:67], v[128:131]
    v_exp_f32 v51, v51
    v_mfma_f32_16x16x32_bf16 v[160:163], a[96:99], v[68:71], v[160:163]
    v_cvt_pk_bf16_f32 v72, v48, v49
    v_cvt_pk_bf16_f32 v73, v50, v51
    v_mfma_f32_16x16x32_bf16 v[132:135], a[100:103], v[64:67], v[132:135]
    v_exp_f32 v56, v56
    v_mfma_f32_16x16x32_bf16 v[164:167], a[100:103], v[68:71], v[164:167]
    s_add_u32 s25, s25, 16384
    s_add_u32 s81, s81, 16384
    v_mfma_f32_16x16x32_bf16 v[136:139], a[104:107], v[64:67], v[136:139]
    v_exp_f32 v57, v57
    v_mfma_f32_16x16x32_bf16 v[168:171], a[104:107], v[68:71], v[168:171]
    v_cvt_pk_bf16_f32 v76, v56, v57
    s_add_u32 m0, s80, 16384
    v_mfma_f32_16x16x32_bf16 v[140:143], a[108:111], v[64:67], v[140:143]
    v_exp_f32 v58, v58
    v_mfma_f32_16x16x32_bf16 v[172:175], a[108:111], v[68:71], v[172:175]
    buffer_load_dwordx4 v16, s[8:11], s26 offen nt lds
    v_mfma_f32_16x16x32_bf16 v[144:147], a[112:115], v[64:67], v[144:147]
    v_exp_f32 v59, v59
    v_mfma_f32_16x16x32_bf16 v[176:179], a[112:115], v[68:71], v[176:179]
    v_cvt_pk_bf16_f32 v77, v58, v59
    v_mfma_f32_16x16x32_bf16 v[148:151], a[116:119], v[64:67], v[148:151]
    v_exp_f32 v52, v52
    v_mfma_f32_16x16x32_bf16 v[180:183], a[116:119], v[68:71], v[180:183]
    s_add_u32 m0, s80, 20480
    v_mfma_f32_16x16x32_bf16 v[152:155], a[120:123], v[64:67], v[152:155]
    v_exp_f32 v53, v53
    v_mfma_f32_16x16x32_bf16 v[184:187], a[120:123], v[68:71], v[184:187]
    buffer_load_dwordx4 v17, s[8:11], s26 offen nt lds
    v_mfma_f32_16x16x32_bf16 v[156:159], a[124:127], v[64:67], v[156:159]
    v_exp_f32 v54, v54
    v_mfma_f32_16x16x32_bf16 v[188:191], a[124:127], v[68:71], v[188:191]
    v_mfma_f32_16x16x32_bf16 v[96:99], v[112:115], v[64:67], v[96:99]
    v_exp_f32 v55, v55
    v_mfma_f32_16x16x32_bf16 v[100:103], v[112:115], v[68:71], v[100:103]
    s_waitcnt lgkmcnt(0)
    v_mfma_f32_16x16x32_bf16 v[32:35], a[64:67], a[0:3], v[80:83]
    v_exp_f32 v60, v60
    v_mfma_f32_16x16x32_bf16 v[40:43], a[64:67], a[16:19], v[84:87]
    v_cvt_pk_bf16_f32 v74, v52, v53
    s_add_u32 m0, s80, 24576
    v_mfma_f32_16x16x32_bf16 v[32:35], a[68:71], a[4:7], v[32:35]
    v_exp_f32 v61, v61
    v_mfma_f32_16x16x32_bf16 v[40:43], a[68:71], a[20:23], v[40:43]
    v_cvt_pk_bf16_f32 v75, v54, v55
    v_cvt_pk_bf16_f32 v78, v60, v61
    v_mfma_f32_16x16x32_bf16 v[32:35], a[72:75], a[8:11], v[32:35]
    v_exp_f32 v62, v62
    v_mfma_f32_16x16x32_bf16 v[40:43], a[72:75], a[24:27], v[40:43]
    buffer_load_dwordx4 v16, s[8:11], s82 offen nt lds
    v_mfma_f32_16x16x32_bf16 v[32:35], a[76:79], a[12:15], v[32:35]
    v_exp_f32 v63, v63
    v_mfma_f32_16x16x32_bf16 v[40:43], a[76:79], a[28:31], v[40:43]
    v_cvt_pk_bf16_f32 v79, v62, v63
    v_mfma_f32_16x16x32_bf16 v[36:39], a[80:83], a[0:3], v[80:83]
    v_mfma_f32_16x16x32_bf16 v[44:47], a[80:83], a[16:19], v[84:87]
    s_add_u32 m0, s80, 28672
    v_mfma_f32_16x16x32_bf16 v[36:39], a[84:87], a[4:7], v[36:39]
    v_exp_f32 v32, v32
    v_mfma_f32_16x16x32_bf16 v[44:47], a[84:87], a[20:23], v[44:47]
    buffer_load_dwordx4 v17, s[8:11], s82 offen nt lds
    v_mfma_f32_16x16x32_bf16 v[36:39], a[88:91], a[8:11], v[36:39]
    v_exp_f32 v33, v33
    v_mfma_f32_16x16x32_bf16 v[44:47], a[88:91], a[24:27], v[44:47]
    v_cvt_pk_bf16_f32 v64, v32, v33
    s_add_u32 s26, s26, 16384
    v_mfma_f32_16x16x32_bf16 v[36:39], a[92:95], a[12:15], v[36:39]
    v_exp_f32 v34, v34
    v_mfma_f32_16x16x32_bf16 v[44:47], a[92:95], a[28:31], v[44:47]
    s_add_u32 s82, s82, 16384
    v_mfma_f32_16x16x32_bf16 v[192:195], a[96:99], v[72:75], v[192:195]
    v_exp_f32 v35, v35
    v_mfma_f32_16x16x32_bf16 v[224:227], a[96:99], v[76:79], v[224:227]
    ds_read_b64_tr_b16 a[96:97], v8 offset:40960
    ds_read_b64_tr_b16 a[98:99], v8 offset:45056
    v_mfma_f32_16x16x32_bf16 v[196:199], a[100:103], v[72:75], v[196:199]
    v_exp_f32 v40, v40
    v_mfma_f32_16x16x32_bf16 v[228:231], a[100:103], v[76:79], v[228:231]
    ds_read_b64_tr_b16 a[100:101], v9 offset:40960
    ds_read_b64_tr_b16 a[102:103], v9 offset:45056
    v_mfma_f32_16x16x32_bf16 v[200:203], a[104:107], v[72:75], v[200:203]
    v_exp_f32 v41, v41
    v_mfma_f32_16x16x32_bf16 v[232:235], a[104:107], v[76:79], v[232:235]
    ds_read_b64_tr_b16 a[104:105], v10 offset:40960
    ds_read_b64_tr_b16 a[106:107], v10 offset:45056
    v_mfma_f32_16x16x32_bf16 v[204:207], a[108:111], v[72:75], v[204:207]
    v_exp_f32 v42, v42
    v_mfma_f32_16x16x32_bf16 v[236:239], a[108:111], v[76:79], v[236:239]
    ds_read_b64_tr_b16 a[108:109], v11 offset:40960
    ds_read_b64_tr_b16 a[110:111], v11 offset:45056
    v_mfma_f32_16x16x32_bf16 v[208:211], a[112:115], v[72:75], v[208:211]
    v_exp_f32 v43, v43
    v_mfma_f32_16x16x32_bf16 v[240:243], a[112:115], v[76:79], v[240:243]
    ds_read_b64_tr_b16 a[112:113], v12 offset:40960
    ds_read_b64_tr_b16 a[114:115], v12 offset:45056
    v_mfma_f32_16x16x32_bf16 v[212:215], a[116:119], v[72:75], v[212:215]
    v_exp_f32 v36, v36
    v_mfma_f32_16x16x32_bf16 v[244:247], a[116:119], v[76:79], v[244:247]
    ds_read_b64_tr_b16 a[116:117], v13 offset:40960
    ds_read_b64_tr_b16 a[118:119], v13 offset:45056
    v_mfma_f32_16x16x32_bf16 v[216:219], a[120:123], v[72:75], v[216:219]
    v_exp_f32 v37, v37
    v_mfma_f32_16x16x32_bf16 v[248:251], a[120:123], v[76:79], v[248:251]
    ds_read_b64_tr_b16 a[120:121], v14 offset:40960
    ds_read_b64_tr_b16 a[122:123], v14 offset:45056
    v_mfma_f32_16x16x32_bf16 v[220:223], a[124:127], v[72:75], v[220:223]
    v_exp_f32 v38, v38
    v_mfma_f32_16x16x32_bf16 v[252:255], a[124:127], v[76:79], v[252:255]
    ds_read_b64_tr_b16 a[124:125], v15 offset:40960
    ds_read_b64_tr_b16 a[126:127], v15 offset:45056
    v_mfma_f32_16x16x32_bf16 v[104:107], v[112:115], v[72:75], v[104:107]
    v_exp_f32 v39, v39
    v_mfma_f32_16x16x32_bf16 v[108:111], v[112:115], v[76:79], v[108:111]
    v_cvt_pk_bf16_f32 v65, v34, v35
    v_cvt_pk_bf16_f32 v68, v40, v41
    v_mfma_f32_16x16x32_bf16 v[48:51], a[64:67], a[32:35], v[88:91]
    v_exp_f32 v44, v44
    v_mfma_f32_16x16x32_bf16 v[56:59], a[64:67], a[48:51], v[92:95]
    ds_read_b128 a[64:67], v4 offset:40960
    v_cvt_pk_bf16_f32 v69, v42, v43
    v_mfma_f32_16x16x32_bf16 v[48:51], a[68:71], a[36:39], v[48:51]
    v_exp_f32 v45, v45
    v_mfma_f32_16x16x32_bf16 v[56:59], a[68:71], a[52:55], v[56:59]
    ds_read_b128 a[68:71], v5 offset:40960
    v_cvt_pk_bf16_f32 v66, v36, v37
    v_mfma_f32_16x16x32_bf16 v[48:51], a[72:75], a[40:43], v[48:51]
    v_exp_f32 v46, v46
    v_mfma_f32_16x16x32_bf16 v[56:59], a[72:75], a[56:59], v[56:59]
    ds_read_b128 a[72:75], v6 offset:40960
    v_cvt_pk_bf16_f32 v67, v38, v39
    v_mfma_f32_16x16x32_bf16 v[48:51], a[76:79], a[44:47], v[48:51]
    v_exp_f32 v47, v47
    v_mfma_f32_16x16x32_bf16 v[56:59], a[76:79], a[60:63], v[56:59]
    ds_read_b128 a[76:79], v7 offset:40960
    v_cvt_pk_bf16_f32 v70, v44, v45
    v_mfma_f32_16x16x32_bf16 v[52:55], a[80:83], a[32:35], v[88:91]
    buffer_store_dwordx4 a[188:191], v119, s[16:19], s78 offen offset:3072 sc1
    v_mfma_f32_16x16x32_bf16 v[60:63], a[80:83], a[48:51], v[92:95]
    ds_read_b128 a[80:83], v4 offset:45056
    v_cvt_pk_bf16_f32 v71, v46, v47
    v_mfma_f32_16x16x32_bf16 v[52:55], a[84:87], a[36:39], v[52:55]
    v_exp_f32 v48, v48
    v_mfma_f32_16x16x32_bf16 v[60:63], a[84:87], a[52:55], v[60:63]
    ds_read_b128 a[84:87], v5 offset:45056
    v_mfma_f32_16x16x32_bf16 v[52:55], a[88:91], a[40:43], v[52:55]
    v_exp_f32 v49, v49
    v_mfma_f32_16x16x32_bf16 v[60:63], a[88:91], a[56:59], v[60:63]
    ds_read_b128 a[88:91], v6 offset:45056
    v_mfma_f32_16x16x32_bf16 v[52:55], a[92:95], a[44:47], v[52:55]
    v_exp_f32 v50, v50
    v_mfma_f32_16x16x32_bf16 v[60:63], a[92:95], a[60:63], v[60:63]
    ds_read_b128 a[92:95], v7 offset:45056
    s_waitcnt lgkmcnt(8)
    v_mfma_f32_16x16x32_bf16 v[128:131], a[96:99], v[64:67], v[128:131]
    v_exp_f32 v51, v51
    v_mfma_f32_16x16x32_bf16 v[160:163], a[96:99], v[68:71], v[160:163]
    v_cvt_pk_bf16_f32 v72, v48, v49
    v_cvt_pk_bf16_f32 v73, v50, v51
    v_mfma_f32_16x16x32_bf16 v[132:135], a[100:103], v[64:67], v[132:135]
    v_exp_f32 v56, v56
    v_mfma_f32_16x16x32_bf16 v[164:167], a[100:103], v[68:71], v[164:167]
    v_mfma_f32_16x16x32_bf16 v[136:139], a[104:107], v[64:67], v[136:139]
    v_exp_f32 v57, v57
    v_mfma_f32_16x16x32_bf16 v[168:171], a[104:107], v[68:71], v[168:171]
    v_cvt_pk_bf16_f32 v76, v56, v57
    v_mfma_f32_16x16x32_bf16 v[140:143], a[108:111], v[64:67], v[140:143]
    v_exp_f32 v58, v58
    v_mfma_f32_16x16x32_bf16 v[172:175], a[108:111], v[68:71], v[172:175]
    v_mfma_f32_16x16x32_bf16 v[144:147], a[112:115], v[64:67], v[144:147]
    v_exp_f32 v59, v59
    v_mfma_f32_16x16x32_bf16 v[176:179], a[112:115], v[68:71], v[176:179]
    v_cvt_pk_bf16_f32 v77, v58, v59
    v_mfma_f32_16x16x32_bf16 v[148:151], a[116:119], v[64:67], v[148:151]
    v_exp_f32 v52, v52
    v_mfma_f32_16x16x32_bf16 v[180:183], a[116:119], v[68:71], v[180:183]
    v_mfma_f32_16x16x32_bf16 v[152:155], a[120:123], v[64:67], v[152:155]
    v_exp_f32 v53, v53
    v_mfma_f32_16x16x32_bf16 v[184:187], a[120:123], v[68:71], v[184:187]
    v_mfma_f32_16x16x32_bf16 v[156:159], a[124:127], v[64:67], v[156:159]
    v_exp_f32 v54, v54
    v_mfma_f32_16x16x32_bf16 v[188:191], a[124:127], v[68:71], v[188:191]
    v_mfma_f32_16x16x32_bf16 v[96:99], v[112:115], v[64:67], v[96:99]
    v_exp_f32 v55, v55
    v_mfma_f32_16x16x32_bf16 v[100:103], v[112:115], v[68:71], v[100:103]
    s_waitcnt vmcnt(21) lgkmcnt(0)
    s_barrier
    v_mfma_f32_16x16x32_bf16 v[32:35], a[64:67], a[0:3], v[80:83]
    v_exp_f32 v60, v60
    v_mfma_f32_16x16x32_bf16 v[40:43], a[64:67], a[16:19], v[84:87]
    v_cvt_pk_bf16_f32 v74, v52, v53
    s_add_u32 m0, s80, 98304
    v_mfma_f32_16x16x32_bf16 v[32:35], a[68:71], a[4:7], v[32:35]
    v_exp_f32 v61, v61
    v_mfma_f32_16x16x32_bf16 v[40:43], a[68:71], a[20:23], v[40:43]
    v_cvt_pk_bf16_f32 v75, v54, v55
    v_cvt_pk_bf16_f32 v78, v60, v61
    v_mfma_f32_16x16x32_bf16 v[32:35], a[72:75], a[8:11], v[32:35]
    v_exp_f32 v62, v62
    v_mfma_f32_16x16x32_bf16 v[40:43], a[72:75], a[24:27], v[40:43]
    buffer_load_dwordx4 v20, s[12:15], s25 offen nt lds
    v_mfma_f32_16x16x32_bf16 v[32:35], a[76:79], a[12:15], v[32:35]
    v_exp_f32 v63, v63
    v_mfma_f32_16x16x32_bf16 v[40:43], a[76:79], a[28:31], v[40:43]
    v_cvt_pk_bf16_f32 v79, v62, v63
    v_mfma_f32_16x16x32_bf16 v[36:39], a[80:83], a[0:3], v[80:83]
    v_mfma_f32_16x16x32_bf16 v[44:47], a[80:83], a[16:19], v[84:87]
    s_add_u32 m0, s80, 102400
    v_mfma_f32_16x16x32_bf16 v[36:39], a[84:87], a[4:7], v[36:39]
    v_exp_f32 v32, v32
    v_mfma_f32_16x16x32_bf16 v[44:47], a[84:87], a[20:23], v[44:47]
    buffer_load_dwordx4 v21, s[12:15], s25 offen nt lds
    v_mfma_f32_16x16x32_bf16 v[36:39], a[88:91], a[8:11], v[36:39]
    v_exp_f32 v33, v33
    v_mfma_f32_16x16x32_bf16 v[44:47], a[88:91], a[24:27], v[44:47]
    v_cvt_pk_bf16_f32 v64, v32, v33
    v_mfma_f32_16x16x32_bf16 v[36:39], a[92:95], a[12:15], v[36:39]
    v_exp_f32 v34, v34
    v_mfma_f32_16x16x32_bf16 v[44:47], a[92:95], a[28:31], v[44:47]
    s_add_u32 m0, s80, 106496
    v_mfma_f32_16x16x32_bf16 v[192:195], a[96:99], v[72:75], v[192:195]
    v_exp_f32 v35, v35
    v_mfma_f32_16x16x32_bf16 v[224:227], a[96:99], v[76:79], v[224:227]
    ds_read_b64_tr_b16 a[96:97], v8 offset:49152
    ds_read_b64_tr_b16 a[98:99], v8 offset:53248
    v_mfma_f32_16x16x32_bf16 v[196:199], a[100:103], v[72:75], v[196:199]
    v_exp_f32 v40, v40
    v_mfma_f32_16x16x32_bf16 v[228:231], a[100:103], v[76:79], v[228:231]
    ds_read_b64_tr_b16 a[100:101], v9 offset:49152
    ds_read_b64_tr_b16 a[102:103], v9 offset:53248
    v_mfma_f32_16x16x32_bf16 v[200:203], a[104:107], v[72:75], v[200:203]
    v_exp_f32 v41, v41
    v_mfma_f32_16x16x32_bf16 v[232:235], a[104:107], v[76:79], v[232:235]
    ds_read_b64_tr_b16 a[104:105], v10 offset:49152
    ds_read_b64_tr_b16 a[106:107], v10 offset:53248
    v_mfma_f32_16x16x32_bf16 v[204:207], a[108:111], v[72:75], v[204:207]
    v_exp_f32 v42, v42
    v_mfma_f32_16x16x32_bf16 v[236:239], a[108:111], v[76:79], v[236:239]
    ds_read_b64_tr_b16 a[108:109], v11 offset:49152
    ds_read_b64_tr_b16 a[110:111], v11 offset:53248
    v_mfma_f32_16x16x32_bf16 v[208:211], a[112:115], v[72:75], v[208:211]
    v_exp_f32 v43, v43
    v_mfma_f32_16x16x32_bf16 v[240:243], a[112:115], v[76:79], v[240:243]
    ds_read_b64_tr_b16 a[112:113], v12 offset:49152
    ds_read_b64_tr_b16 a[114:115], v12 offset:53248
    v_mfma_f32_16x16x32_bf16 v[212:215], a[116:119], v[72:75], v[212:215]
    v_exp_f32 v36, v36
    v_mfma_f32_16x16x32_bf16 v[244:247], a[116:119], v[76:79], v[244:247]
    ds_read_b64_tr_b16 a[116:117], v13 offset:49152
    ds_read_b64_tr_b16 a[118:119], v13 offset:53248
    v_mfma_f32_16x16x32_bf16 v[216:219], a[120:123], v[72:75], v[216:219]
    v_exp_f32 v37, v37
    v_mfma_f32_16x16x32_bf16 v[248:251], a[120:123], v[76:79], v[248:251]
    ds_read_b64_tr_b16 a[120:121], v14 offset:49152
    ds_read_b64_tr_b16 a[122:123], v14 offset:53248
    v_mfma_f32_16x16x32_bf16 v[220:223], a[124:127], v[72:75], v[220:223]
    v_exp_f32 v38, v38
    v_mfma_f32_16x16x32_bf16 v[252:255], a[124:127], v[76:79], v[252:255]
    ds_read_b64_tr_b16 a[124:125], v15 offset:49152
    ds_read_b64_tr_b16 a[126:127], v15 offset:53248
    v_mfma_f32_16x16x32_bf16 v[104:107], v[112:115], v[72:75], v[104:107]
    v_exp_f32 v39, v39
    v_mfma_f32_16x16x32_bf16 v[108:111], v[112:115], v[76:79], v[108:111]
    v_cvt_pk_bf16_f32 v65, v34, v35
    v_cvt_pk_bf16_f32 v68, v40, v41
    v_mfma_f32_16x16x32_bf16 v[48:51], a[64:67], a[32:35], v[88:91]
    v_exp_f32 v44, v44
    v_mfma_f32_16x16x32_bf16 v[56:59], a[64:67], a[48:51], v[92:95]
    ds_read_b128 a[64:67], v4 offset:49152
    v_cvt_pk_bf16_f32 v69, v42, v43
    v_mfma_f32_16x16x32_bf16 v[48:51], a[68:71], a[36:39], v[48:51]
    v_exp_f32 v45, v45
    v_mfma_f32_16x16x32_bf16 v[56:59], a[68:71], a[52:55], v[56:59]
    ds_read_b128 a[68:71], v5 offset:49152
    v_cvt_pk_bf16_f32 v66, v36, v37
    v_mfma_f32_16x16x32_bf16 v[48:51], a[72:75], a[40:43], v[48:51]
    v_exp_f32 v46, v46
    v_mfma_f32_16x16x32_bf16 v[56:59], a[72:75], a[56:59], v[56:59]
    ds_read_b128 a[72:75], v6 offset:49152
    v_cvt_pk_bf16_f32 v67, v38, v39
    v_mfma_f32_16x16x32_bf16 v[48:51], a[76:79], a[44:47], v[48:51]
    v_exp_f32 v47, v47
    v_mfma_f32_16x16x32_bf16 v[56:59], a[76:79], a[60:63], v[56:59]
    ds_read_b128 a[76:79], v7 offset:49152
    v_cvt_pk_bf16_f32 v70, v44, v45
    v_mfma_f32_16x16x32_bf16 v[52:55], a[80:83], a[32:35], v[88:91]
    buffer_load_dwordx4 v20, s[12:15], s81 offen nt lds
    v_mfma_f32_16x16x32_bf16 v[60:63], a[80:83], a[48:51], v[92:95]
    ds_read_b128 a[80:83], v4 offset:53248
    v_cvt_pk_bf16_f32 v71, v46, v47
    v_mfma_f32_16x16x32_bf16 v[52:55], a[84:87], a[36:39], v[52:55]
    v_exp_f32 v48, v48
    v_mfma_f32_16x16x32_bf16 v[60:63], a[84:87], a[52:55], v[60:63]
    ds_read_b128 a[84:87], v5 offset:53248
    s_add_u32 m0, s80, 110592
    v_mfma_f32_16x16x32_bf16 v[52:55], a[88:91], a[40:43], v[52:55]
    v_exp_f32 v49, v49
    v_mfma_f32_16x16x32_bf16 v[60:63], a[88:91], a[56:59], v[60:63]
    ds_read_b128 a[88:91], v6 offset:53248
    buffer_load_dwordx4 v21, s[12:15], s81 offen nt lds
    v_mfma_f32_16x16x32_bf16 v[52:55], a[92:95], a[44:47], v[52:55]
    v_exp_f32 v50, v50
    v_mfma_f32_16x16x32_bf16 v[60:63], a[92:95], a[60:63], v[60:63]
    ds_read_b128 a[92:95], v7 offset:53248
    s_waitcnt lgkmcnt(8)
    v_mfma_f32_16x16x32_bf16 v[128:131], a[96:99], v[64:67], v[128:131]
    v_exp_f32 v51, v51
    v_mfma_f32_16x16x32_bf16 v[160:163], a[96:99], v[68:71], v[160:163]
    v_cvt_pk_bf16_f32 v72, v48, v49
    v_cvt_pk_bf16_f32 v73, v50, v51
    v_mfma_f32_16x16x32_bf16 v[132:135], a[100:103], v[64:67], v[132:135]
    v_exp_f32 v56, v56
    v_mfma_f32_16x16x32_bf16 v[164:167], a[100:103], v[68:71], v[164:167]
    s_add_u32 s25, s25, 16384
    s_add_u32 s81, s81, 16384
    v_mfma_f32_16x16x32_bf16 v[136:139], a[104:107], v[64:67], v[136:139]
    v_exp_f32 v57, v57
    v_mfma_f32_16x16x32_bf16 v[168:171], a[104:107], v[68:71], v[168:171]
    v_cvt_pk_bf16_f32 v76, v56, v57
    s_add_u32 m0, s80, 32768
    v_mfma_f32_16x16x32_bf16 v[140:143], a[108:111], v[64:67], v[140:143]
    v_exp_f32 v58, v58
    v_mfma_f32_16x16x32_bf16 v[172:175], a[108:111], v[68:71], v[172:175]
    buffer_load_dwordx4 v16, s[8:11], s26 offen nt lds
    v_mfma_f32_16x16x32_bf16 v[144:147], a[112:115], v[64:67], v[144:147]
    v_exp_f32 v59, v59
    v_mfma_f32_16x16x32_bf16 v[176:179], a[112:115], v[68:71], v[176:179]
    v_cvt_pk_bf16_f32 v77, v58, v59
    v_mfma_f32_16x16x32_bf16 v[148:151], a[116:119], v[64:67], v[148:151]
    v_exp_f32 v52, v52
    v_mfma_f32_16x16x32_bf16 v[180:183], a[116:119], v[68:71], v[180:183]
    s_add_u32 m0, s80, 36864
    v_mfma_f32_16x16x32_bf16 v[152:155], a[120:123], v[64:67], v[152:155]
    v_exp_f32 v53, v53
    v_mfma_f32_16x16x32_bf16 v[184:187], a[120:123], v[68:71], v[184:187]
    buffer_load_dwordx4 v17, s[8:11], s26 offen nt lds
    v_mfma_f32_16x16x32_bf16 v[156:159], a[124:127], v[64:67], v[156:159]
    v_exp_f32 v54, v54
    v_mfma_f32_16x16x32_bf16 v[188:191], a[124:127], v[68:71], v[188:191]
    v_mfma_f32_16x16x32_bf16 v[96:99], v[112:115], v[64:67], v[96:99]
    v_exp_f32 v55, v55
    v_mfma_f32_16x16x32_bf16 v[100:103], v[112:115], v[68:71], v[100:103]
    s_waitcnt lgkmcnt(0)
    v_mfma_f32_16x16x32_bf16 v[32:35], a[64:67], a[0:3], v[80:83]
    v_exp_f32 v60, v60
    v_mfma_f32_16x16x32_bf16 v[40:43], a[64:67], a[16:19], v[84:87]
    v_cvt_pk_bf16_f32 v74, v52, v53
    s_add_u32 m0, s80, 40960
    v_mfma_f32_16x16x32_bf16 v[32:35], a[68:71], a[4:7], v[32:35]
    v_exp_f32 v61, v61
    v_mfma_f32_16x16x32_bf16 v[40:43], a[68:71], a[20:23], v[40:43]
    v_cvt_pk_bf16_f32 v75, v54, v55
    v_cvt_pk_bf16_f32 v78, v60, v61
    v_mfma_f32_16x16x32_bf16 v[32:35], a[72:75], a[8:11], v[32:35]
    v_exp_f32 v62, v62
    v_mfma_f32_16x16x32_bf16 v[40:43], a[72:75], a[24:27], v[40:43]
    buffer_load_dwordx4 v16, s[8:11], s82 offen nt lds
    v_mfma_f32_16x16x32_bf16 v[32:35], a[76:79], a[12:15], v[32:35]
    v_exp_f32 v63, v63
    v_mfma_f32_16x16x32_bf16 v[40:43], a[76:79], a[28:31], v[40:43]
    v_cvt_pk_bf16_f32 v79, v62, v63
    v_mfma_f32_16x16x32_bf16 v[36:39], a[80:83], a[0:3], v[80:83]
    v_mfma_f32_16x16x32_bf16 v[44:47], a[80:83], a[16:19], v[84:87]
    s_add_u32 m0, s80, 45056
    v_mfma_f32_16x16x32_bf16 v[36:39], a[84:87], a[4:7], v[36:39]
    v_exp_f32 v32, v32
    v_mfma_f32_16x16x32_bf16 v[44:47], a[84:87], a[20:23], v[44:47]
    buffer_load_dwordx4 v17, s[8:11], s82 offen nt lds
    v_mfma_f32_16x16x32_bf16 v[36:39], a[88:91], a[8:11], v[36:39]
    v_exp_f32 v33, v33
    v_mfma_f32_16x16x32_bf16 v[44:47], a[88:91], a[24:27], v[44:47]
    v_cvt_pk_bf16_f32 v64, v32, v33
    s_add_u32 s26, s26, 16384
    v_mfma_f32_16x16x32_bf16 v[36:39], a[92:95], a[12:15], v[36:39]
    v_exp_f32 v34, v34
    v_mfma_f32_16x16x32_bf16 v[44:47], a[92:95], a[28:31], v[44:47]
    s_add_u32 s82, s82, 16384
    v_mfma_f32_16x16x32_bf16 v[192:195], a[96:99], v[72:75], v[192:195]
    v_exp_f32 v35, v35
    v_mfma_f32_16x16x32_bf16 v[224:227], a[96:99], v[76:79], v[224:227]
    ds_read_b64_tr_b16 a[96:97], v8 offset:57344
    ds_read_b64_tr_b16 a[98:99], v8 offset:61440
    v_mfma_f32_16x16x32_bf16 v[196:199], a[100:103], v[72:75], v[196:199]
    v_exp_f32 v40, v40
    v_mfma_f32_16x16x32_bf16 v[228:231], a[100:103], v[76:79], v[228:231]
    ds_read_b64_tr_b16 a[100:101], v9 offset:57344
    ds_read_b64_tr_b16 a[102:103], v9 offset:61440
    v_mfma_f32_16x16x32_bf16 v[200:203], a[104:107], v[72:75], v[200:203]
    v_exp_f32 v41, v41
    v_mfma_f32_16x16x32_bf16 v[232:235], a[104:107], v[76:79], v[232:235]
    ds_read_b64_tr_b16 a[104:105], v10 offset:57344
    ds_read_b64_tr_b16 a[106:107], v10 offset:61440
    v_mfma_f32_16x16x32_bf16 v[204:207], a[108:111], v[72:75], v[204:207]
    v_exp_f32 v42, v42
    v_mfma_f32_16x16x32_bf16 v[236:239], a[108:111], v[76:79], v[236:239]
    ds_read_b64_tr_b16 a[108:109], v11 offset:57344
    ds_read_b64_tr_b16 a[110:111], v11 offset:61440
    v_mfma_f32_16x16x32_bf16 v[208:211], a[112:115], v[72:75], v[208:211]
    v_exp_f32 v43, v43
    v_mfma_f32_16x16x32_bf16 v[240:243], a[112:115], v[76:79], v[240:243]
    ds_read_b64_tr_b16 a[112:113], v12 offset:57344
    ds_read_b64_tr_b16 a[114:115], v12 offset:61440
    v_mfma_f32_16x16x32_bf16 v[212:215], a[116:119], v[72:75], v[212:215]
    v_exp_f32 v36, v36
    v_mfma_f32_16x16x32_bf16 v[244:247], a[116:119], v[76:79], v[244:247]
    ds_read_b64_tr_b16 a[116:117], v13 offset:57344
    ds_read_b64_tr_b16 a[118:119], v13 offset:61440
    v_mfma_f32_16x16x32_bf16 v[216:219], a[120:123], v[72:75], v[216:219]
    v_exp_f32 v37, v37
    v_mfma_f32_16x16x32_bf16 v[248:251], a[120:123], v[76:79], v[248:251]
    ds_read_b64_tr_b16 a[120:121], v14 offset:57344
    ds_read_b64_tr_b16 a[122:123], v14 offset:61440
    v_mfma_f32_16x16x32_bf16 v[220:223], a[124:127], v[72:75], v[220:223]
    v_exp_f32 v38, v38
    v_mfma_f32_16x16x32_bf16 v[252:255], a[124:127], v[76:79], v[252:255]
    ds_read_b64_tr_b16 a[124:125], v15 offset:57344
    ds_read_b64_tr_b16 a[126:127], v15 offset:61440
    v_mfma_f32_16x16x32_bf16 v[104:107], v[112:115], v[72:75], v[104:107]
    v_exp_f32 v39, v39
    v_mfma_f32_16x16x32_bf16 v[108:111], v[112:115], v[76:79], v[108:111]
    v_cvt_pk_bf16_f32 v65, v34, v35
    v_cvt_pk_bf16_f32 v68, v40, v41
    v_mfma_f32_16x16x32_bf16 v[48:51], a[64:67], a[32:35], v[88:91]
    v_exp_f32 v44, v44
    v_mfma_f32_16x16x32_bf16 v[56:59], a[64:67], a[48:51], v[92:95]
    ds_read_b128 a[64:67], v4 offset:57344
    v_cvt_pk_bf16_f32 v69, v42, v43
    v_mfma_f32_16x16x32_bf16 v[48:51], a[68:71], a[36:39], v[48:51]
    v_exp_f32 v45, v45
    v_mfma_f32_16x16x32_bf16 v[56:59], a[68:71], a[52:55], v[56:59]
    ds_read_b128 a[68:71], v5 offset:57344
    v_cvt_pk_bf16_f32 v66, v36, v37
    v_mfma_f32_16x16x32_bf16 v[48:51], a[72:75], a[40:43], v[48:51]
    v_exp_f32 v46, v46
    v_mfma_f32_16x16x32_bf16 v[56:59], a[72:75], a[56:59], v[56:59]
    ds_read_b128 a[72:75], v6 offset:57344
    v_cvt_pk_bf16_f32 v67, v38, v39
    v_mfma_f32_16x16x32_bf16 v[48:51], a[76:79], a[44:47], v[48:51]
    v_exp_f32 v47, v47
    v_mfma_f32_16x16x32_bf16 v[56:59], a[76:79], a[60:63], v[56:59]
    ds_read_b128 a[76:79], v7 offset:57344
    v_cvt_pk_bf16_f32 v70, v44, v45
    v_mfma_f32_16x16x32_bf16 v[52:55], a[80:83], a[32:35], v[88:91]
    v_mfma_f32_16x16x32_bf16 v[60:63], a[80:83], a[48:51], v[92:95]
    ds_read_b128 a[80:83], v4 offset:61440
    v_cvt_pk_bf16_f32 v71, v46, v47
    v_mfma_f32_16x16x32_bf16 v[52:55], a[84:87], a[36:39], v[52:55]
    v_exp_f32 v48, v48
    v_mfma_f32_16x16x32_bf16 v[60:63], a[84:87], a[52:55], v[60:63]
    ds_read_b128 a[84:87], v5 offset:61440
    v_mfma_f32_16x16x32_bf16 v[52:55], a[88:91], a[40:43], v[52:55]
    v_exp_f32 v49, v49
    v_mfma_f32_16x16x32_bf16 v[60:63], a[88:91], a[56:59], v[60:63]
    ds_read_b128 a[88:91], v6 offset:61440
    v_mfma_f32_16x16x32_bf16 v[52:55], a[92:95], a[44:47], v[52:55]
    v_exp_f32 v50, v50
    v_mfma_f32_16x16x32_bf16 v[60:63], a[92:95], a[60:63], v[60:63]
    ds_read_b128 a[92:95], v7 offset:61440
    s_waitcnt lgkmcnt(8)
    v_mfma_f32_16x16x32_bf16 v[128:131], a[96:99], v[64:67], v[128:131]
    v_exp_f32 v51, v51
    v_mfma_f32_16x16x32_bf16 v[160:163], a[96:99], v[68:71], v[160:163]
    v_cvt_pk_bf16_f32 v72, v48, v49
    v_cvt_pk_bf16_f32 v73, v50, v51
    v_mfma_f32_16x16x32_bf16 v[132:135], a[100:103], v[64:67], v[132:135]
    v_exp_f32 v56, v56
    v_mfma_f32_16x16x32_bf16 v[164:167], a[100:103], v[68:71], v[164:167]
    v_mfma_f32_16x16x32_bf16 v[136:139], a[104:107], v[64:67], v[136:139]
    v_exp_f32 v57, v57
    v_mfma_f32_16x16x32_bf16 v[168:171], a[104:107], v[68:71], v[168:171]
    v_cvt_pk_bf16_f32 v76, v56, v57
    v_mfma_f32_16x16x32_bf16 v[140:143], a[108:111], v[64:67], v[140:143]
    v_exp_f32 v58, v58
    v_mfma_f32_16x16x32_bf16 v[172:175], a[108:111], v[68:71], v[172:175]
    v_mfma_f32_16x16x32_bf16 v[144:147], a[112:115], v[64:67], v[144:147]
    v_exp_f32 v59, v59
    v_mfma_f32_16x16x32_bf16 v[176:179], a[112:115], v[68:71], v[176:179]
    v_cvt_pk_bf16_f32 v77, v58, v59
    v_mfma_f32_16x16x32_bf16 v[148:151], a[116:119], v[64:67], v[148:151]
    v_exp_f32 v52, v52
    v_mfma_f32_16x16x32_bf16 v[180:183], a[116:119], v[68:71], v[180:183]
    v_mfma_f32_16x16x32_bf16 v[152:155], a[120:123], v[64:67], v[152:155]
    v_exp_f32 v53, v53
    v_mfma_f32_16x16x32_bf16 v[184:187], a[120:123], v[68:71], v[184:187]
    v_mfma_f32_16x16x32_bf16 v[156:159], a[124:127], v[64:67], v[156:159]
    v_exp_f32 v54, v54
    v_mfma_f32_16x16x32_bf16 v[188:191], a[124:127], v[68:71], v[188:191]
    v_mfma_f32_16x16x32_bf16 v[96:99], v[112:115], v[64:67], v[96:99]
    v_exp_f32 v55, v55
    v_mfma_f32_16x16x32_bf16 v[100:103], v[112:115], v[68:71], v[100:103]
    s_waitcnt vmcnt(8)
    s_waitcnt vmcnt(16) lgkmcnt(0)
    s_barrier
    v_mfma_f32_16x16x32_bf16 v[32:35], a[64:67], a[0:3], v[80:83]
    v_exp_f32 v60, v60
    v_mfma_f32_16x16x32_bf16 v[40:43], a[64:67], a[16:19], v[84:87]
    v_cvt_pk_bf16_f32 v74, v52, v53
    s_add_u32 m0, s80, 114688
    v_mfma_f32_16x16x32_bf16 v[32:35], a[68:71], a[4:7], v[32:35]
    v_exp_f32 v61, v61
    v_mfma_f32_16x16x32_bf16 v[40:43], a[68:71], a[20:23], v[40:43]
    v_cvt_pk_bf16_f32 v75, v54, v55
    v_cvt_pk_bf16_f32 v78, v60, v61
    v_mfma_f32_16x16x32_bf16 v[32:35], a[72:75], a[8:11], v[32:35]
    v_exp_f32 v62, v62
    v_mfma_f32_16x16x32_bf16 v[40:43], a[72:75], a[24:27], v[40:43]
    buffer_load_dwordx4 v20, s[12:15], s25 offen nt lds
    v_mfma_f32_16x16x32_bf16 v[32:35], a[76:79], a[12:15], v[32:35]
    v_exp_f32 v63, v63
    v_mfma_f32_16x16x32_bf16 v[40:43], a[76:79], a[28:31], v[40:43]
    v_cvt_pk_bf16_f32 v79, v62, v63
    v_mfma_f32_16x16x32_bf16 v[36:39], a[80:83], a[0:3], v[80:83]
    v_mfma_f32_16x16x32_bf16 v[44:47], a[80:83], a[16:19], v[84:87]
    s_add_u32 m0, s80, 118784
    v_mfma_f32_16x16x32_bf16 v[36:39], a[84:87], a[4:7], v[36:39]
    v_exp_f32 v32, v32
    v_mfma_f32_16x16x32_bf16 v[44:47], a[84:87], a[20:23], v[44:47]
    buffer_load_dwordx4 v21, s[12:15], s25 offen nt lds
    v_mfma_f32_16x16x32_bf16 v[36:39], a[88:91], a[8:11], v[36:39]
    v_exp_f32 v33, v33
    v_mfma_f32_16x16x32_bf16 v[44:47], a[88:91], a[24:27], v[44:47]
    v_cvt_pk_bf16_f32 v64, v32, v33
    v_mfma_f32_16x16x32_bf16 v[36:39], a[92:95], a[12:15], v[36:39]
    v_exp_f32 v34, v34
    v_mfma_f32_16x16x32_bf16 v[44:47], a[92:95], a[28:31], v[44:47]
    s_add_u32 m0, s80, 122880
    v_mfma_f32_16x16x32_bf16 v[192:195], a[96:99], v[72:75], v[192:195]
    v_exp_f32 v35, v35
    v_mfma_f32_16x16x32_bf16 v[224:227], a[96:99], v[76:79], v[224:227]
    ds_read_b64_tr_b16 a[96:97], v8 offset:0
    ds_read_b64_tr_b16 a[98:99], v8 offset:4096
    v_mfma_f32_16x16x32_bf16 v[196:199], a[100:103], v[72:75], v[196:199]
    v_exp_f32 v40, v40
    v_mfma_f32_16x16x32_bf16 v[228:231], a[100:103], v[76:79], v[228:231]
    ds_read_b64_tr_b16 a[100:101], v9 offset:0
    ds_read_b64_tr_b16 a[102:103], v9 offset:4096
    v_mfma_f32_16x16x32_bf16 v[200:203], a[104:107], v[72:75], v[200:203]
    v_exp_f32 v41, v41
    v_mfma_f32_16x16x32_bf16 v[232:235], a[104:107], v[76:79], v[232:235]
    ds_read_b64_tr_b16 a[104:105], v10 offset:0
    ds_read_b64_tr_b16 a[106:107], v10 offset:4096
    v_mfma_f32_16x16x32_bf16 v[204:207], a[108:111], v[72:75], v[204:207]
    v_exp_f32 v42, v42
    v_mfma_f32_16x16x32_bf16 v[236:239], a[108:111], v[76:79], v[236:239]
    ds_read_b64_tr_b16 a[108:109], v11 offset:0
    ds_read_b64_tr_b16 a[110:111], v11 offset:4096
    v_mfma_f32_16x16x32_bf16 v[208:211], a[112:115], v[72:75], v[208:211]
    v_exp_f32 v43, v43
    v_mfma_f32_16x16x32_bf16 v[240:243], a[112:115], v[76:79], v[240:243]
    ds_read_b64_tr_b16 a[112:113], v12 offset:0
    ds_read_b64_tr_b16 a[114:115], v12 offset:4096
    v_mfma_f32_16x16x32_bf16 v[212:215], a[116:119], v[72:75], v[212:215]
    v_exp_f32 v36, v36
    v_mfma_f32_16x16x32_bf16 v[244:247], a[116:119], v[76:79], v[244:247]
    ds_read_b64_tr_b16 a[116:117], v13 offset:0
    ds_read_b64_tr_b16 a[118:119], v13 offset:4096
    v_mfma_f32_16x16x32_bf16 v[216:219], a[120:123], v[72:75], v[216:219]
    v_exp_f32 v37, v37
    v_mfma_f32_16x16x32_bf16 v[248:251], a[120:123], v[76:79], v[248:251]
    ds_read_b64_tr_b16 a[120:121], v14 offset:0
    ds_read_b64_tr_b16 a[122:123], v14 offset:4096
    v_mfma_f32_16x16x32_bf16 v[220:223], a[124:127], v[72:75], v[220:223]
    v_exp_f32 v38, v38
    v_mfma_f32_16x16x32_bf16 v[252:255], a[124:127], v[76:79], v[252:255]
    ds_read_b64_tr_b16 a[124:125], v15 offset:0
    ds_read_b64_tr_b16 a[126:127], v15 offset:4096
    v_mfma_f32_16x16x32_bf16 v[104:107], v[112:115], v[72:75], v[104:107]
    v_exp_f32 v39, v39
    v_mfma_f32_16x16x32_bf16 v[108:111], v[112:115], v[76:79], v[108:111]
    v_cvt_pk_bf16_f32 v65, v34, v35
    v_cvt_pk_bf16_f32 v68, v40, v41
    v_mfma_f32_16x16x32_bf16 v[48:51], a[64:67], a[32:35], v[88:91]
    v_exp_f32 v44, v44
    v_mfma_f32_16x16x32_bf16 v[56:59], a[64:67], a[48:51], v[92:95]
    ds_read_b128 a[64:67], v4 offset:0
    v_cvt_pk_bf16_f32 v69, v42, v43
    v_mfma_f32_16x16x32_bf16 v[48:51], a[68:71], a[36:39], v[48:51]
    v_exp_f32 v45, v45
    v_mfma_f32_16x16x32_bf16 v[56:59], a[68:71], a[52:55], v[56:59]
    ds_read_b128 a[68:71], v5 offset:0
    v_cvt_pk_bf16_f32 v66, v36, v37
    v_mfma_f32_16x16x32_bf16 v[48:51], a[72:75], a[40:43], v[48:51]
    v_exp_f32 v46, v46
    v_mfma_f32_16x16x32_bf16 v[56:59], a[72:75], a[56:59], v[56:59]
    ds_read_b128 a[72:75], v6 offset:0
    v_cvt_pk_bf16_f32 v67, v38, v39
    v_mfma_f32_16x16x32_bf16 v[48:51], a[76:79], a[44:47], v[48:51]
    v_exp_f32 v47, v47
    v_mfma_f32_16x16x32_bf16 v[56:59], a[76:79], a[60:63], v[56:59]
    ds_read_b128 a[76:79], v7 offset:0
    v_cvt_pk_bf16_f32 v70, v44, v45
    v_mfma_f32_16x16x32_bf16 v[52:55], a[80:83], a[32:35], v[88:91]
    buffer_load_dwordx4 v20, s[12:15], s81 offen nt lds
    v_mfma_f32_16x16x32_bf16 v[60:63], a[80:83], a[48:51], v[92:95]
    ds_read_b128 a[80:83], v4 offset:4096
    v_cvt_pk_bf16_f32 v71, v46, v47
    v_mfma_f32_16x16x32_bf16 v[52:55], a[84:87], a[36:39], v[52:55]
    v_exp_f32 v48, v48
    v_mfma_f32_16x16x32_bf16 v[60:63], a[84:87], a[52:55], v[60:63]
    ds_read_b128 a[84:87], v5 offset:4096
    s_add_u32 m0, s80, 126976
    v_mfma_f32_16x16x32_bf16 v[52:55], a[88:91], a[40:43], v[52:55]
    v_exp_f32 v49, v49
    v_mfma_f32_16x16x32_bf16 v[60:63], a[88:91], a[56:59], v[60:63]
    ds_read_b128 a[88:91], v6 offset:4096
    buffer_load_dwordx4 v21, s[12:15], s81 offen nt lds
    v_mfma_f32_16x16x32_bf16 v[52:55], a[92:95], a[44:47], v[52:55]
    v_exp_f32 v50, v50
    v_mfma_f32_16x16x32_bf16 v[60:63], a[92:95], a[60:63], v[60:63]
    ds_read_b128 a[92:95], v7 offset:4096
    s_waitcnt lgkmcnt(8)
    v_mfma_f32_16x16x32_bf16 v[128:131], a[96:99], v[64:67], v[128:131]
    v_exp_f32 v51, v51
    v_mfma_f32_16x16x32_bf16 v[160:163], a[96:99], v[68:71], v[160:163]
    v_cvt_pk_bf16_f32 v72, v48, v49
    v_cvt_pk_bf16_f32 v73, v50, v51
    v_mfma_f32_16x16x32_bf16 v[132:135], a[100:103], v[64:67], v[132:135]
    v_exp_f32 v56, v56
    v_mfma_f32_16x16x32_bf16 v[164:167], a[100:103], v[68:71], v[164:167]
    s_add_u32 s25, s25, 16384
    s_add_u32 s81, s81, 16384
    v_mfma_f32_16x16x32_bf16 v[136:139], a[104:107], v[64:67], v[136:139]
    v_exp_f32 v57, v57
    v_mfma_f32_16x16x32_bf16 v[168:171], a[104:107], v[68:71], v[168:171]
    v_cvt_pk_bf16_f32 v76, v56, v57
    s_add_u32 m0, s80, 49152
    v_mfma_f32_16x16x32_bf16 v[140:143], a[108:111], v[64:67], v[140:143]
    v_exp_f32 v58, v58
    v_mfma_f32_16x16x32_bf16 v[172:175], a[108:111], v[68:71], v[172:175]
    buffer_load_dwordx4 v16, s[8:11], s26 offen nt lds
    v_mfma_f32_16x16x32_bf16 v[144:147], a[112:115], v[64:67], v[144:147]
    v_exp_f32 v59, v59
    v_mfma_f32_16x16x32_bf16 v[176:179], a[112:115], v[68:71], v[176:179]
    v_cvt_pk_bf16_f32 v77, v58, v59
    v_mfma_f32_16x16x32_bf16 v[148:151], a[116:119], v[64:67], v[148:151]
    v_exp_f32 v52, v52
    v_mfma_f32_16x16x32_bf16 v[180:183], a[116:119], v[68:71], v[180:183]
    s_add_u32 m0, s80, 53248
    v_mfma_f32_16x16x32_bf16 v[152:155], a[120:123], v[64:67], v[152:155]
    v_exp_f32 v53, v53
    v_mfma_f32_16x16x32_bf16 v[184:187], a[120:123], v[68:71], v[184:187]
    buffer_load_dwordx4 v17, s[8:11], s26 offen nt lds
    v_mfma_f32_16x16x32_bf16 v[156:159], a[124:127], v[64:67], v[156:159]
    v_exp_f32 v54, v54
    v_mfma_f32_16x16x32_bf16 v[188:191], a[124:127], v[68:71], v[188:191]
    v_mfma_f32_16x16x32_bf16 v[96:99], v[112:115], v[64:67], v[96:99]
    v_exp_f32 v55, v55
    v_mfma_f32_16x16x32_bf16 v[100:103], v[112:115], v[68:71], v[100:103]
    s_waitcnt lgkmcnt(0)
    v_mfma_f32_16x16x32_bf16 v[32:35], a[64:67], a[0:3], v[80:83]
    v_exp_f32 v60, v60
    v_mfma_f32_16x16x32_bf16 v[40:43], a[64:67], a[16:19], v[84:87]
    v_cvt_pk_bf16_f32 v74, v52, v53
    s_add_u32 m0, s80, 57344
    v_mfma_f32_16x16x32_bf16 v[32:35], a[68:71], a[4:7], v[32:35]
    v_exp_f32 v61, v61
    v_mfma_f32_16x16x32_bf16 v[40:43], a[68:71], a[20:23], v[40:43]
    v_cvt_pk_bf16_f32 v75, v54, v55
    v_cvt_pk_bf16_f32 v78, v60, v61
    v_mfma_f32_16x16x32_bf16 v[32:35], a[72:75], a[8:11], v[32:35]
    v_exp_f32 v62, v62
    v_mfma_f32_16x16x32_bf16 v[40:43], a[72:75], a[24:27], v[40:43]
    buffer_load_dwordx4 v16, s[8:11], s82 offen nt lds
    v_mfma_f32_16x16x32_bf16 v[32:35], a[76:79], a[12:15], v[32:35]
    v_exp_f32 v63, v63
    v_mfma_f32_16x16x32_bf16 v[40:43], a[76:79], a[28:31], v[40:43]
    v_cvt_pk_bf16_f32 v79, v62, v63
    v_mfma_f32_16x16x32_bf16 v[36:39], a[80:83], a[0:3], v[80:83]
    v_mfma_f32_16x16x32_bf16 v[44:47], a[80:83], a[16:19], v[84:87]
    s_add_u32 m0, s80, 61440
    v_mfma_f32_16x16x32_bf16 v[36:39], a[84:87], a[4:7], v[36:39]
    v_exp_f32 v32, v32
    v_mfma_f32_16x16x32_bf16 v[44:47], a[84:87], a[20:23], v[44:47]
    buffer_load_dwordx4 v17, s[8:11], s82 offen nt lds
    v_mfma_f32_16x16x32_bf16 v[36:39], a[88:91], a[8:11], v[36:39]
    v_exp_f32 v33, v33
    v_mfma_f32_16x16x32_bf16 v[44:47], a[88:91], a[24:27], v[44:47]
    v_cvt_pk_bf16_f32 v64, v32, v33
    s_add_u32 s26, s26, 16384
    v_mfma_f32_16x16x32_bf16 v[36:39], a[92:95], a[12:15], v[36:39]
    v_exp_f32 v34, v34
    v_mfma_f32_16x16x32_bf16 v[44:47], a[92:95], a[28:31], v[44:47]
    s_add_u32 s82, s82, 16384
    v_mfma_f32_16x16x32_bf16 v[192:195], a[96:99], v[72:75], v[192:195]
    v_exp_f32 v35, v35
    v_mfma_f32_16x16x32_bf16 v[224:227], a[96:99], v[76:79], v[224:227]
    ds_read_b64_tr_b16 a[96:97], v8 offset:8192
    ds_read_b64_tr_b16 a[98:99], v8 offset:12288
    v_mfma_f32_16x16x32_bf16 v[196:199], a[100:103], v[72:75], v[196:199]
    v_exp_f32 v40, v40
    v_mfma_f32_16x16x32_bf16 v[228:231], a[100:103], v[76:79], v[228:231]
    ds_read_b64_tr_b16 a[100:101], v9 offset:8192
    ds_read_b64_tr_b16 a[102:103], v9 offset:12288
    v_mfma_f32_16x16x32_bf16 v[200:203], a[104:107], v[72:75], v[200:203]
    v_exp_f32 v41, v41
    v_mfma_f32_16x16x32_bf16 v[232:235], a[104:107], v[76:79], v[232:235]
    ds_read_b64_tr_b16 a[104:105], v10 offset:8192
    ds_read_b64_tr_b16 a[106:107], v10 offset:12288
    v_mfma_f32_16x16x32_bf16 v[204:207], a[108:111], v[72:75], v[204:207]
    v_exp_f32 v42, v42
    v_mfma_f32_16x16x32_bf16 v[236:239], a[108:111], v[76:79], v[236:239]
    ds_read_b64_tr_b16 a[108:109], v11 offset:8192
    ds_read_b64_tr_b16 a[110:111], v11 offset:12288
    v_mfma_f32_16x16x32_bf16 v[208:211], a[112:115], v[72:75], v[208:211]
    v_exp_f32 v43, v43
    v_mfma_f32_16x16x32_bf16 v[240:243], a[112:115], v[76:79], v[240:243]
    ds_read_b64_tr_b16 a[112:113], v12 offset:8192
    ds_read_b64_tr_b16 a[114:115], v12 offset:12288
    v_mfma_f32_16x16x32_bf16 v[212:215], a[116:119], v[72:75], v[212:215]
    v_exp_f32 v36, v36
    v_mfma_f32_16x16x32_bf16 v[244:247], a[116:119], v[76:79], v[244:247]
    ds_read_b64_tr_b16 a[116:117], v13 offset:8192
    ds_read_b64_tr_b16 a[118:119], v13 offset:12288
    v_mfma_f32_16x16x32_bf16 v[216:219], a[120:123], v[72:75], v[216:219]
    v_exp_f32 v37, v37
    v_mfma_f32_16x16x32_bf16 v[248:251], a[120:123], v[76:79], v[248:251]
    ds_read_b64_tr_b16 a[120:121], v14 offset:8192
    ds_read_b64_tr_b16 a[122:123], v14 offset:12288
    v_mfma_f32_16x16x32_bf16 v[220:223], a[124:127], v[72:75], v[220:223]
    v_exp_f32 v38, v38
    v_mfma_f32_16x16x32_bf16 v[252:255], a[124:127], v[76:79], v[252:255]
    ds_read_b64_tr_b16 a[124:125], v15 offset:8192
    ds_read_b64_tr_b16 a[126:127], v15 offset:12288
    v_mfma_f32_16x16x32_bf16 v[104:107], v[112:115], v[72:75], v[104:107]
    v_exp_f32 v39, v39
    v_mfma_f32_16x16x32_bf16 v[108:111], v[112:115], v[76:79], v[108:111]
    v_cvt_pk_bf16_f32 v65, v34, v35
    v_cvt_pk_bf16_f32 v68, v40, v41
    v_mfma_f32_16x16x32_bf16 v[48:51], a[64:67], a[32:35], v[88:91]
    v_exp_f32 v44, v44
    v_mfma_f32_16x16x32_bf16 v[56:59], a[64:67], a[48:51], v[92:95]
    ds_read_b128 a[64:67], v4 offset:8192
    v_cvt_pk_bf16_f32 v69, v42, v43
    v_mfma_f32_16x16x32_bf16 v[48:51], a[68:71], a[36:39], v[48:51]
    v_exp_f32 v45, v45
    v_mfma_f32_16x16x32_bf16 v[56:59], a[68:71], a[52:55], v[56:59]
    ds_read_b128 a[68:71], v5 offset:8192
    v_cvt_pk_bf16_f32 v66, v36, v37
    v_mfma_f32_16x16x32_bf16 v[48:51], a[72:75], a[40:43], v[48:51]
    v_exp_f32 v46, v46
    v_mfma_f32_16x16x32_bf16 v[56:59], a[72:75], a[56:59], v[56:59]
    ds_read_b128 a[72:75], v6 offset:8192
    v_cvt_pk_bf16_f32 v67, v38, v39
    v_mfma_f32_16x16x32_bf16 v[48:51], a[76:79], a[44:47], v[48:51]
    v_exp_f32 v47, v47
    v_mfma_f32_16x16x32_bf16 v[56:59], a[76:79], a[60:63], v[56:59]
    ds_read_b128 a[76:79], v7 offset:8192
    v_cvt_pk_bf16_f32 v70, v44, v45
    v_mfma_f32_16x16x32_bf16 v[52:55], a[80:83], a[32:35], v[88:91]
    v_mfma_f32_16x16x32_bf16 v[60:63], a[80:83], a[48:51], v[92:95]
    ds_read_b128 a[80:83], v4 offset:12288
    v_cvt_pk_bf16_f32 v71, v46, v47
    v_mfma_f32_16x16x32_bf16 v[52:55], a[84:87], a[36:39], v[52:55]
    v_exp_f32 v48, v48
    v_mfma_f32_16x16x32_bf16 v[60:63], a[84:87], a[52:55], v[60:63]
    ds_read_b128 a[84:87], v5 offset:12288
    v_mfma_f32_16x16x32_bf16 v[52:55], a[88:91], a[40:43], v[52:55]
    v_exp_f32 v49, v49
    v_mfma_f32_16x16x32_bf16 v[60:63], a[88:91], a[56:59], v[60:63]
    ds_read_b128 a[88:91], v6 offset:12288
    v_mfma_f32_16x16x32_bf16 v[52:55], a[92:95], a[44:47], v[52:55]
    v_exp_f32 v50, v50
    v_mfma_f32_16x16x32_bf16 v[60:63], a[92:95], a[60:63], v[60:63]
    ds_read_b128 a[92:95], v7 offset:12288
    s_waitcnt lgkmcnt(8)
    v_mfma_f32_16x16x32_bf16 v[128:131], a[96:99], v[64:67], v[128:131]
    v_exp_f32 v51, v51
    v_mfma_f32_16x16x32_bf16 v[160:163], a[96:99], v[68:71], v[160:163]
    v_cvt_pk_bf16_f32 v72, v48, v49
    v_cvt_pk_bf16_f32 v73, v50, v51
    v_mfma_f32_16x16x32_bf16 v[132:135], a[100:103], v[64:67], v[132:135]
    v_exp_f32 v56, v56
    v_mfma_f32_16x16x32_bf16 v[164:167], a[100:103], v[68:71], v[164:167]
    v_mfma_f32_16x16x32_bf16 v[136:139], a[104:107], v[64:67], v[136:139]
    v_exp_f32 v57, v57
    v_mfma_f32_16x16x32_bf16 v[168:171], a[104:107], v[68:71], v[168:171]
    v_cvt_pk_bf16_f32 v76, v56, v57
    v_mfma_f32_16x16x32_bf16 v[140:143], a[108:111], v[64:67], v[140:143]
    v_exp_f32 v58, v58
    v_mfma_f32_16x16x32_bf16 v[172:175], a[108:111], v[68:71], v[172:175]
    v_mfma_f32_16x16x32_bf16 v[144:147], a[112:115], v[64:67], v[144:147]
    v_exp_f32 v59, v59
    v_mfma_f32_16x16x32_bf16 v[176:179], a[112:115], v[68:71], v[176:179]
    v_cvt_pk_bf16_f32 v77, v58, v59
    v_mfma_f32_16x16x32_bf16 v[148:151], a[116:119], v[64:67], v[148:151]
    v_exp_f32 v52, v52
    v_mfma_f32_16x16x32_bf16 v[180:183], a[116:119], v[68:71], v[180:183]
    v_mfma_f32_16x16x32_bf16 v[152:155], a[120:123], v[64:67], v[152:155]
    v_exp_f32 v53, v53
    v_mfma_f32_16x16x32_bf16 v[184:187], a[120:123], v[68:71], v[184:187]
    v_mfma_f32_16x16x32_bf16 v[156:159], a[124:127], v[64:67], v[156:159]
    v_exp_f32 v54, v54
    v_mfma_f32_16x16x32_bf16 v[188:191], a[124:127], v[68:71], v[188:191]
    v_mfma_f32_16x16x32_bf16 v[96:99], v[112:115], v[64:67], v[96:99]
    v_exp_f32 v55, v55
    v_mfma_f32_16x16x32_bf16 v[100:103], v[112:115], v[68:71], v[100:103]
    s_cmp_eq_u32 s24, 0
    s_cbranch_scc0 L_nf1
    v_mov_b32 v24, 155632
    ds_read_b128 v[24:27], v24
    s_waitcnt lgkmcnt(0)
    v_or_b32 v24, v24, v25
    v_or_b32 v26, v26, v27
    v_or_b32 v24, v24, v26
    s_nop 0
    v_readfirstlane_b32 s3, v24
    s_nop 3
    s_andn2_b32 s3, s3, s87
    s_cbranch_scc1 L_nf1
    s_lshl_b32 s3, s75, 4
    s_and_b32 s86, s76, 8
    s_add_u32 s3, s3, s86
    s_and_b32 s86, s76, 7
    s_add_u32 s3, s3, s86
    v_mov_b32 v23, s3
    v_mov_b32 v25, 1
    global_store_byte v23, v25, s[94:95] sc1
L_nf1:
    s_waitcnt vmcnt(16) lgkmcnt(0)
    s_barrier
    v_mfma_f32_16x16x32_bf16 v[32:35], a[64:67], a[0:3], v[80:83]
    v_exp_f32 v60, v60
    v_mfma_f32_16x16x32_bf16 v[40:43], a[64:67], a[16:19], v[84:87]
    v_cvt_pk_bf16_f32 v74, v52, v53
    s_add_u32 m0, s80, 65536
    v_mfma_f32_16x16x32_bf16 v[32:35], a[68:71], a[4:7], v[32:35]
    v_exp_f32 v61, v61
    v_mfma_f32_16x16x32_bf16 v[40:43], a[68:71], a[20:23], v[40:43]
    v_cvt_pk_bf16_f32 v75, v54, v55
    v_cvt_pk_bf16_f32 v78, v60, v61
    v_mfma_f32_16x16x32_bf16 v[32:35], a[72:75], a[8:11], v[32:35]
    v_exp_f32 v62, v62
    v_mfma_f32_16x16x32_bf16 v[40:43], a[72:75], a[24:27], v[40:43]
    buffer_load_dwordx4 v20, s[12:15], s25 offen nt lds
    v_mfma_f32_16x16x32_bf16 v[32:35], a[76:79], a[12:15], v[32:35]
    v_exp_f32 v63, v63
    v_mfma_f32_16x16x32_bf16 v[40:43], a[76:79], a[28:31], v[40:43]
    v_cvt_pk_bf16_f32 v79, v62, v63
    v_mfma_f32_16x16x32_bf16 v[36:39], a[80:83], a[0:3], v[80:83]
    v_mfma_f32_16x16x32_bf16 v[44:47], a[80:83], a[16:19], v[84:87]
    s_add_u32 m0, s80, 69632
    v_mfma_f32_16x16x32_bf16 v[36:39], a[84:87], a[4:7], v[36:39]
    v_exp_f32 v32, v32
    v_mfma_f32_16x16x32_bf16 v[44:47], a[84:87], a[20:23], v[44:47]
    buffer_load_dwordx4 v21, s[12:15], s25 offen nt lds
    v_mfma_f32_16x16x32_bf16 v[36:39], a[88:91], a[8:11], v[36:39]
    v_exp_f32 v33, v33
    v_mfma_f32_16x16x32_bf16 v[44:47], a[88:91], a[24:27], v[44:47]
    v_cvt_pk_bf16_f32 v64, v32, v33
    v_mfma_f32_16x16x32_bf16 v[36:39], a[92:95], a[12:15], v[36:39]
    v_exp_f32 v34, v34
    v_mfma_f32_16x16x32_bf16 v[44:47], a[92:95], a[28:31], v[44:47]
    s_add_u32 m0, s80, 73728
    v_mfma_f32_16x16x32_bf16 v[192:195], a[96:99], v[72:75], v[192:195]
    v_exp_f32 v35, v35
    v_mfma_f32_16x16x32_bf16 v[224:227], a[96:99], v[76:79], v[224:227]
    ds_read_b64_tr_b16 a[96:97], v8 offset:16384
    ds_read_b64_tr_b16 a[98:99], v8 offset:20480
    v_mfma_f32_16x16x32_bf16 v[196:199], a[100:103], v[72:75], v[196:199]
    v_exp_f32 v40, v40
    v_mfma_f32_16x16x32_bf16 v[228:231], a[100:103], v[76:79], v[228:231]
    ds_read_b64_tr_b16 a[100:101], v9 offset:16384
    ds_read_b64_tr_b16 a[102:103], v9 offset:20480
    v_mfma_f32_16x16x32_bf16 v[200:203], a[104:107], v[72:75], v[200:203]
    v_exp_f32 v41, v41
    v_mfma_f32_16x16x32_bf16 v[232:235], a[104:107], v[76:79], v[232:235]
    ds_read_b64_tr_b16 a[104:105], v10 offset:16384
    ds_read_b64_tr_b16 a[106:107], v10 offset:20480
    v_mfma_f32_16x16x32_bf16 v[204:207], a[108:111], v[72:75], v[204:207]
    v_exp_f32 v42, v42
    v_mfma_f32_16x16x32_bf16 v[236:239], a[108:111], v[76:79], v[236:239]
    ds_read_b64_tr_b16 a[108:109], v11 offset:16384
    ds_read_b64_tr_b16 a[110:111], v11 offset:20480
    v_mfma_f32_16x16x32_bf16 v[208:211], a[112:115], v[72:75], v[208:211]
    v_exp_f32 v43, v43
    v_mfma_f32_16x16x32_bf16 v[240:243], a[112:115], v[76:79], v[240:243]
    ds_read_b64_tr_b16 a[112:113], v12 offset:16384
    ds_read_b64_tr_b16 a[114:115], v12 offset:20480
    v_mfma_f32_16x16x32_bf16 v[212:215], a[116:119], v[72:75], v[212:215]
    v_exp_f32 v36, v36
    v_mfma_f32_16x16x32_bf16 v[244:247], a[116:119], v[76:79], v[244:247]
    ds_read_b64_tr_b16 a[116:117], v13 offset:16384
    ds_read_b64_tr_b16 a[118:119], v13 offset:20480
    v_mfma_f32_16x16x32_bf16 v[216:219], a[120:123], v[72:75], v[216:219]
    v_exp_f32 v37, v37
    v_mfma_f32_16x16x32_bf16 v[248:251], a[120:123], v[76:79], v[248:251]
    ds_read_b64_tr_b16 a[120:121], v14 offset:16384
    ds_read_b64_tr_b16 a[122:123], v14 offset:20480
    v_mfma_f32_16x16x32_bf16 v[220:223], a[124:127], v[72:75], v[220:223]
    v_exp_f32 v38, v38
    v_mfma_f32_16x16x32_bf16 v[252:255], a[124:127], v[76:79], v[252:255]
    ds_read_b64_tr_b16 a[124:125], v15 offset:16384
    ds_read_b64_tr_b16 a[126:127], v15 offset:20480
    v_mfma_f32_16x16x32_bf16 v[104:107], v[112:115], v[72:75], v[104:107]
    v_exp_f32 v39, v39
    v_mfma_f32_16x16x32_bf16 v[108:111], v[112:115], v[76:79], v[108:111]
    v_cvt_pk_bf16_f32 v65, v34, v35
    v_cvt_pk_bf16_f32 v68, v40, v41
    v_mfma_f32_16x16x32_bf16 v[48:51], a[64:67], a[32:35], v[88:91]
    v_exp_f32 v44, v44
    v_mfma_f32_16x16x32_bf16 v[56:59], a[64:67], a[48:51], v[92:95]
    ds_read_b128 a[64:67], v4 offset:16384
    v_cvt_pk_bf16_f32 v69, v42, v43
    v_mfma_f32_16x16x32_bf16 v[48:51], a[68:71], a[36:39], v[48:51]
    v_exp_f32 v45, v45
    v_mfma_f32_16x16x32_bf16 v[56:59], a[68:71], a[52:55], v[56:59]
    ds_read_b128 a[68:71], v5 offset:16384
    v_cvt_pk_bf16_f32 v66, v36, v37
    v_mfma_f32_16x16x32_bf16 v[48:51], a[72:75], a[40:43], v[48:51]
    v_exp_f32 v46, v46
    v_mfma_f32_16x16x32_bf16 v[56:59], a[72:75], a[56:59], v[56:59]
    ds_read_b128 a[72:75], v6 offset:16384
    v_cvt_pk_bf16_f32 v67, v38, v39
    v_mfma_f32_16x16x32_bf16 v[48:51], a[76:79], a[44:47], v[48:51]
    v_exp_f32 v47, v47
    v_mfma_f32_16x16x32_bf16 v[56:59], a[76:79], a[60:63], v[56:59]
    ds_read_b128 a[76:79], v7 offset:16384
    v_cvt_pk_bf16_f32 v70, v44, v45
    v_mfma_f32_16x16x32_bf16 v[52:55], a[80:83], a[32:35], v[88:91]
    buffer_load_dwordx4 v20, s[12:15], s81 offen nt lds
    v_mfma_f32_16x16x32_bf16 v[60:63], a[80:83], a[48:51], v[92:95]
    ds_read_b128 a[80:83], v4 offset:20480
    v_cvt_pk_bf16_f32 v71, v46, v47
    v_mfma_f32_16x16x32_bf16 v[52:55], a[84:87], a[36:39], v[52:55]
    v_exp_f32 v48, v48
    v_mfma_f32_16x16x32_bf16 v[60:63], a[84:87], a[52:55], v[60:63]
    ds_read_b128 a[84:87], v5 offset:20480
    s_add_u32 m0, s80, 77824
    v_mfma_f32_16x16x32_bf16 v[52:55], a[88:91], a[40:43], v[52:55]
    v_exp_f32 v49, v49
    v_mfma_f32_16x16x32_bf16 v[60:63], a[88:91], a[56:59], v[60:63]
    ds_read_b128 a[88:91], v6 offset:20480
    buffer_load_dwordx4 v21, s[12:15], s81 offen nt lds
    v_mfma_f32_16x16x32_bf16 v[52:55], a[92:95], a[44:47], v[52:55]
    v_exp_f32 v50, v50
    v_mfma_f32_16x16x32_bf16 v[60:63], a[92:95], a[60:63], v[60:63]
    ds_read_b128 a[92:95], v7 offset:20480
    s_waitcnt lgkmcnt(8)
    v_mfma_f32_16x16x32_bf16 v[128:131], a[96:99], v[64:67], v[128:131]
    v_exp_f32 v51, v51
    v_mfma_f32_16x16x32_bf16 v[160:163], a[96:99], v[68:71], v[160:163]
    v_cvt_pk_bf16_f32 v72, v48, v49
    v_cvt_pk_bf16_f32 v73, v50, v51
    v_mfma_f32_16x16x32_bf16 v[132:135], a[100:103], v[64:67], v[132:135]
    v_exp_f32 v56, v56
    v_mfma_f32_16x16x32_bf16 v[164:167], a[100:103], v[68:71], v[164:167]
    s_add_u32 s25, s25, 16384
    s_add_u32 s81, s81, 16384
    v_mfma_f32_16x16x32_bf16 v[136:139], a[104:107], v[64:67], v[136:139]
    v_exp_f32 v57, v57
    v_mfma_f32_16x16x32_bf16 v[168:171], a[104:107], v[68:71], v[168:171]
    v_cvt_pk_bf16_f32 v76, v56, v57
    s_add_u32 m0, s80, 0
    v_mfma_f32_16x16x32_bf16 v[140:143], a[108:111], v[64:67], v[140:143]
    v_exp_f32 v58, v58
    v_mfma_f32_16x16x32_bf16 v[172:175], a[108:111], v[68:71], v[172:175]
    buffer_load_dwordx4 v16, s[8:11], s26 offen nt lds
    v_mfma_f32_16x16x32_bf16 v[144:147], a[112:115], v[64:67], v[144:147]
    v_exp_f32 v59, v59
    v_mfma_f32_16x16x32_bf16 v[176:179], a[112:115], v[68:71], v[176:179]
    v_cvt_pk_bf16_f32 v77, v58, v59
    v_mfma_f32_16x16x32_bf16 v[148:151], a[116:119], v[64:67], v[148:151]
    v_exp_f32 v52, v52
    v_mfma_f32_16x16x32_bf16 v[180:183], a[116:119], v[68:71], v[180:183]
    s_add_u32 m0, s80, 4096
    v_mfma_f32_16x16x32_bf16 v[152:155], a[120:123], v[64:67], v[152:155]
    v_exp_f32 v53, v53
    v_mfma_f32_16x16x32_bf16 v[184:187], a[120:123], v[68:71], v[184:187]
    buffer_load_dwordx4 v17, s[8:11], s26 offen nt lds
    v_mfma_f32_16x16x32_bf16 v[156:159], a[124:127], v[64:67], v[156:159]
    v_exp_f32 v54, v54
    v_mfma_f32_16x16x32_bf16 v[188:191], a[124:127], v[68:71], v[188:191]
    v_mfma_f32_16x16x32_bf16 v[96:99], v[112:115], v[64:67], v[96:99]
    v_exp_f32 v55, v55
    v_mfma_f32_16x16x32_bf16 v[100:103], v[112:115], v[68:71], v[100:103]
    s_waitcnt lgkmcnt(0)
    v_mfma_f32_16x16x32_bf16 v[32:35], a[64:67], a[0:3], v[80:83]
    v_exp_f32 v60, v60
    v_mfma_f32_16x16x32_bf16 v[40:43], a[64:67], a[16:19], v[84:87]
    v_cvt_pk_bf16_f32 v74, v52, v53
    s_add_u32 m0, s80, 8192
    v_mfma_f32_16x16x32_bf16 v[32:35], a[68:71], a[4:7], v[32:35]
    v_exp_f32 v61, v61
    v_mfma_f32_16x16x32_bf16 v[40:43], a[68:71], a[20:23], v[40:43]
    v_cvt_pk_bf16_f32 v75, v54, v55
    v_cvt_pk_bf16_f32 v78, v60, v61
    v_mfma_f32_16x16x32_bf16 v[32:35], a[72:75], a[8:11], v[32:35]
    v_exp_f32 v62, v62
    v_mfma_f32_16x16x32_bf16 v[40:43], a[72:75], a[24:27], v[40:43]
    buffer_load_dwordx4 v16, s[8:11], s82 offen nt lds
    v_mfma_f32_16x16x32_bf16 v[32:35], a[76:79], a[12:15], v[32:35]
    v_exp_f32 v63, v63
    v_mfma_f32_16x16x32_bf16 v[40:43], a[76:79], a[28:31], v[40:43]
    v_cvt_pk_bf16_f32 v79, v62, v63
    v_mfma_f32_16x16x32_bf16 v[36:39], a[80:83], a[0:3], v[80:83]
    v_mfma_f32_16x16x32_bf16 v[44:47], a[80:83], a[16:19], v[84:87]
    s_add_u32 m0, s80, 12288
    v_mfma_f32_16x16x32_bf16 v[36:39], a[84:87], a[4:7], v[36:39]
    v_exp_f32 v32, v32
    v_mfma_f32_16x16x32_bf16 v[44:47], a[84:87], a[20:23], v[44:47]
    buffer_load_dwordx4 v17, s[8:11], s82 offen nt lds
    v_mfma_f32_16x16x32_bf16 v[36:39], a[88:91], a[8:11], v[36:39]
    v_exp_f32 v33, v33
    v_mfma_f32_16x16x32_bf16 v[44:47], a[88:91], a[24:27], v[44:47]
    v_cvt_pk_bf16_f32 v64, v32, v33
    s_add_u32 s26, s26, 16384
    v_mfma_f32_16x16x32_bf16 v[36:39], a[92:95], a[12:15], v[36:39]
    v_exp_f32 v34, v34
    v_mfma_f32_16x16x32_bf16 v[44:47], a[92:95], a[28:31], v[44:47]
    s_add_u32 s82, s82, 16384
    v_mfma_f32_16x16x32_bf16 v[192:195], a[96:99], v[72:75], v[192:195]
    v_exp_f32 v35, v35
    v_mfma_f32_16x16x32_bf16 v[224:227], a[96:99], v[76:79], v[224:227]
    ds_read_b64_tr_b16 a[96:97], v8 offset:24576
    ds_read_b64_tr_b16 a[98:99], v8 offset:28672
    v_mfma_f32_16x16x32_bf16 v[196:199], a[100:103], v[72:75], v[196:199]
    v_exp_f32 v40, v40
    v_mfma_f32_16x16x32_bf16 v[228:231], a[100:103], v[76:79], v[228:231]
    ds_read_b64_tr_b16 a[100:101], v9 offset:24576
    ds_read_b64_tr_b16 a[102:103], v9 offset:28672
    v_mfma_f32_16x16x32_bf16 v[200:203], a[104:107], v[72:75], v[200:203]
    v_exp_f32 v41, v41
    v_mfma_f32_16x16x32_bf16 v[232:235], a[104:107], v[76:79], v[232:235]
    ds_read_b64_tr_b16 a[104:105], v10 offset:24576
    ds_read_b64_tr_b16 a[106:107], v10 offset:28672
    v_mfma_f32_16x16x32_bf16 v[204:207], a[108:111], v[72:75], v[204:207]
    v_exp_f32 v42, v42
    v_mfma_f32_16x16x32_bf16 v[236:239], a[108:111], v[76:79], v[236:239]
    ds_read_b64_tr_b16 a[108:109], v11 offset:24576
    ds_read_b64_tr_b16 a[110:111], v11 offset:28672
    v_mfma_f32_16x16x32_bf16 v[208:211], a[112:115], v[72:75], v[208:211]
    v_exp_f32 v43, v43
    v_mfma_f32_16x16x32_bf16 v[240:243], a[112:115], v[76:79], v[240:243]
    ds_read_b64_tr_b16 a[112:113], v12 offset:24576
    ds_read_b64_tr_b16 a[114:115], v12 offset:28672
    v_mfma_f32_16x16x32_bf16 v[212:215], a[116:119], v[72:75], v[212:215]
    v_exp_f32 v36, v36
    v_mfma_f32_16x16x32_bf16 v[244:247], a[116:119], v[76:79], v[244:247]
    ds_read_b64_tr_b16 a[116:117], v13 offset:24576
    ds_read_b64_tr_b16 a[118:119], v13 offset:28672
    v_mfma_f32_16x16x32_bf16 v[216:219], a[120:123], v[72:75], v[216:219]
    v_exp_f32 v37, v37
    v_mfma_f32_16x16x32_bf16 v[248:251], a[120:123], v[76:79], v[248:251]
    ds_read_b64_tr_b16 a[120:121], v14 offset:24576
    ds_read_b64_tr_b16 a[122:123], v14 offset:28672
    v_mfma_f32_16x16x32_bf16 v[220:223], a[124:127], v[72:75], v[220:223]
    v_exp_f32 v38, v38
    v_mfma_f32_16x16x32_bf16 v[252:255], a[124:127], v[76:79], v[252:255]
    ds_read_b64_tr_b16 a[124:125], v15 offset:24576
    ds_read_b64_tr_b16 a[126:127], v15 offset:28672
    v_mfma_f32_16x16x32_bf16 v[104:107], v[112:115], v[72:75], v[104:107]
    v_exp_f32 v39, v39
    v_mfma_f32_16x16x32_bf16 v[108:111], v[112:115], v[76:79], v[108:111]
    v_cvt_pk_bf16_f32 v65, v34, v35
    v_cvt_pk_bf16_f32 v68, v40, v41
    v_mfma_f32_16x16x32_bf16 v[48:51], a[64:67], a[32:35], v[88:91]
    v_exp_f32 v44, v44
    v_mfma_f32_16x16x32_bf16 v[56:59], a[64:67], a[48:51], v[92:95]
    ds_read_b128 a[64:67], v4 offset:24576
    v_cvt_pk_bf16_f32 v69, v42, v43
    v_mfma_f32_16x16x32_bf16 v[48:51], a[68:71], a[36:39], v[48:51]
    v_exp_f32 v45, v45
    v_mfma_f32_16x16x32_bf16 v[56:59], a[68:71], a[52:55], v[56:59]
    ds_read_b128 a[68:71], v5 offset:24576
    v_cvt_pk_bf16_f32 v66, v36, v37
    v_mfma_f32_16x16x32_bf16 v[48:51], a[72:75], a[40:43], v[48:51]
    v_exp_f32 v46, v46
    v_mfma_f32_16x16x32_bf16 v[56:59], a[72:75], a[56:59], v[56:59]
    ds_read_b128 a[72:75], v6 offset:24576
    v_cvt_pk_bf16_f32 v67, v38, v39
    v_mfma_f32_16x16x32_bf16 v[48:51], a[76:79], a[44:47], v[48:51]
    v_exp_f32 v47, v47
    v_mfma_f32_16x16x32_bf16 v[56:59], a[76:79], a[60:63], v[56:59]
    ds_read_b128 a[76:79], v7 offset:24576
    v_cvt_pk_bf16_f32 v70, v44, v45
    v_mfma_f32_16x16x32_bf16 v[52:55], a[80:83], a[32:35], v[88:91]
    v_mfma_f32_16x16x32_bf16 v[60:63], a[80:83], a[48:51], v[92:95]
    ds_read_b128 a[80:83], v4 offset:28672
    v_cvt_pk_bf16_f32 v71, v46, v47
    v_mfma_f32_16x16x32_bf16 v[52:55], a[84:87], a[36:39], v[52:55]
    v_exp_f32 v48, v48
    v_mfma_f32_16x16x32_bf16 v[60:63], a[84:87], a[52:55], v[60:63]
    ds_read_b128 a[84:87], v5 offset:28672
    v_mfma_f32_16x16x32_bf16 v[52:55], a[88:91], a[40:43], v[52:55]
    v_exp_f32 v49, v49
    v_mfma_f32_16x16x32_bf16 v[60:63], a[88:91], a[56:59], v[60:63]
    ds_read_b128 a[88:91], v6 offset:28672
    v_mfma_f32_16x16x32_bf16 v[52:55], a[92:95], a[44:47], v[52:55]
    v_exp_f32 v50, v50
    v_mfma_f32_16x16x32_bf16 v[60:63], a[92:95], a[60:63], v[60:63]
    ds_read_b128 a[92:95], v7 offset:28672
    s_waitcnt lgkmcnt(8)
    v_mfma_f32_16x16x32_bf16 v[128:131], a[96:99], v[64:67], v[128:131]
    v_exp_f32 v51, v51
    v_mfma_f32_16x16x32_bf16 v[160:163], a[96:99], v[68:71], v[160:163]
    v_cvt_pk_bf16_f32 v72, v48, v49
    v_cvt_pk_bf16_f32 v73, v50, v51
    v_mfma_f32_16x16x32_bf16 v[132:135], a[100:103], v[64:67], v[132:135]
    v_exp_f32 v56, v56
    v_mfma_f32_16x16x32_bf16 v[164:167], a[100:103], v[68:71], v[164:167]
    v_mfma_f32_16x16x32_bf16 v[136:139], a[104:107], v[64:67], v[136:139]
    v_exp_f32 v57, v57
    v_mfma_f32_16x16x32_bf16 v[168:171], a[104:107], v[68:71], v[168:171]
    v_cvt_pk_bf16_f32 v76, v56, v57
    v_mfma_f32_16x16x32_bf16 v[140:143], a[108:111], v[64:67], v[140:143]
    v_exp_f32 v58, v58
    v_mfma_f32_16x16x32_bf16 v[172:175], a[108:111], v[68:71], v[172:175]
    v_mfma_f32_16x16x32_bf16 v[144:147], a[112:115], v[64:67], v[144:147]
    v_exp_f32 v59, v59
    v_mfma_f32_16x16x32_bf16 v[176:179], a[112:115], v[68:71], v[176:179]
    v_cvt_pk_bf16_f32 v77, v58, v59
    v_mfma_f32_16x16x32_bf16 v[148:151], a[116:119], v[64:67], v[148:151]
    v_exp_f32 v52, v52
    v_mfma_f32_16x16x32_bf16 v[180:183], a[116:119], v[68:71], v[180:183]
    v_mfma_f32_16x16x32_bf16 v[152:155], a[120:123], v[64:67], v[152:155]
    v_exp_f32 v53, v53
    v_mfma_f32_16x16x32_bf16 v[184:187], a[120:123], v[68:71], v[184:187]
    v_mfma_f32_16x16x32_bf16 v[156:159], a[124:127], v[64:67], v[156:159]
    v_exp_f32 v54, v54
    v_mfma_f32_16x16x32_bf16 v[188:191], a[124:127], v[68:71], v[188:191]
    v_mfma_f32_16x16x32_bf16 v[96:99], v[112:115], v[64:67], v[96:99]
    v_exp_f32 v55, v55
    v_mfma_f32_16x16x32_bf16 v[100:103], v[112:115], v[68:71], v[100:103]
    s_waitcnt vmcnt(16) lgkmcnt(0)
    s_barrier
    v_mfma_f32_16x16x32_bf16 v[32:35], a[64:67], a[0:3], v[80:83]
    v_exp_f32 v60, v60
    v_mfma_f32_16x16x32_bf16 v[40:43], a[64:67], a[16:19], v[84:87]
    v_cvt_pk_bf16_f32 v74, v52, v53
    s_add_u32 m0, s80, 81920
    v_mfma_f32_16x16x32_bf16 v[32:35], a[68:71], a[4:7], v[32:35]
    v_exp_f32 v61, v61
    v_mfma_f32_16x16x32_bf16 v[40:43], a[68:71], a[20:23], v[40:43]
    v_cvt_pk_bf16_f32 v75, v54, v55
    v_cvt_pk_bf16_f32 v78, v60, v61
    v_mfma_f32_16x16x32_bf16 v[32:35], a[72:75], a[8:11], v[32:35]
    v_exp_f32 v62, v62
    v_mfma_f32_16x16x32_bf16 v[40:43], a[72:75], a[24:27], v[40:43]
    buffer_load_dwordx4 v20, s[12:15], s25 offen nt lds
    v_mfma_f32_16x16x32_bf16 v[32:35], a[76:79], a[12:15], v[32:35]
    v_exp_f32 v63, v63
    v_mfma_f32_16x16x32_bf16 v[40:43], a[76:79], a[28:31], v[40:43]
    v_cvt_pk_bf16_f32 v79, v62, v63
    v_mfma_f32_16x16x32_bf16 v[36:39], a[80:83], a[0:3], v[80:83]
    v_mfma_f32_16x16x32_bf16 v[44:47], a[80:83], a[16:19], v[84:87]
    s_add_u32 m0, s80, 86016
    v_mfma_f32_16x16x32_bf16 v[36:39], a[84:87], a[4:7], v[36:39]
    v_exp_f32 v32, v32
    v_mfma_f32_16x16x32_bf16 v[44:47], a[84:87], a[20:23], v[44:47]
    buffer_load_dwordx4 v21, s[12:15], s25 offen nt lds
    v_mfma_f32_16x16x32_bf16 v[36:39], a[88:91], a[8:11], v[36:39]
    v_exp_f32 v33, v33
    v_mfma_f32_16x16x32_bf16 v[44:47], a[88:91], a[24:27], v[44:47]
    v_cvt_pk_bf16_f32 v64, v32, v33
    v_mfma_f32_16x16x32_bf16 v[36:39], a[92:95], a[12:15], v[36:39]
    v_exp_f32 v34, v34
    v_mfma_f32_16x16x32_bf16 v[44:47], a[92:95], a[28:31], v[44:47]
    s_add_u32 m0, s80, 90112
    v_mfma_f32_16x16x32_bf16 v[192:195], a[96:99], v[72:75], v[192:195]
    v_exp_f32 v35, v35
    v_mfma_f32_16x16x32_bf16 v[224:227], a[96:99], v[76:79], v[224:227]
    ds_read_b64_tr_b16 a[96:97], v8 offset:32768
    ds_read_b64_tr_b16 a[98:99], v8 offset:36864
    v_mfma_f32_16x16x32_bf16 v[196:199], a[100:103], v[72:75], v[196:199]
    v_exp_f32 v40, v40
    v_mfma_f32_16x16x32_bf16 v[228:231], a[100:103], v[76:79], v[228:231]
    ds_read_b64_tr_b16 a[100:101], v9 offset:32768
    ds_read_b64_tr_b16 a[102:103], v9 offset:36864
    v_mfma_f32_16x16x32_bf16 v[200:203], a[104:107], v[72:75], v[200:203]
    v_exp_f32 v41, v41
    v_mfma_f32_16x16x32_bf16 v[232:235], a[104:107], v[76:79], v[232:235]
    ds_read_b64_tr_b16 a[104:105], v10 offset:32768
    ds_read_b64_tr_b16 a[106:107], v10 offset:36864
    v_mfma_f32_16x16x32_bf16 v[204:207], a[108:111], v[72:75], v[204:207]
    v_exp_f32 v42, v42
    v_mfma_f32_16x16x32_bf16 v[236:239], a[108:111], v[76:79], v[236:239]
    ds_read_b64_tr_b16 a[108:109], v11 offset:32768
    ds_read_b64_tr_b16 a[110:111], v11 offset:36864
    v_mfma_f32_16x16x32_bf16 v[208:211], a[112:115], v[72:75], v[208:211]
    v_exp_f32 v43, v43
    v_mfma_f32_16x16x32_bf16 v[240:243], a[112:115], v[76:79], v[240:243]
    ds_read_b64_tr_b16 a[112:113], v12 offset:32768
    ds_read_b64_tr_b16 a[114:115], v12 offset:36864
    v_mfma_f32_16x16x32_bf16 v[212:215], a[116:119], v[72:75], v[212:215]
    v_exp_f32 v36, v36
    v_mfma_f32_16x16x32_bf16 v[244:247], a[116:119], v[76:79], v[244:247]
    ds_read_b64_tr_b16 a[116:117], v13 offset:32768
    ds_read_b64_tr_b16 a[118:119], v13 offset:36864
    v_mfma_f32_16x16x32_bf16 v[216:219], a[120:123], v[72:75], v[216:219]
    v_exp_f32 v37, v37
    v_mfma_f32_16x16x32_bf16 v[248:251], a[120:123], v[76:79], v[248:251]
    ds_read_b64_tr_b16 a[120:121], v14 offset:32768
    ds_read_b64_tr_b16 a[122:123], v14 offset:36864
    v_mfma_f32_16x16x32_bf16 v[220:223], a[124:127], v[72:75], v[220:223]
    v_exp_f32 v38, v38
    v_mfma_f32_16x16x32_bf16 v[252:255], a[124:127], v[76:79], v[252:255]
    ds_read_b64_tr_b16 a[124:125], v15 offset:32768
    ds_read_b64_tr_b16 a[126:127], v15 offset:36864
    v_mfma_f32_16x16x32_bf16 v[104:107], v[112:115], v[72:75], v[104:107]
    v_exp_f32 v39, v39
    v_mfma_f32_16x16x32_bf16 v[108:111], v[112:115], v[76:79], v[108:111]
    v_cvt_pk_bf16_f32 v65, v34, v35
    v_cvt_pk_bf16_f32 v68, v40, v41
    v_mfma_f32_16x16x32_bf16 v[48:51], a[64:67], a[32:35], v[88:91]
    v_exp_f32 v44, v44
    v_mfma_f32_16x16x32_bf16 v[56:59], a[64:67], a[48:51], v[92:95]
    ds_read_b128 a[64:67], v4 offset:32768
    v_cvt_pk_bf16_f32 v69, v42, v43
    v_mfma_f32_16x16x32_bf16 v[48:51], a[68:71], a[36:39], v[48:51]
    v_exp_f32 v45, v45
    v_mfma_f32_16x16x32_bf16 v[56:59], a[68:71], a[52:55], v[56:59]
    ds_read_b128 a[68:71], v5 offset:32768
    v_cvt_pk_bf16_f32 v66, v36, v37
    v_mfma_f32_16x16x32_bf16 v[48:51], a[72:75], a[40:43], v[48:51]
    v_exp_f32 v46, v46
    v_mfma_f32_16x16x32_bf16 v[56:59], a[72:75], a[56:59], v[56:59]
    ds_read_b128 a[72:75], v6 offset:32768
    v_cvt_pk_bf16_f32 v67, v38, v39
    v_mfma_f32_16x16x32_bf16 v[48:51], a[76:79], a[44:47], v[48:51]
    v_exp_f32 v47, v47
    v_mfma_f32_16x16x32_bf16 v[56:59], a[76:79], a[60:63], v[56:59]
    ds_read_b128 a[76:79], v7 offset:32768
    v_cvt_pk_bf16_f32 v70, v44, v45
    v_mfma_f32_16x16x32_bf16 v[52:55], a[80:83], a[32:35], v[88:91]
    buffer_load_dwordx4 v20, s[12:15], s81 offen nt lds
    v_mfma_f32_16x16x32_bf16 v[60:63], a[80:83], a[48:51], v[92:95]
    ds_read_b128 a[80:83], v4 offset:36864
    v_cvt_pk_bf16_f32 v71, v46, v47
    v_mfma_f32_16x16x32_bf16 v[52:55], a[84:87], a[36:39], v[52:55]
    v_exp_f32 v48, v48
    v_mfma_f32_16x16x32_bf16 v[60:63], a[84:87], a[52:55], v[60:63]
    ds_read_b128 a[84:87], v5 offset:36864
    s_add_u32 m0, s80, 94208
    v_mfma_f32_16x16x32_bf16 v[52:55], a[88:91], a[40:43], v[52:55]
    v_exp_f32 v49, v49
    v_mfma_f32_16x16x32_bf16 v[60:63], a[88:91], a[56:59], v[60:63]
    ds_read_b128 a[88:91], v6 offset:36864
    buffer_load_dwordx4 v21, s[12:15], s81 offen nt lds
    v_mfma_f32_16x16x32_bf16 v[52:55], a[92:95], a[44:47], v[52:55]
    v_exp_f32 v50, v50
    v_mfma_f32_16x16x32_bf16 v[60:63], a[92:95], a[60:63], v[60:63]
    ds_read_b128 a[92:95], v7 offset:36864
    s_waitcnt lgkmcnt(8)
    v_mfma_f32_16x16x32_bf16 v[128:131], a[96:99], v[64:67], v[128:131]
    v_exp_f32 v51, v51
    v_mfma_f32_16x16x32_bf16 v[160:163], a[96:99], v[68:71], v[160:163]
    v_cvt_pk_bf16_f32 v72, v48, v49
    v_cvt_pk_bf16_f32 v73, v50, v51
    v_mfma_f32_16x16x32_bf16 v[132:135], a[100:103], v[64:67], v[132:135]
    v_exp_f32 v56, v56
    v_mfma_f32_16x16x32_bf16 v[164:167], a[100:103], v[68:71], v[164:167]
    s_add_u32 s25, s25, 16384
    s_add_u32 s81, s81, 16384
    v_mfma_f32_16x16x32_bf16 v[136:139], a[104:107], v[64:67], v[136:139]
    v_exp_f32 v57, v57
    v_mfma_f32_16x16x32_bf16 v[168:171], a[104:107], v[68:71], v[168:171]
    v_cvt_pk_bf16_f32 v76, v56, v57
    s_add_u32 m0, s80, 16384
    v_mfma_f32_16x16x32_bf16 v[140:143], a[108:111], v[64:67], v[140:143]
    v_exp_f32 v58, v58
    v_mfma_f32_16x16x32_bf16 v[172:175], a[108:111], v[68:71], v[172:175]
    buffer_load_dwordx4 v16, s[8:11], s26 offen nt lds
    v_mfma_f32_16x16x32_bf16 v[144:147], a[112:115], v[64:67], v[144:147]
    v_exp_f32 v59, v59
    v_mfma_f32_16x16x32_bf16 v[176:179], a[112:115], v[68:71], v[176:179]
    v_cvt_pk_bf16_f32 v77, v58, v59
    v_mfma_f32_16x16x32_bf16 v[148:151], a[116:119], v[64:67], v[148:151]
    v_exp_f32 v52, v52
    v_mfma_f32_16x16x32_bf16 v[180:183], a[116:119], v[68:71], v[180:183]
    s_add_u32 m0, s80, 20480
    v_mfma_f32_16x16x32_bf16 v[152:155], a[120:123], v[64:67], v[152:155]
    v_exp_f32 v53, v53
    v_mfma_f32_16x16x32_bf16 v[184:187], a[120:123], v[68:71], v[184:187]
    buffer_load_dwordx4 v17, s[8:11], s26 offen nt lds
    v_mfma_f32_16x16x32_bf16 v[156:159], a[124:127], v[64:67], v[156:159]
    v_exp_f32 v54, v54
    v_mfma_f32_16x16x32_bf16 v[188:191], a[124:127], v[68:71], v[188:191]
    v_mfma_f32_16x16x32_bf16 v[96:99], v[112:115], v[64:67], v[96:99]
    v_exp_f32 v55, v55
    v_mfma_f32_16x16x32_bf16 v[100:103], v[112:115], v[68:71], v[100:103]
    s_waitcnt lgkmcnt(0)
    v_mfma_f32_16x16x32_bf16 v[32:35], a[64:67], a[0:3], v[80:83]
    v_exp_f32 v60, v60
    v_mfma_f32_16x16x32_bf16 v[40:43], a[64:67], a[16:19], v[84:87]
    v_cvt_pk_bf16_f32 v74, v52, v53
    s_add_u32 m0, s80, 24576
    v_mfma_f32_16x16x32_bf16 v[32:35], a[68:71], a[4:7], v[32:35]
    v_exp_f32 v61, v61
    v_mfma_f32_16x16x32_bf16 v[40:43], a[68:71], a[20:23], v[40:43]
    v_cvt_pk_bf16_f32 v75, v54, v55
    v_cvt_pk_bf16_f32 v78, v60, v61
    v_mfma_f32_16x16x32_bf16 v[32:35], a[72:75], a[8:11], v[32:35]
    v_exp_f32 v62, v62
    v_mfma_f32_16x16x32_bf16 v[40:43], a[72:75], a[24:27], v[40:43]
    buffer_load_dwordx4 v16, s[8:11], s82 offen nt lds
    v_mfma_f32_16x16x32_bf16 v[32:35], a[76:79], a[12:15], v[32:35]
    v_exp_f32 v63, v63
    v_mfma_f32_16x16x32_bf16 v[40:43], a[76:79], a[28:31], v[40:43]
    v_cvt_pk_bf16_f32 v79, v62, v63
    v_mfma_f32_16x16x32_bf16 v[36:39], a[80:83], a[0:3], v[80:83]
    v_mfma_f32_16x16x32_bf16 v[44:47], a[80:83], a[16:19], v[84:87]
    s_add_u32 m0, s80, 28672
    v_mfma_f32_16x16x32_bf16 v[36:39], a[84:87], a[4:7], v[36:39]
    v_exp_f32 v32, v32
    v_mfma_f32_16x16x32_bf16 v[44:47], a[84:87], a[20:23], v[44:47]
    buffer_load_dwordx4 v17, s[8:11], s82 offen nt lds
    v_mfma_f32_16x16x32_bf16 v[36:39], a[88:91], a[8:11], v[36:39]
    v_exp_f32 v33, v33
    v_mfma_f32_16x16x32_bf16 v[44:47], a[88:91], a[24:27], v[44:47]
    v_cvt_pk_bf16_f32 v64, v32, v33
    s_add_u32 s26, s26, 16384
    v_mfma_f32_16x16x32_bf16 v[36:39], a[92:95], a[12:15], v[36:39]
    v_exp_f32 v34, v34
    v_mfma_f32_16x16x32_bf16 v[44:47], a[92:95], a[28:31], v[44:47]
    s_add_u32 s82, s82, 16384
    v_mfma_f32_16x16x32_bf16 v[192:195], a[96:99], v[72:75], v[192:195]
    v_exp_f32 v35, v35
    v_mfma_f32_16x16x32_bf16 v[224:227], a[96:99], v[76:79], v[224:227]
    ds_read_b64_tr_b16 a[96:97], v8 offset:40960
    ds_read_b64_tr_b16 a[98:99], v8 offset:45056
    v_mfma_f32_16x16x32_bf16 v[196:199], a[100:103], v[72:75], v[196:199]
    v_exp_f32 v40, v40
    v_mfma_f32_16x16x32_bf16 v[228:231], a[100:103], v[76:79], v[228:231]
    ds_read_b64_tr_b16 a[100:101], v9 offset:40960
    ds_read_b64_tr_b16 a[102:103], v9 offset:45056
    v_mfma_f32_16x16x32_bf16 v[200:203], a[104:107], v[72:75], v[200:203]
    v_exp_f32 v41, v41
    v_mfma_f32_16x16x32_bf16 v[232:235], a[104:107], v[76:79], v[232:235]
    ds_read_b64_tr_b16 a[104:105], v10 offset:40960
    ds_read_b64_tr_b16 a[106:107], v10 offset:45056
    v_mfma_f32_16x16x32_bf16 v[204:207], a[108:111], v[72:75], v[204:207]
    v_exp_f32 v42, v42
    v_mfma_f32_16x16x32_bf16 v[236:239], a[108:111], v[76:79], v[236:239]
    ds_read_b64_tr_b16 a[108:109], v11 offset:40960
    ds_read_b64_tr_b16 a[110:111], v11 offset:45056
    v_mfma_f32_16x16x32_bf16 v[208:211], a[112:115], v[72:75], v[208:211]
    v_exp_f32 v43, v43
    v_mfma_f32_16x16x32_bf16 v[240:243], a[112:115], v[76:79], v[240:243]
    ds_read_b64_tr_b16 a[112:113], v12 offset:40960
    ds_read_b64_tr_b16 a[114:115], v12 offset:45056
    v_mfma_f32_16x16x32_bf16 v[212:215], a[116:119], v[72:75], v[212:215]
    v_exp_f32 v36, v36
    v_mfma_f32_16x16x32_bf16 v[244:247], a[116:119], v[76:79], v[244:247]
    ds_read_b64_tr_b16 a[116:117], v13 offset:40960
    ds_read_b64_tr_b16 a[118:119], v13 offset:45056
    v_mfma_f32_16x16x32_bf16 v[216:219], a[120:123], v[72:75], v[216:219]
    v_exp_f32 v37, v37
    v_mfma_f32_16x16x32_bf16 v[248:251], a[120:123], v[76:79], v[248:251]
    ds_read_b64_tr_b16 a[120:121], v14 offset:40960
    ds_read_b64_tr_b16 a[122:123], v14 offset:45056
    v_mfma_f32_16x16x32_bf16 v[220:223], a[124:127], v[72:75], v[220:223]
    v_exp_f32 v38, v38
    v_mfma_f32_16x16x32_bf16 v[252:255], a[124:127], v[76:79], v[252:255]
    ds_read_b64_tr_b16 a[124:125], v15 offset:40960
    ds_read_b64_tr_b16 a[126:127], v15 offset:45056
    v_mfma_f32_16x16x32_bf16 v[104:107], v[112:115], v[72:75], v[104:107]
    v_exp_f32 v39, v39
    v_mfma_f32_16x16x32_bf16 v[108:111], v[112:115], v[76:79], v[108:111]
    v_cvt_pk_bf16_f32 v65, v34, v35
    v_cvt_pk_bf16_f32 v68, v40, v41
    v_mfma_f32_16x16x32_bf16 v[48:51], a[64:67], a[32:35], v[88:91]
    v_exp_f32 v44, v44
    v_mfma_f32_16x16x32_bf16 v[56:59], a[64:67], a[48:51], v[92:95]
    ds_read_b128 a[64:67], v4 offset:40960
    v_cvt_pk_bf16_f32 v69, v42, v43
    v_mfma_f32_16x16x32_bf16 v[48:51], a[68:71], a[36:39], v[48:51]
    v_exp_f32 v45, v45
    v_mfma_f32_16x16x32_bf16 v[56:59], a[68:71], a[52:55], v[56:59]
    ds_read_b128 a[68:71], v5 offset:40960
    v_cvt_pk_bf16_f32 v66, v36, v37
    v_mfma_f32_16x16x32_bf16 v[48:51], a[72:75], a[40:43], v[48:51]
    v_exp_f32 v46, v46
    v_mfma_f32_16x16x32_bf16 v[56:59], a[72:75], a[56:59], v[56:59]
    ds_read_b128 a[72:75], v6 offset:40960
    v_cvt_pk_bf16_f32 v67, v38, v39
    v_mfma_f32_16x16x32_bf16 v[48:51], a[76:79], a[44:47], v[48:51]
    v_exp_f32 v47, v47
    v_mfma_f32_16x16x32_bf16 v[56:59], a[76:79], a[60:63], v[56:59]
    ds_read_b128 a[76:79], v7 offset:40960
    v_cvt_pk_bf16_f32 v70, v44, v45
    v_mfma_f32_16x16x32_bf16 v[52:55], a[80:83], a[32:35], v[88:91]
    v_mfma_f32_16x16x32_bf16 v[60:63], a[80:83], a[48:51], v[92:95]
    ds_read_b128 a[80:83], v4 offset:45056
    v_cvt_pk_bf16_f32 v71, v46, v47
    v_mfma_f32_16x16x32_bf16 v[52:55], a[84:87], a[36:39], v[52:55]
    v_exp_f32 v48, v48
    v_mfma_f32_16x16x32_bf16 v[60:63], a[84:87], a[52:55], v[60:63]
    ds_read_b128 a[84:87], v5 offset:45056
    v_mfma_f32_16x16x32_bf16 v[52:55], a[88:91], a[40:43], v[52:55]
    v_exp_f32 v49, v49
    v_mfma_f32_16x16x32_bf16 v[60:63], a[88:91], a[56:59], v[60:63]
    ds_read_b128 a[88:91], v6 offset:45056
    v_mfma_f32_16x16x32_bf16 v[52:55], a[92:95], a[44:47], v[52:55]
    v_exp_f32 v50, v50
    v_mfma_f32_16x16x32_bf16 v[60:63], a[92:95], a[60:63], v[60:63]
    ds_read_b128 a[92:95], v7 offset:45056
    s_waitcnt lgkmcnt(8)
    v_mfma_f32_16x16x32_bf16 v[128:131], a[96:99], v[64:67], v[128:131]
    v_exp_f32 v51, v51
    v_mfma_f32_16x16x32_bf16 v[160:163], a[96:99], v[68:71], v[160:163]
    v_cvt_pk_bf16_f32 v72, v48, v49
    v_cvt_pk_bf16_f32 v73, v50, v51
    v_mfma_f32_16x16x32_bf16 v[132:135], a[100:103], v[64:67], v[132:135]
    v_exp_f32 v56, v56
    v_mfma_f32_16x16x32_bf16 v[164:167], a[100:103], v[68:71], v[164:167]
    v_mfma_f32_16x16x32_bf16 v[136:139], a[104:107], v[64:67], v[136:139]
    v_exp_f32 v57, v57
    v_mfma_f32_16x16x32_bf16 v[168:171], a[104:107], v[68:71], v[168:171]
    v_cvt_pk_bf16_f32 v76, v56, v57
    v_mfma_f32_16x16x32_bf16 v[140:143], a[108:111], v[64:67], v[140:143]
    v_exp_f32 v58, v58
    v_mfma_f32_16x16x32_bf16 v[172:175], a[108:111], v[68:71], v[172:175]
    v_mfma_f32_16x16x32_bf16 v[144:147], a[112:115], v[64:67], v[144:147]
    v_exp_f32 v59, v59
    v_mfma_f32_16x16x32_bf16 v[176:179], a[112:115], v[68:71], v[176:179]
    v_cvt_pk_bf16_f32 v77, v58, v59
    v_mfma_f32_16x16x32_bf16 v[148:151], a[116:119], v[64:67], v[148:151]
    v_exp_f32 v52, v52
    v_mfma_f32_16x16x32_bf16 v[180:183], a[116:119], v[68:71], v[180:183]
    v_mfma_f32_16x16x32_bf16 v[152:155], a[120:123], v[64:67], v[152:155]
    v_exp_f32 v53, v53
    v_mfma_f32_16x16x32_bf16 v[184:187], a[120:123], v[68:71], v[184:187]
    v_mfma_f32_16x16x32_bf16 v[156:159], a[124:127], v[64:67], v[156:159]
    v_exp_f32 v54, v54
    v_mfma_f32_16x16x32_bf16 v[188:191], a[124:127], v[68:71], v[188:191]
    v_mfma_f32_16x16x32_bf16 v[96:99], v[112:115], v[64:67], v[96:99]
    v_exp_f32 v55, v55
    v_mfma_f32_16x16x32_bf16 v[100:103], v[112:115], v[68:71], v[100:103]
    s_waitcnt vmcnt(16) lgkmcnt(0)
    s_barrier
    v_mfma_f32_16x16x32_bf16 v[32:35], a[64:67], a[0:3], v[80:83]
    v_exp_f32 v60, v60
    v_mfma_f32_16x16x32_bf16 v[40:43], a[64:67], a[16:19], v[84:87]
    v_cvt_pk_bf16_f32 v74, v52, v53
    s_add_u32 m0, s80, 98304
    v_mfma_f32_16x16x32_bf16 v[32:35], a[68:71], a[4:7], v[32:35]
    v_exp_f32 v61, v61
    v_mfma_f32_16x16x32_bf16 v[40:43], a[68:71], a[20:23], v[40:43]
    v_cvt_pk_bf16_f32 v75, v54, v55
    v_cvt_pk_bf16_f32 v78, v60, v61
    v_mfma_f32_16x16x32_bf16 v[32:35], a[72:75], a[8:11], v[32:35]
    v_exp_f32 v62, v62
    v_mfma_f32_16x16x32_bf16 v[40:43], a[72:75], a[24:27], v[40:43]
    buffer_load_dwordx4 v20, s[12:15], s25 offen nt lds
    v_mfma_f32_16x16x32_bf16 v[32:35], a[76:79], a[12:15], v[32:35]
    v_exp_f32 v63, v63
    v_mfma_f32_16x16x32_bf16 v[40:43], a[76:79], a[28:31], v[40:43]
    v_cvt_pk_bf16_f32 v79, v62, v63
    v_mfma_f32_16x16x32_bf16 v[36:39], a[80:83], a[0:3], v[80:83]
    v_mfma_f32_16x16x32_bf16 v[44:47], a[80:83], a[16:19], v[84:87]
    s_add_u32 m0, s80, 102400
    v_mfma_f32_16x16x32_bf16 v[36:39], a[84:87], a[4:7], v[36:39]
    v_exp_f32 v32, v32
    v_mfma_f32_16x16x32_bf16 v[44:47], a[84:87], a[20:23], v[44:47]
    buffer_load_dwordx4 v21, s[12:15], s25 offen nt lds
    v_mfma_f32_16x16x32_bf16 v[36:39], a[88:91], a[8:11], v[36:39]
    v_exp_f32 v33, v33
    v_mfma_f32_16x16x32_bf16 v[44:47], a[88:91], a[24:27], v[44:47]
    v_cvt_pk_bf16_f32 v64, v32, v33
    v_mfma_f32_16x16x32_bf16 v[36:39], a[92:95], a[12:15], v[36:39]
    v_exp_f32 v34, v34
    v_mfma_f32_16x16x32_bf16 v[44:47], a[92:95], a[28:31], v[44:47]
    s_add_u32 m0, s80, 106496
    v_mfma_f32_16x16x32_bf16 v[192:195], a[96:99], v[72:75], v[192:195]
    v_exp_f32 v35, v35
    v_mfma_f32_16x16x32_bf16 v[224:227], a[96:99], v[76:79], v[224:227]
    ds_read_b64_tr_b16 a[96:97], v8 offset:49152
    ds_read_b64_tr_b16 a[98:99], v8 offset:53248
    v_mfma_f32_16x16x32_bf16 v[196:199], a[100:103], v[72:75], v[196:199]
    v_exp_f32 v40, v40
    v_mfma_f32_16x16x32_bf16 v[228:231], a[100:103], v[76:79], v[228:231]
    ds_read_b64_tr_b16 a[100:101], v9 offset:49152
    ds_read_b64_tr_b16 a[102:103], v9 offset:53248
    v_mfma_f32_16x16x32_bf16 v[200:203], a[104:107], v[72:75], v[200:203]
    v_exp_f32 v41, v41
    v_mfma_f32_16x16x32_bf16 v[232:235], a[104:107], v[76:79], v[232:235]
    ds_read_b64_tr_b16 a[104:105], v10 offset:49152
    ds_read_b64_tr_b16 a[106:107], v10 offset:53248
    v_mfma_f32_16x16x32_bf16 v[204:207], a[108:111], v[72:75], v[204:207]
    v_exp_f32 v42, v42
    v_mfma_f32_16x16x32_bf16 v[236:239], a[108:111], v[76:79], v[236:239]
    ds_read_b64_tr_b16 a[108:109], v11 offset:49152
    ds_read_b64_tr_b16 a[110:111], v11 offset:53248
    v_mfma_f32_16x16x32_bf16 v[208:211], a[112:115], v[72:75], v[208:211]
    v_exp_f32 v43, v43
    v_mfma_f32_16x16x32_bf16 v[240:243], a[112:115], v[76:79], v[240:243]
    ds_read_b64_tr_b16 a[112:113], v12 offset:49152
    ds_read_b64_tr_b16 a[114:115], v12 offset:53248
    v_mfma_f32_16x16x32_bf16 v[212:215], a[116:119], v[72:75], v[212:215]
    v_exp_f32 v36, v36
    v_mfma_f32_16x16x32_bf16 v[244:247], a[116:119], v[76:79], v[244:247]
    ds_read_b64_tr_b16 a[116:117], v13 offset:49152
    ds_read_b64_tr_b16 a[118:119], v13 offset:53248
    v_mfma_f32_16x16x32_bf16 v[216:219], a[120:123], v[72:75], v[216:219]
    v_exp_f32 v37, v37
    v_mfma_f32_16x16x32_bf16 v[248:251], a[120:123], v[76:79], v[248:251]
    ds_read_b64_tr_b16 a[120:121], v14 offset:49152
    ds_read_b64_tr_b16 a[122:123], v14 offset:53248
    v_mfma_f32_16x16x32_bf16 v[220:223], a[124:127], v[72:75], v[220:223]
    v_exp_f32 v38, v38
    v_mfma_f32_16x16x32_bf16 v[252:255], a[124:127], v[76:79], v[252:255]
    ds_read_b64_tr_b16 a[124:125], v15 offset:49152
    ds_read_b64_tr_b16 a[126:127], v15 offset:53248
    v_mfma_f32_16x16x32_bf16 v[104:107], v[112:115], v[72:75], v[104:107]
    v_exp_f32 v39, v39
    v_mfma_f32_16x16x32_bf16 v[108:111], v[112:115], v[76:79], v[108:111]
    v_cvt_pk_bf16_f32 v65, v34, v35
    v_cvt_pk_bf16_f32 v68, v40, v41
    v_mfma_f32_16x16x32_bf16 v[48:51], a[64:67], a[32:35], v[88:91]
    v_exp_f32 v44, v44
    v_mfma_f32_16x16x32_bf16 v[56:59], a[64:67], a[48:51], v[92:95]
    ds_read_b128 a[64:67], v4 offset:49152
    v_cvt_pk_bf16_f32 v69, v42, v43
    v_mfma_f32_16x16x32_bf16 v[48:51], a[68:71], a[36:39], v[48:51]
    v_exp_f32 v45, v45
    v_mfma_f32_16x16x32_bf16 v[56:59], a[68:71], a[52:55], v[56:59]
    ds_read_b128 a[68:71], v5 offset:49152
    v_cvt_pk_bf16_f32 v66, v36, v37
    v_mfma_f32_16x16x32_bf16 v[48:51], a[72:75], a[40:43], v[48:51]
    v_exp_f32 v46, v46
    v_mfma_f32_16x16x32_bf16 v[56:59], a[72:75], a[56:59], v[56:59]
    ds_read_b128 a[72:75], v6 offset:49152
    v_cvt_pk_bf16_f32 v67, v38, v39
    v_mfma_f32_16x16x32_bf16 v[48:51], a[76:79], a[44:47], v[48:51]
    v_exp_f32 v47, v47
    v_mfma_f32_16x16x32_bf16 v[56:59], a[76:79], a[60:63], v[56:59]
    ds_read_b128 a[76:79], v7 offset:49152
    v_cvt_pk_bf16_f32 v70, v44, v45
    v_mfma_f32_16x16x32_bf16 v[52:55], a[80:83], a[32:35], v[88:91]
    buffer_load_dwordx4 v20, s[12:15], s81 offen nt lds
    v_mfma_f32_16x16x32_bf16 v[60:63], a[80:83], a[48:51], v[92:95]
    ds_read_b128 a[80:83], v4 offset:53248
    v_cvt_pk_bf16_f32 v71, v46, v47
    v_mfma_f32_16x16x32_bf16 v[52:55], a[84:87], a[36:39], v[52:55]
    v_exp_f32 v48, v48
    v_mfma_f32_16x16x32_bf16 v[60:63], a[84:87], a[52:55], v[60:63]
    ds_read_b128 a[84:87], v5 offset:53248
    s_add_u32 m0, s80, 110592
    v_mfma_f32_16x16x32_bf16 v[52:55], a[88:91], a[40:43], v[52:55]
    v_exp_f32 v49, v49
    v_mfma_f32_16x16x32_bf16 v[60:63], a[88:91], a[56:59], v[60:63]
    ds_read_b128 a[88:91], v6 offset:53248
    buffer_load_dwordx4 v21, s[12:15], s81 offen nt lds
    v_mfma_f32_16x16x32_bf16 v[52:55], a[92:95], a[44:47], v[52:55]
    v_exp_f32 v50, v50
    v_mfma_f32_16x16x32_bf16 v[60:63], a[92:95], a[60:63], v[60:63]
    ds_read_b128 a[92:95], v7 offset:53248
    s_waitcnt lgkmcnt(8)
    v_mfma_f32_16x16x32_bf16 v[128:131], a[96:99], v[64:67], v[128:131]
    v_exp_f32 v51, v51
    v_mfma_f32_16x16x32_bf16 v[160:163], a[96:99], v[68:71], v[160:163]
    v_cvt_pk_bf16_f32 v72, v48, v49
    v_cvt_pk_bf16_f32 v73, v50, v51
    v_mfma_f32_16x16x32_bf16 v[132:135], a[100:103], v[64:67], v[132:135]
    v_exp_f32 v56, v56
    v_mfma_f32_16x16x32_bf16 v[164:167], a[100:103], v[68:71], v[164:167]
    s_add_u32 s25, s25, 16384
    s_add_u32 s81, s81, 16384
    v_mfma_f32_16x16x32_bf16 v[136:139], a[104:107], v[64:67], v[136:139]
    v_exp_f32 v57, v57
    v_mfma_f32_16x16x32_bf16 v[168:171], a[104:107], v[68:71], v[168:171]
    v_cvt_pk_bf16_f32 v76, v56, v57
    s_add_u32 m0, s80, 32768
    v_mfma_f32_16x16x32_bf16 v[140:143], a[108:111], v[64:67], v[140:143]
    v_exp_f32 v58, v58
    v_mfma_f32_16x16x32_bf16 v[172:175], a[108:111], v[68:71], v[172:175]
    buffer_load_dwordx4 v16, s[8:11], s26 offen nt lds
    v_mfma_f32_16x16x32_bf16 v[144:147], a[112:115], v[64:67], v[144:147]
    v_exp_f32 v59, v59
    v_mfma_f32_16x16x32_bf16 v[176:179], a[112:115], v[68:71], v[176:179]
    v_cvt_pk_bf16_f32 v77, v58, v59
    v_mfma_f32_16x16x32_bf16 v[148:151], a[116:119], v[64:67], v[148:151]
    v_exp_f32 v52, v52
    v_mfma_f32_16x16x32_bf16 v[180:183], a[116:119], v[68:71], v[180:183]
    s_add_u32 m0, s80, 36864
    v_mfma_f32_16x16x32_bf16 v[152:155], a[120:123], v[64:67], v[152:155]
    v_exp_f32 v53, v53
    v_mfma_f32_16x16x32_bf16 v[184:187], a[120:123], v[68:71], v[184:187]
    buffer_load_dwordx4 v17, s[8:11], s26 offen nt lds
    v_mfma_f32_16x16x32_bf16 v[156:159], a[124:127], v[64:67], v[156:159]
    v_exp_f32 v54, v54
    v_mfma_f32_16x16x32_bf16 v[188:191], a[124:127], v[68:71], v[188:191]
    v_mfma_f32_16x16x32_bf16 v[96:99], v[112:115], v[64:67], v[96:99]
    v_exp_f32 v55, v55
    v_mfma_f32_16x16x32_bf16 v[100:103], v[112:115], v[68:71], v[100:103]
    s_waitcnt lgkmcnt(0)
    v_mfma_f32_16x16x32_bf16 v[32:35], a[64:67], a[0:3], v[80:83]
    v_exp_f32 v60, v60
    v_mfma_f32_16x16x32_bf16 v[40:43], a[64:67], a[16:19], v[84:87]
    v_cvt_pk_bf16_f32 v74, v52, v53
    s_add_u32 m0, s80, 40960
    v_mfma_f32_16x16x32_bf16 v[32:35], a[68:71], a[4:7], v[32:35]
    v_exp_f32 v61, v61
    v_mfma_f32_16x16x32_bf16 v[40:43], a[68:71], a[20:23], v[40:43]
    v_cvt_pk_bf16_f32 v75, v54, v55
    v_cvt_pk_bf16_f32 v78, v60, v61
    v_mfma_f32_16x16x32_bf16 v[32:35], a[72:75], a[8:11], v[32:35]
    v_exp_f32 v62, v62
    v_mfma_f32_16x16x32_bf16 v[40:43], a[72:75], a[24:27], v[40:43]
    buffer_load_dwordx4 v16, s[8:11], s82 offen nt lds
    v_mfma_f32_16x16x32_bf16 v[32:35], a[76:79], a[12:15], v[32:35]
    v_exp_f32 v63, v63
    v_mfma_f32_16x16x32_bf16 v[40:43], a[76:79], a[28:31], v[40:43]
    v_cvt_pk_bf16_f32 v79, v62, v63
    v_mfma_f32_16x16x32_bf16 v[36:39], a[80:83], a[0:3], v[80:83]
    v_mfma_f32_16x16x32_bf16 v[44:47], a[80:83], a[16:19], v[84:87]
    s_add_u32 m0, s80, 45056
    v_mfma_f32_16x16x32_bf16 v[36:39], a[84:87], a[4:7], v[36:39]
    v_exp_f32 v32, v32
    v_mfma_f32_16x16x32_bf16 v[44:47], a[84:87], a[20:23], v[44:47]
    buffer_load_dwordx4 v17, s[8:11], s82 offen nt lds
    v_mfma_f32_16x16x32_bf16 v[36:39], a[88:91], a[8:11], v[36:39]
    v_exp_f32 v33, v33
    v_mfma_f32_16x16x32_bf16 v[44:47], a[88:91], a[24:27], v[44:47]
    v_cvt_pk_bf16_f32 v64, v32, v33
    s_add_u32 s26, s26, 16384
    v_mfma_f32_16x16x32_bf16 v[36:39], a[92:95], a[12:15], v[36:39]
    v_exp_f32 v34, v34
    v_mfma_f32_16x16x32_bf16 v[44:47], a[92:95], a[28:31], v[44:47]
    s_add_u32 s82, s82, 16384
    v_mfma_f32_16x16x32_bf16 v[192:195], a[96:99], v[72:75], v[192:195]
    v_exp_f32 v35, v35
    v_mfma_f32_16x16x32_bf16 v[224:227], a[96:99], v[76:79], v[224:227]
    ds_read_b64_tr_b16 a[96:97], v8 offset:57344
    ds_read_b64_tr_b16 a[98:99], v8 offset:61440
    v_mfma_f32_16x16x32_bf16 v[196:199], a[100:103], v[72:75], v[196:199]
    v_exp_f32 v40, v40
    v_mfma_f32_16x16x32_bf16 v[228:231], a[100:103], v[76:79], v[228:231]
    ds_read_b64_tr_b16 a[100:101], v9 offset:57344
    ds_read_b64_tr_b16 a[102:103], v9 offset:61440
    v_mfma_f32_16x16x32_bf16 v[200:203], a[104:107], v[72:75], v[200:203]
    v_exp_f32 v41, v41
    v_mfma_f32_16x16x32_bf16 v[232:235], a[104:107], v[76:79], v[232:235]
    ds_read_b64_tr_b16 a[104:105], v10 offset:57344
    ds_read_b64_tr_b16 a[106:107], v10 offset:61440
    v_mfma_f32_16x16x32_bf16 v[204:207], a[108:111], v[72:75], v[204:207]
    v_exp_f32 v42, v42
    v_mfma_f32_16x16x32_bf16 v[236:239], a[108:111], v[76:79], v[236:239]
    ds_read_b64_tr_b16 a[108:109], v11 offset:57344
    ds_read_b64_tr_b16 a[110:111], v11 offset:61440
    v_mfma_f32_16x16x32_bf16 v[208:211], a[112:115], v[72:75], v[208:211]
    v_exp_f32 v43, v43
    v_mfma_f32_16x16x32_bf16 v[240:243], a[112:115], v[76:79], v[240:243]
    ds_read_b64_tr_b16 a[112:113], v12 offset:57344
    ds_read_b64_tr_b16 a[114:115], v12 offset:61440
    v_mfma_f32_16x16x32_bf16 v[212:215], a[116:119], v[72:75], v[212:215]
    v_exp_f32 v36, v36
    v_mfma_f32_16x16x32_bf16 v[244:247], a[116:119], v[76:79], v[244:247]
    ds_read_b64_tr_b16 a[116:117], v13 offset:57344
    ds_read_b64_tr_b16 a[118:119], v13 offset:61440
    v_mfma_f32_16x16x32_bf16 v[216:219], a[120:123], v[72:75], v[216:219]
    v_exp_f32 v37, v37
    v_mfma_f32_16x16x32_bf16 v[248:251], a[120:123], v[76:79], v[248:251]
    ds_read_b64_tr_b16 a[120:121], v14 offset:57344
    ds_read_b64_tr_b16 a[122:123], v14 offset:61440
    v_mfma_f32_16x16x32_bf16 v[220:223], a[124:127], v[72:75], v[220:223]
    v_exp_f32 v38, v38
    v_mfma_f32_16x16x32_bf16 v[252:255], a[124:127], v[76:79], v[252:255]
    ds_read_b64_tr_b16 a[124:125], v15 offset:57344
    ds_read_b64_tr_b16 a[126:127], v15 offset:61440
    v_mfma_f32_16x16x32_bf16 v[104:107], v[112:115], v[72:75], v[104:107]
    v_exp_f32 v39, v39
    v_mfma_f32_16x16x32_bf16 v[108:111], v[112:115], v[76:79], v[108:111]
    v_cvt_pk_bf16_f32 v65, v34, v35
    v_cvt_pk_bf16_f32 v68, v40, v41
    v_mfma_f32_16x16x32_bf16 v[48:51], a[64:67], a[32:35], v[88:91]
    v_exp_f32 v44, v44
    v_mfma_f32_16x16x32_bf16 v[56:59], a[64:67], a[48:51], v[92:95]
    ds_read_b128 a[64:67], v4 offset:57344
    v_cvt_pk_bf16_f32 v69, v42, v43
    v_mfma_f32_16x16x32_bf16 v[48:51], a[68:71], a[36:39], v[48:51]
    v_exp_f32 v45, v45
    v_mfma_f32_16x16x32_bf16 v[56:59], a[68:71], a[52:55], v[56:59]
    ds_read_b128 a[68:71], v5 offset:57344
    v_cvt_pk_bf16_f32 v66, v36, v37
    v_mfma_f32_16x16x32_bf16 v[48:51], a[72:75], a[40:43], v[48:51]
    v_exp_f32 v46, v46
    v_mfma_f32_16x16x32_bf16 v[56:59], a[72:75], a[56:59], v[56:59]
    ds_read_b128 a[72:75], v6 offset:57344
    v_cvt_pk_bf16_f32 v67, v38, v39
    v_mfma_f32_16x16x32_bf16 v[48:51], a[76:79], a[44:47], v[48:51]
    v_exp_f32 v47, v47
    v_mfma_f32_16x16x32_bf16 v[56:59], a[76:79], a[60:63], v[56:59]
    ds_read_b128 a[76:79], v7 offset:57344
    v_cvt_pk_bf16_f32 v70, v44, v45
    v_mfma_f32_16x16x32_bf16 v[52:55], a[80:83], a[32:35], v[88:91]
    v_mfma_f32_16x16x32_bf16 v[60:63], a[80:83], a[48:51], v[92:95]
    ds_read_b128 a[80:83], v4 offset:61440
    v_cvt_pk_bf16_f32 v71, v46, v47
    v_mfma_f32_16x16x32_bf16 v[52:55], a[84:87], a[36:39], v[52:55]
    v_exp_f32 v48, v48
    v_mfma_f32_16x16x32_bf16 v[60:63], a[84:87], a[52:55], v[60:63]
    ds_read_b128 a[84:87], v5 offset:61440
    v_mfma_f32_16x16x32_bf16 v[52:55], a[88:91], a[40:43], v[52:55]
    v_exp_f32 v49, v49
    v_mfma_f32_16x16x32_bf16 v[60:63], a[88:91], a[56:59], v[60:63]
    ds_read_b128 a[88:91], v6 offset:61440
    v_mfma_f32_16x16x32_bf16 v[52:55], a[92:95], a[44:47], v[52:55]
    v_exp_f32 v50, v50
    v_mfma_f32_16x16x32_bf16 v[60:63], a[92:95], a[60:63], v[60:63]
    ds_read_b128 a[92:95], v7 offset:61440
    s_waitcnt lgkmcnt(8)
    v_mfma_f32_16x16x32_bf16 v[128:131], a[96:99], v[64:67], v[128:131]
    v_exp_f32 v51, v51
    v_mfma_f32_16x16x32_bf16 v[160:163], a[96:99], v[68:71], v[160:163]
    v_cvt_pk_bf16_f32 v72, v48, v49
    v_cvt_pk_bf16_f32 v73, v50, v51
    v_mfma_f32_16x16x32_bf16 v[132:135], a[100:103], v[64:67], v[132:135]
    v_exp_f32 v56, v56
    v_mfma_f32_16x16x32_bf16 v[164:167], a[100:103], v[68:71], v[164:167]
    v_mfma_f32_16x16x32_bf16 v[136:139], a[104:107], v[64:67], v[136:139]
    v_exp_f32 v57, v57
    v_mfma_f32_16x16x32_bf16 v[168:171], a[104:107], v[68:71], v[168:171]
    v_cvt_pk_bf16_f32 v76, v56, v57
    v_mfma_f32_16x16x32_bf16 v[140:143], a[108:111], v[64:67], v[140:143]
    v_exp_f32 v58, v58
    v_mfma_f32_16x16x32_bf16 v[172:175], a[108:111], v[68:71], v[172:175]
    v_mfma_f32_16x16x32_bf16 v[144:147], a[112:115], v[64:67], v[144:147]
    v_exp_f32 v59, v59
    v_mfma_f32_16x16x32_bf16 v[176:179], a[112:115], v[68:71], v[176:179]
    v_cvt_pk_bf16_f32 v77, v58, v59
    v_mfma_f32_16x16x32_bf16 v[148:151], a[116:119], v[64:67], v[148:151]
    v_exp_f32 v52, v52
    v_mfma_f32_16x16x32_bf16 v[180:183], a[116:119], v[68:71], v[180:183]
    v_mfma_f32_16x16x32_bf16 v[152:155], a[120:123], v[64:67], v[152:155]
    v_exp_f32 v53, v53
    v_mfma_f32_16x16x32_bf16 v[184:187], a[120:123], v[68:71], v[184:187]
    v_mfma_f32_16x16x32_bf16 v[156:159], a[124:127], v[64:67], v[156:159]
    v_exp_f32 v54, v54
    v_mfma_f32_16x16x32_bf16 v[188:191], a[124:127], v[68:71], v[188:191]
    v_mfma_f32_16x16x32_bf16 v[96:99], v[112:115], v[64:67], v[96:99]
    v_exp_f32 v55, v55
    v_mfma_f32_16x16x32_bf16 v[100:103], v[112:115], v[68:71], v[100:103]
    v_mov_b32 v24, 155632
    ds_read_b128 v[24:27], v24
    s_waitcnt lgkmcnt(0)
    v_or_b32 v24, v24, v25
    v_or_b32 v26, v26, v27
    v_or_b32 v24, v24, v26
    s_nop 0
    v_readfirstlane_b32 s101, v24
    s_nop 3
    s_andn2_b32 s101, s101, s87
    s_lshl_b32 s3, s75, 4
    s_and_b32 s86, s76, 8
    s_add_u32 s3, s3, s86
    v_mov_b32 v23, s3
    s_xor_b32 s86, s76, 8
    s_and_b32 s90, s76, 7
    s_lshl_b32 s3, s75, 4
    s_and_b32 s86, s86, 8
    s_add_u32 s3, s3, s86
    s_add_u32 s3, s3, s90
    v_mov_b32 v25, s3
    global_load_dwordx2 v[26:27], v23, s[94:95] sc1
    global_load_ubyte v28, v25, s[94:95] sc1
    s_waitcnt vmcnt(16) lgkmcnt(0)
    s_barrier
    v_mfma_f32_16x16x32_bf16 v[32:35], a[64:67], a[0:3], v[80:83]
    v_exp_f32 v60, v60
    v_mfma_f32_16x16x32_bf16 v[40:43], a[64:67], a[16:19], v[84:87]
    v_cvt_pk_bf16_f32 v74, v52, v53
    s_add_u32 m0, s80, 114688
    v_mfma_f32_16x16x32_bf16 v[32:35], a[68:71], a[4:7], v[32:35]
    v_exp_f32 v61, v61
    v_mfma_f32_16x16x32_bf16 v[40:43], a[68:71], a[20:23], v[40:43]
    v_cvt_pk_bf16_f32 v75, v54, v55
    v_cvt_pk_bf16_f32 v78, v60, v61
    v_mfma_f32_16x16x32_bf16 v[32:35], a[72:75], a[8:11], v[32:35]
    v_exp_f32 v62, v62
    v_mfma_f32_16x16x32_bf16 v[40:43], a[72:75], a[24:27], v[40:43]
    buffer_load_dwordx4 v20, s[12:15], s25 offen nt lds
    v_mfma_f32_16x16x32_bf16 v[32:35], a[76:79], a[12:15], v[32:35]
    v_exp_f32 v63, v63
    v_mfma_f32_16x16x32_bf16 v[40:43], a[76:79], a[28:31], v[40:43]
    v_cvt_pk_bf16_f32 v79, v62, v63
    v_mfma_f32_16x16x32_bf16 v[36:39], a[80:83], a[0:3], v[80:83]
    v_mfma_f32_16x16x32_bf16 v[44:47], a[80:83], a[16:19], v[84:87]
    s_add_u32 m0, s80, 118784
    v_mfma_f32_16x16x32_bf16 v[36:39], a[84:87], a[4:7], v[36:39]
    v_exp_f32 v32, v32
    v_mfma_f32_16x16x32_bf16 v[44:47], a[84:87], a[20:23], v[44:47]
    buffer_load_dwordx4 v21, s[12:15], s25 offen nt lds
    v_mfma_f32_16x16x32_bf16 v[36:39], a[88:91], a[8:11], v[36:39]
    v_exp_f32 v33, v33
    v_mfma_f32_16x16x32_bf16 v[44:47], a[88:91], a[24:27], v[44:47]
    v_cvt_pk_bf16_f32 v64, v32, v33
    v_mfma_f32_16x16x32_bf16 v[36:39], a[92:95], a[12:15], v[36:39]
    v_exp_f32 v34, v34
    v_mfma_f32_16x16x32_bf16 v[44:47], a[92:95], a[28:31], v[44:47]
    s_add_u32 m0, s80, 122880
    v_mfma_f32_16x16x32_bf16 v[192:195], a[96:99], v[72:75], v[192:195]
    v_exp_f32 v35, v35
    v_mfma_f32_16x16x32_bf16 v[224:227], a[96:99], v[76:79], v[224:227]
    ds_read_b64_tr_b16 a[96:97], v8 offset:0
    ds_read_b64_tr_b16 a[98:99], v8 offset:4096
    v_mfma_f32_16x16x32_bf16 v[196:199], a[100:103], v[72:75], v[196:199]
    v_exp_f32 v40, v40
    v_mfma_f32_16x16x32_bf16 v[228:231], a[100:103], v[76:79], v[228:231]
    ds_read_b64_tr_b16 a[100:101], v9 offset:0
    ds_read_b64_tr_b16 a[102:103], v9 offset:4096
    v_mfma_f32_16x16x32_bf16 v[200:203], a[104:107], v[72:75], v[200:203]
    v_exp_f32 v41, v41
    v_mfma_f32_16x16x32_bf16 v[232:235], a[104:107], v[76:79], v[232:235]
    ds_read_b64_tr_b16 a[104:105], v10 offset:0
    ds_read_b64_tr_b16 a[106:107], v10 offset:4096
    v_mfma_f32_16x16x32_bf16 v[204:207], a[108:111], v[72:75], v[204:207]
    v_exp_f32 v42, v42
    v_mfma_f32_16x16x32_bf16 v[236:239], a[108:111], v[76:79], v[236:239]
    ds_read_b64_tr_b16 a[108:109], v11 offset:0
    ds_read_b64_tr_b16 a[110:111], v11 offset:4096
    v_mfma_f32_16x16x32_bf16 v[208:211], a[112:115], v[72:75], v[208:211]
    v_exp_f32 v43, v43
    v_mfma_f32_16x16x32_bf16 v[240:243], a[112:115], v[76:79], v[240:243]
    ds_read_b64_tr_b16 a[112:113], v12 offset:0
    ds_read_b64_tr_b16 a[114:115], v12 offset:4096
    v_mfma_f32_16x16x32_bf16 v[212:215], a[116:119], v[72:75], v[212:215]
    v_exp_f32 v36, v36
    v_mfma_f32_16x16x32_bf16 v[244:247], a[116:119], v[76:79], v[244:247]
    ds_read_b64_tr_b16 a[116:117], v13 offset:0
    ds_read_b64_tr_b16 a[118:119], v13 offset:4096
    v_mfma_f32_16x16x32_bf16 v[216:219], a[120:123], v[72:75], v[216:219]
    v_exp_f32 v37, v37
    v_mfma_f32_16x16x32_bf16 v[248:251], a[120:123], v[76:79], v[248:251]
    ds_read_b64_tr_b16 a[120:121], v14 offset:0
    ds_read_b64_tr_b16 a[122:123], v14 offset:4096
    v_mfma_f32_16x16x32_bf16 v[220:223], a[124:127], v[72:75], v[220:223]
    v_exp_f32 v38, v38
    v_mfma_f32_16x16x32_bf16 v[252:255], a[124:127], v[76:79], v[252:255]
    ds_read_b64_tr_b16 a[124:125], v15 offset:0
    ds_read_b64_tr_b16 a[126:127], v15 offset:4096
    v_mfma_f32_16x16x32_bf16 v[104:107], v[112:115], v[72:75], v[104:107]
    v_exp_f32 v39, v39
    v_mfma_f32_16x16x32_bf16 v[108:111], v[112:115], v[76:79], v[108:111]
    v_cvt_pk_bf16_f32 v65, v34, v35
    v_cvt_pk_bf16_f32 v68, v40, v41
    v_mfma_f32_16x16x32_bf16 v[48:51], a[64:67], a[32:35], v[88:91]
    v_exp_f32 v44, v44
    v_mfma_f32_16x16x32_bf16 v[56:59], a[64:67], a[48:51], v[92:95]
    ds_read_b128 a[64:67], v4 offset:0
    v_cvt_pk_bf16_f32 v69, v42, v43
    v_mfma_f32_16x16x32_bf16 v[48:51], a[68:71], a[36:39], v[48:51]
    v_exp_f32 v45, v45
    v_mfma_f32_16x16x32_bf16 v[56:59], a[68:71], a[52:55], v[56:59]
    ds_read_b128 a[68:71], v5 offset:0
    v_cvt_pk_bf16_f32 v66, v36, v37
    v_mfma_f32_16x16x32_bf16 v[48:51], a[72:75], a[40:43], v[48:51]
    v_exp_f32 v46, v46
    v_mfma_f32_16x16x32_bf16 v[56:59], a[72:75], a[56:59], v[56:59]
    ds_read_b128 a[72:75], v6 offset:0
    v_cvt_pk_bf16_f32 v67, v38, v39
    v_mfma_f32_16x16x32_bf16 v[48:51], a[76:79], a[44:47], v[48:51]
    v_exp_f32 v47, v47
    v_mfma_f32_16x16x32_bf16 v[56:59], a[76:79], a[60:63], v[56:59]
    ds_read_b128 a[76:79], v7 offset:0
    v_cvt_pk_bf16_f32 v70, v44, v45
    v_mfma_f32_16x16x32_bf16 v[52:55], a[80:83], a[32:35], v[88:91]
    buffer_load_dwordx4 v20, s[12:15], s81 offen nt lds
    v_mfma_f32_16x16x32_bf16 v[60:63], a[80:83], a[48:51], v[92:95]
    ds_read_b128 a[80:83], v4 offset:4096
    v_cvt_pk_bf16_f32 v71, v46, v47
    v_mfma_f32_16x16x32_bf16 v[52:55], a[84:87], a[36:39], v[52:55]
    v_exp_f32 v48, v48
    v_mfma_f32_16x16x32_bf16 v[60:63], a[84:87], a[52:55], v[60:63]
    ds_read_b128 a[84:87], v5 offset:4096
    s_add_u32 m0, s80, 126976
    v_mfma_f32_16x16x32_bf16 v[52:55], a[88:91], a[40:43], v[52:55]
    v_exp_f32 v49, v49
    v_mfma_f32_16x16x32_bf16 v[60:63], a[88:91], a[56:59], v[60:63]
    ds_read_b128 a[88:91], v6 offset:4096
    buffer_load_dwordx4 v21, s[12:15], s81 offen nt lds
    v_mfma_f32_16x16x32_bf16 v[52:55], a[92:95], a[44:47], v[52:55]
    v_exp_f32 v50, v50
    v_mfma_f32_16x16x32_bf16 v[60:63], a[92:95], a[60:63], v[60:63]
    ds_read_b128 a[92:95], v7 offset:4096
    s_waitcnt lgkmcnt(8)
    v_mfma_f32_16x16x32_bf16 v[128:131], a[96:99], v[64:67], v[128:131]
    v_exp_f32 v51, v51
    v_mfma_f32_16x16x32_bf16 v[160:163], a[96:99], v[68:71], v[160:163]
    v_cvt_pk_bf16_f32 v72, v48, v49
    v_cvt_pk_bf16_f32 v73, v50, v51
    v_mfma_f32_16x16x32_bf16 v[132:135], a[100:103], v[64:67], v[132:135]
    v_exp_f32 v56, v56
    v_mfma_f32_16x16x32_bf16 v[164:167], a[100:103], v[68:71], v[164:167]
    s_add_u32 s25, s25, 16384
    s_add_u32 s81, s81, 16384
    v_mfma_f32_16x16x32_bf16 v[136:139], a[104:107], v[64:67], v[136:139]
    v_exp_f32 v57, v57
    v_mfma_f32_16x16x32_bf16 v[168:171], a[104:107], v[68:71], v[168:171]
    v_cvt_pk_bf16_f32 v76, v56, v57
    s_add_u32 m0, s80, 49152
    v_mfma_f32_16x16x32_bf16 v[140:143], a[108:111], v[64:67], v[140:143]
    v_exp_f32 v58, v58
    v_mfma_f32_16x16x32_bf16 v[172:175], a[108:111], v[68:71], v[172:175]
    buffer_load_dwordx4 v16, s[8:11], s26 offen nt lds
    v_mfma_f32_16x16x32_bf16 v[144:147], a[112:115], v[64:67], v[144:147]
    v_exp_f32 v59, v59
    v_mfma_f32_16x16x32_bf16 v[176:179], a[112:115], v[68:71], v[176:179]
    v_cvt_pk_bf16_f32 v77, v58, v59
    v_mfma_f32_16x16x32_bf16 v[148:151], a[116:119], v[64:67], v[148:151]
    v_exp_f32 v52, v52
    v_mfma_f32_16x16x32_bf16 v[180:183], a[116:119], v[68:71], v[180:183]
    s_add_u32 m0, s80, 53248
    v_mfma_f32_16x16x32_bf16 v[152:155], a[120:123], v[64:67], v[152:155]
    v_exp_f32 v53, v53
    v_mfma_f32_16x16x32_bf16 v[184:187], a[120:123], v[68:71], v[184:187]
    buffer_load_dwordx4 v17, s[8:11], s26 offen nt lds
    v_mfma_f32_16x16x32_bf16 v[156:159], a[124:127], v[64:67], v[156:159]
    v_exp_f32 v54, v54
    v_mfma_f32_16x16x32_bf16 v[188:191], a[124:127], v[68:71], v[188:191]
    v_mfma_f32_16x16x32_bf16 v[96:99], v[112:115], v[64:67], v[96:99]
    v_exp_f32 v55, v55
    v_mfma_f32_16x16x32_bf16 v[100:103], v[112:115], v[68:71], v[100:103]
    s_waitcnt lgkmcnt(0)
    v_mfma_f32_16x16x32_bf16 v[32:35], a[64:67], a[0:3], v[80:83]
    v_exp_f32 v60, v60
    v_mfma_f32_16x16x32_bf16 v[40:43], a[64:67], a[16:19], v[84:87]
    v_cvt_pk_bf16_f32 v74, v52, v53
    s_add_u32 m0, s80, 57344
    v_mfma_f32_16x16x32_bf16 v[32:35], a[68:71], a[4:7], v[32:35]
    v_exp_f32 v61, v61
    v_mfma_f32_16x16x32_bf16 v[40:43], a[68:71], a[20:23], v[40:43]
    v_cvt_pk_bf16_f32 v75, v54, v55
    v_cvt_pk_bf16_f32 v78, v60, v61
    v_mfma_f32_16x16x32_bf16 v[32:35], a[72:75], a[8:11], v[32:35]
    v_exp_f32 v62, v62
    v_mfma_f32_16x16x32_bf16 v[40:43], a[72:75], a[24:27], v[40:43]
    buffer_load_dwordx4 v16, s[8:11], s82 offen nt lds
    v_mfma_f32_16x16x32_bf16 v[32:35], a[76:79], a[12:15], v[32:35]
    v_exp_f32 v63, v63
    v_mfma_f32_16x16x32_bf16 v[40:43], a[76:79], a[28:31], v[40:43]
    v_cvt_pk_bf16_f32 v79, v62, v63
    v_mfma_f32_16x16x32_bf16 v[36:39], a[80:83], a[0:3], v[80:83]
    v_mfma_f32_16x16x32_bf16 v[44:47], a[80:83], a[16:19], v[84:87]
    s_add_u32 m0, s80, 61440
    v_mfma_f32_16x16x32_bf16 v[36:39], a[84:87], a[4:7], v[36:39]
    v_exp_f32 v32, v32
    v_mfma_f32_16x16x32_bf16 v[44:47], a[84:87], a[20:23], v[44:47]
    buffer_load_dwordx4 v17, s[8:11], s82 offen nt lds
    v_mfma_f32_16x16x32_bf16 v[36:39], a[88:91], a[8:11], v[36:39]
    v_exp_f32 v33, v33
    v_mfma_f32_16x16x32_bf16 v[44:47], a[88:91], a[24:27], v[44:47]
    v_cvt_pk_bf16_f32 v64, v32, v33
    s_add_u32 s26, s26, 16384
    v_mfma_f32_16x16x32_bf16 v[36:39], a[92:95], a[12:15], v[36:39]
    v_exp_f32 v34, v34
    v_mfma_f32_16x16x32_bf16 v[44:47], a[92:95], a[28:31], v[44:47]
    s_add_u32 s82, s82, 16384
    v_mfma_f32_16x16x32_bf16 v[192:195], a[96:99], v[72:75], v[192:195]
    v_exp_f32 v35, v35
    v_mfma_f32_16x16x32_bf16 v[224:227], a[96:99], v[76:79], v[224:227]
    ds_read_b64_tr_b16 a[96:97], v8 offset:8192
    ds_read_b64_tr_b16 a[98:99], v8 offset:12288
    v_mfma_f32_16x16x32_bf16 v[196:199], a[100:103], v[72:75], v[196:199]
    v_exp_f32 v40, v40
    v_mfma_f32_16x16x32_bf16 v[228:231], a[100:103], v[76:79], v[228:231]
    ds_read_b64_tr_b16 a[100:101], v9 offset:8192
    ds_read_b64_tr_b16 a[102:103], v9 offset:12288
    v_mfma_f32_16x16x32_bf16 v[200:203], a[104:107], v[72:75], v[200:203]
    v_exp_f32 v41, v41
    v_mfma_f32_16x16x32_bf16 v[232:235], a[104:107], v[76:79], v[232:235]
    ds_read_b64_tr_b16 a[104:105], v10 offset:8192
    ds_read_b64_tr_b16 a[106:107], v10 offset:12288
    v_mfma_f32_16x16x32_bf16 v[204:207], a[108:111], v[72:75], v[204:207]
    v_exp_f32 v42, v42
    v_mfma_f32_16x16x32_bf16 v[236:239], a[108:111], v[76:79], v[236:239]
    ds_read_b64_tr_b16 a[108:109], v11 offset:8192
    ds_read_b64_tr_b16 a[110:111], v11 offset:12288
    v_mfma_f32_16x16x32_bf16 v[208:211], a[112:115], v[72:75], v[208:211]
    v_exp_f32 v43, v43
    v_mfma_f32_16x16x32_bf16 v[240:243], a[112:115], v[76:79], v[240:243]
    ds_read_b64_tr_b16 a[112:113], v12 offset:8192
    ds_read_b64_tr_b16 a[114:115], v12 offset:12288
    v_mfma_f32_16x16x32_bf16 v[212:215], a[116:119], v[72:75], v[212:215]
    v_exp_f32 v36, v36
    v_mfma_f32_16x16x32_bf16 v[244:247], a[116:119], v[76:79], v[244:247]
    ds_read_b64_tr_b16 a[116:117], v13 offset:8192
    ds_read_b64_tr_b16 a[118:119], v13 offset:12288
    v_mfma_f32_16x16x32_bf16 v[216:219], a[120:123], v[72:75], v[216:219]
    v_exp_f32 v37, v37
    v_mfma_f32_16x16x32_bf16 v[248:251], a[120:123], v[76:79], v[248:251]
    ds_read_b64_tr_b16 a[120:121], v14 offset:8192
    ds_read_b64_tr_b16 a[122:123], v14 offset:12288
    v_mfma_f32_16x16x32_bf16 v[220:223], a[124:127], v[72:75], v[220:223]
    v_exp_f32 v38, v38
    v_mfma_f32_16x16x32_bf16 v[252:255], a[124:127], v[76:79], v[252:255]
    ds_read_b64_tr_b16 a[124:125], v15 offset:8192
    ds_read_b64_tr_b16 a[126:127], v15 offset:12288
    v_mfma_f32_16x16x32_bf16 v[104:107], v[112:115], v[72:75], v[104:107]
    v_exp_f32 v39, v39
    v_mfma_f32_16x16x32_bf16 v[108:111], v[112:115], v[76:79], v[108:111]
    v_cvt_pk_bf16_f32 v65, v34, v35
    v_cvt_pk_bf16_f32 v68, v40, v41
    v_mfma_f32_16x16x32_bf16 v[48:51], a[64:67], a[32:35], v[88:91]
    v_exp_f32 v44, v44
    v_mfma_f32_16x16x32_bf16 v[56:59], a[64:67], a[48:51], v[92:95]
    ds_read_b128 a[64:67], v4 offset:8192
    v_cvt_pk_bf16_f32 v69, v42, v43
    v_mfma_f32_16x16x32_bf16 v[48:51], a[68:71], a[36:39], v[48:51]
    v_exp_f32 v45, v45
    v_mfma_f32_16x16x32_bf16 v[56:59], a[68:71], a[52:55], v[56:59]
    ds_read_b128 a[68:71], v5 offset:8192
    v_cvt_pk_bf16_f32 v66, v36, v37
    v_mfma_f32_16x16x32_bf16 v[48:51], a[72:75], a[40:43], v[48:51]
    v_exp_f32 v46, v46
    v_mfma_f32_16x16x32_bf16 v[56:59], a[72:75], a[56:59], v[56:59]
    ds_read_b128 a[72:75], v6 offset:8192
    v_cvt_pk_bf16_f32 v67, v38, v39
    v_mfma_f32_16x16x32_bf16 v[48:51], a[76:79], a[44:47], v[48:51]
    v_exp_f32 v47, v47
    v_mfma_f32_16x16x32_bf16 v[56:59], a[76:79], a[60:63], v[56:59]
    ds_read_b128 a[76:79], v7 offset:8192
    v_cvt_pk_bf16_f32 v70, v44, v45
    v_mfma_f32_16x16x32_bf16 v[52:55], a[80:83], a[32:35], v[88:91]
    v_mfma_f32_16x16x32_bf16 v[60:63], a[80:83], a[48:51], v[92:95]
    ds_read_b128 a[80:83], v4 offset:12288
    v_cvt_pk_bf16_f32 v71, v46, v47
    v_mfma_f32_16x16x32_bf16 v[52:55], a[84:87], a[36:39], v[52:55]
    v_exp_f32 v48, v48
    v_mfma_f32_16x16x32_bf16 v[60:63], a[84:87], a[52:55], v[60:63]
    ds_read_b128 a[84:87], v5 offset:12288
    v_mfma_f32_16x16x32_bf16 v[52:55], a[88:91], a[40:43], v[52:55]
    v_exp_f32 v49, v49
    v_mfma_f32_16x16x32_bf16 v[60:63], a[88:91], a[56:59], v[60:63]
    ds_read_b128 a[88:91], v6 offset:12288
    v_mfma_f32_16x16x32_bf16 v[52:55], a[92:95], a[44:47], v[52:55]
    v_exp_f32 v50, v50
    v_mfma_f32_16x16x32_bf16 v[60:63], a[92:95], a[60:63], v[60:63]
    ds_read_b128 a[92:95], v7 offset:12288
    s_waitcnt lgkmcnt(8)
    v_mfma_f32_16x16x32_bf16 v[128:131], a[96:99], v[64:67], v[128:131]
    v_exp_f32 v51, v51
    v_mfma_f32_16x16x32_bf16 v[160:163], a[96:99], v[68:71], v[160:163]
    v_cvt_pk_bf16_f32 v72, v48, v49
    v_cvt_pk_bf16_f32 v73, v50, v51
    v_mfma_f32_16x16x32_bf16 v[132:135], a[100:103], v[64:67], v[132:135]
    v_exp_f32 v56, v56
    v_mfma_f32_16x16x32_bf16 v[164:167], a[100:103], v[68:71], v[164:167]
    v_mfma_f32_16x16x32_bf16 v[136:139], a[104:107], v[64:67], v[136:139]
    v_exp_f32 v57, v57
    v_mfma_f32_16x16x32_bf16 v[168:171], a[104:107], v[68:71], v[168:171]
    v_cvt_pk_bf16_f32 v76, v56, v57
    v_mfma_f32_16x16x32_bf16 v[140:143], a[108:111], v[64:67], v[140:143]
    v_exp_f32 v58, v58
    v_mfma_f32_16x16x32_bf16 v[172:175], a[108:111], v[68:71], v[172:175]
    v_mfma_f32_16x16x32_bf16 v[144:147], a[112:115], v[64:67], v[144:147]
    v_exp_f32 v59, v59
    v_mfma_f32_16x16x32_bf16 v[176:179], a[112:115], v[68:71], v[176:179]
    v_cvt_pk_bf16_f32 v77, v58, v59
    v_mfma_f32_16x16x32_bf16 v[148:151], a[116:119], v[64:67], v[148:151]
    v_exp_f32 v52, v52
    v_mfma_f32_16x16x32_bf16 v[180:183], a[116:119], v[68:71], v[180:183]
    v_mfma_f32_16x16x32_bf16 v[152:155], a[120:123], v[64:67], v[152:155]
    v_exp_f32 v53, v53
    v_mfma_f32_16x16x32_bf16 v[184:187], a[120:123], v[68:71], v[184:187]
    v_mfma_f32_16x16x32_bf16 v[156:159], a[124:127], v[64:67], v[156:159]
    v_exp_f32 v54, v54
    v_mfma_f32_16x16x32_bf16 v[188:191], a[124:127], v[68:71], v[188:191]
    v_mfma_f32_16x16x32_bf16 v[96:99], v[112:115], v[64:67], v[96:99]
    v_exp_f32 v55, v55
    v_mfma_f32_16x16x32_bf16 v[100:103], v[112:115], v[68:71], v[100:103]
    s_waitcnt vmcnt(8)
    v_readfirstlane_b32 s3, v26
    v_readfirstlane_b32 s86, v27
    s_nop 0
    s_sub_u32 s90, s3, 0x01010101
    s_andn2_b32 s90, s90, s3
    s_sub_u32 s3, s86, 0x01010101
    s_andn2_b32 s3, s3, s86
    s_or_b32 s90, s90, s3
    s_and_b32 s90, s90, 0x80808080
    v_readfirstlane_b32 s3, v28
    s_nop 0
    s_and_b32 s3, s3, 3
    s_cmp_eq_u32 s3, 0
    s_cselect_b32 s3, 1, 0
    s_or_b32 s90, s90, s3
    s_cmp_eq_u32 s90, 0
    s_cbranch_scc1 L_p1_skip
    s_cmp_lg_u32 s101, 0
    s_cbranch_scc1 L_p1_skip
    s_mov_b32 s91, 262144
    s_lshl_b32 s3, s75, 4
    s_and_b32 s86, s76, 8
    s_add_u32 s3, s3, s86
    v_mov_b32 v23, s3
    s_xor_b32 s86, s76, 8
    s_and_b32 s90, s76, 7
    s_lshl_b32 s3, s75, 4
    s_and_b32 s86, s86, 8
    s_add_u32 s3, s3, s86
    s_add_u32 s3, s3, s90
    v_mov_b32 v25, s3
L_poll1:
    global_load_dwordx2 v[30:31], v23, s[94:95] sc1
    global_load_ubyte v27, v25, s[94:95] sc1
    s_waitcnt vmcnt(0)
    v_readfirstlane_b32 s3, v30
    v_readfirstlane_b32 s86, v31
    s_nop 0
    s_sub_u32 s90, s3, 0x01010101
    s_andn2_b32 s90, s90, s3
    s_sub_u32 s3, s86, 0x01010101
    s_andn2_b32 s3, s3, s86
    s_or_b32 s90, s90, s3
    s_and_b32 s90, s90, 0x80808080
    v_readfirstlane_b32 s3, v27
    s_nop 0
    s_and_b32 s3, s3, 3
    s_cmp_eq_u32 s3, 0
    s_cselect_b32 s3, 1, 0
    s_or_b32 s90, s90, s3
    s_cmp_eq_u32 s90, 0
    s_cbranch_scc1 L_poll1_ok
    s_sleep 2
    s_sub_u32 s91, s91, 1
    s_cmp_lg_u32 s91, 0
    s_cbranch_scc1 L_poll1
L_poll1_ok:
L_p1_skip:
    s_lshr_b32 s77, s76, 3
    s_lshl_b32 s3, s77, 21
    s_and_b32 s86, s76, 3
    s_lshl_b32 s86, s86, 8
    s_add_u32 s3, s3, s86
    s_add_u32 s8, s84, s3
    s_addc_u32 s9, s85, 0
    s_sub_u32 s10, 0x200000, s86
    s_mov_b32 s11, 0x20000
    s_lshl_b32 s3, s75, 21
    s_add_u32 s3, s3, 33554432
    s_bfe_u32 s86, s76, 0x10002
    s_lshl_b32 s86, s86, 20
    s_add_u32 s3, s3, s86
    s_lshl_b32 s86, s77, 16
    s_add_u32 s3, s3, s86
    s_add_u32 s12, s30, s3
    s_addc_u32 s13, s31, 0
    s_sub_u32 s14, 0x100000, s86
    s_mov_b32 s15, 0x20000
    s_lshl_b32 s3, s75, 18
    s_bfe_u32 s86, s76, 0x10002
    s_lshl_b32 s86, s86, 17
    s_add_u32 s3, s3, s86
    s_and_b32 s86, s76, 3
    s_lshl_b32 s86, s86, 8
    s_add_u32 s3, s3, s86
    s_add_u32 s16, s92, s3
    s_addc_u32 s17, s93, 0
    s_sub_u32 s18, 0x20000, s86
    s_mov_b32 s19, 0x20000
    v_bfe_u32 v29, v0, 4, 2
    v_add_u32 v23, 0, v29
    v_and_b32 v25, 7, v23
    v_lshlrev_b32 v25, 1, v25
    v_xor_b32 v25, v25, v3
    v_lshl_add_u32 v23, v2, 4, v23
    v_lshlrev_b32 v23, 10, v23
    v_lshl_add_u32 v23, v25, 4, v23
    v_subrev_u32 v16, 0, v23
    v_add_u32 v23, 4, v29
    v_and_b32 v25, 7, v23
    v_lshlrev_b32 v25, 1, v25
    v_xor_b32 v25, v25, v3
    v_lshl_add_u32 v23, v2, 4, v23
    v_lshlrev_b32 v23, 10, v23
    v_lshl_add_u32 v23, v25, 4, v23
    v_subrev_u32 v17, 1024, v23
    v_add_u32 v23, 8, v29
    v_and_b32 v25, 7, v23
    v_lshlrev_b32 v25, 1, v25
    v_xor_b32 v25, v25, v3
    v_lshl_add_u32 v23, v2, 4, v23
    v_lshlrev_b32 v23, 10, v23
    v_lshl_add_u32 v23, v25, 4, v23
    v_subrev_u32 v18, 2048, v23
    v_add_u32 v23, 12, v29
    v_and_b32 v25, 7, v23
    v_lshlrev_b32 v25, 1, v25
    v_xor_b32 v25, v25, v3
    v_lshl_add_u32 v23, v2, 4, v23
    v_lshlrev_b32 v23, 10, v23
    v_lshl_add_u32 v23, v25, 4, v23
    v_subrev_u32 v19, 3072, v23
    v_lshlrev_b32 v23, 1, v2
    v_add_u32 v23, 0, v23
    v_lshlrev_b32 v23, 17, v23
    v_lshl_add_u32 v20, v1, 4, v23
    v_lshlrev_b32 v23, 1, v2
    v_add_u32 v23, 1, v23
    v_lshlrev_b32 v23, 17, v23
    v_lshl_add_u32 v21, v1, 4, v23
    s_lshr_b32 s3, s2, 3
    s_lshl_b32 s3, s3, 16
    s_lshl_b32 s86, s77, 21
    s_add_u32 s3, s3, s86
    v_lshrrev_b32 v23, 3, v1
    v_lshl_add_u32 v23, v2, 4, v23
    v_lshlrev_b32 v23, 10, v23
    v_and_b32 v25, 7, v1
    v_lshl_add_u32 v23, v25, 7, v23
    v_add_u32 v23, s3, v23
    v_add_u32 v25, 0x2000, v23
    global_load_dword v31, v23, s[84:85]
    global_load_dword v31, v25, s[84:85]
    s_waitcnt vmcnt(10) lgkmcnt(0)
    s_barrier
    v_mfma_f32_16x16x32_bf16 v[32:35], a[64:67], a[0:3], v[80:83]
    v_exp_f32 v60, v60
    v_mfma_f32_16x16x32_bf16 v[40:43], a[64:67], a[16:19], v[84:87]
    v_cvt_pk_bf16_f32 v74, v52, v53
    s_add_u32 m0, s24, 65536
    s_mov_b32 s25, 0
    v_mfma_f32_16x16x32_bf16 v[32:35], a[68:71], a[4:7], v[32:35]
    v_exp_f32 v61, v61
    v_mfma_f32_16x16x32_bf16 v[40:43], a[68:71], a[20:23], v[40:43]
    v_cvt_pk_bf16_f32 v75, v54, v55
    v_cvt_pk_bf16_f32 v78, v60, v61
    v_mfma_f32_16x16x32_bf16 v[32:35], a[72:75], a[8:11], v[32:35]
    v_exp_f32 v62, v62
    v_mfma_f32_16x16x32_bf16 v[40:43], a[72:75], a[24:27], v[40:43]
    buffer_load_dwordx4 v16, s[8:11], s25 offen offset:0 lds
    v_mfma_f32_16x16x32_bf16 v[32:35], a[76:79], a[12:15], v[32:35]
    v_exp_f32 v63, v63
    v_mfma_f32_16x16x32_bf16 v[40:43], a[76:79], a[28:31], v[40:43]
    v_cvt_pk_bf16_f32 v79, v62, v63
    v_mfma_f32_16x16x32_bf16 v[36:39], a[80:83], a[0:3], v[80:83]
    v_mfma_f32_16x16x32_bf16 v[44:47], a[80:83], a[16:19], v[84:87]
    v_mfma_f32_16x16x32_bf16 v[36:39], a[84:87], a[4:7], v[36:39]
    v_exp_f32 v32, v32
    v_mfma_f32_16x16x32_bf16 v[44:47], a[84:87], a[20:23], v[44:47]
    buffer_load_dwordx4 v17, s[8:11], s25 offen offset:1024 lds
    v_mfma_f32_16x16x32_bf16 v[36:39], a[88:91], a[8:11], v[36:39]
    v_exp_f32 v33, v33
    v_mfma_f32_16x16x32_bf16 v[44:47], a[88:91], a[24:27], v[44:47]
    v_cvt_pk_bf16_f32 v64, v32, v33
    v_mfma_f32_16x16x32_bf16 v[36:39], a[92:95], a[12:15], v[36:39]
    v_exp_f32 v34, v34
    v_mfma_f32_16x16x32_bf16 v[44:47], a[92:95], a[28:31], v[44:47]
    v_mfma_f32_16x16x32_bf16 v[192:195], a[96:99], v[72:75], v[192:195]
    v_exp_f32 v35, v35
    v_mfma_f32_16x16x32_bf16 v[224:227], a[96:99], v[76:79], v[224:227]
    ds_read_b64_tr_b16 a[96:97], v8 offset:16384
    ds_read_b64_tr_b16 a[98:99], v8 offset:20480
    v_mfma_f32_16x16x32_bf16 v[196:199], a[100:103], v[72:75], v[196:199]
    v_exp_f32 v40, v40
    v_mfma_f32_16x16x32_bf16 v[228:231], a[100:103], v[76:79], v[228:231]
    ds_read_b64_tr_b16 a[100:101], v9 offset:16384
    ds_read_b64_tr_b16 a[102:103], v9 offset:20480
    v_mfma_f32_16x16x32_bf16 v[200:203], a[104:107], v[72:75], v[200:203]
    v_exp_f32 v41, v41
    v_mfma_f32_16x16x32_bf16 v[232:235], a[104:107], v[76:79], v[232:235]
    ds_read_b64_tr_b16 a[104:105], v10 offset:16384
    ds_read_b64_tr_b16 a[106:107], v10 offset:20480
    v_mfma_f32_16x16x32_bf16 v[204:207], a[108:111], v[72:75], v[204:207]
    v_exp_f32 v42, v42
    v_mfma_f32_16x16x32_bf16 v[236:239], a[108:111], v[76:79], v[236:239]
    ds_read_b64_tr_b16 a[108:109], v11 offset:16384
    ds_read_b64_tr_b16 a[110:111], v11 offset:20480
    v_mfma_f32_16x16x32_bf16 v[208:211], a[112:115], v[72:75], v[208:211]
    v_exp_f32 v43, v43
    v_mfma_f32_16x16x32_bf16 v[240:243], a[112:115], v[76:79], v[240:243]
    ds_read_b64_tr_b16 a[112:113], v12 offset:16384
    ds_read_b64_tr_b16 a[114:115], v12 offset:20480
    v_mfma_f32_16x16x32_bf16 v[212:215], a[116:119], v[72:75], v[212:215]
    v_exp_f32 v36, v36
    v_mfma_f32_16x16x32_bf16 v[244:247], a[116:119], v[76:79], v[244:247]
    ds_read_b64_tr_b16 a[116:117], v13 offset:16384
    ds_read_b64_tr_b16 a[118:119], v13 offset:20480
    v_mfma_f32_16x16x32_bf16 v[216:219], a[120:123], v[72:75], v[216:219]
    v_exp_f32 v37, v37
    v_mfma_f32_16x16x32_bf16 v[248:251], a[120:123], v[76:79], v[248:251]
    ds_read_b64_tr_b16 a[120:121], v14 offset:16384
    ds_read_b64_tr_b16 a[122:123], v14 offset:20480
    v_mfma_f32_16x16x32_bf16 v[220:223], a[124:127], v[72:75], v[220:223]
    v_exp_f32 v38, v38
    v_mfma_f32_16x16x32_bf16 v[252:255], a[124:127], v[76:79], v[252:255]
    ds_read_b64_tr_b16 a[124:125], v15 offset:16384
    ds_read_b64_tr_b16 a[126:127], v15 offset:20480
    v_mfma_f32_16x16x32_bf16 v[104:107], v[112:115], v[72:75], v[104:107]
    v_exp_f32 v39, v39
    v_mfma_f32_16x16x32_bf16 v[108:111], v[112:115], v[76:79], v[108:111]
    v_cvt_pk_bf16_f32 v65, v34, v35
    v_cvt_pk_bf16_f32 v68, v40, v41
    v_mfma_f32_16x16x32_bf16 v[48:51], a[64:67], a[32:35], v[88:91]
    v_exp_f32 v44, v44
    v_mfma_f32_16x16x32_bf16 v[56:59], a[64:67], a[48:51], v[92:95]
    ds_read_b128 a[64:67], v4 offset:16384
    v_cvt_pk_bf16_f32 v69, v42, v43
    v_mfma_f32_16x16x32_bf16 v[48:51], a[68:71], a[36:39], v[48:51]
    v_exp_f32 v45, v45
    v_mfma_f32_16x16x32_bf16 v[56:59], a[68:71], a[52:55], v[56:59]
    ds_read_b128 a[68:71], v5 offset:16384
    v_cvt_pk_bf16_f32 v66, v36, v37
    v_mfma_f32_16x16x32_bf16 v[48:51], a[72:75], a[40:43], v[48:51]
    v_exp_f32 v46, v46
    v_mfma_f32_16x16x32_bf16 v[56:59], a[72:75], a[56:59], v[56:59]
    ds_read_b128 a[72:75], v6 offset:16384
    v_cvt_pk_bf16_f32 v67, v38, v39
    v_mfma_f32_16x16x32_bf16 v[48:51], a[76:79], a[44:47], v[48:51]
    v_exp_f32 v47, v47
    v_mfma_f32_16x16x32_bf16 v[56:59], a[76:79], a[60:63], v[56:59]
    ds_read_b128 a[76:79], v7 offset:16384
    v_cvt_pk_bf16_f32 v70, v44, v45
    v_mfma_f32_16x16x32_bf16 v[52:55], a[80:83], a[32:35], v[88:91]
    buffer_load_dwordx4 v18, s[8:11], s25 offen offset:2048 lds
    v_mfma_f32_16x16x32_bf16 v[60:63], a[80:83], a[48:51], v[92:95]
    ds_read_b128 a[80:83], v4 offset:20480
    v_cvt_pk_bf16_f32 v71, v46, v47
    v_mfma_f32_16x16x32_bf16 v[52:55], a[84:87], a[36:39], v[52:55]
    v_exp_f32 v48, v48
    v_mfma_f32_16x16x32_bf16 v[60:63], a[84:87], a[52:55], v[60:63]
    ds_read_b128 a[84:87], v5 offset:20480
    v_mfma_f32_16x16x32_bf16 v[52:55], a[88:91], a[40:43], v[52:55]
    v_exp_f32 v49, v49
    v_mfma_f32_16x16x32_bf16 v[60:63], a[88:91], a[56:59], v[60:63]
    ds_read_b128 a[88:91], v6 offset:20480
    buffer_load_dwordx4 v19, s[8:11], s25 offen offset:3072 lds
    v_mfma_f32_16x16x32_bf16 v[52:55], a[92:95], a[44:47], v[52:55]
    v_exp_f32 v50, v50
    v_mfma_f32_16x16x32_bf16 v[60:63], a[92:95], a[60:63], v[60:63]
    ds_read_b128 a[92:95], v7 offset:20480
    s_waitcnt lgkmcnt(8)
    v_mfma_f32_16x16x32_bf16 v[128:131], a[96:99], v[64:67], v[128:131]
    v_exp_f32 v51, v51
    v_mfma_f32_16x16x32_bf16 v[160:163], a[96:99], v[68:71], v[160:163]
    v_cvt_pk_bf16_f32 v72, v48, v49
    v_cvt_pk_bf16_f32 v73, v50, v51
    v_mfma_f32_16x16x32_bf16 v[132:135], a[100:103], v[64:67], v[132:135]
    v_exp_f32 v56, v56
    v_mfma_f32_16x16x32_bf16 v[164:167], a[100:103], v[68:71], v[164:167]
    s_mov_b32 s26, 0
    buffer_load_dwordx4 a[128:131], v20, s[12:15], s26 offen offset:0 sc1
    v_mfma_f32_16x16x32_bf16 v[136:139], a[104:107], v[64:67], v[136:139]
    v_exp_f32 v57, v57
    v_mfma_f32_16x16x32_bf16 v[168:171], a[104:107], v[68:71], v[168:171]
    v_cvt_pk_bf16_f32 v76, v56, v57
    v_mfma_f32_16x16x32_bf16 v[140:143], a[108:111], v[64:67], v[140:143]
    v_exp_f32 v58, v58
    v_mfma_f32_16x16x32_bf16 v[172:175], a[108:111], v[68:71], v[172:175]
    buffer_load_dwordx4 a[132:135], v21, s[12:15], s26 offen offset:0 sc1
    v_mfma_f32_16x16x32_bf16 v[144:147], a[112:115], v[64:67], v[144:147]
    v_exp_f32 v59, v59
    v_mfma_f32_16x16x32_bf16 v[176:179], a[112:115], v[68:71], v[176:179]
    v_cvt_pk_bf16_f32 v77, v58, v59
    v_mfma_f32_16x16x32_bf16 v[148:151], a[116:119], v[64:67], v[148:151]
    v_exp_f32 v52, v52
    v_mfma_f32_16x16x32_bf16 v[180:183], a[116:119], v[68:71], v[180:183]
    buffer_load_dwordx4 a[136:139], v20, s[12:15], s26 offen offset:1024 sc1
    v_mfma_f32_16x16x32_bf16 v[152:155], a[120:123], v[64:67], v[152:155]
    v_exp_f32 v53, v53
    v_mfma_f32_16x16x32_bf16 v[184:187], a[120:123], v[68:71], v[184:187]
    v_mfma_f32_16x16x32_bf16 v[156:159], a[124:127], v[64:67], v[156:159]
    v_exp_f32 v54, v54
    v_mfma_f32_16x16x32_bf16 v[188:191], a[124:127], v[68:71], v[188:191]
    buffer_load_dwordx4 a[140:143], v21, s[12:15], s26 offen offset:1024 sc1
    v_mfma_f32_16x16x32_bf16 v[96:99], v[112:115], v[64:67], v[96:99]
    v_exp_f32 v55, v55
    v_mfma_f32_16x16x32_bf16 v[100:103], v[112:115], v[68:71], v[100:103]
    s_waitcnt lgkmcnt(0)
    v_mfma_f32_16x16x32_bf16 v[32:35], a[64:67], a[0:3], v[80:83]
    v_exp_f32 v60, v60
    v_mfma_f32_16x16x32_bf16 v[40:43], a[64:67], a[16:19], v[84:87]
    v_cvt_pk_bf16_f32 v74, v52, v53
    s_add_u32 m0, s24, 0
    s_mov_b32 s25, 65536
    v_mfma_f32_16x16x32_bf16 v[32:35], a[68:71], a[4:7], v[32:35]
    v_exp_f32 v61, v61
    v_mfma_f32_16x16x32_bf16 v[40:43], a[68:71], a[20:23], v[40:43]
    v_cvt_pk_bf16_f32 v75, v54, v55
    v_cvt_pk_bf16_f32 v78, v60, v61
    v_mfma_f32_16x16x32_bf16 v[32:35], a[72:75], a[8:11], v[32:35]
    v_exp_f32 v62, v62
    v_mfma_f32_16x16x32_bf16 v[40:43], a[72:75], a[24:27], v[40:43]
    buffer_load_dwordx4 v16, s[8:11], s25 offen offset:0 lds
    v_mfma_f32_16x16x32_bf16 v[32:35], a[76:79], a[12:15], v[32:35]
    v_exp_f32 v63, v63
    v_mfma_f32_16x16x32_bf16 v[40:43], a[76:79], a[28:31], v[40:43]
    v_cvt_pk_bf16_f32 v79, v62, v63
    v_mfma_f32_16x16x32_bf16 v[36:39], a[80:83], a[0:3], v[80:83]
    v_mfma_f32_16x16x32_bf16 v[44:47], a[80:83], a[16:19], v[84:87]
    v_mfma_f32_16x16x32_bf16 v[36:39], a[84:87], a[4:7], v[36:39]
    v_exp_f32 v32, v32
    v_mfma_f32_16x16x32_bf16 v[44:47], a[84:87], a[20:23], v[44:47]
    buffer_load_dwordx4 v17, s[8:11], s25 offen offset:1024 lds
    v_mfma_f32_16x16x32_bf16 v[36:39], a[88:91], a[8:11], v[36:39]
    v_exp_f32 v33, v33
    v_mfma_f32_16x16x32_bf16 v[44:47], a[88:91], a[24:27], v[44:47]
    v_cvt_pk_bf16_f32 v64, v32, v33
    v_mfma_f32_16x16x32_bf16 v[36:39], a[92:95], a[12:15], v[36:39]
    v_exp_f32 v34, v34
    v_mfma_f32_16x16x32_bf16 v[44:47], a[92:95], a[28:31], v[44:47]
    v_mfma_f32_16x16x32_bf16 v[192:195], a[96:99], v[72:75], v[192:195]
    v_exp_f32 v35, v35
    v_mfma_f32_16x16x32_bf16 v[224:227], a[96:99], v[76:79], v[224:227]
    ds_read_b64_tr_b16 a[96:97], v8 offset:24576
    ds_read_b64_tr_b16 a[98:99], v8 offset:28672
    v_mfma_f32_16x16x32_bf16 v[196:199], a[100:103], v[72:75], v[196:199]
    v_exp_f32 v40, v40
    v_mfma_f32_16x16x32_bf16 v[228:231], a[100:103], v[76:79], v[228:231]
    ds_read_b64_tr_b16 a[100:101], v9 offset:24576
    ds_read_b64_tr_b16 a[102:103], v9 offset:28672
    v_mfma_f32_16x16x32_bf16 v[200:203], a[104:107], v[72:75], v[200:203]
    v_exp_f32 v41, v41
    v_mfma_f32_16x16x32_bf16 v[232:235], a[104:107], v[76:79], v[232:235]
    ds_read_b64_tr_b16 a[104:105], v10 offset:24576
    ds_read_b64_tr_b16 a[106:107], v10 offset:28672
    v_mfma_f32_16x16x32_bf16 v[204:207], a[108:111], v[72:75], v[204:207]
    v_exp_f32 v42, v42
    v_mfma_f32_16x16x32_bf16 v[236:239], a[108:111], v[76:79], v[236:239]
    ds_read_b64_tr_b16 a[108:109], v11 offset:24576
    ds_read_b64_tr_b16 a[110:111], v11 offset:28672
    v_mfma_f32_16x16x32_bf16 v[208:211], a[112:115], v[72:75], v[208:211]
    v_exp_f32 v43, v43
    v_mfma_f32_16x16x32_bf16 v[240:243], a[112:115], v[76:79], v[240:243]
    ds_read_b64_tr_b16 a[112:113], v12 offset:24576
    ds_read_b64_tr_b16 a[114:115], v12 offset:28672
    v_mfma_f32_16x16x32_bf16 v[212:215], a[116:119], v[72:75], v[212:215]
    v_exp_f32 v36, v36
    v_mfma_f32_16x16x32_bf16 v[244:247], a[116:119], v[76:79], v[244:247]
    ds_read_b64_tr_b16 a[116:117], v13 offset:24576
    ds_read_b64_tr_b16 a[118:119], v13 offset:28672
    v_mfma_f32_16x16x32_bf16 v[216:219], a[120:123], v[72:75], v[216:219]
    v_exp_f32 v37, v37
    v_mfma_f32_16x16x32_bf16 v[248:251], a[120:123], v[76:79], v[248:251]
    ds_read_b64_tr_b16 a[120:121], v14 offset:24576
    ds_read_b64_tr_b16 a[122:123], v14 offset:28672
    v_mfma_f32_16x16x32_bf16 v[220:223], a[124:127], v[72:75], v[220:223]
    v_exp_f32 v38, v38
    v_mfma_f32_16x16x32_bf16 v[252:255], a[124:127], v[76:79], v[252:255]
    ds_read_b64_tr_b16 a[124:125], v15 offset:24576
    ds_read_b64_tr_b16 a[126:127], v15 offset:28672
    v_mfma_f32_16x16x32_bf16 v[104:107], v[112:115], v[72:75], v[104:107]
    v_exp_f32 v39, v39
    v_mfma_f32_16x16x32_bf16 v[108:111], v[112:115], v[76:79], v[108:111]
    v_cvt_pk_bf16_f32 v65, v34, v35
    v_cvt_pk_bf16_f32 v68, v40, v41
    v_mfma_f32_16x16x32_bf16 v[48:51], a[64:67], a[32:35], v[88:91]
    v_exp_f32 v44, v44
    v_mfma_f32_16x16x32_bf16 v[56:59], a[64:67], a[48:51], v[92:95]
    ds_read_b128 a[64:67], v4 offset:24576
    v_cvt_pk_bf16_f32 v69, v42, v43
    v_mfma_f32_16x16x32_bf16 v[48:51], a[68:71], a[36:39], v[48:51]
    v_exp_f32 v45, v45
    v_mfma_f32_16x16x32_bf16 v[56:59], a[68:71], a[52:55], v[56:59]
    ds_read_b128 a[68:71], v5 offset:24576
    v_cvt_pk_bf16_f32 v66, v36, v37
    v_mfma_f32_16x16x32_bf16 v[48:51], a[72:75], a[40:43], v[48:51]
    v_exp_f32 v46, v46
    v_mfma_f32_16x16x32_bf16 v[56:59], a[72:75], a[56:59], v[56:59]
    ds_read_b128 a[72:75], v6 offset:24576
    v_cvt_pk_bf16_f32 v67, v38, v39
    v_mfma_f32_16x16x32_bf16 v[48:51], a[76:79], a[44:47], v[48:51]
    v_exp_f32 v47, v47
    v_mfma_f32_16x16x32_bf16 v[56:59], a[76:79], a[60:63], v[56:59]
    ds_read_b128 a[76:79], v7 offset:24576
    v_cvt_pk_bf16_f32 v70, v44, v45
    v_mfma_f32_16x16x32_bf16 v[52:55], a[80:83], a[32:35], v[88:91]
    buffer_load_dwordx4 v18, s[8:11], s25 offen offset:2048 lds
    v_mfma_f32_16x16x32_bf16 v[60:63], a[80:83], a[48:51], v[92:95]
    ds_read_b128 a[80:83], v4 offset:28672
    v_cvt_pk_bf16_f32 v71, v46, v47
    v_mfma_f32_16x16x32_bf16 v[52:55], a[84:87], a[36:39], v[52:55]
    v_exp_f32 v48, v48
    v_mfma_f32_16x16x32_bf16 v[60:63], a[84:87], a[52:55], v[60:63]
    ds_read_b128 a[84:87], v5 offset:28672
    v_mfma_f32_16x16x32_bf16 v[52:55], a[88:91], a[40:43], v[52:55]
    v_exp_f32 v49, v49
    v_mfma_f32_16x16x32_bf16 v[60:63], a[88:91], a[56:59], v[60:63]
    ds_read_b128 a[88:91], v6 offset:28672
    buffer_load_dwordx4 v19, s[8:11], s25 offen offset:3072 lds
    v_mfma_f32_16x16x32_bf16 v[52:55], a[92:95], a[44:47], v[52:55]
    v_exp_f32 v50, v50
    v_mfma_f32_16x16x32_bf16 v[60:63], a[92:95], a[60:63], v[60:63]
    ds_read_b128 a[92:95], v7 offset:28672
    s_waitcnt lgkmcnt(8)
    v_mfma_f32_16x16x32_bf16 v[128:131], a[96:99], v[64:67], v[128:131]
    v_exp_f32 v51, v51
    v_mfma_f32_16x16x32_bf16 v[160:163], a[96:99], v[68:71], v[160:163]
    v_cvt_pk_bf16_f32 v72, v48, v49
    v_cvt_pk_bf16_f32 v73, v50, v51
    v_mfma_f32_16x16x32_bf16 v[132:135], a[100:103], v[64:67], v[132:135]
    v_exp_f32 v56, v56
    v_mfma_f32_16x16x32_bf16 v[164:167], a[100:103], v[68:71], v[164:167]
    s_mov_b32 s26, 2048
    buffer_load_dwordx4 a[144:147], v20, s[12:15], s26 offen offset:0 sc1
    v_mfma_f32_16x16x32_bf16 v[136:139], a[104:107], v[64:67], v[136:139]
    v_exp_f32 v57, v57
    v_mfma_f32_16x16x32_bf16 v[168:171], a[104:107], v[68:71], v[168:171]
    v_cvt_pk_bf16_f32 v76, v56, v57
    v_mfma_f32_16x16x32_bf16 v[140:143], a[108:111], v[64:67], v[140:143]
    v_exp_f32 v58, v58
    v_mfma_f32_16x16x32_bf16 v[172:175], a[108:111], v[68:71], v[172:175]
    buffer_load_dwordx4 a[148:151], v21, s[12:15], s26 offen offset:0 sc1
    v_mfma_f32_16x16x32_bf16 v[144:147], a[112:115], v[64:67], v[144:147]
    v_exp_f32 v59, v59
    v_mfma_f32_16x16x32_bf16 v[176:179], a[112:115], v[68:71], v[176:179]
    v_cvt_pk_bf16_f32 v77, v58, v59
    v_mfma_f32_16x16x32_bf16 v[148:151], a[116:119], v[64:67], v[148:151]
    v_exp_f32 v52, v52
    v_mfma_f32_16x16x32_bf16 v[180:183], a[116:119], v[68:71], v[180:183]
    buffer_load_dwordx4 a[152:155], v20, s[12:15], s26 offen offset:1024 sc1
    v_mfma_f32_16x16x32_bf16 v[152:155], a[120:123], v[64:67], v[152:155]
    v_exp_f32 v53, v53
    v_mfma_f32_16x16x32_bf16 v[184:187], a[120:123], v[68:71], v[184:187]
    v_mfma_f32_16x16x32_bf16 v[156:159], a[124:127], v[64:67], v[156:159]
    v_exp_f32 v54, v54
    v_mfma_f32_16x16x32_bf16 v[188:191], a[124:127], v[68:71], v[188:191]
    buffer_load_dwordx4 a[156:159], v21, s[12:15], s26 offen offset:1024 sc1
    v_mfma_f32_16x16x32_bf16 v[96:99], v[112:115], v[64:67], v[96:99]
    v_exp_f32 v55, v55
    v_mfma_f32_16x16x32_bf16 v[100:103], v[112:115], v[68:71], v[100:103]
    s_waitcnt vmcnt(26) lgkmcnt(0)
    s_barrier
    v_mfma_f32_16x16x32_bf16 v[32:35], a[64:67], a[0:3], v[80:83]
    v_exp_f32 v60, v60
    v_mfma_f32_16x16x32_bf16 v[40:43], a[64:67], a[16:19], v[84:87]
    v_cvt_pk_bf16_f32 v74, v52, v53
    s_add_u32 m0, s24, 81920
    s_mov_b32 s25, 262144
    v_mfma_f32_16x16x32_bf16 v[32:35], a[68:71], a[4:7], v[32:35]
    v_exp_f32 v61, v61
    v_mfma_f32_16x16x32_bf16 v[40:43], a[68:71], a[20:23], v[40:43]
    v_cvt_pk_bf16_f32 v75, v54, v55
    v_cvt_pk_bf16_f32 v78, v60, v61
    v_mfma_f32_16x16x32_bf16 v[32:35], a[72:75], a[8:11], v[32:35]
    v_exp_f32 v62, v62
    v_mfma_f32_16x16x32_bf16 v[40:43], a[72:75], a[24:27], v[40:43]
    buffer_load_dwordx4 v16, s[8:11], s25 offen offset:0 lds
    v_mfma_f32_16x16x32_bf16 v[32:35], a[76:79], a[12:15], v[32:35]
    v_exp_f32 v63, v63
    v_mfma_f32_16x16x32_bf16 v[40:43], a[76:79], a[28:31], v[40:43]
    v_cvt_pk_bf16_f32 v79, v62, v63
    v_mfma_f32_16x16x32_bf16 v[36:39], a[80:83], a[0:3], v[80:83]
    v_mfma_f32_16x16x32_bf16 v[44:47], a[80:83], a[16:19], v[84:87]
    v_mfma_f32_16x16x32_bf16 v[36:39], a[84:87], a[4:7], v[36:39]
    v_exp_f32 v32, v32
    v_mfma_f32_16x16x32_bf16 v[44:47], a[84:87], a[20:23], v[44:47]
    buffer_load_dwordx4 v17, s[8:11], s25 offen offset:1024 lds
    v_mfma_f32_16x16x32_bf16 v[36:39], a[88:91], a[8:11], v[36:39]
    v_exp_f32 v33, v33
    v_mfma_f32_16x16x32_bf16 v[44:47], a[88:91], a[24:27], v[44:47]
    v_cvt_pk_bf16_f32 v64, v32, v33
    v_mfma_f32_16x16x32_bf16 v[36:39], a[92:95], a[12:15], v[36:39]
    v_exp_f32 v34, v34
    v_mfma_f32_16x16x32_bf16 v[44:47], a[92:95], a[28:31], v[44:47]
    v_mfma_f32_16x16x32_bf16 v[192:195], a[96:99], v[72:75], v[192:195]
    v_exp_f32 v35, v35
    v_mfma_f32_16x16x32_bf16 v[224:227], a[96:99], v[76:79], v[224:227]
    ds_read_b64_tr_b16 a[96:97], v8 offset:32768
    ds_read_b64_tr_b16 a[98:99], v8 offset:36864
    v_mfma_f32_16x16x32_bf16 v[196:199], a[100:103], v[72:75], v[196:199]
    v_exp_f32 v40, v40
    v_mfma_f32_16x16x32_bf16 v[228:231], a[100:103], v[76:79], v[228:231]
    ds_read_b64_tr_b16 a[100:101], v9 offset:32768
    ds_read_b64_tr_b16 a[102:103], v9 offset:36864
    v_mfma_f32_16x16x32_bf16 v[200:203], a[104:107], v[72:75], v[200:203]
    v_exp_f32 v41, v41
    v_mfma_f32_16x16x32_bf16 v[232:235], a[104:107], v[76:79], v[232:235]
    ds_read_b64_tr_b16 a[104:105], v10 offset:32768
    ds_read_b64_tr_b16 a[106:107], v10 offset:36864
    v_mfma_f32_16x16x32_bf16 v[204:207], a[108:111], v[72:75], v[204:207]
    v_exp_f32 v42, v42
    v_mfma_f32_16x16x32_bf16 v[236:239], a[108:111], v[76:79], v[236:239]
    ds_read_b64_tr_b16 a[108:109], v11 offset:32768
    ds_read_b64_tr_b16 a[110:111], v11 offset:36864
    v_mfma_f32_16x16x32_bf16 v[208:211], a[112:115], v[72:75], v[208:211]
    v_exp_f32 v43, v43
    v_mfma_f32_16x16x32_bf16 v[240:243], a[112:115], v[76:79], v[240:243]
    ds_read_b64_tr_b16 a[112:113], v12 offset:32768
    ds_read_b64_tr_b16 a[114:115], v12 offset:36864
    v_mfma_f32_16x16x32_bf16 v[212:215], a[116:119], v[72:75], v[212:215]
    v_exp_f32 v36, v36
    v_mfma_f32_16x16x32_bf16 v[244:247], a[116:119], v[76:79], v[244:247]
    ds_read_b64_tr_b16 a[116:117], v13 offset:32768
    ds_read_b64_tr_b16 a[118:119], v13 offset:36864
    v_mfma_f32_16x16x32_bf16 v[216:219], a[120:123], v[72:75], v[216:219]
    v_exp_f32 v37, v37
    v_mfma_f32_16x16x32_bf16 v[248:251], a[120:123], v[76:79], v[248:251]
    ds_read_b64_tr_b16 a[120:121], v14 offset:32768
    ds_read_b64_tr_b16 a[122:123], v14 offset:36864
    v_mfma_f32_16x16x32_bf16 v[220:223], a[124:127], v[72:75], v[220:223]
    v_exp_f32 v38, v38
    v_mfma_f32_16x16x32_bf16 v[252:255], a[124:127], v[76:79], v[252:255]
    ds_read_b64_tr_b16 a[124:125], v15 offset:32768
    ds_read_b64_tr_b16 a[126:127], v15 offset:36864
    v_mfma_f32_16x16x32_bf16 v[104:107], v[112:115], v[72:75], v[104:107]
    v_exp_f32 v39, v39
    v_mfma_f32_16x16x32_bf16 v[108:111], v[112:115], v[76:79], v[108:111]
    v_cvt_pk_bf16_f32 v65, v34, v35
    v_cvt_pk_bf16_f32 v68, v40, v41
    v_mfma_f32_16x16x32_bf16 v[48:51], a[64:67], a[32:35], v[88:91]
    v_exp_f32 v44, v44
    v_mfma_f32_16x16x32_bf16 v[56:59], a[64:67], a[48:51], v[92:95]
    ds_read_b128 a[64:67], v4 offset:32768
    v_cvt_pk_bf16_f32 v69, v42, v43
    v_mfma_f32_16x16x32_bf16 v[48:51], a[68:71], a[36:39], v[48:51]
    v_exp_f32 v45, v45
    v_mfma_f32_16x16x32_bf16 v[56:59], a[68:71], a[52:55], v[56:59]
    ds_read_b128 a[68:71], v5 offset:32768
    v_cvt_pk_bf16_f32 v66, v36, v37
    v_mfma_f32_16x16x32_bf16 v[48:51], a[72:75], a[40:43], v[48:51]
    v_exp_f32 v46, v46
    v_mfma_f32_16x16x32_bf16 v[56:59], a[72:75], a[56:59], v[56:59]
    ds_read_b128 a[72:75], v6 offset:32768
    v_cvt_pk_bf16_f32 v67, v38, v39
    v_mfma_f32_16x16x32_bf16 v[48:51], a[76:79], a[44:47], v[48:51]
    v_exp_f32 v47, v47
    v_mfma_f32_16x16x32_bf16 v[56:59], a[76:79], a[60:63], v[56:59]
    ds_read_b128 a[76:79], v7 offset:32768
    v_cvt_pk_bf16_f32 v70, v44, v45
    v_mfma_f32_16x16x32_bf16 v[52:55], a[80:83], a[32:35], v[88:91]
    buffer_load_dwordx4 v18, s[8:11], s25 offen offset:2048 lds
    v_mfma_f32_16x16x32_bf16 v[60:63], a[80:83], a[48:51], v[92:95]
    ds_read_b128 a[80:83], v4 offset:36864
    v_cvt_pk_bf16_f32 v71, v46, v47
    v_mfma_f32_16x16x32_bf16 v[52:55], a[84:87], a[36:39], v[52:55]
    v_exp_f32 v48, v48
    v_mfma_f32_16x16x32_bf16 v[60:63], a[84:87], a[52:55], v[60:63]
    ds_read_b128 a[84:87], v5 offset:36864
    v_mfma_f32_16x16x32_bf16 v[52:55], a[88:91], a[40:43], v[52:55]
    v_exp_f32 v49, v49
    v_mfma_f32_16x16x32_bf16 v[60:63], a[88:91], a[56:59], v[60:63]
    ds_read_b128 a[88:91], v6 offset:36864
    buffer_load_dwordx4 v19, s[8:11], s25 offen offset:3072 lds
    v_mfma_f32_16x16x32_bf16 v[52:55], a[92:95], a[44:47], v[52:55]
    v_exp_f32 v50, v50
    v_mfma_f32_16x16x32_bf16 v[60:63], a[92:95], a[60:63], v[60:63]
    ds_read_b128 a[92:95], v7 offset:36864
    s_waitcnt lgkmcnt(8)
    v_mfma_f32_16x16x32_bf16 v[128:131], a[96:99], v[64:67], v[128:131]
    v_exp_f32 v51, v51
    v_mfma_f32_16x16x32_bf16 v[160:163], a[96:99], v[68:71], v[160:163]
    v_cvt_pk_bf16_f32 v72, v48, v49
    v_cvt_pk_bf16_f32 v73, v50, v51
    v_mfma_f32_16x16x32_bf16 v[132:135], a[100:103], v[64:67], v[132:135]
    v_exp_f32 v56, v56
    v_mfma_f32_16x16x32_bf16 v[164:167], a[100:103], v[68:71], v[164:167]
    s_mov_b32 s26, 8192
    buffer_load_dwordx4 a[160:163], v20, s[12:15], s26 offen offset:0 sc1
    v_mfma_f32_16x16x32_bf16 v[136:139], a[104:107], v[64:67], v[136:139]
    v_exp_f32 v57, v57
    v_mfma_f32_16x16x32_bf16 v[168:171], a[104:107], v[68:71], v[168:171]
    v_cvt_pk_bf16_f32 v76, v56, v57
    v_mfma_f32_16x16x32_bf16 v[140:143], a[108:111], v[64:67], v[140:143]
    v_exp_f32 v58, v58
    v_mfma_f32_16x16x32_bf16 v[172:175], a[108:111], v[68:71], v[172:175]
    buffer_load_dwordx4 a[164:167], v21, s[12:15], s26 offen offset:0 sc1
    v_mfma_f32_16x16x32_bf16 v[144:147], a[112:115], v[64:67], v[144:147]
    v_exp_f32 v59, v59
    v_mfma_f32_16x16x32_bf16 v[176:179], a[112:115], v[68:71], v[176:179]
    v_cvt_pk_bf16_f32 v77, v58, v59
    v_mfma_f32_16x16x32_bf16 v[148:151], a[116:119], v[64:67], v[148:151]
    v_exp_f32 v52, v52
    v_mfma_f32_16x16x32_bf16 v[180:183], a[116:119], v[68:71], v[180:183]
    buffer_load_dwordx4 a[168:171], v20, s[12:15], s26 offen offset:1024 sc1
    v_mfma_f32_16x16x32_bf16 v[152:155], a[120:123], v[64:67], v[152:155]
    v_exp_f32 v53, v53
    v_mfma_f32_16x16x32_bf16 v[184:187], a[120:123], v[68:71], v[184:187]
    v_mfma_f32_16x16x32_bf16 v[156:159], a[124:127], v[64:67], v[156:159]
    v_exp_f32 v54, v54
    v_mfma_f32_16x16x32_bf16 v[188:191], a[124:127], v[68:71], v[188:191]
    buffer_load_dwordx4 a[172:175], v21, s[12:15], s26 offen offset:1024 sc1
    v_mfma_f32_16x16x32_bf16 v[96:99], v[112:115], v[64:67], v[96:99]
    v_exp_f32 v55, v55
    v_mfma_f32_16x16x32_bf16 v[100:103], v[112:115], v[68:71], v[100:103]
    s_waitcnt lgkmcnt(0)
    v_mfma_f32_16x16x32_bf16 v[32:35], a[64:67], a[0:3], v[80:83]
    v_exp_f32 v60, v60
    v_mfma_f32_16x16x32_bf16 v[40:43], a[64:67], a[16:19], v[84:87]
    v_cvt_pk_bf16_f32 v74, v52, v53
    s_add_u32 m0, s24, 16384
    s_mov_b32 s25, 327680
    v_mfma_f32_16x16x32_bf16 v[32:35], a[68:71], a[4:7], v[32:35]
    v_exp_f32 v61, v61
    v_mfma_f32_16x16x32_bf16 v[40:43], a[68:71], a[20:23], v[40:43]
    v_cvt_pk_bf16_f32 v75, v54, v55
    v_cvt_pk_bf16_f32 v78, v60, v61
    v_mfma_f32_16x16x32_bf16 v[32:35], a[72:75], a[8:11], v[32:35]
    v_exp_f32 v62, v62
    v_mfma_f32_16x16x32_bf16 v[40:43], a[72:75], a[24:27], v[40:43]
    buffer_load_dwordx4 v16, s[8:11], s25 offen offset:0 lds
    v_mfma_f32_16x16x32_bf16 v[32:35], a[76:79], a[12:15], v[32:35]
    v_exp_f32 v63, v63
    v_mfma_f32_16x16x32_bf16 v[40:43], a[76:79], a[28:31], v[40:43]
    v_cvt_pk_bf16_f32 v79, v62, v63
    v_mfma_f32_16x16x32_bf16 v[36:39], a[80:83], a[0:3], v[80:83]
    v_mfma_f32_16x16x32_bf16 v[44:47], a[80:83], a[16:19], v[84:87]
    v_mfma_f32_16x16x32_bf16 v[36:39], a[84:87], a[4:7], v[36:39]
    v_exp_f32 v32, v32
    v_mfma_f32_16x16x32_bf16 v[44:47], a[84:87], a[20:23], v[44:47]
    buffer_load_dwordx4 v17, s[8:11], s25 offen offset:1024 lds
    v_mfma_f32_16x16x32_bf16 v[36:39], a[88:91], a[8:11], v[36:39]
    v_exp_f32 v33, v33
    v_mfma_f32_16x16x32_bf16 v[44:47], a[88:91], a[24:27], v[44:47]
    v_cvt_pk_bf16_f32 v64, v32, v33
    v_mfma_f32_16x16x32_bf16 v[36:39], a[92:95], a[12:15], v[36:39]
    v_exp_f32 v34, v34
    v_mfma_f32_16x16x32_bf16 v[44:47], a[92:95], a[28:31], v[44:47]
    v_mfma_f32_16x16x32_bf16 v[192:195], a[96:99], v[72:75], v[192:195]
    v_exp_f32 v35, v35
    v_mfma_f32_16x16x32_bf16 v[224:227], a[96:99], v[76:79], v[224:227]
    ds_read_b64_tr_b16 a[96:97], v8 offset:40960
    ds_read_b64_tr_b16 a[98:99], v8 offset:45056
    v_mfma_f32_16x16x32_bf16 v[196:199], a[100:103], v[72:75], v[196:199]
    v_exp_f32 v40, v40
    v_mfma_f32_16x16x32_bf16 v[228:231], a[100:103], v[76:79], v[228:231]
    ds_read_b64_tr_b16 a[100:101], v9 offset:40960
    ds_read_b64_tr_b16 a[102:103], v9 offset:45056
    v_mfma_f32_16x16x32_bf16 v[200:203], a[104:107], v[72:75], v[200:203]
    v_exp_f32 v41, v41
    v_mfma_f32_16x16x32_bf16 v[232:235], a[104:107], v[76:79], v[232:235]
    ds_read_b64_tr_b16 a[104:105], v10 offset:40960
    ds_read_b64_tr_b16 a[106:107], v10 offset:45056
    v_mfma_f32_16x16x32_bf16 v[204:207], a[108:111], v[72:75], v[204:207]
    v_exp_f32 v42, v42
    v_mfma_f32_16x16x32_bf16 v[236:239], a[108:111], v[76:79], v[236:239]
    ds_read_b64_tr_b16 a[108:109], v11 offset:40960
    ds_read_b64_tr_b16 a[110:111], v11 offset:45056
    v_mfma_f32_16x16x32_bf16 v[208:211], a[112:115], v[72:75], v[208:211]
    v_exp_f32 v43, v43
    v_mfma_f32_16x16x32_bf16 v[240:243], a[112:115], v[76:79], v[240:243]
    ds_read_b64_tr_b16 a[112:113], v12 offset:40960
    ds_read_b64_tr_b16 a[114:115], v12 offset:45056
    v_mfma_f32_16x16x32_bf16 v[212:215], a[116:119], v[72:75], v[212:215]
    v_exp_f32 v36, v36
    v_mfma_f32_16x16x32_bf16 v[244:247], a[116:119], v[76:79], v[244:247]
    ds_read_b64_tr_b16 a[116:117], v13 offset:40960
    ds_read_b64_tr_b16 a[118:119], v13 offset:45056
    v_mfma_f32_16x16x32_bf16 v[216:219], a[120:123], v[72:75], v[216:219]
    v_exp_f32 v37, v37
    v_mfma_f32_16x16x32_bf16 v[248:251], a[120:123], v[76:79], v[248:251]
    ds_read_b64_tr_b16 a[120:121], v14 offset:40960
    ds_read_b64_tr_b16 a[122:123], v14 offset:45056
    v_mfma_f32_16x16x32_bf16 v[220:223], a[124:127], v[72:75], v[220:223]
    v_exp_f32 v38, v38
    v_mfma_f32_16x16x32_bf16 v[252:255], a[124:127], v[76:79], v[252:255]
    ds_read_b64_tr_b16 a[124:125], v15 offset:40960
    ds_read_b64_tr_b16 a[126:127], v15 offset:45056
    v_mfma_f32_16x16x32_bf16 v[104:107], v[112:115], v[72:75], v[104:107]
    v_exp_f32 v39, v39
    v_mfma_f32_16x16x32_bf16 v[108:111], v[112:115], v[76:79], v[108:111]
    v_cvt_pk_bf16_f32 v65, v34, v35
    v_cvt_pk_bf16_f32 v68, v40, v41
    v_mfma_f32_16x16x32_bf16 v[48:51], a[64:67], a[32:35], v[88:91]
    v_exp_f32 v44, v44
    v_mfma_f32_16x16x32_bf16 v[56:59], a[64:67], a[48:51], v[92:95]
    ds_read_b128 a[64:67], v4 offset:40960
    v_cvt_pk_bf16_f32 v69, v42, v43
    v_mfma_f32_16x16x32_bf16 v[48:51], a[68:71], a[36:39], v[48:51]
    v_exp_f32 v45, v45
    v_mfma_f32_16x16x32_bf16 v[56:59], a[68:71], a[52:55], v[56:59]
    ds_read_b128 a[68:71], v5 offset:40960
    v_cvt_pk_bf16_f32 v66, v36, v37
    v_mfma_f32_16x16x32_bf16 v[48:51], a[72:75], a[40:43], v[48:51]
    v_exp_f32 v46, v46
    v_mfma_f32_16x16x32_bf16 v[56:59], a[72:75], a[56:59], v[56:59]
    ds_read_b128 a[72:75], v6 offset:40960
    v_cvt_pk_bf16_f32 v67, v38, v39
    v_mfma_f32_16x16x32_bf16 v[48:51], a[76:79], a[44:47], v[48:51]
    v_exp_f32 v47, v47
    v_mfma_f32_16x16x32_bf16 v[56:59], a[76:79], a[60:63], v[56:59]
    ds_read_b128 a[76:79], v7 offset:40960
    v_cvt_pk_bf16_f32 v70, v44, v45
    v_mfma_f32_16x16x32_bf16 v[52:55], a[80:83], a[32:35], v[88:91]
    buffer_load_dwordx4 v18, s[8:11], s25 offen offset:2048 lds
    v_mfma_f32_16x16x32_bf16 v[60:63], a[80:83], a[48:51], v[92:95]
    ds_read_b128 a[80:83], v4 offset:45056
    v_cvt_pk_bf16_f32 v71, v46, v47
    v_mfma_f32_16x16x32_bf16 v[52:55], a[84:87], a[36:39], v[52:55]
    v_exp_f32 v48, v48
    v_mfma_f32_16x16x32_bf16 v[60:63], a[84:87], a[52:55], v[60:63]
    ds_read_b128 a[84:87], v5 offset:45056
    v_mfma_f32_16x16x32_bf16 v[52:55], a[88:91], a[40:43], v[52:55]
    v_exp_f32 v49, v49
    v_mfma_f32_16x16x32_bf16 v[60:63], a[88:91], a[56:59], v[60:63]
    ds_read_b128 a[88:91], v6 offset:45056
    buffer_load_dwordx4 v19, s[8:11], s25 offen offset:3072 lds
    v_mfma_f32_16x16x32_bf16 v[52:55], a[92:95], a[44:47], v[52:55]
    v_exp_f32 v50, v50
    v_mfma_f32_16x16x32_bf16 v[60:63], a[92:95], a[60:63], v[60:63]
    ds_read_b128 a[92:95], v7 offset:45056
    s_waitcnt lgkmcnt(8)
    v_mfma_f32_16x16x32_bf16 v[128:131], a[96:99], v[64:67], v[128:131]
    v_exp_f32 v51, v51
    v_mfma_f32_16x16x32_bf16 v[160:163], a[96:99], v[68:71], v[160:163]
    v_cvt_pk_bf16_f32 v72, v48, v49
    v_cvt_pk_bf16_f32 v73, v50, v51
    v_mfma_f32_16x16x32_bf16 v[132:135], a[100:103], v[64:67], v[132:135]
    v_exp_f32 v56, v56
    v_mfma_f32_16x16x32_bf16 v[164:167], a[100:103], v[68:71], v[164:167]
    s_mov_b32 s26, 10240
    buffer_load_dwordx4 a[176:179], v20, s[12:15], s26 offen offset:0 sc1
    v_mfma_f32_16x16x32_bf16 v[136:139], a[104:107], v[64:67], v[136:139]
    v_exp_f32 v57, v57
    v_mfma_f32_16x16x32_bf16 v[168:171], a[104:107], v[68:71], v[168:171]
    v_cvt_pk_bf16_f32 v76, v56, v57
    v_mfma_f32_16x16x32_bf16 v[140:143], a[108:111], v[64:67], v[140:143]
    v_exp_f32 v58, v58
    v_mfma_f32_16x16x32_bf16 v[172:175], a[108:111], v[68:71], v[172:175]
    buffer_load_dwordx4 a[180:183], v21, s[12:15], s26 offen offset:0 sc1
    v_mfma_f32_16x16x32_bf16 v[144:147], a[112:115], v[64:67], v[144:147]
    v_exp_f32 v59, v59
    v_mfma_f32_16x16x32_bf16 v[176:179], a[112:115], v[68:71], v[176:179]
    v_cvt_pk_bf16_f32 v77, v58, v59
    v_mfma_f32_16x16x32_bf16 v[148:151], a[116:119], v[64:67], v[148:151]
    v_exp_f32 v52, v52
    v_mfma_f32_16x16x32_bf16 v[180:183], a[116:119], v[68:71], v[180:183]
    buffer_load_dwordx4 a[184:187], v20, s[12:15], s26 offen offset:1024 sc1
    v_mfma_f32_16x16x32_bf16 v[152:155], a[120:123], v[64:67], v[152:155]
    v_exp_f32 v53, v53
    v_mfma_f32_16x16x32_bf16 v[184:187], a[120:123], v[68:71], v[184:187]
    v_mfma_f32_16x16x32_bf16 v[156:159], a[124:127], v[64:67], v[156:159]
    v_exp_f32 v54, v54
    v_mfma_f32_16x16x32_bf16 v[188:191], a[124:127], v[68:71], v[188:191]
    buffer_load_dwordx4 a[188:191], v21, s[12:15], s26 offen offset:1024 sc1
    v_mfma_f32_16x16x32_bf16 v[96:99], v[112:115], v[64:67], v[96:99]
    v_exp_f32 v55, v55
    v_mfma_f32_16x16x32_bf16 v[100:103], v[112:115], v[68:71], v[100:103]
    s_waitcnt vmcnt(34) lgkmcnt(0)
    s_barrier
    v_mfma_f32_16x16x32_bf16 v[32:35], a[64:67], a[0:3], v[80:83]
    v_exp_f32 v60, v60
    v_mfma_f32_16x16x32_bf16 v[40:43], a[64:67], a[16:19], v[84:87]
    v_cvt_pk_bf16_f32 v74, v52, v53
    s_add_u32 m0, s24, 98304
    s_mov_b32 s25, 524288
    v_mfma_f32_16x16x32_bf16 v[32:35], a[68:71], a[4:7], v[32:35]
    v_exp_f32 v61, v61
    v_mfma_f32_16x16x32_bf16 v[40:43], a[68:71], a[20:23], v[40:43]
    v_cvt_pk_bf16_f32 v75, v54, v55
    v_cvt_pk_bf16_f32 v78, v60, v61
    v_mfma_f32_16x16x32_bf16 v[32:35], a[72:75], a[8:11], v[32:35]
    v_exp_f32 v62, v62
    v_mfma_f32_16x16x32_bf16 v[40:43], a[72:75], a[24:27], v[40:43]
    buffer_load_dwordx4 v16, s[8:11], s25 offen offset:0 lds
    v_mfma_f32_16x16x32_bf16 v[32:35], a[76:79], a[12:15], v[32:35]
    v_exp_f32 v63, v63
    v_mfma_f32_16x16x32_bf16 v[40:43], a[76:79], a[28:31], v[40:43]
    v_cvt_pk_bf16_f32 v79, v62, v63
    v_mfma_f32_16x16x32_bf16 v[36:39], a[80:83], a[0:3], v[80:83]
    v_mfma_f32_16x16x32_bf16 v[44:47], a[80:83], a[16:19], v[84:87]
    v_mfma_f32_16x16x32_bf16 v[36:39], a[84:87], a[4:7], v[36:39]
    v_exp_f32 v32, v32
    v_mfma_f32_16x16x32_bf16 v[44:47], a[84:87], a[20:23], v[44:47]
    buffer_load_dwordx4 v17, s[8:11], s25 offen offset:1024 lds
    v_mfma_f32_16x16x32_bf16 v[36:39], a[88:91], a[8:11], v[36:39]
    v_exp_f32 v33, v33
    v_mfma_f32_16x16x32_bf16 v[44:47], a[88:91], a[24:27], v[44:47]
    v_cvt_pk_bf16_f32 v64, v32, v33
    v_mfma_f32_16x16x32_bf16 v[36:39], a[92:95], a[12:15], v[36:39]
    v_exp_f32 v34, v34
    v_mfma_f32_16x16x32_bf16 v[44:47], a[92:95], a[28:31], v[44:47]
    v_mfma_f32_16x16x32_bf16 v[192:195], a[96:99], v[72:75], v[192:195]
    v_exp_f32 v35, v35
    v_mfma_f32_16x16x32_bf16 v[224:227], a[96:99], v[76:79], v[224:227]
    ds_read_b64_tr_b16 a[96:97], v8 offset:49152
    ds_read_b64_tr_b16 a[98:99], v8 offset:53248
    v_mfma_f32_16x16x32_bf16 v[196:199], a[100:103], v[72:75], v[196:199]
    v_exp_f32 v40, v40
    v_mfma_f32_16x16x32_bf16 v[228:231], a[100:103], v[76:79], v[228:231]
    ds_read_b64_tr_b16 a[100:101], v9 offset:49152
    ds_read_b64_tr_b16 a[102:103], v9 offset:53248
    v_mfma_f32_16x16x32_bf16 v[200:203], a[104:107], v[72:75], v[200:203]
    v_exp_f32 v41, v41
    v_mfma_f32_16x16x32_bf16 v[232:235], a[104:107], v[76:79], v[232:235]
    ds_read_b64_tr_b16 a[104:105], v10 offset:49152
    ds_read_b64_tr_b16 a[106:107], v10 offset:53248
    v_mfma_f32_16x16x32_bf16 v[204:207], a[108:111], v[72:75], v[204:207]
    v_exp_f32 v42, v42
    v_mfma_f32_16x16x32_bf16 v[236:239], a[108:111], v[76:79], v[236:239]
    ds_read_b64_tr_b16 a[108:109], v11 offset:49152
    ds_read_b64_tr_b16 a[110:111], v11 offset:53248
    v_mfma_f32_16x16x32_bf16 v[208:211], a[112:115], v[72:75], v[208:211]
    v_exp_f32 v43, v43
    v_mfma_f32_16x16x32_bf16 v[240:243], a[112:115], v[76:79], v[240:243]
    ds_read_b64_tr_b16 a[112:113], v12 offset:49152
    ds_read_b64_tr_b16 a[114:115], v12 offset:53248
    v_mfma_f32_16x16x32_bf16 v[212:215], a[116:119], v[72:75], v[212:215]
    v_exp_f32 v36, v36
    v_mfma_f32_16x16x32_bf16 v[244:247], a[116:119], v[76:79], v[244:247]
    ds_read_b64_tr_b16 a[116:117], v13 offset:49152
    ds_read_b64_tr_b16 a[118:119], v13 offset:53248
    v_mfma_f32_16x16x32_bf16 v[216:219], a[120:123], v[72:75], v[216:219]
    v_exp_f32 v37, v37
    v_mfma_f32_16x16x32_bf16 v[248:251], a[120:123], v[76:79], v[248:251]
    ds_read_b64_tr_b16 a[120:121], v14 offset:49152
    ds_read_b64_tr_b16 a[122:123], v14 offset:53248
    v_mfma_f32_16x16x32_bf16 v[220:223], a[124:127], v[72:75], v[220:223]
    v_exp_f32 v38, v38
    v_mfma_f32_16x16x32_bf16 v[252:255], a[124:127], v[76:79], v[252:255]
    ds_read_b64_tr_b16 a[124:125], v15 offset:49152
    ds_read_b64_tr_b16 a[126:127], v15 offset:53248
    v_mfma_f32_16x16x32_bf16 v[104:107], v[112:115], v[72:75], v[104:107]
    v_exp_f32 v39, v39
    v_mfma_f32_16x16x32_bf16 v[108:111], v[112:115], v[76:79], v[108:111]
    v_cvt_pk_bf16_f32 v65, v34, v35
    v_cvt_pk_bf16_f32 v68, v40, v41
    v_mfma_f32_16x16x32_bf16 v[48:51], a[64:67], a[32:35], v[88:91]
    v_exp_f32 v44, v44
    v_mfma_f32_16x16x32_bf16 v[56:59], a[64:67], a[48:51], v[92:95]
    ds_read_b128 a[64:67], v4 offset:49152
    v_cvt_pk_bf16_f32 v69, v42, v43
    v_mfma_f32_16x16x32_bf16 v[48:51], a[68:71], a[36:39], v[48:51]
    v_exp_f32 v45, v45
    v_mfma_f32_16x16x32_bf16 v[56:59], a[68:71], a[52:55], v[56:59]
    ds_read_b128 a[68:71], v5 offset:49152
    v_cvt_pk_bf16_f32 v66, v36, v37
    v_mfma_f32_16x16x32_bf16 v[48:51], a[72:75], a[40:43], v[48:51]
    v_exp_f32 v46, v46
    v_mfma_f32_16x16x32_bf16 v[56:59], a[72:75], a[56:59], v[56:59]
    ds_read_b128 a[72:75], v6 offset:49152
    v_cvt_pk_bf16_f32 v67, v38, v39
    v_mfma_f32_16x16x32_bf16 v[48:51], a[76:79], a[44:47], v[48:51]
    v_exp_f32 v47, v47
    v_mfma_f32_16x16x32_bf16 v[56:59], a[76:79], a[60:63], v[56:59]
    ds_read_b128 a[76:79], v7 offset:49152
    v_cvt_pk_bf16_f32 v70, v44, v45
    v_mfma_f32_16x16x32_bf16 v[52:55], a[80:83], a[32:35], v[88:91]
    buffer_load_dwordx4 v18, s[8:11], s25 offen offset:2048 lds
    v_mfma_f32_16x16x32_bf16 v[60:63], a[80:83], a[48:51], v[92:95]
    ds_read_b128 a[80:83], v4 offset:53248
    v_cvt_pk_bf16_f32 v71, v46, v47
    v_mfma_f32_16x16x32_bf16 v[52:55], a[84:87], a[36:39], v[52:55]
    v_exp_f32 v48, v48
    v_mfma_f32_16x16x32_bf16 v[60:63], a[84:87], a[52:55], v[60:63]
    ds_read_b128 a[84:87], v5 offset:53248
    v_mfma_f32_16x16x32_bf16 v[52:55], a[88:91], a[40:43], v[52:55]
    v_exp_f32 v49, v49
    v_mfma_f32_16x16x32_bf16 v[60:63], a[88:91], a[56:59], v[60:63]
    ds_read_b128 a[88:91], v6 offset:53248
    buffer_load_dwordx4 v19, s[8:11], s25 offen offset:3072 lds
    v_mfma_f32_16x16x32_bf16 v[52:55], a[92:95], a[44:47], v[52:55]
    v_exp_f32 v50, v50
    v_mfma_f32_16x16x32_bf16 v[60:63], a[92:95], a[60:63], v[60:63]
    ds_read_b128 a[92:95], v7 offset:53248
    s_waitcnt lgkmcnt(8)
    v_mfma_f32_16x16x32_bf16 v[128:131], a[96:99], v[64:67], v[128:131]
    v_exp_f32 v51, v51
    v_mfma_f32_16x16x32_bf16 v[160:163], a[96:99], v[68:71], v[160:163]
    v_cvt_pk_bf16_f32 v72, v48, v49
    v_cvt_pk_bf16_f32 v73, v50, v51
    v_mfma_f32_16x16x32_bf16 v[132:135], a[100:103], v[64:67], v[132:135]
    v_exp_f32 v56, v56
    v_mfma_f32_16x16x32_bf16 v[164:167], a[100:103], v[68:71], v[164:167]
    s_mov_b32 s26, 16384
    buffer_load_dwordx4 a[192:195], v20, s[12:15], s26 offen offset:0 sc1
    v_mfma_f32_16x16x32_bf16 v[136:139], a[104:107], v[64:67], v[136:139]
    v_exp_f32 v57, v57
    v_mfma_f32_16x16x32_bf16 v[168:171], a[104:107], v[68:71], v[168:171]
    v_cvt_pk_bf16_f32 v76, v56, v57
    v_mfma_f32_16x16x32_bf16 v[140:143], a[108:111], v[64:67], v[140:143]
    v_exp_f32 v58, v58
    v_mfma_f32_16x16x32_bf16 v[172:175], a[108:111], v[68:71], v[172:175]
    buffer_load_dwordx4 a[196:199], v21, s[12:15], s26 offen offset:0 sc1
    v_mfma_f32_16x16x32_bf16 v[144:147], a[112:115], v[64:67], v[144:147]
    v_exp_f32 v59, v59
    v_mfma_f32_16x16x32_bf16 v[176:179], a[112:115], v[68:71], v[176:179]
    v_cvt_pk_bf16_f32 v77, v58, v59
    v_mfma_f32_16x16x32_bf16 v[148:151], a[116:119], v[64:67], v[148:151]
    v_exp_f32 v52, v52
    v_mfma_f32_16x16x32_bf16 v[180:183], a[116:119], v[68:71], v[180:183]
    buffer_load_dwordx4 a[200:203], v20, s[12:15], s26 offen offset:1024 sc1
    v_mfma_f32_16x16x32_bf16 v[152:155], a[120:123], v[64:67], v[152:155]
    v_exp_f32 v53, v53
    v_mfma_f32_16x16x32_bf16 v[184:187], a[120:123], v[68:71], v[184:187]
    v_mfma_f32_16x16x32_bf16 v[156:159], a[124:127], v[64:67], v[156:159]
    v_exp_f32 v54, v54
    v_mfma_f32_16x16x32_bf16 v[188:191], a[124:127], v[68:71], v[188:191]
    buffer_load_dwordx4 a[204:207], v21, s[12:15], s26 offen offset:1024 sc1
    v_mfma_f32_16x16x32_bf16 v[96:99], v[112:115], v[64:67], v[96:99]
    v_exp_f32 v55, v55
    v_mfma_f32_16x16x32_bf16 v[100:103], v[112:115], v[68:71], v[100:103]
    s_waitcnt lgkmcnt(0)
    v_mfma_f32_16x16x32_bf16 v[32:35], a[64:67], a[0:3], v[80:83]
    v_exp_f32 v60, v60
    v_mfma_f32_16x16x32_bf16 v[40:43], a[64:67], a[16:19], v[84:87]
    v_cvt_pk_bf16_f32 v74, v52, v53
    s_add_u32 m0, s24, 32768
    s_mov_b32 s25, 589824
    v_mfma_f32_16x16x32_bf16 v[32:35], a[68:71], a[4:7], v[32:35]
    v_exp_f32 v61, v61
    v_mfma_f32_16x16x32_bf16 v[40:43], a[68:71], a[20:23], v[40:43]
    v_cvt_pk_bf16_f32 v75, v54, v55
    v_cvt_pk_bf16_f32 v78, v60, v61
    v_mfma_f32_16x16x32_bf16 v[32:35], a[72:75], a[8:11], v[32:35]
    v_exp_f32 v62, v62
    v_mfma_f32_16x16x32_bf16 v[40:43], a[72:75], a[24:27], v[40:43]
    buffer_load_dwordx4 v16, s[8:11], s25 offen offset:0 lds
    v_mfma_f32_16x16x32_bf16 v[32:35], a[76:79], a[12:15], v[32:35]
    v_exp_f32 v63, v63
    v_mfma_f32_16x16x32_bf16 v[40:43], a[76:79], a[28:31], v[40:43]
    v_cvt_pk_bf16_f32 v79, v62, v63
    v_mfma_f32_16x16x32_bf16 v[36:39], a[80:83], a[0:3], v[80:83]
    v_mfma_f32_16x16x32_bf16 v[44:47], a[80:83], a[16:19], v[84:87]
    v_mfma_f32_16x16x32_bf16 v[36:39], a[84:87], a[4:7], v[36:39]
    v_exp_f32 v32, v32
    v_mfma_f32_16x16x32_bf16 v[44:47], a[84:87], a[20:23], v[44:47]
    buffer_load_dwordx4 v17, s[8:11], s25 offen offset:1024 lds
    v_mfma_f32_16x16x32_bf16 v[36:39], a[88:91], a[8:11], v[36:39]
    v_exp_f32 v33, v33
    v_mfma_f32_16x16x32_bf16 v[44:47], a[88:91], a[24:27], v[44:47]
    v_cvt_pk_bf16_f32 v64, v32, v33
    v_mfma_f32_16x16x32_bf16 v[36:39], a[92:95], a[12:15], v[36:39]
    v_exp_f32 v34, v34
    v_mfma_f32_16x16x32_bf16 v[44:47], a[92:95], a[28:31], v[44:47]
    v_mfma_f32_16x16x32_bf16 v[192:195], a[96:99], v[72:75], v[192:195]
    v_exp_f32 v35, v35
    v_mfma_f32_16x16x32_bf16 v[224:227], a[96:99], v[76:79], v[224:227]
    ds_read_b64_tr_b16 a[96:97], v8 offset:57344
    ds_read_b64_tr_b16 a[98:99], v8 offset:61440
    v_mfma_f32_16x16x32_bf16 v[196:199], a[100:103], v[72:75], v[196:199]
    v_exp_f32 v40, v40
    v_mfma_f32_16x16x32_bf16 v[228:231], a[100:103], v[76:79], v[228:231]
    ds_read_b64_tr_b16 a[100:101], v9 offset:57344
    ds_read_b64_tr_b16 a[102:103], v9 offset:61440
    v_mfma_f32_16x16x32_bf16 v[200:203], a[104:107], v[72:75], v[200:203]
    v_exp_f32 v41, v41
    v_mfma_f32_16x16x32_bf16 v[232:235], a[104:107], v[76:79], v[232:235]
    ds_read_b64_tr_b16 a[104:105], v10 offset:57344
    ds_read_b64_tr_b16 a[106:107], v10 offset:61440
    v_mfma_f32_16x16x32_bf16 v[204:207], a[108:111], v[72:75], v[204:207]
    v_exp_f32 v42, v42
    v_mfma_f32_16x16x32_bf16 v[236:239], a[108:111], v[76:79], v[236:239]
    ds_read_b64_tr_b16 a[108:109], v11 offset:57344
    ds_read_b64_tr_b16 a[110:111], v11 offset:61440
    v_mfma_f32_16x16x32_bf16 v[208:211], a[112:115], v[72:75], v[208:211]
    v_exp_f32 v43, v43
    v_mfma_f32_16x16x32_bf16 v[240:243], a[112:115], v[76:79], v[240:243]
    ds_read_b64_tr_b16 a[112:113], v12 offset:57344
    ds_read_b64_tr_b16 a[114:115], v12 offset:61440
    v_mfma_f32_16x16x32_bf16 v[212:215], a[116:119], v[72:75], v[212:215]
    v_exp_f32 v36, v36
    v_mfma_f32_16x16x32_bf16 v[244:247], a[116:119], v[76:79], v[244:247]
    ds_read_b64_tr_b16 a[116:117], v13 offset:57344
    ds_read_b64_tr_b16 a[118:119], v13 offset:61440
    v_mfma_f32_16x16x32_bf16 v[216:219], a[120:123], v[72:75], v[216:219]
    v_exp_f32 v37, v37
    v_mfma_f32_16x16x32_bf16 v[248:251], a[120:123], v[76:79], v[248:251]
    ds_read_b64_tr_b16 a[120:121], v14 offset:57344
    ds_read_b64_tr_b16 a[122:123], v14 offset:61440
    v_mfma_f32_16x16x32_bf16 v[220:223], a[124:127], v[72:75], v[220:223]
    v_exp_f32 v38, v38
    v_mfma_f32_16x16x32_bf16 v[252:255], a[124:127], v[76:79], v[252:255]
    ds_read_b64_tr_b16 a[124:125], v15 offset:57344
    ds_read_b64_tr_b16 a[126:127], v15 offset:61440
    v_mfma_f32_16x16x32_bf16 v[104:107], v[112:115], v[72:75], v[104:107]
    v_exp_f32 v39, v39
    v_mfma_f32_16x16x32_bf16 v[108:111], v[112:115], v[76:79], v[108:111]
    v_cvt_pk_bf16_f32 v65, v34, v35
    v_cvt_pk_bf16_f32 v68, v40, v41
    v_mfma_f32_16x16x32_bf16 v[48:51], a[64:67], a[32:35], v[88:91]
    v_exp_f32 v44, v44
    v_mfma_f32_16x16x32_bf16 v[56:59], a[64:67], a[48:51], v[92:95]
    v_cvt_pk_bf16_f32 v69, v42, v43
    v_mfma_f32_16x16x32_bf16 v[48:51], a[68:71], a[36:39], v[48:51]
    v_exp_f32 v45, v45
    v_mfma_f32_16x16x32_bf16 v[56:59], a[68:71], a[52:55], v[56:59]
    v_cvt_pk_bf16_f32 v66, v36, v37
    v_mfma_f32_16x16x32_bf16 v[48:51], a[72:75], a[40:43], v[48:51]
    v_exp_f32 v46, v46
    v_mfma_f32_16x16x32_bf16 v[56:59], a[72:75], a[56:59], v[56:59]
    v_cvt_pk_bf16_f32 v67, v38, v39
    v_mfma_f32_16x16x32_bf16 v[48:51], a[76:79], a[44:47], v[48:51]
    v_exp_f32 v47, v47
    v_mfma_f32_16x16x32_bf16 v[56:59], a[76:79], a[60:63], v[56:59]
    v_cvt_pk_bf16_f32 v70, v44, v45
    v_mfma_f32_16x16x32_bf16 v[52:55], a[80:83], a[32:35], v[88:91]
    buffer_load_dwordx4 v18, s[8:11], s25 offen offset:2048 lds
    v_mfma_f32_16x16x32_bf16 v[60:63], a[80:83], a[48:51], v[92:95]
    v_cvt_pk_bf16_f32 v71, v46, v47
    v_mfma_f32_16x16x32_bf16 v[52:55], a[84:87], a[36:39], v[52:55]
    v_exp_f32 v48, v48
    v_mfma_f32_16x16x32_bf16 v[60:63], a[84:87], a[52:55], v[60:63]
    v_mfma_f32_16x16x32_bf16 v[52:55], a[88:91], a[40:43], v[52:55]
    v_exp_f32 v49, v49
    v_mfma_f32_16x16x32_bf16 v[60:63], a[88:91], a[56:59], v[60:63]
    buffer_load_dwordx4 v19, s[8:11], s25 offen offset:3072 lds
    v_mfma_f32_16x16x32_bf16 v[52:55], a[92:95], a[44:47], v[52:55]
    v_exp_f32 v50, v50
    v_mfma_f32_16x16x32_bf16 v[60:63], a[92:95], a[60:63], v[60:63]
    s_waitcnt lgkmcnt(0)
    v_mfma_f32_16x16x32_bf16 v[128:131], a[96:99], v[64:67], v[128:131]
    v_exp_f32 v51, v51
    v_mfma_f32_16x16x32_bf16 v[160:163], a[96:99], v[68:71], v[160:163]
    v_cvt_pk_bf16_f32 v72, v48, v49
    v_cvt_pk_bf16_f32 v73, v50, v51
    v_mfma_f32_16x16x32_bf16 v[132:135], a[100:103], v[64:67], v[132:135]
    v_exp_f32 v56, v56
    v_mfma_f32_16x16x32_bf16 v[164:167], a[100:103], v[68:71], v[164:167]
    s_mov_b32 s26, 18432
    buffer_load_dwordx4 a[208:211], v20, s[12:15], s26 offen offset:0 sc1
    v_mfma_f32_16x16x32_bf16 v[136:139], a[104:107], v[64:67], v[136:139]
    v_exp_f32 v57, v57
    v_mfma_f32_16x16x32_bf16 v[168:171], a[104:107], v[68:71], v[168:171]
    v_cvt_pk_bf16_f32 v76, v56, v57
    v_mfma_f32_16x16x32_bf16 v[140:143], a[108:111], v[64:67], v[140:143]
    v_exp_f32 v58, v58
    v_mfma_f32_16x16x32_bf16 v[172:175], a[108:111], v[68:71], v[172:175]
    buffer_load_dwordx4 a[212:215], v21, s[12:15], s26 offen offset:0 sc1
    v_mfma_f32_16x16x32_bf16 v[144:147], a[112:115], v[64:67], v[144:147]
    v_exp_f32 v59, v59
    v_mfma_f32_16x16x32_bf16 v[176:179], a[112:115], v[68:71], v[176:179]
    v_cvt_pk_bf16_f32 v77, v58, v59
    v_mfma_f32_16x16x32_bf16 v[148:151], a[116:119], v[64:67], v[148:151]
    v_exp_f32 v52, v52
    v_mfma_f32_16x16x32_bf16 v[180:183], a[116:119], v[68:71], v[180:183]
    buffer_load_dwordx4 a[216:219], v20, s[12:15], s26 offen offset:1024 sc1
    v_mfma_f32_16x16x32_bf16 v[152:155], a[120:123], v[64:67], v[152:155]
    v_exp_f32 v53, v53
    v_mfma_f32_16x16x32_bf16 v[184:187], a[120:123], v[68:71], v[184:187]
    v_mfma_f32_16x16x32_bf16 v[156:159], a[124:127], v[64:67], v[156:159]
    v_exp_f32 v54, v54
    v_mfma_f32_16x16x32_bf16 v[188:191], a[124:127], v[68:71], v[188:191]
    buffer_load_dwordx4 a[220:223], v21, s[12:15], s26 offen offset:1024 sc1
    v_mfma_f32_16x16x32_bf16 v[96:99], v[112:115], v[64:67], v[96:99]
    v_exp_f32 v55, v55
    v_mfma_f32_16x16x32_bf16 v[100:103], v[112:115], v[68:71], v[100:103]
    v_exp_f32 v60, v60
    v_exp_f32 v61, v61
    v_exp_f32 v62, v62
    v_exp_f32 v63, v63
    v_cvt_pk_bf16_f32 v74, v52, v53
    v_cvt_pk_bf16_f32 v75, v54, v55
    v_cvt_pk_bf16_f32 v78, v60, v61
    v_cvt_pk_bf16_f32 v79, v62, v63
    s_nop 1
    v_mfma_f32_16x16x32_bf16 v[192:195], a[96:99], v[72:75], v[192:195]
    v_mfma_f32_16x16x32_bf16 v[224:227], a[96:99], v[76:79], v[224:227]
    v_mfma_f32_16x16x32_bf16 v[196:199], a[100:103], v[72:75], v[196:199]
    v_mfma_f32_16x16x32_bf16 v[228:231], a[100:103], v[76:79], v[228:231]
    v_mfma_f32_16x16x32_bf16 v[200:203], a[104:107], v[72:75], v[200:203]
    v_mfma_f32_16x16x32_bf16 v[232:235], a[104:107], v[76:79], v[232:235]
    v_mfma_f32_16x16x32_bf16 v[204:207], a[108:111], v[72:75], v[204:207]
    v_mfma_f32_16x16x32_bf16 v[236:239], a[108:111], v[76:79], v[236:239]
    v_mfma_f32_16x16x32_bf16 v[208:211], a[112:115], v[72:75], v[208:211]
    v_mfma_f32_16x16x32_bf16 v[240:243], a[112:115], v[76:79], v[240:243]
    v_mfma_f32_16x16x32_bf16 v[212:215], a[116:119], v[72:75], v[212:215]
    v_mfma_f32_16x16x32_bf16 v[244:247], a[116:119], v[76:79], v[244:247]
    v_mfma_f32_16x16x32_bf16 v[216:219], a[120:123], v[72:75], v[216:219]
    v_mfma_f32_16x16x32_bf16 v[248:251], a[120:123], v[76:79], v[248:251]
    v_mfma_f32_16x16x32_bf16 v[220:223], a[124:127], v[72:75], v[220:223]
    v_mfma_f32_16x16x32_bf16 v[252:255], a[124:127], v[76:79], v[252:255]
    v_mfma_f32_16x16x32_bf16 v[104:107], v[112:115], v[72:75], v[104:107]
    v_mfma_f32_16x16x32_bf16 v[108:111], v[112:115], v[76:79], v[108:111]
    s_nop 7
    v_mov_b32 v30, 0x4e800000
    v_cmp_nlt_f32 vcc, v96, v30
    s_or_b64 s[88:89], s[88:89], vcc
    v_cmp_nlt_f32 vcc, v100, v30
    s_or_b64 s[88:89], s[88:89], vcc
    v_cmp_nlt_f32 vcc, v104, v30
    s_or_b64 s[88:89], s[88:89], vcc
    v_cmp_nlt_f32 vcc, v108, v30
    s_or_b64 s[88:89], s[88:89], vcc
    v_rcp_f32 v22, v96
    v_rcp_f32 v24, v100
    v_rcp_f32 v26, v104
    v_rcp_f32 v28, v108
    s_cmp_lg_u64 s[88:89], 0
    s_cselect_b32 s3, 1, 0
    v_mov_b32 v23, s3
    v_lshlrev_b32 v25, 2, v2
    v_add_u32 v25, 155632, v25
    ds_write_b32 v25, v23
    s_waitcnt lgkmcnt(0)
    s_barrier
    v_mov_b32 v30, 155632
    ds_read_b128 v[96:99], v30
    s_waitcnt lgkmcnt(0)
    v_or_b32 v96, v96, v97
    v_or_b32 v98, v98, v99
    v_or_b32 v96, v96, v98
    s_nop 0
    v_readfirstlane_b32 s3, v96
    s_nop 3
    s_cmp_lg_u32 s87, 0
    s_cbranch_scc1 L_fin
    s_cmp_eq_u32 s3, 0
    s_cbranch_scc1 L_fin
    s_mov_b32 s87, 1
    s_waitcnt vmcnt(0)
    s_barrier
    s_branch L_start
L_fin:
    v_subrev_u32 v96, 0x10000, v8
    v_subrev_u32 v97, 0x10000, v9
    v_subrev_u32 v98, 0x10000, v10
    v_subrev_u32 v99, 0x10000, v11
    v_subrev_u32 v100, 0x10000, v12
    v_subrev_u32 v101, 0x10000, v13
    v_subrev_u32 v102, 0x10000, v14
    v_subrev_u32 v103, 0x10000, v15
    s_waitcnt vmcnt(36) lgkmcnt(0)
    s_barrier
    ds_read_b64_tr_b16 a[0:1], v8 offset:0
    v_pk_mul_f32 v[128:129], v[128:129], v[22:23] op_sel_hi:[1,0]
    ds_read_b64_tr_b16 a[2:3], v8 offset:4096
    v_pk_mul_f32 v[130:131], v[130:131], v[22:23] op_sel_hi:[1,0]
    ds_read_b64_tr_b16 a[4:5], v9 offset:0
    v_pk_mul_f32 v[132:133], v[132:133], v[22:23] op_sel_hi:[1,0]
    ds_read_b64_tr_b16 a[6:7], v9 offset:4096
    v_pk_mul_f32 v[134:135], v[134:135], v[22:23] op_sel_hi:[1,0]
    ds_read_b64_tr_b16 a[8:9], v10 offset:0
    v_cvt_pk_bf16_f32 v128, v128, v129
    ds_read_b64_tr_b16 a[10:11], v10 offset:4096
    v_cvt_pk_bf16_f32 v129, v130, v131
    ds_read_b64_tr_b16 a[12:13], v11 offset:0
    v_cvt_pk_bf16_f32 v130, v132, v133
    ds_read_b64_tr_b16 a[14:15], v11 offset:4096
    v_cvt_pk_bf16_f32 v131, v134, v135
    ds_read_b64_tr_b16 a[16:17], v12 offset:0
    buffer_store_dwordx4 v[128:131], v116, s[20:23], s29 offen offset:0 sc1
    ds_read_b64_tr_b16 a[18:19], v12 offset:4096
    v_pk_mul_f32 v[136:137], v[136:137], v[22:23] op_sel_hi:[1,0]
    ds_read_b64_tr_b16 a[20:21], v13 offset:0
    v_pk_mul_f32 v[138:139], v[138:139], v[22:23] op_sel_hi:[1,0]
    ds_read_b64_tr_b16 a[22:23], v13 offset:4096
    v_pk_mul_f32 v[140:141], v[140:141], v[22:23] op_sel_hi:[1,0]
    ds_read_b64_tr_b16 a[24:25], v14 offset:0
    v_pk_mul_f32 v[142:143], v[142:143], v[22:23] op_sel_hi:[1,0]
    ds_read_b64_tr_b16 a[26:27], v14 offset:4096
    v_cvt_pk_bf16_f32 v136, v136, v137
    ds_read_b64_tr_b16 a[28:29], v15 offset:0
    v_cvt_pk_bf16_f32 v137, v138, v139
    ds_read_b64_tr_b16 a[30:31], v15 offset:4096
    v_cvt_pk_bf16_f32 v138, v140, v141
    ds_read_b64_tr_b16 a[32:33], v8 offset:8192
    v_cvt_pk_bf16_f32 v139, v142, v143
    ds_read_b64_tr_b16 a[34:35], v8 offset:12288
    buffer_store_dwordx4 v[136:139], v116, s[20:23], s29 offen offset:1024 sc1
    ds_read_b64_tr_b16 a[36:37], v9 offset:8192
    v_pk_mul_f32 v[144:145], v[144:145], v[22:23] op_sel_hi:[1,0]
    ds_read_b64_tr_b16 a[38:39], v9 offset:12288
    v_pk_mul_f32 v[146:147], v[146:147], v[22:23] op_sel_hi:[1,0]
    ds_read_b64_tr_b16 a[40:41], v10 offset:8192
    v_pk_mul_f32 v[148:149], v[148:149], v[22:23] op_sel_hi:[1,0]
    ds_read_b64_tr_b16 a[42:43], v10 offset:12288
    v_pk_mul_f32 v[150:151], v[150:151], v[22:23] op_sel_hi:[1,0]
    ds_read_b64_tr_b16 a[44:45], v11 offset:8192
    v_cvt_pk_bf16_f32 v144, v144, v145
    ds_read_b64_tr_b16 a[46:47], v11 offset:12288
    v_cvt_pk_bf16_f32 v145, v146, v147
    ds_read_b64_tr_b16 a[48:49], v12 offset:8192
    v_cvt_pk_bf16_f32 v146, v148, v149
    ds_read_b64_tr_b16 a[50:51], v12 offset:12288
    v_cvt_pk_bf16_f32 v147, v150, v151
    ds_read_b64_tr_b16 a[52:53], v13 offset:8192
    buffer_store_dwordx4 v[144:147], v116, s[20:23], s29 offen offset:2048 sc1
    ds_read_b64_tr_b16 a[54:55], v13 offset:12288
    v_pk_mul_f32 v[152:153], v[152:153], v[22:23] op_sel_hi:[1,0]
    ds_read_b64_tr_b16 a[56:57], v14 offset:8192
    v_pk_mul_f32 v[154:155], v[154:155], v[22:23] op_sel_hi:[1,0]
    ds_read_b64_tr_b16 a[58:59], v14 offset:12288
    v_pk_mul_f32 v[156:157], v[156:157], v[22:23] op_sel_hi:[1,0]
    ds_read_b64_tr_b16 a[60:61], v15 offset:8192
    v_pk_mul_f32 v[158:159], v[158:159], v[22:23] op_sel_hi:[1,0]
    ds_read_b64_tr_b16 a[62:63], v15 offset:12288
    v_cvt_pk_bf16_f32 v152, v152, v153
    s_waitcnt vmcnt(43) lgkmcnt(0)
    v_mfma_f32_16x16x32_bf16 v[32:35], a[0:3], a[128:131], 0
    ds_read_b64_tr_b16 a[64:65], v96 offset:0
    v_cvt_pk_bf16_f32 v153, v154, v155
    v_cvt_pk_bf16_f32 v154, v156, v157
    v_mfma_f32_16x16x32_bf16 v[64:67], a[0:3], a[132:135], 0
    ds_read_b64_tr_b16 a[66:67], v96 offset:4096
    v_cvt_pk_bf16_f32 v155, v158, v159
    buffer_store_dwordx4 v[152:155], v116, s[20:23], s29 offen offset:3072 sc1
    v_mfma_f32_16x16x32_bf16 v[36:39], a[4:7], a[128:131], 0
    ds_read_b64_tr_b16 a[68:69], v97 offset:0
    v_pk_mul_f32 v[160:161], v[160:161], v[24:25] op_sel_hi:[1,0]
    v_pk_mul_f32 v[162:163], v[162:163], v[24:25] op_sel_hi:[1,0]
    v_mfma_f32_16x16x32_bf16 v[68:71], a[4:7], a[132:135], 0
    ds_read_b64_tr_b16 a[70:71], v97 offset:4096
    v_pk_mul_f32 v[164:165], v[164:165], v[24:25] op_sel_hi:[1,0]
    v_pk_mul_f32 v[166:167], v[166:167], v[24:25] op_sel_hi:[1,0]
    v_mfma_f32_16x16x32_bf16 v[40:43], a[8:11], a[128:131], 0
    ds_read_b64_tr_b16 a[72:73], v98 offset:0
    v_cvt_pk_bf16_f32 v160, v160, v161
    v_cvt_pk_bf16_f32 v161, v162, v163
    v_mfma_f32_16x16x32_bf16 v[72:75], a[8:11], a[132:135], 0
    ds_read_b64_tr_b16 a[74:75], v98 offset:4096
    v_cvt_pk_bf16_f32 v162, v164, v165
    v_cvt_pk_bf16_f32 v163, v166, v167
    v_mfma_f32_16x16x32_bf16 v[44:47], a[12:15], a[128:131], 0
    ds_read_b64_tr_b16 a[76:77], v99 offset:0
    buffer_store_dwordx4 v[160:163], v117, s[20:23], s29 offen offset:0 sc1
    v_pk_mul_f32 v[168:169], v[168:169], v[24:25] op_sel_hi:[1,0]
    v_mfma_f32_16x16x32_bf16 v[76:79], a[12:15], a[132:135], 0
    ds_read_b64_tr_b16 a[78:79], v99 offset:4096
    v_pk_mul_f32 v[170:171], v[170:171], v[24:25] op_sel_hi:[1,0]
    v_pk_mul_f32 v[172:173], v[172:173], v[24:25] op_sel_hi:[1,0]
    v_mfma_f32_16x16x32_bf16 v[48:51], a[16:19], a[128:131], 0
    ds_read_b64_tr_b16 a[80:81], v100 offset:0
    v_pk_mul_f32 v[174:175], v[174:175], v[24:25] op_sel_hi:[1,0]
    v_cvt_pk_bf16_f32 v168, v168, v169
    v_mfma_f32_16x16x32_bf16 v[80:83], a[16:19], a[132:135], 0
    ds_read_b64_tr_b16 a[82:83], v100 offset:4096
    v_cvt_pk_bf16_f32 v169, v170, v171
    v_cvt_pk_bf16_f32 v170, v172, v173
    v_mfma_f32_16x16x32_bf16 v[52:55], a[20:23], a[128:131], 0
    ds_read_b64_tr_b16 a[84:85], v101 offset:0
    v_cvt_pk_bf16_f32 v171, v174, v175
    buffer_store_dwordx4 v[168:171], v117, s[20:23], s29 offen offset:1024 sc1
    v_mfma_f32_16x16x32_bf16 v[84:87], a[20:23], a[132:135], 0
    ds_read_b64_tr_b16 a[86:87], v101 offset:4096
    v_pk_mul_f32 v[176:177], v[176:177], v[24:25] op_sel_hi:[1,0]
    v_pk_mul_f32 v[178:179], v[178:179], v[24:25] op_sel_hi:[1,0]
    v_mfma_f32_16x16x32_bf16 v[56:59], a[24:27], a[128:131], 0
    ds_read_b64_tr_b16 a[88:89], v102 offset:0
    v_pk_mul_f32 v[180:181], v[180:181], v[24:25] op_sel_hi:[1,0]
    v_pk_mul_f32 v[182:183], v[182:183], v[24:25] op_sel_hi:[1,0]
    v_mfma_f32_16x16x32_bf16 v[88:91], a[24:27], a[132:135], 0
    ds_read_b64_tr_b16 a[90:91], v102 offset:4096
    v_cvt_pk_bf16_f32 v176, v176, v177
    v_cvt_pk_bf16_f32 v177, v178, v179
    v_mfma_f32_16x16x32_bf16 v[60:63], a[28:31], a[128:131], 0
    ds_read_b64_tr_b16 a[92:93], v103 offset:0
    v_cvt_pk_bf16_f32 v178, v180, v181
    v_cvt_pk_bf16_f32 v179, v182, v183
    v_mfma_f32_16x16x32_bf16 v[92:95], a[28:31], a[132:135], 0
    ds_read_b64_tr_b16 a[94:95], v103 offset:4096
    buffer_store_dwordx4 v[176:179], v117, s[20:23], s29 offen offset:2048 sc1
    v_pk_mul_f32 v[184:185], v[184:185], v[24:25] op_sel_hi:[1,0]
    v_mfma_f32_16x16x32_bf16 v[32:35], a[32:35], a[136:139], v[32:35]
    ds_read_b64_tr_b16 a[96:97], v96 offset:8192
    v_pk_mul_f32 v[186:187], v[186:187], v[24:25] op_sel_hi:[1,0]
    v_pk_mul_f32 v[188:189], v[188:189], v[24:25] op_sel_hi:[1,0]
    v_mfma_f32_16x16x32_bf16 v[64:67], a[32:35], a[140:143], v[64:67]
    ds_read_b64_tr_b16 a[98:99], v96 offset:12288
    v_pk_mul_f32 v[190:191], v[190:191], v[24:25] op_sel_hi:[1,0]
    v_cvt_pk_bf16_f32 v184, v184, v185
    v_mfma_f32_16x16x32_bf16 v[36:39], a[36:39], a[136:139], v[36:39]
    ds_read_b64_tr_b16 a[100:101], v97 offset:8192
    v_cvt_pk_bf16_f32 v185, v186, v187
    v_cvt_pk_bf16_f32 v186, v188, v189
    v_mfma_f32_16x16x32_bf16 v[68:71], a[36:39], a[140:143], v[68:71]
    ds_read_b64_tr_b16 a[102:103], v97 offset:12288
    v_cvt_pk_bf16_f32 v187, v190, v191
    buffer_store_dwordx4 v[184:187], v117, s[20:23], s29 offen offset:3072 sc1
    v_mfma_f32_16x16x32_bf16 v[40:43], a[40:43], a[136:139], v[40:43]
    ds_read_b64_tr_b16 a[104:105], v98 offset:8192
    v_pk_mul_f32 v[192:193], v[192:193], v[26:27] op_sel_hi:[1,0]
    v_pk_mul_f32 v[194:195], v[194:195], v[26:27] op_sel_hi:[1,0]
    v_mfma_f32_16x16x32_bf16 v[72:75], a[40:43], a[140:143], v[72:75]
    ds_read_b64_tr_b16 a[106:107], v98 offset:12288
    v_pk_mul_f32 v[196:197], v[196:197], v[26:27] op_sel_hi:[1,0]
    v_pk_mul_f32 v[198:199], v[198:199], v[26:27] op_sel_hi:[1,0]
    v_mfma_f32_16x16x32_bf16 v[44:47], a[44:47], a[136:139], v[44:47]
    ds_read_b64_tr_b16 a[108:109], v99 offset:8192
    v_cvt_pk_bf16_f32 v192, v192, v193
    v_cvt_pk_bf16_f32 v193, v194, v195
    v_mfma_f32_16x16x32_bf16 v[76:79], a[44:47], a[140:143], v[76:79]
    ds_read_b64_tr_b16 a[110:111], v99 offset:12288
    v_cvt_pk_bf16_f32 v194, v196, v197
    v_cvt_pk_bf16_f32 v195, v198, v199
    v_mfma_f32_16x16x32_bf16 v[48:51], a[48:51], a[136:139], v[48:51]
    ds_read_b64_tr_b16 a[112:113], v100 offset:8192
    buffer_store_dwordx4 v[192:195], v118, s[20:23], s29 offen offset:0 sc1
    v_pk_mul_f32 v[200:201], v[200:201], v[26:27] op_sel_hi:[1,0]
    v_mfma_f32_16x16x32_bf16 v[80:83], a[48:51], a[140:143], v[80:83]
    ds_read_b64_tr_b16 a[114:115], v100 offset:12288
    v_pk_mul_f32 v[202:203], v[202:203], v[26:27] op_sel_hi:[1,0]
    v_pk_mul_f32 v[204:205], v[204:205], v[26:27] op_sel_hi:[1,0]
    v_mfma_f32_16x16x32_bf16 v[52:55], a[52:55], a[136:139], v[52:55]
    ds_read_b64_tr_b16 a[116:117], v101 offset:8192
    v_pk_mul_f32 v[206:207], v[206:207], v[26:27] op_sel_hi:[1,0]
    v_cvt_pk_bf16_f32 v200, v200, v201
    v_mfma_f32_16x16x32_bf16 v[84:87], a[52:55], a[140:143], v[84:87]
    ds_read_b64_tr_b16 a[118:119], v101 offset:12288
    v_cvt_pk_bf16_f32 v201, v202, v203
    v_cvt_pk_bf16_f32 v202, v204, v205
    v_mfma_f32_16x16x32_bf16 v[56:59], a[56:59], a[136:139], v[56:59]
    ds_read_b64_tr_b16 a[120:121], v102 offset:8192
    v_cvt_pk_bf16_f32 v203, v206, v207
    buffer_store_dwordx4 v[200:203], v118, s[20:23], s29 offen offset:1024 sc1
    v_mfma_f32_16x16x32_bf16 v[88:91], a[56:59], a[140:143], v[88:91]
    ds_read_b64_tr_b16 a[122:123], v102 offset:12288
    v_pk_mul_f32 v[208:209], v[208:209], v[26:27] op_sel_hi:[1,0]
    v_pk_mul_f32 v[210:211], v[210:211], v[26:27] op_sel_hi:[1,0]
    v_mfma_f32_16x16x32_bf16 v[60:63], a[60:63], a[136:139], v[60:63]
    ds_read_b64_tr_b16 a[124:125], v103 offset:8192
    v_pk_mul_f32 v[212:213], v[212:213], v[26:27] op_sel_hi:[1,0]
    v_pk_mul_f32 v[214:215], v[214:215], v[26:27] op_sel_hi:[1,0]
    v_mfma_f32_16x16x32_bf16 v[92:95], a[60:63], a[140:143], v[92:95]
    ds_read_b64_tr_b16 a[126:127], v103 offset:12288
    v_cvt_pk_bf16_f32 v208, v208, v209
    v_cvt_pk_bf16_f32 v209, v210, v211
    s_waitcnt vmcnt(30) lgkmcnt(0)
    s_barrier
    v_mfma_f32_16x16x32_bf16 v[32:35], a[64:67], a[144:147], v[32:35]
    ds_read_b64_tr_b16 a[0:1], v8 offset:16384
    v_cvt_pk_bf16_f32 v210, v212, v213
    v_cvt_pk_bf16_f32 v211, v214, v215
    v_mfma_f32_16x16x32_bf16 v[64:67], a[64:67], a[148:151], v[64:67]
    ds_read_b64_tr_b16 a[2:3], v8 offset:20480
    buffer_store_dwordx4 v[208:211], v118, s[20:23], s29 offen offset:2048 sc1
    v_pk_mul_f32 v[216:217], v[216:217], v[26:27] op_sel_hi:[1,0]
    v_mfma_f32_16x16x32_bf16 v[36:39], a[68:71], a[144:147], v[36:39]
    ds_read_b64_tr_b16 a[4:5], v9 offset:16384
    v_pk_mul_f32 v[218:219], v[218:219], v[26:27] op_sel_hi:[1,0]
    v_pk_mul_f32 v[220:221], v[220:221], v[26:27] op_sel_hi:[1,0]
    v_mfma_f32_16x16x32_bf16 v[68:71], a[68:71], a[148:151], v[68:71]
    ds_read_b64_tr_b16 a[6:7], v9 offset:20480
    v_pk_mul_f32 v[222:223], v[222:223], v[26:27] op_sel_hi:[1,0]
    v_cvt_pk_bf16_f32 v216, v216, v217
    v_mfma_f32_16x16x32_bf16 v[40:43], a[72:75], a[144:147], v[40:43]
    ds_read_b64_tr_b16 a[8:9], v10 offset:16384
    v_cvt_pk_bf16_f32 v217, v218, v219
    v_cvt_pk_bf16_f32 v218, v220, v221
    v_mfma_f32_16x16x32_bf16 v[72:75], a[72:75], a[148:151], v[72:75]
    ds_read_b64_tr_b16 a[10:11], v10 offset:20480
    v_cvt_pk_bf16_f32 v219, v222, v223
    buffer_store_dwordx4 v[216:219], v118, s[20:23], s29 offen offset:3072 sc1
    v_mfma_f32_16x16x32_bf16 v[44:47], a[76:79], a[144:147], v[44:47]
    ds_read_b64_tr_b16 a[12:13], v11 offset:16384
    v_pk_mul_f32 v[224:225], v[224:225], v[28:29] op_sel_hi:[1,0]
    v_pk_mul_f32 v[226:227], v[226:227], v[28:29] op_sel_hi:[1,0]
    v_mfma_f32_16x16x32_bf16 v[76:79], a[76:79], a[148:151], v[76:79]
    ds_read_b64_tr_b16 a[14:15], v11 offset:20480
    v_pk_mul_f32 v[228:229], v[228:229], v[28:29] op_sel_hi:[1,0]
    v_pk_mul_f32 v[230:231], v[230:231], v[28:29] op_sel_hi:[1,0]
    v_mfma_f32_16x16x32_bf16 v[48:51], a[80:83], a[144:147], v[48:51]
    ds_read_b64_tr_b16 a[16:17], v12 offset:16384
    v_cvt_pk_bf16_f32 v224, v224, v225
    v_cvt_pk_bf16_f32 v225, v226, v227
    v_mfma_f32_16x16x32_bf16 v[80:83], a[80:83], a[148:151], v[80:83]
    ds_read_b64_tr_b16 a[18:19], v12 offset:20480
    v_cvt_pk_bf16_f32 v226, v228, v229
    v_cvt_pk_bf16_f32 v227, v230, v231
    v_mfma_f32_16x16x32_bf16 v[52:55], a[84:87], a[144:147], v[52:55]
    ds_read_b64_tr_b16 a[20:21], v13 offset:16384
    buffer_store_dwordx4 v[224:227], v119, s[20:23], s29 offen offset:0 sc1
    v_pk_mul_f32 v[232:233], v[232:233], v[28:29] op_sel_hi:[1,0]
    v_mfma_f32_16x16x32_bf16 v[84:87], a[84:87], a[148:151], v[84:87]
    ds_read_b64_tr_b16 a[22:23], v13 offset:20480
    v_pk_mul_f32 v[234:235], v[234:235], v[28:29] op_sel_hi:[1,0]
    v_pk_mul_f32 v[236:237], v[236:237], v[28:29] op_sel_hi:[1,0]
    v_mfma_f32_16x16x32_bf16 v[56:59], a[88:91], a[144:147], v[56:59]
    ds_read_b64_tr_b16 a[24:25], v14 offset:16384
    v_pk_mul_f32 v[238:239], v[238:239], v[28:29] op_sel_hi:[1,0]
    v_cvt_pk_bf16_f32 v232, v232, v233
    v_mfma_f32_16x16x32_bf16 v[88:91], a[88:91], a[148:151], v[88:91]
    ds_read_b64_tr_b16 a[26:27], v14 offset:20480
    v_cvt_pk_bf16_f32 v233, v234, v235
    v_cvt_pk_bf16_f32 v234, v236, v237
    v_mfma_f32_16x16x32_bf16 v[60:63], a[92:95], a[144:147], v[60:63]
    ds_read_b64_tr_b16 a[28:29], v15 offset:16384
    v_cvt_pk_bf16_f32 v235, v238, v239
    buffer_store_dwordx4 v[232:235], v119, s[20:23], s29 offen offset:1024 sc1
    v_mfma_f32_16x16x32_bf16 v[92:95], a[92:95], a[148:151], v[92:95]
    ds_read_b64_tr_b16 a[30:31], v15 offset:20480
    v_pk_mul_f32 v[240:241], v[240:241], v[28:29] op_sel_hi:[1,0]
    v_pk_mul_f32 v[242:243], v[242:243], v[28:29] op_sel_hi:[1,0]
    v_mfma_f32_16x16x32_bf16 v[32:35], a[96:99], a[152:155], v[32:35]
    ds_read_b64_tr_b16 a[32:33], v8 offset:24576
    v_pk_mul_f32 v[244:245], v[244:245], v[28:29] op_sel_hi:[1,0]
    v_pk_mul_f32 v[246:247], v[246:247], v[28:29] op_sel_hi:[1,0]
    v_mfma_f32_16x16x32_bf16 v[64:67], a[96:99], a[156:159], v[64:67]
    ds_read_b64_tr_b16 a[34:35], v8 offset:28672
    v_cvt_pk_bf16_f32 v240, v240, v241
    v_cvt_pk_bf16_f32 v241, v242, v243
    v_mfma_f32_16x16x32_bf16 v[36:39], a[100:103], a[152:155], v[36:39]
    ds_read_b64_tr_b16 a[36:37], v9 offset:24576
    v_cvt_pk_bf16_f32 v242, v244, v245
    v_cvt_pk_bf16_f32 v243, v246, v247
    v_mfma_f32_16x16x32_bf16 v[68:71], a[100:103], a[156:159], v[68:71]
    ds_read_b64_tr_b16 a[38:39], v9 offset:28672
    buffer_store_dwordx4 v[240:243], v119, s[20:23], s29 offen offset:2048 sc1
    v_pk_mul_f32 v[248:249], v[248:249], v[28:29] op_sel_hi:[1,0]
    v_mfma_f32_16x16x32_bf16 v[40:43], a[104:107], a[152:155], v[40:43]
    ds_read_b64_tr_b16 a[40:41], v10 offset:24576
    v_pk_mul_f32 v[250:251], v[250:251], v[28:29] op_sel_hi:[1,0]
    v_pk_mul_f32 v[252:253], v[252:253], v[28:29] op_sel_hi:[1,0]
    v_mfma_f32_16x16x32_bf16 v[72:75], a[104:107], a[156:159], v[72:75]
    ds_read_b64_tr_b16 a[42:43], v10 offset:28672
    v_pk_mul_f32 v[254:255], v[254:255], v[28:29] op_sel_hi:[1,0]
    v_cvt_pk_bf16_f32 v248, v248, v249
    v_mfma_f32_16x16x32_bf16 v[44:47], a[108:111], a[152:155], v[44:47]
    ds_read_b64_tr_b16 a[44:45], v11 offset:24576
    v_cvt_pk_bf16_f32 v249, v250, v251
    v_cvt_pk_bf16_f32 v250, v252, v253
    v_mfma_f32_16x16x32_bf16 v[76:79], a[108:111], a[156:159], v[76:79]
    ds_read_b64_tr_b16 a[46:47], v11 offset:28672
    v_cvt_pk_bf16_f32 v251, v254, v255
    buffer_store_dwordx4 v[248:251], v119, s[20:23], s29 offen offset:3072 sc1
    v_mfma_f32_16x16x32_bf16 v[48:51], a[112:115], a[152:155], v[48:51]
    ds_read_b64_tr_b16 a[48:49], v12 offset:24576
    v_mfma_f32_16x16x32_bf16 v[80:83], a[112:115], a[156:159], v[80:83]
    ds_read_b64_tr_b16 a[50:51], v12 offset:28672
    v_mfma_f32_16x16x32_bf16 v[52:55], a[116:119], a[152:155], v[52:55]
    ds_read_b64_tr_b16 a[52:53], v13 offset:24576
    v_mfma_f32_16x16x32_bf16 v[84:87], a[116:119], a[156:159], v[84:87]
    ds_read_b64_tr_b16 a[54:55], v13 offset:28672
    v_mfma_f32_16x16x32_bf16 v[56:59], a[120:123], a[152:155], v[56:59]
    ds_read_b64_tr_b16 a[56:57], v14 offset:24576
    v_mfma_f32_16x16x32_bf16 v[88:91], a[120:123], a[156:159], v[88:91]
    ds_read_b64_tr_b16 a[58:59], v14 offset:28672
    v_mfma_f32_16x16x32_bf16 v[60:63], a[124:127], a[152:155], v[60:63]
    ds_read_b64_tr_b16 a[60:61], v15 offset:24576
    v_mfma_f32_16x16x32_bf16 v[92:95], a[124:127], a[156:159], v[92:95]
    ds_read_b64_tr_b16 a[62:63], v15 offset:28672
    s_waitcnt vmcnt(40) lgkmcnt(0)
    v_mfma_f32_16x16x32_bf16 v[32:35], a[0:3], a[160:163], v[32:35]
    ds_read_b64_tr_b16 a[64:65], v96 offset:16384
    s_add_u32 m0, s24, 114688
    v_mfma_f32_16x16x32_bf16 v[64:67], a[0:3], a[164:167], v[64:67]
    ds_read_b64_tr_b16 a[66:67], v96 offset:20480
    s_mov_b32 s25, 786432
    v_mfma_f32_16x16x32_bf16 v[36:39], a[4:7], a[160:163], v[36:39]
    ds_read_b64_tr_b16 a[68:69], v97 offset:16384
    v_mfma_f32_16x16x32_bf16 v[68:71], a[4:7], a[164:167], v[68:71]
    ds_read_b64_tr_b16 a[70:71], v97 offset:20480
    buffer_load_dwordx4 v16, s[8:11], s25 offen offset:0 lds
    v_mfma_f32_16x16x32_bf16 v[40:43], a[8:11], a[160:163], v[40:43]
    ds_read_b64_tr_b16 a[72:73], v98 offset:16384
    v_mfma_f32_16x16x32_bf16 v[72:75], a[8:11], a[164:167], v[72:75]
    ds_read_b64_tr_b16 a[74:75], v98 offset:20480
    v_mfma_f32_16x16x32_bf16 v[44:47], a[12:15], a[160:163], v[44:47]
    ds_read_b64_tr_b16 a[76:77], v99 offset:16384
    buffer_load_dwordx4 v17, s[8:11], s25 offen offset:1024 lds
    v_mfma_f32_16x16x32_bf16 v[76:79], a[12:15], a[164:167], v[76:79]
    ds_read_b64_tr_b16 a[78:79], v99 offset:20480
    v_mfma_f32_16x16x32_bf16 v[48:51], a[16:19], a[160:163], v[48:51]
    ds_read_b64_tr_b16 a[80:81], v100 offset:16384
    v_mfma_f32_16x16x32_bf16 v[80:83], a[16:19], a[164:167], v[80:83]
    ds_read_b64_tr_b16 a[82:83], v100 offset:20480
    buffer_load_dwordx4 v18, s[8:11], s25 offen offset:2048 lds
    v_mfma_f32_16x16x32_bf16 v[52:55], a[20:23], a[160:163], v[52:55]
    ds_read_b64_tr_b16 a[84:85], v101 offset:16384
    v_mfma_f32_16x16x32_bf16 v[84:87], a[20:23], a[164:167], v[84:87]
    ds_read_b64_tr_b16 a[86:87], v101 offset:20480
    v_mfma_f32_16x16x32_bf16 v[56:59], a[24:27], a[160:163], v[56:59]
    ds_read_b64_tr_b16 a[88:89], v102 offset:16384
    buffer_load_dwordx4 v19, s[8:11], s25 offen offset:3072 lds
    v_mfma_f32_16x16x32_bf16 v[88:91], a[24:27], a[164:167], v[88:91]
    ds_read_b64_tr_b16 a[90:91], v102 offset:20480
    s_add_u32 m0, s24, 49152
    v_mfma_f32_16x16x32_bf16 v[60:63], a[28:31], a[160:163], v[60:63]
    ds_read_b64_tr_b16 a[92:93], v103 offset:16384
    s_mov_b32 s25, 851968
    v_mfma_f32_16x16x32_bf16 v[92:95], a[28:31], a[164:167], v[92:95]
    ds_read_b64_tr_b16 a[94:95], v103 offset:20480
    buffer_load_dwordx4 v16, s[8:11], s25 offen offset:0 lds
    v_mfma_f32_16x16x32_bf16 v[32:35], a[32:35], a[168:171], v[32:35]
    ds_read_b64_tr_b16 a[96:97], v96 offset:24576
    v_mfma_f32_16x16x32_bf16 v[64:67], a[32:35], a[172:175], v[64:67]
    ds_read_b64_tr_b16 a[98:99], v96 offset:28672
    v_mfma_f32_16x16x32_bf16 v[36:39], a[36:39], a[168:171], v[36:39]
    ds_read_b64_tr_b16 a[100:101], v97 offset:24576
    buffer_load_dwordx4 v17, s[8:11], s25 offen offset:1024 lds
    v_mfma_f32_16x16x32_bf16 v[68:71], a[36:39], a[172:175], v[68:71]
    ds_read_b64_tr_b16 a[102:103], v97 offset:28672
    v_mfma_f32_16x16x32_bf16 v[40:43], a[40:43], a[168:171], v[40:43]
    ds_read_b64_tr_b16 a[104:105], v98 offset:24576
    v_mfma_f32_16x16x32_bf16 v[72:75], a[40:43], a[172:175], v[72:75]
    ds_read_b64_tr_b16 a[106:107], v98 offset:28672
    buffer_load_dwordx4 v18, s[8:11], s25 offen offset:2048 lds
    v_mfma_f32_16x16x32_bf16 v[44:47], a[44:47], a[168:171], v[44:47]
    ds_read_b64_tr_b16 a[108:109], v99 offset:24576
    v_mfma_f32_16x16x32_bf16 v[76:79], a[44:47], a[172:175], v[76:79]
    ds_read_b64_tr_b16 a[110:111], v99 offset:28672
    v_mfma_f32_16x16x32_bf16 v[48:51], a[48:51], a[168:171], v[48:51]
    ds_read_b64_tr_b16 a[112:113], v100 offset:24576
    buffer_load_dwordx4 v19, s[8:11], s25 offen offset:3072 lds
    v_mfma_f32_16x16x32_bf16 v[80:83], a[48:51], a[172:175], v[80:83]
    ds_read_b64_tr_b16 a[114:115], v100 offset:28672
    s_mov_b32 s26, 24576
    v_mfma_f32_16x16x32_bf16 v[52:55], a[52:55], a[168:171], v[52:55]
    ds_read_b64_tr_b16 a[116:117], v101 offset:24576
    v_mfma_f32_16x16x32_bf16 v[84:87], a[52:55], a[172:175], v[84:87]
    ds_read_b64_tr_b16 a[118:119], v101 offset:28672
    buffer_load_dwordx4 a[224:227], v20, s[12:15], s26 offen offset:0 sc1
    v_mfma_f32_16x16x32_bf16 v[56:59], a[56:59], a[168:171], v[56:59]
    ds_read_b64_tr_b16 a[120:121], v102 offset:24576
    v_mfma_f32_16x16x32_bf16 v[88:91], a[56:59], a[172:175], v[88:91]
    ds_read_b64_tr_b16 a[122:123], v102 offset:28672
    v_mfma_f32_16x16x32_bf16 v[60:63], a[60:63], a[168:171], v[60:63]
    ds_read_b64_tr_b16 a[124:125], v103 offset:24576
    buffer_load_dwordx4 a[228:231], v21, s[12:15], s26 offen offset:0 sc1
    v_mfma_f32_16x16x32_bf16 v[92:95], a[60:63], a[172:175], v[92:95]
    ds_read_b64_tr_b16 a[126:127], v103 offset:28672
    buffer_load_dwordx4 a[232:235], v20, s[12:15], s26 offen offset:1024 sc1
    buffer_load_dwordx4 a[236:239], v21, s[12:15], s26 offen offset:1024 sc1
    s_waitcnt vmcnt(32) lgkmcnt(0)
    s_barrier
    v_mfma_f32_16x16x32_bf16 v[32:35], a[64:67], a[176:179], v[32:35]
    ds_read_b64_tr_b16 a[0:1], v8 offset:32768
    s_add_u32 m0, s24, 65536
    v_mfma_f32_16x16x32_bf16 v[64:67], a[64:67], a[180:183], v[64:67]
    ds_read_b64_tr_b16 a[2:3], v8 offset:36864
    s_mov_b32 s25, 1048576
    v_mfma_f32_16x16x32_bf16 v[36:39], a[68:71], a[176:179], v[36:39]
    ds_read_b64_tr_b16 a[4:5], v9 offset:32768
    v_mfma_f32_16x16x32_bf16 v[68:71], a[68:71], a[180:183], v[68:71]
    ds_read_b64_tr_b16 a[6:7], v9 offset:36864
    buffer_load_dwordx4 v16, s[8:11], s25 offen offset:0 lds
    v_mfma_f32_16x16x32_bf16 v[40:43], a[72:75], a[176:179], v[40:43]
    ds_read_b64_tr_b16 a[8:9], v10 offset:32768
    v_mfma_f32_16x16x32_bf16 v[72:75], a[72:75], a[180:183], v[72:75]
    ds_read_b64_tr_b16 a[10:11], v10 offset:36864
    v_mfma_f32_16x16x32_bf16 v[44:47], a[76:79], a[176:179], v[44:47]
    ds_read_b64_tr_b16 a[12:13], v11 offset:32768
    buffer_load_dwordx4 v17, s[8:11], s25 offen offset:1024 lds
    v_mfma_f32_16x16x32_bf16 v[76:79], a[76:79], a[180:183], v[76:79]
    ds_read_b64_tr_b16 a[14:15], v11 offset:36864
    v_mfma_f32_16x16x32_bf16 v[48:51], a[80:83], a[176:179], v[48:51]
    ds_read_b64_tr_b16 a[16:17], v12 offset:32768
    v_mfma_f32_16x16x32_bf16 v[80:83], a[80:83], a[180:183], v[80:83]
    ds_read_b64_tr_b16 a[18:19], v12 offset:36864
    buffer_load_dwordx4 v18, s[8:11], s25 offen offset:2048 lds
    v_mfma_f32_16x16x32_bf16 v[52:55], a[84:87], a[176:179], v[52:55]
    ds_read_b64_tr_b16 a[20:21], v13 offset:32768
    v_mfma_f32_16x16x32_bf16 v[84:87], a[84:87], a[180:183], v[84:87]
    ds_read_b64_tr_b16 a[22:23], v13 offset:36864
    v_mfma_f32_16x16x32_bf16 v[56:59], a[88:91], a[176:179], v[56:59]
    ds_read_b64_tr_b16 a[24:25], v14 offset:32768
    buffer_load_dwordx4 v19, s[8:11], s25 offen offset:3072 lds
    v_mfma_f32_16x16x32_bf16 v[88:91], a[88:91], a[180:183], v[88:91]
    ds_read_b64_tr_b16 a[26:27], v14 offset:36864
    s_mov_b32 s26, 26624
    v_mfma_f32_16x16x32_bf16 v[60:63], a[92:95], a[176:179], v[60:63]
    ds_read_b64_tr_b16 a[28:29], v15 offset:32768
    v_mfma_f32_16x16x32_bf16 v[92:95], a[92:95], a[180:183], v[92:95]
    ds_read_b64_tr_b16 a[30:31], v15 offset:36864
    buffer_load_dwordx4 a[240:243], v20, s[12:15], s26 offen offset:0 sc1
    v_mfma_f32_16x16x32_bf16 v[32:35], a[96:99], a[184:187], v[32:35]
    ds_read_b64_tr_b16 a[32:33], v8 offset:40960
    v_mfma_f32_16x16x32_bf16 v[64:67], a[96:99], a[188:191], v[64:67]
    ds_read_b64_tr_b16 a[34:35], v8 offset:45056
    v_mfma_f32_16x16x32_bf16 v[36:39], a[100:103], a[184:187], v[36:39]
    ds_read_b64_tr_b16 a[36:37], v9 offset:40960
    buffer_load_dwordx4 a[244:247], v21, s[12:15], s26 offen offset:0 sc1
    v_mfma_f32_16x16x32_bf16 v[68:71], a[100:103], a[188:191], v[68:71]
    ds_read_b64_tr_b16 a[38:39], v9 offset:45056
    v_mfma_f32_16x16x32_bf16 v[40:43], a[104:107], a[184:187], v[40:43]
    ds_read_b64_tr_b16 a[40:41], v10 offset:40960
    v_mfma_f32_16x16x32_bf16 v[72:75], a[104:107], a[188:191], v[72:75]
    ds_read_b64_tr_b16 a[42:43], v10 offset:45056
    buffer_load_dwordx4 a[248:251], v20, s[12:15], s26 offen offset:1024 sc1
    v_mfma_f32_16x16x32_bf16 v[44:47], a[108:111], a[184:187], v[44:47]
    ds_read_b64_tr_b16 a[44:45], v11 offset:40960
    v_mfma_f32_16x16x32_bf16 v[76:79], a[108:111], a[188:191], v[76:79]
    ds_read_b64_tr_b16 a[46:47], v11 offset:45056
    v_mfma_f32_16x16x32_bf16 v[48:51], a[112:115], a[184:187], v[48:51]
    ds_read_b64_tr_b16 a[48:49], v12 offset:40960
    buffer_load_dwordx4 a[252:255], v21, s[12:15], s26 offen offset:1024 sc1
    v_mfma_f32_16x16x32_bf16 v[80:83], a[112:115], a[188:191], v[80:83]
    ds_read_b64_tr_b16 a[50:51], v12 offset:45056
    v_mfma_f32_16x16x32_bf16 v[52:55], a[116:119], a[184:187], v[52:55]
    ds_read_b64_tr_b16 a[52:53], v13 offset:40960
    v_mfma_f32_16x16x32_bf16 v[84:87], a[116:119], a[188:191], v[84:87]
    ds_read_b64_tr_b16 a[54:55], v13 offset:45056
    v_mfma_f32_16x16x32_bf16 v[56:59], a[120:123], a[184:187], v[56:59]
    ds_read_b64_tr_b16 a[56:57], v14 offset:40960
    v_mfma_f32_16x16x32_bf16 v[88:91], a[120:123], a[188:191], v[88:91]
    ds_read_b64_tr_b16 a[58:59], v14 offset:45056
    v_mfma_f32_16x16x32_bf16 v[60:63], a[124:127], a[184:187], v[60:63]
    ds_read_b64_tr_b16 a[60:61], v15 offset:40960
    v_mfma_f32_16x16x32_bf16 v[92:95], a[124:127], a[188:191], v[92:95]
    ds_read_b64_tr_b16 a[62:63], v15 offset:45056
    s_waitcnt vmcnt(44) lgkmcnt(0)
    v_mfma_f32_16x16x32_bf16 v[32:35], a[0:3], a[192:195], v[32:35]
    ds_read_b64_tr_b16 a[64:65], v96 offset:32768
    s_add_u32 m0, s24, 0
    v_mfma_f32_16x16x32_bf16 v[64:67], a[0:3], a[196:199], v[64:67]
    ds_read_b64_tr_b16 a[66:67], v96 offset:36864
    s_mov_b32 s25, 1114112
    v_mfma_f32_16x16x32_bf16 v[36:39], a[4:7], a[192:195], v[36:39]
    ds_read_b64_tr_b16 a[68:69], v97 offset:32768
    v_mfma_f32_16x16x32_bf16 v[68:71], a[4:7], a[196:199], v[68:71]
    ds_read_b64_tr_b16 a[70:71], v97 offset:36864
    buffer_load_dwordx4 v16, s[8:11], s25 offen offset:0 lds
    v_mfma_f32_16x16x32_bf16 v[40:43], a[8:11], a[192:195], v[40:43]
    ds_read_b64_tr_b16 a[72:73], v98 offset:32768
    v_mfma_f32_16x16x32_bf16 v[72:75], a[8:11], a[196:199], v[72:75]
    ds_read_b64_tr_b16 a[74:75], v98 offset:36864
    v_mfma_f32_16x16x32_bf16 v[44:47], a[12:15], a[192:195], v[44:47]
    ds_read_b64_tr_b16 a[76:77], v99 offset:32768
    buffer_load_dwordx4 v17, s[8:11], s25 offen offset:1024 lds
    v_mfma_f32_16x16x32_bf16 v[76:79], a[12:15], a[196:199], v[76:79]
    ds_read_b64_tr_b16 a[78:79], v99 offset:36864
    v_mfma_f32_16x16x32_bf16 v[48:51], a[16:19], a[192:195], v[48:51]
    ds_read_b64_tr_b16 a[80:81], v100 offset:32768
    v_mfma_f32_16x16x32_bf16 v[80:83], a[16:19], a[196:199], v[80:83]
    ds_read_b64_tr_b16 a[82:83], v100 offset:36864
    buffer_load_dwordx4 v18, s[8:11], s25 offen offset:2048 lds
    v_mfma_f32_16x16x32_bf16 v[52:55], a[20:23], a[192:195], v[52:55]
    ds_read_b64_tr_b16 a[84:85], v101 offset:32768
    v_mfma_f32_16x16x32_bf16 v[84:87], a[20:23], a[196:199], v[84:87]
    ds_read_b64_tr_b16 a[86:87], v101 offset:36864
    v_mfma_f32_16x16x32_bf16 v[56:59], a[24:27], a[192:195], v[56:59]
    ds_read_b64_tr_b16 a[88:89], v102 offset:32768
    buffer_load_dwordx4 v19, s[8:11], s25 offen offset:3072 lds
    v_mfma_f32_16x16x32_bf16 v[88:91], a[24:27], a[196:199], v[88:91]
    ds_read_b64_tr_b16 a[90:91], v102 offset:36864
    s_mov_b32 s26, 32768
    v_mfma_f32_16x16x32_bf16 v[60:63], a[28:31], a[192:195], v[60:63]
    ds_read_b64_tr_b16 a[92:93], v103 offset:32768
    v_mfma_f32_16x16x32_bf16 v[92:95], a[28:31], a[196:199], v[92:95]
    ds_read_b64_tr_b16 a[94:95], v103 offset:36864
    buffer_load_dwordx4 a[128:131], v20, s[12:15], s26 offen offset:0 sc1
    v_mfma_f32_16x16x32_bf16 v[32:35], a[32:35], a[200:203], v[32:35]
    ds_read_b64_tr_b16 a[96:97], v96 offset:40960
    v_mfma_f32_16x16x32_bf16 v[64:67], a[32:35], a[204:207], v[64:67]
    ds_read_b64_tr_b16 a[98:99], v96 offset:45056
    v_mfma_f32_16x16x32_bf16 v[36:39], a[36:39], a[200:203], v[36:39]
    ds_read_b64_tr_b16 a[100:101], v97 offset:40960
    buffer_load_dwordx4 a[132:135], v21, s[12:15], s26 offen offset:0 sc1
    v_mfma_f32_16x16x32_bf16 v[68:71], a[36:39], a[204:207], v[68:71]
    ds_read_b64_tr_b16 a[102:103], v97 offset:45056
    v_mfma_f32_16x16x32_bf16 v[40:43], a[40:43], a[200:203], v[40:43]
    ds_read_b64_tr_b16 a[104:105], v98 offset:40960
    v_mfma_f32_16x16x32_bf16 v[72:75], a[40:43], a[204:207], v[72:75]
    ds_read_b64_tr_b16 a[106:107], v98 offset:45056
    buffer_load_dwordx4 a[136:139], v20, s[12:15], s26 offen offset:1024 sc1
    v_mfma_f32_16x16x32_bf16 v[44:47], a[44:47], a[200:203], v[44:47]
    ds_read_b64_tr_b16 a[108:109], v99 offset:40960
    v_mfma_f32_16x16x32_bf16 v[76:79], a[44:47], a[204:207], v[76:79]
    ds_read_b64_tr_b16 a[110:111], v99 offset:45056
    v_mfma_f32_16x16x32_bf16 v[48:51], a[48:51], a[200:203], v[48:51]
    ds_read_b64_tr_b16 a[112:113], v100 offset:40960
    buffer_load_dwordx4 a[140:143], v21, s[12:15], s26 offen offset:1024 sc1
    v_mfma_f32_16x16x32_bf16 v[80:83], a[48:51], a[204:207], v[80:83]
    ds_read_b64_tr_b16 a[114:115], v100 offset:45056
    v_mfma_f32_16x16x32_bf16 v[52:55], a[52:55], a[200:203], v[52:55]
    ds_read_b64_tr_b16 a[116:117], v101 offset:40960
    v_mfma_f32_16x16x32_bf16 v[84:87], a[52:55], a[204:207], v[84:87]
    ds_read_b64_tr_b16 a[118:119], v101 offset:45056
    v_mfma_f32_16x16x32_bf16 v[56:59], a[56:59], a[200:203], v[56:59]
    ds_read_b64_tr_b16 a[120:121], v102 offset:40960
    v_mfma_f32_16x16x32_bf16 v[88:91], a[56:59], a[204:207], v[88:91]
    ds_read_b64_tr_b16 a[122:123], v102 offset:45056
    v_mfma_f32_16x16x32_bf16 v[60:63], a[60:63], a[200:203], v[60:63]
    ds_read_b64_tr_b16 a[124:125], v103 offset:40960
    v_mfma_f32_16x16x32_bf16 v[92:95], a[60:63], a[204:207], v[92:95]
    ds_read_b64_tr_b16 a[126:127], v103 offset:45056
    s_waitcnt vmcnt(20) lgkmcnt(0)
    s_barrier
    s_cmp_eq_u32 s24, 0
    s_cbranch_scc0 L_nf2
    s_lshl_b32 s3, s75, 4
    s_and_b32 s86, s76, 8
    s_add_u32 s3, s3, s86
    s_and_b32 s86, s76, 7
    s_add_u32 s3, s3, s86
    v_mov_b32 v23, s3
    v_mov_b32 v25, 2
    global_store_byte v23, v25, s[94:95] sc1
L_nf2:
    v_mfma_f32_16x16x32_bf16 v[32:35], a[64:67], a[208:211], v[32:35]
    ds_read_b64_tr_b16 a[0:1], v8 offset:49152
    s_add_u32 m0, s24, 81920
    v_mfma_f32_16x16x32_bf16 v[64:67], a[64:67], a[212:215], v[64:67]
    ds_read_b64_tr_b16 a[2:3], v8 offset:53248
    s_mov_b32 s25, 1310720
    v_mfma_f32_16x16x32_bf16 v[36:39], a[68:71], a[208:211], v[36:39]
    ds_read_b64_tr_b16 a[4:5], v9 offset:49152
    v_mfma_f32_16x16x32_bf16 v[68:71], a[68:71], a[212:215], v[68:71]
    ds_read_b64_tr_b16 a[6:7], v9 offset:53248
    buffer_load_dwordx4 v16, s[8:11], s25 offen offset:0 lds
    v_mfma_f32_16x16x32_bf16 v[40:43], a[72:75], a[208:211], v[40:43]
    ds_read_b64_tr_b16 a[8:9], v10 offset:49152
    v_mfma_f32_16x16x32_bf16 v[72:75], a[72:75], a[212:215], v[72:75]
    ds_read_b64_tr_b16 a[10:11], v10 offset:53248
    v_mfma_f32_16x16x32_bf16 v[44:47], a[76:79], a[208:211], v[44:47]
    ds_read_b64_tr_b16 a[12:13], v11 offset:49152
    buffer_load_dwordx4 v17, s[8:11], s25 offen offset:1024 lds
    v_mfma_f32_16x16x32_bf16 v[76:79], a[76:79], a[212:215], v[76:79]
    ds_read_b64_tr_b16 a[14:15], v11 offset:53248
    v_mfma_f32_16x16x32_bf16 v[48:51], a[80:83], a[208:211], v[48:51]
    ds_read_b64_tr_b16 a[16:17], v12 offset:49152
    v_mfma_f32_16x16x32_bf16 v[80:83], a[80:83], a[212:215], v[80:83]
    ds_read_b64_tr_b16 a[18:19], v12 offset:53248
    buffer_load_dwordx4 v18, s[8:11], s25 offen offset:2048 lds
    v_mfma_f32_16x16x32_bf16 v[52:55], a[84:87], a[208:211], v[52:55]
    ds_read_b64_tr_b16 a[20:21], v13 offset:49152
    v_mfma_f32_16x16x32_bf16 v[84:87], a[84:87], a[212:215], v[84:87]
    ds_read_b64_tr_b16 a[22:23], v13 offset:53248
    v_mfma_f32_16x16x32_bf16 v[56:59], a[88:91], a[208:211], v[56:59]
    ds_read_b64_tr_b16 a[24:25], v14 offset:49152
    buffer_load_dwordx4 v19, s[8:11], s25 offen offset:3072 lds
    v_mfma_f32_16x16x32_bf16 v[88:91], a[88:91], a[212:215], v[88:91]
    ds_read_b64_tr_b16 a[26:27], v14 offset:53248
    s_mov_b32 s26, 34816
    v_mfma_f32_16x16x32_bf16 v[60:63], a[92:95], a[208:211], v[60:63]
    ds_read_b64_tr_b16 a[28:29], v15 offset:49152
    v_mfma_f32_16x16x32_bf16 v[92:95], a[92:95], a[212:215], v[92:95]
    ds_read_b64_tr_b16 a[30:31], v15 offset:53248
    buffer_load_dwordx4 a[144:147], v20, s[12:15], s26 offen offset:0 sc1
    v_mfma_f32_16x16x32_bf16 v[32:35], a[96:99], a[216:219], v[32:35]
    ds_read_b64_tr_b16 a[32:33], v8 offset:57344
    v_mfma_f32_16x16x32_bf16 v[64:67], a[96:99], a[220:223], v[64:67]
    ds_read_b64_tr_b16 a[34:35], v8 offset:61440
    v_mfma_f32_16x16x32_bf16 v[36:39], a[100:103], a[216:219], v[36:39]
    ds_read_b64_tr_b16 a[36:37], v9 offset:57344
    buffer_load_dwordx4 a[148:151], v21, s[12:15], s26 offen offset:0 sc1
    v_mfma_f32_16x16x32_bf16 v[68:71], a[100:103], a[220:223], v[68:71]
    ds_read_b64_tr_b16 a[38:39], v9 offset:61440
    v_mfma_f32_16x16x32_bf16 v[40:43], a[104:107], a[216:219], v[40:43]
    ds_read_b64_tr_b16 a[40:41], v10 offset:57344
    v_mfma_f32_16x16x32_bf16 v[72:75], a[104:107], a[220:223], v[72:75]
    ds_read_b64_tr_b16 a[42:43], v10 offset:61440
    buffer_load_dwordx4 a[152:155], v20, s[12:15], s26 offen offset:1024 sc1
    v_mfma_f32_16x16x32_bf16 v[44:47], a[108:111], a[216:219], v[44:47]
    ds_read_b64_tr_b16 a[44:45], v11 offset:57344
    v_mfma_f32_16x16x32_bf16 v[76:79], a[108:111], a[220:223], v[76:79]
    ds_read_b64_tr_b16 a[46:47], v11 offset:61440
    v_mfma_f32_16x16x32_bf16 v[48:51], a[112:115], a[216:219], v[48:51]
    ds_read_b64_tr_b16 a[48:49], v12 offset:57344
    buffer_load_dwordx4 a[156:159], v21, s[12:15], s26 offen offset:1024 sc1
    v_mfma_f32_16x16x32_bf16 v[80:83], a[112:115], a[220:223], v[80:83]
    ds_read_b64_tr_b16 a[50:51], v12 offset:61440
    v_mfma_f32_16x16x32_bf16 v[52:55], a[116:119], a[216:219], v[52:55]
    ds_read_b64_tr_b16 a[52:53], v13 offset:57344
    v_mfma_f32_16x16x32_bf16 v[84:87], a[116:119], a[220:223], v[84:87]
    ds_read_b64_tr_b16 a[54:55], v13 offset:61440
    v_mfma_f32_16x16x32_bf16 v[56:59], a[120:123], a[216:219], v[56:59]
    ds_read_b64_tr_b16 a[56:57], v14 offset:57344
    v_mfma_f32_16x16x32_bf16 v[88:91], a[120:123], a[220:223], v[88:91]
    ds_read_b64_tr_b16 a[58:59], v14 offset:61440
    v_mfma_f32_16x16x32_bf16 v[60:63], a[124:127], a[216:219], v[60:63]
    ds_read_b64_tr_b16 a[60:61], v15 offset:57344
    v_mfma_f32_16x16x32_bf16 v[92:95], a[124:127], a[220:223], v[92:95]
    ds_read_b64_tr_b16 a[62:63], v15 offset:61440
    s_waitcnt vmcnt(24) lgkmcnt(0)
    v_mfma_f32_16x16x32_bf16 v[32:35], a[0:3], a[224:227], v[32:35]
    ds_read_b64_tr_b16 a[64:65], v96 offset:49152
    s_add_u32 m0, s24, 16384
    v_mfma_f32_16x16x32_bf16 v[64:67], a[0:3], a[228:231], v[64:67]
    ds_read_b64_tr_b16 a[66:67], v96 offset:53248
    s_mov_b32 s25, 1376256
    v_mfma_f32_16x16x32_bf16 v[36:39], a[4:7], a[224:227], v[36:39]
    ds_read_b64_tr_b16 a[68:69], v97 offset:49152
    v_mfma_f32_16x16x32_bf16 v[68:71], a[4:7], a[228:231], v[68:71]
    ds_read_b64_tr_b16 a[70:71], v97 offset:53248
    buffer_load_dwordx4 v16, s[8:11], s25 offen offset:0 lds
    v_mfma_f32_16x16x32_bf16 v[40:43], a[8:11], a[224:227], v[40:43]
    ds_read_b64_tr_b16 a[72:73], v98 offset:49152
    v_mfma_f32_16x16x32_bf16 v[72:75], a[8:11], a[228:231], v[72:75]
    ds_read_b64_tr_b16 a[74:75], v98 offset:53248
    v_mfma_f32_16x16x32_bf16 v[44:47], a[12:15], a[224:227], v[44:47]
    ds_read_b64_tr_b16 a[76:77], v99 offset:49152
    buffer_load_dwordx4 v17, s[8:11], s25 offen offset:1024 lds
    v_mfma_f32_16x16x32_bf16 v[76:79], a[12:15], a[228:231], v[76:79]
    ds_read_b64_tr_b16 a[78:79], v99 offset:53248
    v_mfma_f32_16x16x32_bf16 v[48:51], a[16:19], a[224:227], v[48:51]
    ds_read_b64_tr_b16 a[80:81], v100 offset:49152
    v_mfma_f32_16x16x32_bf16 v[80:83], a[16:19], a[228:231], v[80:83]
    ds_read_b64_tr_b16 a[82:83], v100 offset:53248
    buffer_load_dwordx4 v18, s[8:11], s25 offen offset:2048 lds
    v_mfma_f32_16x16x32_bf16 v[52:55], a[20:23], a[224:227], v[52:55]
    ds_read_b64_tr_b16 a[84:85], v101 offset:49152
    v_mfma_f32_16x16x32_bf16 v[84:87], a[20:23], a[228:231], v[84:87]
    ds_read_b64_tr_b16 a[86:87], v101 offset:53248
    v_mfma_f32_16x16x32_bf16 v[56:59], a[24:27], a[224:227], v[56:59]
    ds_read_b64_tr_b16 a[88:89], v102 offset:49152
    buffer_load_dwordx4 v19, s[8:11], s25 offen offset:3072 lds
    v_mfma_f32_16x16x32_bf16 v[88:91], a[24:27], a[228:231], v[88:91]
    ds_read_b64_tr_b16 a[90:91], v102 offset:53248
    s_add_u32 m0, s24, 98304
    v_mfma_f32_16x16x32_bf16 v[60:63], a[28:31], a[224:227], v[60:63]
    ds_read_b64_tr_b16 a[92:93], v103 offset:49152
    s_mov_b32 s25, 1572864
    v_mfma_f32_16x16x32_bf16 v[92:95], a[28:31], a[228:231], v[92:95]
    ds_read_b64_tr_b16 a[94:95], v103 offset:53248
    buffer_load_dwordx4 v16, s[8:11], s25 offen offset:0 lds
    v_mfma_f32_16x16x32_bf16 v[32:35], a[32:35], a[232:235], v[32:35]
    ds_read_b64_tr_b16 a[96:97], v96 offset:57344
    v_mfma_f32_16x16x32_bf16 v[64:67], a[32:35], a[236:239], v[64:67]
    ds_read_b64_tr_b16 a[98:99], v96 offset:61440
    v_mfma_f32_16x16x32_bf16 v[36:39], a[36:39], a[232:235], v[36:39]
    ds_read_b64_tr_b16 a[100:101], v97 offset:57344
    buffer_load_dwordx4 v17, s[8:11], s25 offen offset:1024 lds
    v_mfma_f32_16x16x32_bf16 v[68:71], a[36:39], a[236:239], v[68:71]
    ds_read_b64_tr_b16 a[102:103], v97 offset:61440
    v_mfma_f32_16x16x32_bf16 v[40:43], a[40:43], a[232:235], v[40:43]
    ds_read_b64_tr_b16 a[104:105], v98 offset:57344
    v_mfma_f32_16x16x32_bf16 v[72:75], a[40:43], a[236:239], v[72:75]
    ds_read_b64_tr_b16 a[106:107], v98 offset:61440
    buffer_load_dwordx4 v18, s[8:11], s25 offen offset:2048 lds
    v_mfma_f32_16x16x32_bf16 v[44:47], a[44:47], a[232:235], v[44:47]
    ds_read_b64_tr_b16 a[108:109], v99 offset:57344
    v_mfma_f32_16x16x32_bf16 v[76:79], a[44:47], a[236:239], v[76:79]
    ds_read_b64_tr_b16 a[110:111], v99 offset:61440
    v_mfma_f32_16x16x32_bf16 v[48:51], a[48:51], a[232:235], v[48:51]
    ds_read_b64_tr_b16 a[112:113], v100 offset:57344
    buffer_load_dwordx4 v19, s[8:11], s25 offen offset:3072 lds
    v_mfma_f32_16x16x32_bf16 v[80:83], a[48:51], a[236:239], v[80:83]
    ds_read_b64_tr_b16 a[114:115], v100 offset:61440
    s_mov_b32 s26, 40960
    v_mfma_f32_16x16x32_bf16 v[52:55], a[52:55], a[232:235], v[52:55]
    ds_read_b64_tr_b16 a[116:117], v101 offset:57344
    v_mfma_f32_16x16x32_bf16 v[84:87], a[52:55], a[236:239], v[84:87]
    ds_read_b64_tr_b16 a[118:119], v101 offset:61440
    buffer_load_dwordx4 a[160:163], v20, s[12:15], s26 offen offset:0 sc1
    v_mfma_f32_16x16x32_bf16 v[56:59], a[56:59], a[232:235], v[56:59]
    ds_read_b64_tr_b16 a[120:121], v102 offset:57344
    v_mfma_f32_16x16x32_bf16 v[88:91], a[56:59], a[236:239], v[88:91]
    ds_read_b64_tr_b16 a[122:123], v102 offset:61440
    v_mfma_f32_16x16x32_bf16 v[60:63], a[60:63], a[232:235], v[60:63]
    ds_read_b64_tr_b16 a[124:125], v103 offset:57344
    buffer_load_dwordx4 a[164:167], v21, s[12:15], s26 offen offset:0 sc1
    v_mfma_f32_16x16x32_bf16 v[92:95], a[60:63], a[236:239], v[92:95]
    ds_read_b64_tr_b16 a[126:127], v103 offset:61440
    buffer_load_dwordx4 a[168:171], v20, s[12:15], s26 offen offset:1024 sc1
    buffer_load_dwordx4 a[172:175], v21, s[12:15], s26 offen offset:1024 sc1
    s_waitcnt vmcnt(24) lgkmcnt(0)
    s_barrier
    v_mfma_f32_16x16x32_bf16 v[32:35], a[64:67], a[240:243], v[32:35]
    ds_read_b64_tr_b16 a[0:1], v8 offset:0
    s_add_u32 m0, s24, 32768
    v_mfma_f32_16x16x32_bf16 v[64:67], a[64:67], a[244:247], v[64:67]
    ds_read_b64_tr_b16 a[2:3], v8 offset:4096
    s_mov_b32 s25, 1638400
    v_mfma_f32_16x16x32_bf16 v[36:39], a[68:71], a[240:243], v[36:39]
    ds_read_b64_tr_b16 a[4:5], v9 offset:0
    v_mfma_f32_16x16x32_bf16 v[68:71], a[68:71], a[244:247], v[68:71]
    ds_read_b64_tr_b16 a[6:7], v9 offset:4096
    buffer_load_dwordx4 v16, s[8:11], s25 offen offset:0 lds
    v_mfma_f32_16x16x32_bf16 v[40:43], a[72:75], a[240:243], v[40:43]
    ds_read_b64_tr_b16 a[8:9], v10 offset:0
    v_mfma_f32_16x16x32_bf16 v[72:75], a[72:75], a[244:247], v[72:75]
    ds_read_b64_tr_b16 a[10:11], v10 offset:4096
    v_mfma_f32_16x16x32_bf16 v[44:47], a[76:79], a[240:243], v[44:47]
    ds_read_b64_tr_b16 a[12:13], v11 offset:0
    buffer_load_dwordx4 v17, s[8:11], s25 offen offset:1024 lds
    v_mfma_f32_16x16x32_bf16 v[76:79], a[76:79], a[244:247], v[76:79]
    ds_read_b64_tr_b16 a[14:15], v11 offset:4096
    v_mfma_f32_16x16x32_bf16 v[48:51], a[80:83], a[240:243], v[48:51]
    ds_read_b64_tr_b16 a[16:17], v12 offset:0
    v_mfma_f32_16x16x32_bf16 v[80:83], a[80:83], a[244:247], v[80:83]
    ds_read_b64_tr_b16 a[18:19], v12 offset:4096
    buffer_load_dwordx4 v18, s[8:11], s25 offen offset:2048 lds
    v_mfma_f32_16x16x32_bf16 v[52:55], a[84:87], a[240:243], v[52:55]
    ds_read_b64_tr_b16 a[20:21], v13 offset:0
    v_mfma_f32_16x16x32_bf16 v[84:87], a[84:87], a[244:247], v[84:87]
    ds_read_b64_tr_b16 a[22:23], v13 offset:4096
    v_mfma_f32_16x16x32_bf16 v[56:59], a[88:91], a[240:243], v[56:59]
    ds_read_b64_tr_b16 a[24:25], v14 offset:0
    buffer_load_dwordx4 v19, s[8:11], s25 offen offset:3072 lds
    v_mfma_f32_16x16x32_bf16 v[88:91], a[88:91], a[244:247], v[88:91]
    ds_read_b64_tr_b16 a[26:27], v14 offset:4096
    s_add_u32 m0, s24, 114688
    v_mfma_f32_16x16x32_bf16 v[60:63], a[92:95], a[240:243], v[60:63]
    ds_read_b64_tr_b16 a[28:29], v15 offset:0
    s_mov_b32 s25, 1835008
    v_mfma_f32_16x16x32_bf16 v[92:95], a[92:95], a[244:247], v[92:95]
    ds_read_b64_tr_b16 a[30:31], v15 offset:4096
    buffer_load_dwordx4 v16, s[8:11], s25 offen offset:0 lds
    v_mfma_f32_16x16x32_bf16 v[32:35], a[96:99], a[248:251], v[32:35]
    ds_read_b64_tr_b16 a[32:33], v8 offset:8192
    v_mfma_f32_16x16x32_bf16 v[64:67], a[96:99], a[252:255], v[64:67]
    ds_read_b64_tr_b16 a[34:35], v8 offset:12288
    v_mfma_f32_16x16x32_bf16 v[36:39], a[100:103], a[248:251], v[36:39]
    ds_read_b64_tr_b16 a[36:37], v9 offset:8192
    buffer_load_dwordx4 v17, s[8:11], s25 offen offset:1024 lds
    v_mfma_f32_16x16x32_bf16 v[68:71], a[100:103], a[252:255], v[68:71]
    ds_read_b64_tr_b16 a[38:39], v9 offset:12288
    v_mfma_f32_16x16x32_bf16 v[40:43], a[104:107], a[248:251], v[40:43]
    ds_read_b64_tr_b16 a[40:41], v10 offset:8192
    v_mfma_f32_16x16x32_bf16 v[72:75], a[104:107], a[252:255], v[72:75]
    ds_read_b64_tr_b16 a[42:43], v10 offset:12288
    buffer_load_dwordx4 v18, s[8:11], s25 offen offset:2048 lds
    v_mfma_f32_16x16x32_bf16 v[44:47], a[108:111], a[248:251], v[44:47]
    ds_read_b64_tr_b16 a[44:45], v11 offset:8192
    v_mfma_f32_16x16x32_bf16 v[76:79], a[108:111], a[252:255], v[76:79]
    ds_read_b64_tr_b16 a[46:47], v11 offset:12288
    v_mfma_f32_16x16x32_bf16 v[48:51], a[112:115], a[248:251], v[48:51]
    ds_read_b64_tr_b16 a[48:49], v12 offset:8192
    buffer_load_dwordx4 v19, s[8:11], s25 offen offset:3072 lds
    v_mfma_f32_16x16x32_bf16 v[80:83], a[112:115], a[252:255], v[80:83]
    ds_read_b64_tr_b16 a[50:51], v12 offset:12288
    s_mov_b32 s26, 43008
    v_mfma_f32_16x16x32_bf16 v[52:55], a[116:119], a[248:251], v[52:55]
    ds_read_b64_tr_b16 a[52:53], v13 offset:8192
    v_mfma_f32_16x16x32_bf16 v[84:87], a[116:119], a[252:255], v[84:87]
    ds_read_b64_tr_b16 a[54:55], v13 offset:12288
    buffer_load_dwordx4 a[176:179], v20, s[12:15], s26 offen offset:0 sc1
    v_mfma_f32_16x16x32_bf16 v[56:59], a[120:123], a[248:251], v[56:59]
    ds_read_b64_tr_b16 a[56:57], v14 offset:8192
    v_mfma_f32_16x16x32_bf16 v[88:91], a[120:123], a[252:255], v[88:91]
    ds_read_b64_tr_b16 a[58:59], v14 offset:12288
    v_mfma_f32_16x16x32_bf16 v[60:63], a[124:127], a[248:251], v[60:63]
    ds_read_b64_tr_b16 a[60:61], v15 offset:8192
    buffer_load_dwordx4 a[180:183], v21, s[12:15], s26 offen offset:0 sc1
    v_mfma_f32_16x16x32_bf16 v[92:95], a[124:127], a[252:255], v[92:95]
    ds_read_b64_tr_b16 a[62:63], v15 offset:12288
    buffer_load_dwordx4 a[184:187], v20, s[12:15], s26 offen offset:1024 sc1
    buffer_load_dwordx4 a[188:191], v21, s[12:15], s26 offen offset:1024 sc1
    s_waitcnt vmcnt(32) lgkmcnt(0)
    v_mfma_f32_16x16x32_bf16 v[32:35], a[0:3], a[128:131], v[32:35]
    ds_read_b64_tr_b16 a[64:65], v96 offset:0
    s_add_u32 m0, s24, 49152
    v_mfma_f32_16x16x32_bf16 v[64:67], a[0:3], a[132:135], v[64:67]
    ds_read_b64_tr_b16 a[66:67], v96 offset:4096
    s_mov_b32 s25, 1900544
    v_mfma_f32_16x16x32_bf16 v[36:39], a[4:7], a[128:131], v[36:39]
    ds_read_b64_tr_b16 a[68:69], v97 offset:0
    v_mfma_f32_16x16x32_bf16 v[68:71], a[4:7], a[132:135], v[68:71]
    ds_read_b64_tr_b16 a[70:71], v97 offset:4096
    buffer_load_dwordx4 v16, s[8:11], s25 offen offset:0 lds
    v_mfma_f32_16x16x32_bf16 v[40:43], a[8:11], a[128:131], v[40:43]
    ds_read_b64_tr_b16 a[72:73], v98 offset:0
    v_mfma_f32_16x16x32_bf16 v[72:75], a[8:11], a[132:135], v[72:75]
    ds_read_b64_tr_b16 a[74:75], v98 offset:4096
    v_mfma_f32_16x16x32_bf16 v[44:47], a[12:15], a[128:131], v[44:47]
    ds_read_b64_tr_b16 a[76:77], v99 offset:0
    buffer_load_dwordx4 v17, s[8:11], s25 offen offset:1024 lds
    v_mfma_f32_16x16x32_bf16 v[76:79], a[12:15], a[132:135], v[76:79]
    ds_read_b64_tr_b16 a[78:79], v99 offset:4096
    v_mfma_f32_16x16x32_bf16 v[48:51], a[16:19], a[128:131], v[48:51]
    ds_read_b64_tr_b16 a[80:81], v100 offset:0
    v_mfma_f32_16x16x32_bf16 v[80:83], a[16:19], a[132:135], v[80:83]
    ds_read_b64_tr_b16 a[82:83], v100 offset:4096
    buffer_load_dwordx4 v18, s[8:11], s25 offen offset:2048 lds
    v_mfma_f32_16x16x32_bf16 v[52:55], a[20:23], a[128:131], v[52:55]
    ds_read_b64_tr_b16 a[84:85], v101 offset:0
    v_mfma_f32_16x16x32_bf16 v[84:87], a[20:23], a[132:135], v[84:87]
    ds_read_b64_tr_b16 a[86:87], v101 offset:4096
    v_mfma_f32_16x16x32_bf16 v[56:59], a[24:27], a[128:131], v[56:59]
    ds_read_b64_tr_b16 a[88:89], v102 offset:0
    buffer_load_dwordx4 v19, s[8:11], s25 offen offset:3072 lds
    v_mfma_f32_16x16x32_bf16 v[88:91], a[24:27], a[132:135], v[88:91]
    ds_read_b64_tr_b16 a[90:91], v102 offset:4096
    s_mov_b32 s26, 49152
    v_mfma_f32_16x16x32_bf16 v[60:63], a[28:31], a[128:131], v[60:63]
    ds_read_b64_tr_b16 a[92:93], v103 offset:0
    v_mfma_f32_16x16x32_bf16 v[92:95], a[28:31], a[132:135], v[92:95]
    ds_read_b64_tr_b16 a[94:95], v103 offset:4096
    buffer_load_dwordx4 a[192:195], v20, s[12:15], s26 offen offset:0 sc1
    v_mfma_f32_16x16x32_bf16 v[32:35], a[32:35], a[136:139], v[32:35]
    ds_read_b64_tr_b16 a[96:97], v96 offset:8192
    v_mfma_f32_16x16x32_bf16 v[64:67], a[32:35], a[140:143], v[64:67]
    ds_read_b64_tr_b16 a[98:99], v96 offset:12288
    v_mfma_f32_16x16x32_bf16 v[36:39], a[36:39], a[136:139], v[36:39]
    ds_read_b64_tr_b16 a[100:101], v97 offset:8192
    buffer_load_dwordx4 a[196:199], v21, s[12:15], s26 offen offset:0 sc1
    v_mfma_f32_16x16x32_bf16 v[68:71], a[36:39], a[140:143], v[68:71]
    ds_read_b64_tr_b16 a[102:103], v97 offset:12288
    v_mfma_f32_16x16x32_bf16 v[40:43], a[40:43], a[136:139], v[40:43]
    ds_read_b64_tr_b16 a[104:105], v98 offset:8192
    v_mfma_f32_16x16x32_bf16 v[72:75], a[40:43], a[140:143], v[72:75]
    ds_read_b64_tr_b16 a[106:107], v98 offset:12288
    buffer_load_dwordx4 a[200:203], v20, s[12:15], s26 offen offset:1024 sc1
    v_mfma_f32_16x16x32_bf16 v[44:47], a[44:47], a[136:139], v[44:47]
    ds_read_b64_tr_b16 a[108:109], v99 offset:8192
    v_mfma_f32_16x16x32_bf16 v[76:79], a[44:47], a[140:143], v[76:79]
    ds_read_b64_tr_b16 a[110:111], v99 offset:12288
    v_mfma_f32_16x16x32_bf16 v[48:51], a[48:51], a[136:139], v[48:51]
    ds_read_b64_tr_b16 a[112:113], v100 offset:8192
    buffer_load_dwordx4 a[204:207], v21, s[12:15], s26 offen offset:1024 sc1
    v_mfma_f32_16x16x32_bf16 v[80:83], a[48:51], a[140:143], v[80:83]
    ds_read_b64_tr_b16 a[114:115], v100 offset:12288
    v_mfma_f32_16x16x32_bf16 v[52:55], a[52:55], a[136:139], v[52:55]
    ds_read_b64_tr_b16 a[116:117], v101 offset:8192
    v_mfma_f32_16x16x32_bf16 v[84:87], a[52:55], a[140:143], v[84:87]
    ds_read_b64_tr_b16 a[118:119], v101 offset:12288
    v_mfma_f32_16x16x32_bf16 v[56:59], a[56:59], a[136:139], v[56:59]
    ds_read_b64_tr_b16 a[120:121], v102 offset:8192
    v_mfma_f32_16x16x32_bf16 v[88:91], a[56:59], a[140:143], v[88:91]
    ds_read_b64_tr_b16 a[122:123], v102 offset:12288
    v_mfma_f32_16x16x32_bf16 v[60:63], a[60:63], a[136:139], v[60:63]
    ds_read_b64_tr_b16 a[124:125], v103 offset:8192
    v_mfma_f32_16x16x32_bf16 v[92:95], a[60:63], a[140:143], v[92:95]
    ds_read_b64_tr_b16 a[126:127], v103 offset:12288
    s_waitcnt vmcnt(28) lgkmcnt(0)
    s_barrier
    v_mfma_f32_16x16x32_bf16 v[32:35], a[64:67], a[144:147], v[32:35]
    ds_read_b64_tr_b16 a[0:1], v8 offset:16384
    s_add_u32 m0, s24, 65536
    v_mfma_f32_16x16x32_bf16 v[64:67], a[64:67], a[148:151], v[64:67]
    ds_read_b64_tr_b16 a[2:3], v8 offset:20480
    s_mov_b32 s25, 131072
    v_mfma_f32_16x16x32_bf16 v[36:39], a[68:71], a[144:147], v[36:39]
    ds_read_b64_tr_b16 a[4:5], v9 offset:16384
    v_mfma_f32_16x16x32_bf16 v[68:71], a[68:71], a[148:151], v[68:71]
    ds_read_b64_tr_b16 a[6:7], v9 offset:20480
    buffer_load_dwordx4 v16, s[8:11], s25 offen offset:0 lds
    v_mfma_f32_16x16x32_bf16 v[40:43], a[72:75], a[144:147], v[40:43]
    ds_read_b64_tr_b16 a[8:9], v10 offset:16384
    v_mfma_f32_16x16x32_bf16 v[72:75], a[72:75], a[148:151], v[72:75]
    ds_read_b64_tr_b16 a[10:11], v10 offset:20480
    v_mfma_f32_16x16x32_bf16 v[44:47], a[76:79], a[144:147], v[44:47]
    ds_read_b64_tr_b16 a[12:13], v11 offset:16384
    buffer_load_dwordx4 v17, s[8:11], s25 offen offset:1024 lds
    v_mfma_f32_16x16x32_bf16 v[76:79], a[76:79], a[148:151], v[76:79]
    ds_read_b64_tr_b16 a[14:15], v11 offset:20480
    v_mfma_f32_16x16x32_bf16 v[48:51], a[80:83], a[144:147], v[48:51]
    ds_read_b64_tr_b16 a[16:17], v12 offset:16384
    v_mfma_f32_16x16x32_bf16 v[80:83], a[80:83], a[148:151], v[80:83]
    ds_read_b64_tr_b16 a[18:19], v12 offset:20480
    buffer_load_dwordx4 v18, s[8:11], s25 offen offset:2048 lds
    v_mfma_f32_16x16x32_bf16 v[52:55], a[84:87], a[144:147], v[52:55]
    ds_read_b64_tr_b16 a[20:21], v13 offset:16384
    v_mfma_f32_16x16x32_bf16 v[84:87], a[84:87], a[148:151], v[84:87]
    ds_read_b64_tr_b16 a[22:23], v13 offset:20480
    v_mfma_f32_16x16x32_bf16 v[56:59], a[88:91], a[144:147], v[56:59]
    ds_read_b64_tr_b16 a[24:25], v14 offset:16384
    buffer_load_dwordx4 v19, s[8:11], s25 offen offset:3072 lds
    v_mfma_f32_16x16x32_bf16 v[88:91], a[88:91], a[148:151], v[88:91]
    ds_read_b64_tr_b16 a[26:27], v14 offset:20480
    s_mov_b32 s26, 51200
    v_mfma_f32_16x16x32_bf16 v[60:63], a[92:95], a[144:147], v[60:63]
    ds_read_b64_tr_b16 a[28:29], v15 offset:16384
    v_mfma_f32_16x16x32_bf16 v[92:95], a[92:95], a[148:151], v[92:95]
    ds_read_b64_tr_b16 a[30:31], v15 offset:20480
    buffer_load_dwordx4 a[208:211], v20, s[12:15], s26 offen offset:0 sc1
    v_mfma_f32_16x16x32_bf16 v[32:35], a[96:99], a[152:155], v[32:35]
    ds_read_b64_tr_b16 a[32:33], v8 offset:24576
    v_mfma_f32_16x16x32_bf16 v[64:67], a[96:99], a[156:159], v[64:67]
    ds_read_b64_tr_b16 a[34:35], v8 offset:28672
    v_mfma_f32_16x16x32_bf16 v[36:39], a[100:103], a[152:155], v[36:39]
    ds_read_b64_tr_b16 a[36:37], v9 offset:24576
    buffer_load_dwordx4 a[212:215], v21, s[12:15], s26 offen offset:0 sc1
    v_mfma_f32_16x16x32_bf16 v[68:71], a[100:103], a[156:159], v[68:71]
    ds_read_b64_tr_b16 a[38:39], v9 offset:28672
    v_mfma_f32_16x16x32_bf16 v[40:43], a[104:107], a[152:155], v[40:43]
    ds_read_b64_tr_b16 a[40:41], v10 offset:24576
    v_mfma_f32_16x16x32_bf16 v[72:75], a[104:107], a[156:159], v[72:75]
    ds_read_b64_tr_b16 a[42:43], v10 offset:28672
    buffer_load_dwordx4 a[216:219], v20, s[12:15], s26 offen offset:1024 sc1
    v_mfma_f32_16x16x32_bf16 v[44:47], a[108:111], a[152:155], v[44:47]
    ds_read_b64_tr_b16 a[44:45], v11 offset:24576
    v_mfma_f32_16x16x32_bf16 v[76:79], a[108:111], a[156:159], v[76:79]
    ds_read_b64_tr_b16 a[46:47], v11 offset:28672
    v_mfma_f32_16x16x32_bf16 v[48:51], a[112:115], a[152:155], v[48:51]
    ds_read_b64_tr_b16 a[48:49], v12 offset:24576
    buffer_load_dwordx4 a[220:223], v21, s[12:15], s26 offen offset:1024 sc1
    v_mfma_f32_16x16x32_bf16 v[80:83], a[112:115], a[156:159], v[80:83]
    ds_read_b64_tr_b16 a[50:51], v12 offset:28672
    v_mfma_f32_16x16x32_bf16 v[52:55], a[116:119], a[152:155], v[52:55]
    ds_read_b64_tr_b16 a[52:53], v13 offset:24576
    v_mfma_f32_16x16x32_bf16 v[84:87], a[116:119], a[156:159], v[84:87]
    ds_read_b64_tr_b16 a[54:55], v13 offset:28672
    v_mfma_f32_16x16x32_bf16 v[56:59], a[120:123], a[152:155], v[56:59]
    ds_read_b64_tr_b16 a[56:57], v14 offset:24576
    v_mfma_f32_16x16x32_bf16 v[88:91], a[120:123], a[156:159], v[88:91]
    ds_read_b64_tr_b16 a[58:59], v14 offset:28672
    v_mfma_f32_16x16x32_bf16 v[60:63], a[124:127], a[152:155], v[60:63]
    ds_read_b64_tr_b16 a[60:61], v15 offset:24576
    v_mfma_f32_16x16x32_bf16 v[92:95], a[124:127], a[156:159], v[92:95]
    ds_read_b64_tr_b16 a[62:63], v15 offset:28672
    s_waitcnt vmcnt(28) lgkmcnt(0)
    v_mfma_f32_16x16x32_bf16 v[32:35], a[0:3], a[160:163], v[32:35]
    ds_read_b64_tr_b16 a[64:65], v96 offset:16384
    s_add_u32 m0, s24, 0
    v_mfma_f32_16x16x32_bf16 v[64:67], a[0:3], a[164:167], v[64:67]
    ds_read_b64_tr_b16 a[66:67], v96 offset:20480
    s_mov_b32 s25, 196608
    v_mfma_f32_16x16x32_bf16 v[36:39], a[4:7], a[160:163], v[36:39]
    ds_read_b64_tr_b16 a[68:69], v97 offset:16384
    v_mfma_f32_16x16x32_bf16 v[68:71], a[4:7], a[164:167], v[68:71]
    ds_read_b64_tr_b16 a[70:71], v97 offset:20480
    buffer_load_dwordx4 v16, s[8:11], s25 offen offset:0 lds
    v_mfma_f32_16x16x32_bf16 v[40:43], a[8:11], a[160:163], v[40:43]
    ds_read_b64_tr_b16 a[72:73], v98 offset:16384
    v_mfma_f32_16x16x32_bf16 v[72:75], a[8:11], a[164:167], v[72:75]
    ds_read_b64_tr_b16 a[74:75], v98 offset:20480
    v_mfma_f32_16x16x32_bf16 v[44:47], a[12:15], a[160:163], v[44:47]
    ds_read_b64_tr_b16 a[76:77], v99 offset:16384
    buffer_load_dwordx4 v17, s[8:11], s25 offen offset:1024 lds
    v_mfma_f32_16x16x32_bf16 v[76:79], a[12:15], a[164:167], v[76:79]
    ds_read_b64_tr_b16 a[78:79], v99 offset:20480
    v_mfma_f32_16x16x32_bf16 v[48:51], a[16:19], a[160:163], v[48:51]
    ds_read_b64_tr_b16 a[80:81], v100 offset:16384
    v_mfma_f32_16x16x32_bf16 v[80:83], a[16:19], a[164:167], v[80:83]
    ds_read_b64_tr_b16 a[82:83], v100 offset:20480
    buffer_load_dwordx4 v18, s[8:11], s25 offen offset:2048 lds
    v_mfma_f32_16x16x32_bf16 v[52:55], a[20:23], a[160:163], v[52:55]
    ds_read_b64_tr_b16 a[84:85], v101 offset:16384
    v_mfma_f32_16x16x32_bf16 v[84:87], a[20:23], a[164:167], v[84:87]
    ds_read_b64_tr_b16 a[86:87], v101 offset:20480
    v_mfma_f32_16x16x32_bf16 v[56:59], a[24:27], a[160:163], v[56:59]
    ds_read_b64_tr_b16 a[88:89], v102 offset:16384
    buffer_load_dwordx4 v19, s[8:11], s25 offen offset:3072 lds
    v_mfma_f32_16x16x32_bf16 v[88:91], a[24:27], a[164:167], v[88:91]
    ds_read_b64_tr_b16 a[90:91], v102 offset:20480
    s_mov_b32 s26, 57344
    v_mfma_f32_16x16x32_bf16 v[60:63], a[28:31], a[160:163], v[60:63]
    ds_read_b64_tr_b16 a[92:93], v103 offset:16384
    v_mfma_f32_16x16x32_bf16 v[92:95], a[28:31], a[164:167], v[92:95]
    ds_read_b64_tr_b16 a[94:95], v103 offset:20480
    buffer_load_dwordx4 a[224:227], v20, s[12:15], s26 offen offset:0 sc1
    v_mfma_f32_16x16x32_bf16 v[32:35], a[32:35], a[168:171], v[32:35]
    ds_read_b64_tr_b16 a[96:97], v96 offset:24576
    v_mfma_f32_16x16x32_bf16 v[64:67], a[32:35], a[172:175], v[64:67]
    ds_read_b64_tr_b16 a[98:99], v96 offset:28672
    v_mfma_f32_16x16x32_bf16 v[36:39], a[36:39], a[168:171], v[36:39]
    ds_read_b64_tr_b16 a[100:101], v97 offset:24576
    buffer_load_dwordx4 a[228:231], v21, s[12:15], s26 offen offset:0 sc1
    v_mfma_f32_16x16x32_bf16 v[68:71], a[36:39], a[172:175], v[68:71]
    ds_read_b64_tr_b16 a[102:103], v97 offset:28672
    v_mfma_f32_16x16x32_bf16 v[40:43], a[40:43], a[168:171], v[40:43]
    ds_read_b64_tr_b16 a[104:105], v98 offset:24576
    v_mfma_f32_16x16x32_bf16 v[72:75], a[40:43], a[172:175], v[72:75]
    ds_read_b64_tr_b16 a[106:107], v98 offset:28672
    buffer_load_dwordx4 a[232:235], v20, s[12:15], s26 offen offset:1024 sc1
    v_mfma_f32_16x16x32_bf16 v[44:47], a[44:47], a[168:171], v[44:47]
    ds_read_b64_tr_b16 a[108:109], v99 offset:24576
    v_mfma_f32_16x16x32_bf16 v[76:79], a[44:47], a[172:175], v[76:79]
    ds_read_b64_tr_b16 a[110:111], v99 offset:28672
    v_mfma_f32_16x16x32_bf16 v[48:51], a[48:51], a[168:171], v[48:51]
    ds_read_b64_tr_b16 a[112:113], v100 offset:24576
    buffer_load_dwordx4 a[236:239], v21, s[12:15], s26 offen offset:1024 sc1
    v_mfma_f32_16x16x32_bf16 v[80:83], a[48:51], a[172:175], v[80:83]
    ds_read_b64_tr_b16 a[114:115], v100 offset:28672
    s_mov_b32 s26, 59392
    v_mfma_f32_16x16x32_bf16 v[52:55], a[52:55], a[168:171], v[52:55]
    ds_read_b64_tr_b16 a[116:117], v101 offset:24576
    v_mfma_f32_16x16x32_bf16 v[84:87], a[52:55], a[172:175], v[84:87]
    ds_read_b64_tr_b16 a[118:119], v101 offset:28672
    buffer_load_dwordx4 a[240:243], v20, s[12:15], s26 offen offset:0 sc1
    v_mfma_f32_16x16x32_bf16 v[56:59], a[56:59], a[168:171], v[56:59]
    ds_read_b64_tr_b16 a[120:121], v102 offset:24576
    v_mfma_f32_16x16x32_bf16 v[88:91], a[56:59], a[172:175], v[88:91]
    ds_read_b64_tr_b16 a[122:123], v102 offset:28672
    v_mfma_f32_16x16x32_bf16 v[60:63], a[60:63], a[168:171], v[60:63]
    ds_read_b64_tr_b16 a[124:125], v103 offset:24576
    buffer_load_dwordx4 a[244:247], v21, s[12:15], s26 offen offset:0 sc1
    v_mfma_f32_16x16x32_bf16 v[92:95], a[60:63], a[172:175], v[92:95]
    ds_read_b64_tr_b16 a[126:127], v103 offset:28672
    buffer_load_dwordx4 a[248:251], v20, s[12:15], s26 offen offset:1024 sc1
    buffer_load_dwordx4 a[252:255], v21, s[12:15], s26 offen offset:1024 sc1
    s_lshl_b32 s3, s75, 4
    s_and_b32 s86, s76, 8
    s_add_u32 s3, s3, s86
    v_mov_b32 v23, s3
    global_load_dwordx2 v[28:29], v23, s[94:95] sc1
    s_waitcnt vmcnt(29) lgkmcnt(0)
    s_barrier
    s_waitcnt vmcnt(0)
    v_readfirstlane_b32 s3, v28
    v_readfirstlane_b32 s86, v29
    s_nop 0
    s_and_b32 s90, s3, s86
    s_and_b32 s90, s90, 0x02020202
    s_xor_b32 s90, s90, 0x02020202
    s_cmp_eq_u32 s90, 0
    s_cbranch_scc1 L_p2_skip
    s_mov_b32 s91, 262144
    s_lshl_b32 s3, s75, 4
    s_and_b32 s86, s76, 8
    s_add_u32 s3, s3, s86
    v_mov_b32 v23, s3
L_poll2:
    global_load_dwordx2 v[30:31], v23, s[94:95] sc1
    s_waitcnt vmcnt(0)
    v_readfirstlane_b32 s3, v30
    v_readfirstlane_b32 s86, v31
    s_nop 0
    s_and_b32 s90, s3, s86
    s_and_b32 s90, s90, 0x02020202
    s_xor_b32 s90, s90, 0x02020202
    s_cmp_eq_u32 s90, 0
    s_cbranch_scc1 L_poll2_ok
    s_sleep 2
    s_sub_u32 s91, s91, 1
    s_cmp_lg_u32 s91, 0
    s_cbranch_scc1 L_poll2
L_poll2_ok:
L_p2_skip:
    v_mfma_f32_16x16x32_bf16 v[32:35], a[64:67], a[176:179], v[32:35]
    ds_read_b64_tr_b16 a[0:1], v8 offset:32768
    s_add_u32 m0, s24, 81920
    v_mfma_f32_16x16x32_bf16 v[64:67], a[64:67], a[180:183], v[64:67]
    ds_read_b64_tr_b16 a[2:3], v8 offset:36864
    s_mov_b32 s25, 393216
    v_mfma_f32_16x16x32_bf16 v[36:39], a[68:71], a[176:179], v[36:39]
    ds_read_b64_tr_b16 a[4:5], v9 offset:32768
    v_mfma_f32_16x16x32_bf16 v[68:71], a[68:71], a[180:183], v[68:71]
    ds_read_b64_tr_b16 a[6:7], v9 offset:36864
    buffer_load_dwordx4 v16, s[8:11], s25 offen offset:0 lds
    v_mfma_f32_16x16x32_bf16 v[40:43], a[72:75], a[176:179], v[40:43]
    ds_read_b64_tr_b16 a[8:9], v10 offset:32768
    v_mfma_f32_16x16x32_bf16 v[72:75], a[72:75], a[180:183], v[72:75]
    ds_read_b64_tr_b16 a[10:11], v10 offset:36864
    v_mfma_f32_16x16x32_bf16 v[44:47], a[76:79], a[176:179], v[44:47]
    ds_read_b64_tr_b16 a[12:13], v11 offset:32768
    buffer_load_dwordx4 v17, s[8:11], s25 offen offset:1024 lds
    v_mfma_f32_16x16x32_bf16 v[76:79], a[76:79], a[180:183], v[76:79]
    ds_read_b64_tr_b16 a[14:15], v11 offset:36864
    v_mfma_f32_16x16x32_bf16 v[48:51], a[80:83], a[176:179], v[48:51]
    ds_read_b64_tr_b16 a[16:17], v12 offset:32768
    v_mfma_f32_16x16x32_bf16 v[80:83], a[80:83], a[180:183], v[80:83]
    ds_read_b64_tr_b16 a[18:19], v12 offset:36864
    buffer_load_dwordx4 v18, s[8:11], s25 offen offset:2048 lds
    v_mfma_f32_16x16x32_bf16 v[52:55], a[84:87], a[176:179], v[52:55]
    ds_read_b64_tr_b16 a[20:21], v13 offset:32768
    v_mfma_f32_16x16x32_bf16 v[84:87], a[84:87], a[180:183], v[84:87]
    ds_read_b64_tr_b16 a[22:23], v13 offset:36864
    v_mfma_f32_16x16x32_bf16 v[56:59], a[88:91], a[176:179], v[56:59]
    ds_read_b64_tr_b16 a[24:25], v14 offset:32768
    buffer_load_dwordx4 v19, s[8:11], s25 offen offset:3072 lds
    v_mfma_f32_16x16x32_bf16 v[88:91], a[88:91], a[180:183], v[88:91]
    ds_read_b64_tr_b16 a[26:27], v14 offset:36864
    s_mov_b32 s26, 4096
    v_mfma_f32_16x16x32_bf16 v[60:63], a[92:95], a[176:179], v[60:63]
    ds_read_b64_tr_b16 a[28:29], v15 offset:32768
    v_mfma_f32_16x16x32_bf16 v[92:95], a[92:95], a[180:183], v[92:95]
    ds_read_b64_tr_b16 a[30:31], v15 offset:36864
    buffer_load_dwordx4 a[128:131], v20, s[12:15], s26 offen offset:0 sc1
    v_mfma_f32_16x16x32_bf16 v[32:35], a[96:99], a[184:187], v[32:35]
    ds_read_b64_tr_b16 a[32:33], v8 offset:40960
    v_mfma_f32_16x16x32_bf16 v[64:67], a[96:99], a[188:191], v[64:67]
    ds_read_b64_tr_b16 a[34:35], v8 offset:45056
    v_mfma_f32_16x16x32_bf16 v[36:39], a[100:103], a[184:187], v[36:39]
    ds_read_b64_tr_b16 a[36:37], v9 offset:40960
    buffer_load_dwordx4 a[132:135], v21, s[12:15], s26 offen offset:0 sc1
    v_mfma_f32_16x16x32_bf16 v[68:71], a[100:103], a[188:191], v[68:71]
    ds_read_b64_tr_b16 a[38:39], v9 offset:45056
    v_mfma_f32_16x16x32_bf16 v[40:43], a[104:107], a[184:187], v[40:43]
    ds_read_b64_tr_b16 a[40:41], v10 offset:40960
    v_mfma_f32_16x16x32_bf16 v[72:75], a[104:107], a[188:191], v[72:75]
    ds_read_b64_tr_b16 a[42:43], v10 offset:45056
    buffer_load_dwordx4 a[136:139], v20, s[12:15], s26 offen offset:1024 sc1
    v_mfma_f32_16x16x32_bf16 v[44:47], a[108:111], a[184:187], v[44:47]
    ds_read_b64_tr_b16 a[44:45], v11 offset:40960
    v_mfma_f32_16x16x32_bf16 v[76:79], a[108:111], a[188:191], v[76:79]
    ds_read_b64_tr_b16 a[46:47], v11 offset:45056
    v_mfma_f32_16x16x32_bf16 v[48:51], a[112:115], a[184:187], v[48:51]
    ds_read_b64_tr_b16 a[48:49], v12 offset:40960
    buffer_load_dwordx4 a[140:143], v21, s[12:15], s26 offen offset:1024 sc1
    v_mfma_f32_16x16x32_bf16 v[80:83], a[112:115], a[188:191], v[80:83]
    ds_read_b64_tr_b16 a[50:51], v12 offset:45056
    v_mfma_f32_16x16x32_bf16 v[52:55], a[116:119], a[184:187], v[52:55]
    ds_read_b64_tr_b16 a[52:53], v13 offset:40960
    v_mfma_f32_16x16x32_bf16 v[84:87], a[116:119], a[188:191], v[84:87]
    ds_read_b64_tr_b16 a[54:55], v13 offset:45056
    v_mfma_f32_16x16x32_bf16 v[56:59], a[120:123], a[184:187], v[56:59]
    ds_read_b64_tr_b16 a[56:57], v14 offset:40960
    v_mfma_f32_16x16x32_bf16 v[88:91], a[120:123], a[188:191], v[88:91]
    ds_read_b64_tr_b16 a[58:59], v14 offset:45056
    v_mfma_f32_16x16x32_bf16 v[60:63], a[124:127], a[184:187], v[60:63]
    ds_read_b64_tr_b16 a[60:61], v15 offset:40960
    v_mfma_f32_16x16x32_bf16 v[92:95], a[124:127], a[188:191], v[92:95]
    ds_read_b64_tr_b16 a[62:63], v15 offset:45056
    s_waitcnt vmcnt(29) lgkmcnt(0)
    v_mfma_f32_16x16x32_bf16 v[32:35], a[0:3], a[192:195], v[32:35]
    ds_read_b64_tr_b16 a[64:65], v96 offset:32768
    s_add_u32 m0, s24, 16384
    v_mfma_f32_16x16x32_bf16 v[64:67], a[0:3], a[196:199], v[64:67]
    ds_read_b64_tr_b16 a[66:67], v96 offset:36864
    s_mov_b32 s25, 458752
    v_mfma_f32_16x16x32_bf16 v[36:39], a[4:7], a[192:195], v[36:39]
    ds_read_b64_tr_b16 a[68:69], v97 offset:32768
    v_mfma_f32_16x16x32_bf16 v[68:71], a[4:7], a[196:199], v[68:71]
    ds_read_b64_tr_b16 a[70:71], v97 offset:36864
    buffer_load_dwordx4 v16, s[8:11], s25 offen offset:0 lds
    v_mfma_f32_16x16x32_bf16 v[40:43], a[8:11], a[192:195], v[40:43]
    ds_read_b64_tr_b16 a[72:73], v98 offset:32768
    v_mfma_f32_16x16x32_bf16 v[72:75], a[8:11], a[196:199], v[72:75]
    ds_read_b64_tr_b16 a[74:75], v98 offset:36864
    v_mfma_f32_16x16x32_bf16 v[44:47], a[12:15], a[192:195], v[44:47]
    ds_read_b64_tr_b16 a[76:77], v99 offset:32768
    buffer_load_dwordx4 v17, s[8:11], s25 offen offset:1024 lds
    v_mfma_f32_16x16x32_bf16 v[76:79], a[12:15], a[196:199], v[76:79]
    ds_read_b64_tr_b16 a[78:79], v99 offset:36864
    v_mfma_f32_16x16x32_bf16 v[48:51], a[16:19], a[192:195], v[48:51]
    ds_read_b64_tr_b16 a[80:81], v100 offset:32768
    v_mfma_f32_16x16x32_bf16 v[80:83], a[16:19], a[196:199], v[80:83]
    ds_read_b64_tr_b16 a[82:83], v100 offset:36864
    buffer_load_dwordx4 v18, s[8:11], s25 offen offset:2048 lds
    v_mfma_f32_16x16x32_bf16 v[52:55], a[20:23], a[192:195], v[52:55]
    ds_read_b64_tr_b16 a[84:85], v101 offset:32768
    v_mfma_f32_16x16x32_bf16 v[84:87], a[20:23], a[196:199], v[84:87]
    ds_read_b64_tr_b16 a[86:87], v101 offset:36864
    v_mfma_f32_16x16x32_bf16 v[56:59], a[24:27], a[192:195], v[56:59]
    ds_read_b64_tr_b16 a[88:89], v102 offset:32768
    buffer_load_dwordx4 v19, s[8:11], s25 offen offset:3072 lds
    v_mfma_f32_16x16x32_bf16 v[88:91], a[24:27], a[196:199], v[88:91]
    ds_read_b64_tr_b16 a[90:91], v102 offset:36864
    s_mov_b32 s26, 6144
    v_mfma_f32_16x16x32_bf16 v[60:63], a[28:31], a[192:195], v[60:63]
    ds_read_b64_tr_b16 a[92:93], v103 offset:32768
    v_mfma_f32_16x16x32_bf16 v[92:95], a[28:31], a[196:199], v[92:95]
    ds_read_b64_tr_b16 a[94:95], v103 offset:36864
    buffer_load_dwordx4 a[144:147], v20, s[12:15], s26 offen offset:0 sc1
    v_mfma_f32_16x16x32_bf16 v[32:35], a[32:35], a[200:203], v[32:35]
    ds_read_b64_tr_b16 a[96:97], v96 offset:40960
    v_mfma_f32_16x16x32_bf16 v[64:67], a[32:35], a[204:207], v[64:67]
    ds_read_b64_tr_b16 a[98:99], v96 offset:45056
    v_mfma_f32_16x16x32_bf16 v[36:39], a[36:39], a[200:203], v[36:39]
    ds_read_b64_tr_b16 a[100:101], v97 offset:40960
    buffer_load_dwordx4 a[148:151], v21, s[12:15], s26 offen offset:0 sc1
    v_mfma_f32_16x16x32_bf16 v[68:71], a[36:39], a[204:207], v[68:71]
    ds_read_b64_tr_b16 a[102:103], v97 offset:45056
    v_mfma_f32_16x16x32_bf16 v[40:43], a[40:43], a[200:203], v[40:43]
    ds_read_b64_tr_b16 a[104:105], v98 offset:40960
    v_mfma_f32_16x16x32_bf16 v[72:75], a[40:43], a[204:207], v[72:75]
    ds_read_b64_tr_b16 a[106:107], v98 offset:45056
    buffer_load_dwordx4 a[152:155], v20, s[12:15], s26 offen offset:1024 sc1
    v_mfma_f32_16x16x32_bf16 v[44:47], a[44:47], a[200:203], v[44:47]
    ds_read_b64_tr_b16 a[108:109], v99 offset:40960
    v_mfma_f32_16x16x32_bf16 v[76:79], a[44:47], a[204:207], v[76:79]
    ds_read_b64_tr_b16 a[110:111], v99 offset:45056
    v_mfma_f32_16x16x32_bf16 v[48:51], a[48:51], a[200:203], v[48:51]
    ds_read_b64_tr_b16 a[112:113], v100 offset:40960
    buffer_load_dwordx4 a[156:159], v21, s[12:15], s26 offen offset:1024 sc1
    v_mfma_f32_16x16x32_bf16 v[80:83], a[48:51], a[204:207], v[80:83]
    ds_read_b64_tr_b16 a[114:115], v100 offset:45056
    v_mfma_f32_16x16x32_bf16 v[52:55], a[52:55], a[200:203], v[52:55]
    ds_read_b64_tr_b16 a[116:117], v101 offset:40960
    v_mfma_f32_16x16x32_bf16 v[84:87], a[52:55], a[204:207], v[84:87]
    ds_read_b64_tr_b16 a[118:119], v101 offset:45056
    v_mfma_f32_16x16x32_bf16 v[56:59], a[56:59], a[200:203], v[56:59]
    ds_read_b64_tr_b16 a[120:121], v102 offset:40960
    v_mfma_f32_16x16x32_bf16 v[88:91], a[56:59], a[204:207], v[88:91]
    ds_read_b64_tr_b16 a[122:123], v102 offset:45056
    v_mfma_f32_16x16x32_bf16 v[60:63], a[60:63], a[200:203], v[60:63]
    ds_read_b64_tr_b16 a[124:125], v103 offset:40960
    v_mfma_f32_16x16x32_bf16 v[92:95], a[60:63], a[204:207], v[92:95]
    ds_read_b64_tr_b16 a[126:127], v103 offset:45056
    s_waitcnt vmcnt(29) lgkmcnt(0)
    s_barrier
    v_mfma_f32_16x16x32_bf16 v[32:35], a[64:67], a[208:211], v[32:35]
    ds_read_b64_tr_b16 a[0:1], v8 offset:49152
    s_add_u32 m0, s24, 98304
    v_mfma_f32_16x16x32_bf16 v[64:67], a[64:67], a[212:215], v[64:67]
    ds_read_b64_tr_b16 a[2:3], v8 offset:53248
    s_mov_b32 s25, 655360
    v_mfma_f32_16x16x32_bf16 v[36:39], a[68:71], a[208:211], v[36:39]
    ds_read_b64_tr_b16 a[4:5], v9 offset:49152
    v_mfma_f32_16x16x32_bf16 v[68:71], a[68:71], a[212:215], v[68:71]
    ds_read_b64_tr_b16 a[6:7], v9 offset:53248
    buffer_load_dwordx4 v16, s[8:11], s25 offen offset:0 lds
    v_mfma_f32_16x16x32_bf16 v[40:43], a[72:75], a[208:211], v[40:43]
    ds_read_b64_tr_b16 a[8:9], v10 offset:49152
    v_mfma_f32_16x16x32_bf16 v[72:75], a[72:75], a[212:215], v[72:75]
    ds_read_b64_tr_b16 a[10:11], v10 offset:53248
    v_mfma_f32_16x16x32_bf16 v[44:47], a[76:79], a[208:211], v[44:47]
    ds_read_b64_tr_b16 a[12:13], v11 offset:49152
    buffer_load_dwordx4 v17, s[8:11], s25 offen offset:1024 lds
    v_mfma_f32_16x16x32_bf16 v[76:79], a[76:79], a[212:215], v[76:79]
    ds_read_b64_tr_b16 a[14:15], v11 offset:53248
    v_mfma_f32_16x16x32_bf16 v[48:51], a[80:83], a[208:211], v[48:51]
    ds_read_b64_tr_b16 a[16:17], v12 offset:49152
    v_mfma_f32_16x16x32_bf16 v[80:83], a[80:83], a[212:215], v[80:83]
    ds_read_b64_tr_b16 a[18:19], v12 offset:53248
    buffer_load_dwordx4 v18, s[8:11], s25 offen offset:2048 lds
    v_mfma_f32_16x16x32_bf16 v[52:55], a[84:87], a[208:211], v[52:55]
    ds_read_b64_tr_b16 a[20:21], v13 offset:49152
    v_mfma_f32_16x16x32_bf16 v[84:87], a[84:87], a[212:215], v[84:87]
    ds_read_b64_tr_b16 a[22:23], v13 offset:53248
    v_mfma_f32_16x16x32_bf16 v[56:59], a[88:91], a[208:211], v[56:59]
    ds_read_b64_tr_b16 a[24:25], v14 offset:49152
    buffer_load_dwordx4 v19, s[8:11], s25 offen offset:3072 lds
    v_mfma_f32_16x16x32_bf16 v[88:91], a[88:91], a[212:215], v[88:91]
    ds_read_b64_tr_b16 a[26:27], v14 offset:53248
    s_mov_b32 s26, 12288
    v_mfma_f32_16x16x32_bf16 v[60:63], a[92:95], a[208:211], v[60:63]
    ds_read_b64_tr_b16 a[28:29], v15 offset:49152
    v_mfma_f32_16x16x32_bf16 v[92:95], a[92:95], a[212:215], v[92:95]
    ds_read_b64_tr_b16 a[30:31], v15 offset:53248
    buffer_load_dwordx4 a[160:163], v20, s[12:15], s26 offen offset:0 sc1
    v_mfma_f32_16x16x32_bf16 v[32:35], a[96:99], a[216:219], v[32:35]
    ds_read_b64_tr_b16 a[32:33], v8 offset:57344
    v_mfma_f32_16x16x32_bf16 v[64:67], a[96:99], a[220:223], v[64:67]
    ds_read_b64_tr_b16 a[34:35], v8 offset:61440
    v_mfma_f32_16x16x32_bf16 v[36:39], a[100:103], a[216:219], v[36:39]
    ds_read_b64_tr_b16 a[36:37], v9 offset:57344
    buffer_load_dwordx4 a[164:167], v21, s[12:15], s26 offen offset:0 sc1
    v_mfma_f32_16x16x32_bf16 v[68:71], a[100:103], a[220:223], v[68:71]
    ds_read_b64_tr_b16 a[38:39], v9 offset:61440
    v_mfma_f32_16x16x32_bf16 v[40:43], a[104:107], a[216:219], v[40:43]
    ds_read_b64_tr_b16 a[40:41], v10 offset:57344
    v_mfma_f32_16x16x32_bf16 v[72:75], a[104:107], a[220:223], v[72:75]
    ds_read_b64_tr_b16 a[42:43], v10 offset:61440
    buffer_load_dwordx4 a[168:171], v20, s[12:15], s26 offen offset:1024 sc1
    v_mfma_f32_16x16x32_bf16 v[44:47], a[108:111], a[216:219], v[44:47]
    ds_read_b64_tr_b16 a[44:45], v11 offset:57344
    v_mfma_f32_16x16x32_bf16 v[76:79], a[108:111], a[220:223], v[76:79]
    ds_read_b64_tr_b16 a[46:47], v11 offset:61440
    v_mfma_f32_16x16x32_bf16 v[48:51], a[112:115], a[216:219], v[48:51]
    ds_read_b64_tr_b16 a[48:49], v12 offset:57344
    buffer_load_dwordx4 a[172:175], v21, s[12:15], s26 offen offset:1024 sc1
    v_mfma_f32_16x16x32_bf16 v[80:83], a[112:115], a[220:223], v[80:83]
    ds_read_b64_tr_b16 a[50:51], v12 offset:61440
    v_mfma_f32_16x16x32_bf16 v[52:55], a[116:119], a[216:219], v[52:55]
    ds_read_b64_tr_b16 a[52:53], v13 offset:57344
    v_mfma_f32_16x16x32_bf16 v[84:87], a[116:119], a[220:223], v[84:87]
    ds_read_b64_tr_b16 a[54:55], v13 offset:61440
    v_mfma_f32_16x16x32_bf16 v[56:59], a[120:123], a[216:219], v[56:59]
    ds_read_b64_tr_b16 a[56:57], v14 offset:57344
    v_mfma_f32_16x16x32_bf16 v[88:91], a[120:123], a[220:223], v[88:91]
    ds_read_b64_tr_b16 a[58:59], v14 offset:61440
    v_mfma_f32_16x16x32_bf16 v[60:63], a[124:127], a[216:219], v[60:63]
    ds_read_b64_tr_b16 a[60:61], v15 offset:57344
    v_mfma_f32_16x16x32_bf16 v[92:95], a[124:127], a[220:223], v[92:95]
    ds_read_b64_tr_b16 a[62:63], v15 offset:61440
    s_waitcnt vmcnt(29) lgkmcnt(0)
    v_mfma_f32_16x16x32_bf16 v[32:35], a[0:3], a[224:227], v[32:35]
    ds_read_b64_tr_b16 a[64:65], v96 offset:49152
    s_add_u32 m0, s24, 32768
    v_mfma_f32_16x16x32_bf16 v[64:67], a[0:3], a[228:231], v[64:67]
    ds_read_b64_tr_b16 a[66:67], v96 offset:53248
    s_mov_b32 s25, 720896
    v_mfma_f32_16x16x32_bf16 v[36:39], a[4:7], a[224:227], v[36:39]
    ds_read_b64_tr_b16 a[68:69], v97 offset:49152
    v_mfma_f32_16x16x32_bf16 v[68:71], a[4:7], a[228:231], v[68:71]
    ds_read_b64_tr_b16 a[70:71], v97 offset:53248
    buffer_load_dwordx4 v16, s[8:11], s25 offen offset:0 lds
    v_mfma_f32_16x16x32_bf16 v[40:43], a[8:11], a[224:227], v[40:43]
    ds_read_b64_tr_b16 a[72:73], v98 offset:49152
    v_mfma_f32_16x16x32_bf16 v[72:75], a[8:11], a[228:231], v[72:75]
    ds_read_b64_tr_b16 a[74:75], v98 offset:53248
    v_mfma_f32_16x16x32_bf16 v[44:47], a[12:15], a[224:227], v[44:47]
    ds_read_b64_tr_b16 a[76:77], v99 offset:49152
    buffer_load_dwordx4 v17, s[8:11], s25 offen offset:1024 lds
    v_mfma_f32_16x16x32_bf16 v[76:79], a[12:15], a[228:231], v[76:79]
    ds_read_b64_tr_b16 a[78:79], v99 offset:53248
    v_mfma_f32_16x16x32_bf16 v[48:51], a[16:19], a[224:227], v[48:51]
    ds_read_b64_tr_b16 a[80:81], v100 offset:49152
    v_mfma_f32_16x16x32_bf16 v[80:83], a[16:19], a[228:231], v[80:83]
    ds_read_b64_tr_b16 a[82:83], v100 offset:53248
    buffer_load_dwordx4 v18, s[8:11], s25 offen offset:2048 lds
    v_mfma_f32_16x16x32_bf16 v[52:55], a[20:23], a[224:227], v[52:55]
    ds_read_b64_tr_b16 a[84:85], v101 offset:49152
    v_mfma_f32_16x16x32_bf16 v[84:87], a[20:23], a[228:231], v[84:87]
    ds_read_b64_tr_b16 a[86:87], v101 offset:53248
    v_mfma_f32_16x16x32_bf16 v[56:59], a[24:27], a[224:227], v[56:59]
    ds_read_b64_tr_b16 a[88:89], v102 offset:49152
    buffer_load_dwordx4 v19, s[8:11], s25 offen offset:3072 lds
    v_mfma_f32_16x16x32_bf16 v[88:91], a[24:27], a[228:231], v[88:91]
    ds_read_b64_tr_b16 a[90:91], v102 offset:53248
    s_mov_b32 s26, 14336
    v_mfma_f32_16x16x32_bf16 v[60:63], a[28:31], a[224:227], v[60:63]
    ds_read_b64_tr_b16 a[92:93], v103 offset:49152
    v_mfma_f32_16x16x32_bf16 v[92:95], a[28:31], a[228:231], v[92:95]
    ds_read_b64_tr_b16 a[94:95], v103 offset:53248
    buffer_load_dwordx4 a[176:179], v20, s[12:15], s26 offen offset:0 sc1
    v_mfma_f32_16x16x32_bf16 v[32:35], a[32:35], a[232:235], v[32:35]
    ds_read_b64_tr_b16 a[96:97], v96 offset:57344
    v_mfma_f32_16x16x32_bf16 v[64:67], a[32:35], a[236:239], v[64:67]
    ds_read_b64_tr_b16 a[98:99], v96 offset:61440
    v_mfma_f32_16x16x32_bf16 v[36:39], a[36:39], a[232:235], v[36:39]
    ds_read_b64_tr_b16 a[100:101], v97 offset:57344
    buffer_load_dwordx4 a[180:183], v21, s[12:15], s26 offen offset:0 sc1
    v_mfma_f32_16x16x32_bf16 v[68:71], a[36:39], a[236:239], v[68:71]
    ds_read_b64_tr_b16 a[102:103], v97 offset:61440
    v_mfma_f32_16x16x32_bf16 v[40:43], a[40:43], a[232:235], v[40:43]
    ds_read_b64_tr_b16 a[104:105], v98 offset:57344
    v_mfma_f32_16x16x32_bf16 v[72:75], a[40:43], a[236:239], v[72:75]
    ds_read_b64_tr_b16 a[106:107], v98 offset:61440
    buffer_load_dwordx4 a[184:187], v20, s[12:15], s26 offen offset:1024 sc1
    v_mfma_f32_16x16x32_bf16 v[44:47], a[44:47], a[232:235], v[44:47]
    ds_read_b64_tr_b16 a[108:109], v99 offset:57344
    v_mfma_f32_16x16x32_bf16 v[76:79], a[44:47], a[236:239], v[76:79]
    ds_read_b64_tr_b16 a[110:111], v99 offset:61440
    v_mfma_f32_16x16x32_bf16 v[48:51], a[48:51], a[232:235], v[48:51]
    ds_read_b64_tr_b16 a[112:113], v100 offset:57344
    buffer_load_dwordx4 a[188:191], v21, s[12:15], s26 offen offset:1024 sc1
    v_mfma_f32_16x16x32_bf16 v[80:83], a[48:51], a[236:239], v[80:83]
    ds_read_b64_tr_b16 a[114:115], v100 offset:61440
    v_mfma_f32_16x16x32_bf16 v[52:55], a[52:55], a[232:235], v[52:55]
    ds_read_b64_tr_b16 a[116:117], v101 offset:57344
    v_mfma_f32_16x16x32_bf16 v[84:87], a[52:55], a[236:239], v[84:87]
    ds_read_b64_tr_b16 a[118:119], v101 offset:61440
    v_mfma_f32_16x16x32_bf16 v[56:59], a[56:59], a[232:235], v[56:59]
    ds_read_b64_tr_b16 a[120:121], v102 offset:57344
    v_mfma_f32_16x16x32_bf16 v[88:91], a[56:59], a[236:239], v[88:91]
    ds_read_b64_tr_b16 a[122:123], v102 offset:61440
    v_mfma_f32_16x16x32_bf16 v[60:63], a[60:63], a[232:235], v[60:63]
    ds_read_b64_tr_b16 a[124:125], v103 offset:57344
    v_mfma_f32_16x16x32_bf16 v[92:95], a[60:63], a[236:239], v[92:95]
    ds_read_b64_tr_b16 a[126:127], v103 offset:61440
    s_waitcnt vmcnt(33) lgkmcnt(0)
    s_barrier
    v_mfma_f32_16x16x32_bf16 v[32:35], a[64:67], a[240:243], v[32:35]
    ds_read_b64_tr_b16 a[0:1], v8 offset:0
    s_add_u32 m0, s24, 114688
    v_mfma_f32_16x16x32_bf16 v[64:67], a[64:67], a[244:247], v[64:67]
    ds_read_b64_tr_b16 a[2:3], v8 offset:4096
    s_mov_b32 s25, 917504
    v_mfma_f32_16x16x32_bf16 v[36:39], a[68:71], a[240:243], v[36:39]
    ds_read_b64_tr_b16 a[4:5], v9 offset:0
    v_mfma_f32_16x16x32_bf16 v[68:71], a[68:71], a[244:247], v[68:71]
    ds_read_b64_tr_b16 a[6:7], v9 offset:4096
    buffer_load_dwordx4 v16, s[8:11], s25 offen offset:0 lds
    v_mfma_f32_16x16x32_bf16 v[40:43], a[72:75], a[240:243], v[40:43]
    ds_read_b64_tr_b16 a[8:9], v10 offset:0
    v_mfma_f32_16x16x32_bf16 v[72:75], a[72:75], a[244:247], v[72:75]
    ds_read_b64_tr_b16 a[10:11], v10 offset:4096
    v_mfma_f32_16x16x32_bf16 v[44:47], a[76:79], a[240:243], v[44:47]
    ds_read_b64_tr_b16 a[12:13], v11 offset:0
    buffer_load_dwordx4 v17, s[8:11], s25 offen offset:1024 lds
    v_mfma_f32_16x16x32_bf16 v[76:79], a[76:79], a[244:247], v[76:79]
    ds_read_b64_tr_b16 a[14:15], v11 offset:4096
    v_mfma_f32_16x16x32_bf16 v[48:51], a[80:83], a[240:243], v[48:51]
    ds_read_b64_tr_b16 a[16:17], v12 offset:0
    v_mfma_f32_16x16x32_bf16 v[80:83], a[80:83], a[244:247], v[80:83]
    ds_read_b64_tr_b16 a[18:19], v12 offset:4096
    buffer_load_dwordx4 v18, s[8:11], s25 offen offset:2048 lds
    v_mfma_f32_16x16x32_bf16 v[52:55], a[84:87], a[240:243], v[52:55]
    ds_read_b64_tr_b16 a[20:21], v13 offset:0
    v_mfma_f32_16x16x32_bf16 v[84:87], a[84:87], a[244:247], v[84:87]
    ds_read_b64_tr_b16 a[22:23], v13 offset:4096
    v_mfma_f32_16x16x32_bf16 v[56:59], a[88:91], a[240:243], v[56:59]
    ds_read_b64_tr_b16 a[24:25], v14 offset:0
    buffer_load_dwordx4 v19, s[8:11], s25 offen offset:3072 lds
    v_mfma_f32_16x16x32_bf16 v[88:91], a[88:91], a[244:247], v[88:91]
    ds_read_b64_tr_b16 a[26:27], v14 offset:4096
    s_mov_b32 s26, 20480
    v_mfma_f32_16x16x32_bf16 v[60:63], a[92:95], a[240:243], v[60:63]
    ds_read_b64_tr_b16 a[28:29], v15 offset:0
    v_mfma_f32_16x16x32_bf16 v[92:95], a[92:95], a[244:247], v[92:95]
    ds_read_b64_tr_b16 a[30:31], v15 offset:4096
    buffer_load_dwordx4 a[192:195], v20, s[12:15], s26 offen offset:0 sc1
    v_mfma_f32_16x16x32_bf16 v[32:35], a[96:99], a[248:251], v[32:35]
    ds_read_b64_tr_b16 a[32:33], v8 offset:8192
    v_mfma_f32_16x16x32_bf16 v[64:67], a[96:99], a[252:255], v[64:67]
    ds_read_b64_tr_b16 a[34:35], v8 offset:12288
    v_mfma_f32_16x16x32_bf16 v[36:39], a[100:103], a[248:251], v[36:39]
    ds_read_b64_tr_b16 a[36:37], v9 offset:8192
    buffer_load_dwordx4 a[196:199], v21, s[12:15], s26 offen offset:0 sc1
    v_mfma_f32_16x16x32_bf16 v[68:71], a[100:103], a[252:255], v[68:71]
    ds_read_b64_tr_b16 a[38:39], v9 offset:12288
    v_mfma_f32_16x16x32_bf16 v[40:43], a[104:107], a[248:251], v[40:43]
    ds_read_b64_tr_b16 a[40:41], v10 offset:8192
    v_mfma_f32_16x16x32_bf16 v[72:75], a[104:107], a[252:255], v[72:75]
    ds_read_b64_tr_b16 a[42:43], v10 offset:12288
    buffer_load_dwordx4 a[200:203], v20, s[12:15], s26 offen offset:1024 sc1
    v_mfma_f32_16x16x32_bf16 v[44:47], a[108:111], a[248:251], v[44:47]
    ds_read_b64_tr_b16 a[44:45], v11 offset:8192
    v_mfma_f32_16x16x32_bf16 v[76:79], a[108:111], a[252:255], v[76:79]
    ds_read_b64_tr_b16 a[46:47], v11 offset:12288
    v_mfma_f32_16x16x32_bf16 v[48:51], a[112:115], a[248:251], v[48:51]
    ds_read_b64_tr_b16 a[48:49], v12 offset:8192
    buffer_load_dwordx4 a[204:207], v21, s[12:15], s26 offen offset:1024 sc1
    v_mfma_f32_16x16x32_bf16 v[80:83], a[112:115], a[252:255], v[80:83]
    ds_read_b64_tr_b16 a[50:51], v12 offset:12288
    v_mfma_f32_16x16x32_bf16 v[52:55], a[116:119], a[248:251], v[52:55]
    ds_read_b64_tr_b16 a[52:53], v13 offset:8192
    v_mfma_f32_16x16x32_bf16 v[84:87], a[116:119], a[252:255], v[84:87]
    ds_read_b64_tr_b16 a[54:55], v13 offset:12288
    v_mfma_f32_16x16x32_bf16 v[56:59], a[120:123], a[248:251], v[56:59]
    ds_read_b64_tr_b16 a[56:57], v14 offset:8192
    v_mfma_f32_16x16x32_bf16 v[88:91], a[120:123], a[252:255], v[88:91]
    ds_read_b64_tr_b16 a[58:59], v14 offset:12288
    v_mfma_f32_16x16x32_bf16 v[60:63], a[124:127], a[248:251], v[60:63]
    ds_read_b64_tr_b16 a[60:61], v15 offset:8192
    v_mfma_f32_16x16x32_bf16 v[92:95], a[124:127], a[252:255], v[92:95]
    ds_read_b64_tr_b16 a[62:63], v15 offset:12288
    s_waitcnt vmcnt(32) lgkmcnt(0)
    v_mfma_f32_16x16x32_bf16 v[32:35], a[0:3], a[128:131], v[32:35]
    ds_read_b64_tr_b16 a[64:65], v96 offset:0
    s_add_u32 m0, s24, 49152
    v_mfma_f32_16x16x32_bf16 v[64:67], a[0:3], a[132:135], v[64:67]
    ds_read_b64_tr_b16 a[66:67], v96 offset:4096
    s_mov_b32 s25, 983040
    v_mfma_f32_16x16x32_bf16 v[36:39], a[4:7], a[128:131], v[36:39]
    ds_read_b64_tr_b16 a[68:69], v97 offset:0
    v_mfma_f32_16x16x32_bf16 v[68:71], a[4:7], a[132:135], v[68:71]
    ds_read_b64_tr_b16 a[70:71], v97 offset:4096
    buffer_load_dwordx4 v16, s[8:11], s25 offen offset:0 lds
    v_mfma_f32_16x16x32_bf16 v[40:43], a[8:11], a[128:131], v[40:43]
    ds_read_b64_tr_b16 a[72:73], v98 offset:0
    v_mfma_f32_16x16x32_bf16 v[72:75], a[8:11], a[132:135], v[72:75]
    ds_read_b64_tr_b16 a[74:75], v98 offset:4096
    v_mfma_f32_16x16x32_bf16 v[44:47], a[12:15], a[128:131], v[44:47]
    ds_read_b64_tr_b16 a[76:77], v99 offset:0
    buffer_load_dwordx4 v17, s[8:11], s25 offen offset:1024 lds
    v_mfma_f32_16x16x32_bf16 v[76:79], a[12:15], a[132:135], v[76:79]
    ds_read_b64_tr_b16 a[78:79], v99 offset:4096
    v_mfma_f32_16x16x32_bf16 v[48:51], a[16:19], a[128:131], v[48:51]
    ds_read_b64_tr_b16 a[80:81], v100 offset:0
    v_mfma_f32_16x16x32_bf16 v[80:83], a[16:19], a[132:135], v[80:83]
    ds_read_b64_tr_b16 a[82:83], v100 offset:4096
    buffer_load_dwordx4 v18, s[8:11], s25 offen offset:2048 lds
    v_mfma_f32_16x16x32_bf16 v[52:55], a[20:23], a[128:131], v[52:55]
    ds_read_b64_tr_b16 a[84:85], v101 offset:0
    v_mfma_f32_16x16x32_bf16 v[84:87], a[20:23], a[132:135], v[84:87]
    ds_read_b64_tr_b16 a[86:87], v101 offset:4096
    v_mfma_f32_16x16x32_bf16 v[56:59], a[24:27], a[128:131], v[56:59]
    ds_read_b64_tr_b16 a[88:89], v102 offset:0
    buffer_load_dwordx4 v19, s[8:11], s25 offen offset:3072 lds
    v_mfma_f32_16x16x32_bf16 v[88:91], a[24:27], a[132:135], v[88:91]
    ds_read_b64_tr_b16 a[90:91], v102 offset:4096
    s_mov_b32 s26, 22528
    v_mfma_f32_16x16x32_bf16 v[60:63], a[28:31], a[128:131], v[60:63]
    ds_read_b64_tr_b16 a[92:93], v103 offset:0
    v_mfma_f32_16x16x32_bf16 v[92:95], a[28:31], a[132:135], v[92:95]
    ds_read_b64_tr_b16 a[94:95], v103 offset:4096
    buffer_load_dwordx4 a[208:211], v20, s[12:15], s26 offen offset:0 sc1
    v_mfma_f32_16x16x32_bf16 v[32:35], a[32:35], a[136:139], v[32:35]
    ds_read_b64_tr_b16 a[96:97], v96 offset:8192
    v_mfma_f32_16x16x32_bf16 v[64:67], a[32:35], a[140:143], v[64:67]
    ds_read_b64_tr_b16 a[98:99], v96 offset:12288
    v_mfma_f32_16x16x32_bf16 v[36:39], a[36:39], a[136:139], v[36:39]
    ds_read_b64_tr_b16 a[100:101], v97 offset:8192
    buffer_load_dwordx4 a[212:215], v21, s[12:15], s26 offen offset:0 sc1
    v_mfma_f32_16x16x32_bf16 v[68:71], a[36:39], a[140:143], v[68:71]
    ds_read_b64_tr_b16 a[102:103], v97 offset:12288
    v_mfma_f32_16x16x32_bf16 v[40:43], a[40:43], a[136:139], v[40:43]
    ds_read_b64_tr_b16 a[104:105], v98 offset:8192
    v_mfma_f32_16x16x32_bf16 v[72:75], a[40:43], a[140:143], v[72:75]
    ds_read_b64_tr_b16 a[106:107], v98 offset:12288
    buffer_load_dwordx4 a[216:219], v20, s[12:15], s26 offen offset:1024 sc1
    v_mfma_f32_16x16x32_bf16 v[44:47], a[44:47], a[136:139], v[44:47]
    ds_read_b64_tr_b16 a[108:109], v99 offset:8192
    v_mfma_f32_16x16x32_bf16 v[76:79], a[44:47], a[140:143], v[76:79]
    ds_read_b64_tr_b16 a[110:111], v99 offset:12288
    v_mfma_f32_16x16x32_bf16 v[48:51], a[48:51], a[136:139], v[48:51]
    ds_read_b64_tr_b16 a[112:113], v100 offset:8192
    buffer_load_dwordx4 a[220:223], v21, s[12:15], s26 offen offset:1024 sc1
    v_mfma_f32_16x16x32_bf16 v[80:83], a[48:51], a[140:143], v[80:83]
    ds_read_b64_tr_b16 a[114:115], v100 offset:12288
    v_mfma_f32_16x16x32_bf16 v[52:55], a[52:55], a[136:139], v[52:55]
    ds_read_b64_tr_b16 a[116:117], v101 offset:8192
    v_mfma_f32_16x16x32_bf16 v[84:87], a[52:55], a[140:143], v[84:87]
    ds_read_b64_tr_b16 a[118:119], v101 offset:12288
    v_mfma_f32_16x16x32_bf16 v[56:59], a[56:59], a[136:139], v[56:59]
    ds_read_b64_tr_b16 a[120:121], v102 offset:8192
    v_mfma_f32_16x16x32_bf16 v[88:91], a[56:59], a[140:143], v[88:91]
    ds_read_b64_tr_b16 a[122:123], v102 offset:12288
    v_mfma_f32_16x16x32_bf16 v[60:63], a[60:63], a[136:139], v[60:63]
    ds_read_b64_tr_b16 a[124:125], v103 offset:8192
    v_mfma_f32_16x16x32_bf16 v[92:95], a[60:63], a[140:143], v[92:95]
    ds_read_b64_tr_b16 a[126:127], v103 offset:12288
    s_waitcnt vmcnt(32) lgkmcnt(0)
    s_barrier
    v_mfma_f32_16x16x32_bf16 v[32:35], a[64:67], a[144:147], v[32:35]
    ds_read_b64_tr_b16 a[0:1], v8 offset:16384
    s_add_u32 m0, s24, 65536
    v_mfma_f32_16x16x32_bf16 v[64:67], a[64:67], a[148:151], v[64:67]
    ds_read_b64_tr_b16 a[2:3], v8 offset:20480
    s_mov_b32 s25, 1179648
    v_mfma_f32_16x16x32_bf16 v[36:39], a[68:71], a[144:147], v[36:39]
    ds_read_b64_tr_b16 a[4:5], v9 offset:16384
    v_mfma_f32_16x16x32_bf16 v[68:71], a[68:71], a[148:151], v[68:71]
    ds_read_b64_tr_b16 a[6:7], v9 offset:20480
    buffer_load_dwordx4 v16, s[8:11], s25 offen offset:0 lds
    v_mfma_f32_16x16x32_bf16 v[40:43], a[72:75], a[144:147], v[40:43]
    ds_read_b64_tr_b16 a[8:9], v10 offset:16384
    v_mfma_f32_16x16x32_bf16 v[72:75], a[72:75], a[148:151], v[72:75]
    ds_read_b64_tr_b16 a[10:11], v10 offset:20480
    v_mfma_f32_16x16x32_bf16 v[44:47], a[76:79], a[144:147], v[44:47]
    ds_read_b64_tr_b16 a[12:13], v11 offset:16384
    buffer_load_dwordx4 v17, s[8:11], s25 offen offset:1024 lds
    v_mfma_f32_16x16x32_bf16 v[76:79], a[76:79], a[148:151], v[76:79]
    ds_read_b64_tr_b16 a[14:15], v11 offset:20480
    v_mfma_f32_16x16x32_bf16 v[48:51], a[80:83], a[144:147], v[48:51]
    ds_read_b64_tr_b16 a[16:17], v12 offset:16384
    v_mfma_f32_16x16x32_bf16 v[80:83], a[80:83], a[148:151], v[80:83]
    ds_read_b64_tr_b16 a[18:19], v12 offset:20480
    buffer_load_dwordx4 v18, s[8:11], s25 offen offset:2048 lds
    v_mfma_f32_16x16x32_bf16 v[52:55], a[84:87], a[144:147], v[52:55]
    ds_read_b64_tr_b16 a[20:21], v13 offset:16384
    v_mfma_f32_16x16x32_bf16 v[84:87], a[84:87], a[148:151], v[84:87]
    ds_read_b64_tr_b16 a[22:23], v13 offset:20480
    v_mfma_f32_16x16x32_bf16 v[56:59], a[88:91], a[144:147], v[56:59]
    ds_read_b64_tr_b16 a[24:25], v14 offset:16384
    buffer_load_dwordx4 v19, s[8:11], s25 offen offset:3072 lds
    v_mfma_f32_16x16x32_bf16 v[88:91], a[88:91], a[148:151], v[88:91]
    ds_read_b64_tr_b16 a[26:27], v14 offset:20480
    s_mov_b32 s26, 28672
    v_mfma_f32_16x16x32_bf16 v[60:63], a[92:95], a[144:147], v[60:63]
    ds_read_b64_tr_b16 a[28:29], v15 offset:16384
    v_mfma_f32_16x16x32_bf16 v[92:95], a[92:95], a[148:151], v[92:95]
    ds_read_b64_tr_b16 a[30:31], v15 offset:20480
    buffer_load_dwordx4 a[224:227], v20, s[12:15], s26 offen offset:0 sc1
    v_mfma_f32_16x16x32_bf16 v[32:35], a[96:99], a[152:155], v[32:35]
    ds_read_b64_tr_b16 a[32:33], v8 offset:24576
    v_mfma_f32_16x16x32_bf16 v[64:67], a[96:99], a[156:159], v[64:67]
    ds_read_b64_tr_b16 a[34:35], v8 offset:28672
    v_mfma_f32_16x16x32_bf16 v[36:39], a[100:103], a[152:155], v[36:39]
    ds_read_b64_tr_b16 a[36:37], v9 offset:24576
    buffer_load_dwordx4 a[228:231], v21, s[12:15], s26 offen offset:0 sc1
    v_mfma_f32_16x16x32_bf16 v[68:71], a[100:103], a[156:159], v[68:71]
    ds_read_b64_tr_b16 a[38:39], v9 offset:28672
    v_mfma_f32_16x16x32_bf16 v[40:43], a[104:107], a[152:155], v[40:43]
    ds_read_b64_tr_b16 a[40:41], v10 offset:24576
    v_mfma_f32_16x16x32_bf16 v[72:75], a[104:107], a[156:159], v[72:75]
    ds_read_b64_tr_b16 a[42:43], v10 offset:28672
    buffer_load_dwordx4 a[232:235], v20, s[12:15], s26 offen offset:1024 sc1
    v_mfma_f32_16x16x32_bf16 v[44:47], a[108:111], a[152:155], v[44:47]
    ds_read_b64_tr_b16 a[44:45], v11 offset:24576
    v_mfma_f32_16x16x32_bf16 v[76:79], a[108:111], a[156:159], v[76:79]
    ds_read_b64_tr_b16 a[46:47], v11 offset:28672
    v_mfma_f32_16x16x32_bf16 v[48:51], a[112:115], a[152:155], v[48:51]
    ds_read_b64_tr_b16 a[48:49], v12 offset:24576
    buffer_load_dwordx4 a[236:239], v21, s[12:15], s26 offen offset:1024 sc1
    v_mfma_f32_16x16x32_bf16 v[80:83], a[112:115], a[156:159], v[80:83]
    ds_read_b64_tr_b16 a[50:51], v12 offset:28672
    v_mfma_f32_16x16x32_bf16 v[52:55], a[116:119], a[152:155], v[52:55]
    ds_read_b64_tr_b16 a[52:53], v13 offset:24576
    v_mfma_f32_16x16x32_bf16 v[84:87], a[116:119], a[156:159], v[84:87]
    ds_read_b64_tr_b16 a[54:55], v13 offset:28672
    v_mfma_f32_16x16x32_bf16 v[56:59], a[120:123], a[152:155], v[56:59]
    ds_read_b64_tr_b16 a[56:57], v14 offset:24576
    v_mfma_f32_16x16x32_bf16 v[88:91], a[120:123], a[156:159], v[88:91]
    ds_read_b64_tr_b16 a[58:59], v14 offset:28672
    v_mfma_f32_16x16x32_bf16 v[60:63], a[124:127], a[152:155], v[60:63]
    ds_read_b64_tr_b16 a[60:61], v15 offset:24576
    v_mfma_f32_16x16x32_bf16 v[92:95], a[124:127], a[156:159], v[92:95]
    ds_read_b64_tr_b16 a[62:63], v15 offset:28672
    s_waitcnt vmcnt(32) lgkmcnt(0)
    v_mfma_f32_16x16x32_bf16 v[32:35], a[0:3], a[160:163], v[32:35]
    ds_read_b64_tr_b16 a[64:65], v96 offset:16384
    s_add_u32 m0, s24, 0
    v_mfma_f32_16x16x32_bf16 v[64:67], a[0:3], a[164:167], v[64:67]
    ds_read_b64_tr_b16 a[66:67], v96 offset:20480
    s_mov_b32 s25, 1245184
    v_mfma_f32_16x16x32_bf16 v[36:39], a[4:7], a[160:163], v[36:39]
    ds_read_b64_tr_b16 a[68:69], v97 offset:16384
    v_mfma_f32_16x16x32_bf16 v[68:71], a[4:7], a[164:167], v[68:71]
    ds_read_b64_tr_b16 a[70:71], v97 offset:20480
    buffer_load_dwordx4 v16, s[8:11], s25 offen offset:0 lds
    v_mfma_f32_16x16x32_bf16 v[40:43], a[8:11], a[160:163], v[40:43]
    ds_read_b64_tr_b16 a[72:73], v98 offset:16384
    v_mfma_f32_16x16x32_bf16 v[72:75], a[8:11], a[164:167], v[72:75]
    ds_read_b64_tr_b16 a[74:75], v98 offset:20480
    v_mfma_f32_16x16x32_bf16 v[44:47], a[12:15], a[160:163], v[44:47]
    ds_read_b64_tr_b16 a[76:77], v99 offset:16384
    buffer_load_dwordx4 v17, s[8:11], s25 offen offset:1024 lds
    v_mfma_f32_16x16x32_bf16 v[76:79], a[12:15], a[164:167], v[76:79]
    ds_read_b64_tr_b16 a[78:79], v99 offset:20480
    v_mfma_f32_16x16x32_bf16 v[48:51], a[16:19], a[160:163], v[48:51]
    ds_read_b64_tr_b16 a[80:81], v100 offset:16384
    v_mfma_f32_16x16x32_bf16 v[80:83], a[16:19], a[164:167], v[80:83]
    ds_read_b64_tr_b16 a[82:83], v100 offset:20480
    buffer_load_dwordx4 v18, s[8:11], s25 offen offset:2048 lds
    v_mfma_f32_16x16x32_bf16 v[52:55], a[20:23], a[160:163], v[52:55]
    ds_read_b64_tr_b16 a[84:85], v101 offset:16384
    v_mfma_f32_16x16x32_bf16 v[84:87], a[20:23], a[164:167], v[84:87]
    ds_read_b64_tr_b16 a[86:87], v101 offset:20480
    v_mfma_f32_16x16x32_bf16 v[56:59], a[24:27], a[160:163], v[56:59]
    ds_read_b64_tr_b16 a[88:89], v102 offset:16384
    buffer_load_dwordx4 v19, s[8:11], s25 offen offset:3072 lds
    v_mfma_f32_16x16x32_bf16 v[88:91], a[24:27], a[164:167], v[88:91]
    ds_read_b64_tr_b16 a[90:91], v102 offset:20480
    s_mov_b32 s26, 30720
    v_mfma_f32_16x16x32_bf16 v[60:63], a[28:31], a[160:163], v[60:63]
    ds_read_b64_tr_b16 a[92:93], v103 offset:16384
    v_mfma_f32_16x16x32_bf16 v[92:95], a[28:31], a[164:167], v[92:95]
    ds_read_b64_tr_b16 a[94:95], v103 offset:20480
    buffer_load_dwordx4 a[240:243], v20, s[12:15], s26 offen offset:0 sc1
    v_mfma_f32_16x16x32_bf16 v[32:35], a[32:35], a[168:171], v[32:35]
    ds_read_b64_tr_b16 a[96:97], v96 offset:24576
    v_mfma_f32_16x16x32_bf16 v[64:67], a[32:35], a[172:175], v[64:67]
    ds_read_b64_tr_b16 a[98:99], v96 offset:28672
    v_mfma_f32_16x16x32_bf16 v[36:39], a[36:39], a[168:171], v[36:39]
    ds_read_b64_tr_b16 a[100:101], v97 offset:24576
    buffer_load_dwordx4 a[244:247], v21, s[12:15], s26 offen offset:0 sc1
    v_mfma_f32_16x16x32_bf16 v[68:71], a[36:39], a[172:175], v[68:71]
    ds_read_b64_tr_b16 a[102:103], v97 offset:28672
    v_mfma_f32_16x16x32_bf16 v[40:43], a[40:43], a[168:171], v[40:43]
    ds_read_b64_tr_b16 a[104:105], v98 offset:24576
    v_mfma_f32_16x16x32_bf16 v[72:75], a[40:43], a[172:175], v[72:75]
    ds_read_b64_tr_b16 a[106:107], v98 offset:28672
    buffer_load_dwordx4 a[248:251], v20, s[12:15], s26 offen offset:1024 sc1
    v_mfma_f32_16x16x32_bf16 v[44:47], a[44:47], a[168:171], v[44:47]
    ds_read_b64_tr_b16 a[108:109], v99 offset:24576
    v_mfma_f32_16x16x32_bf16 v[76:79], a[44:47], a[172:175], v[76:79]
    ds_read_b64_tr_b16 a[110:111], v99 offset:28672
    v_mfma_f32_16x16x32_bf16 v[48:51], a[48:51], a[168:171], v[48:51]
    ds_read_b64_tr_b16 a[112:113], v100 offset:24576
    buffer_load_dwordx4 a[252:255], v21, s[12:15], s26 offen offset:1024 sc1
    v_mfma_f32_16x16x32_bf16 v[80:83], a[48:51], a[172:175], v[80:83]
    ds_read_b64_tr_b16 a[114:115], v100 offset:28672
    v_mfma_f32_16x16x32_bf16 v[52:55], a[52:55], a[168:171], v[52:55]
    ds_read_b64_tr_b16 a[116:117], v101 offset:24576
    v_mfma_f32_16x16x32_bf16 v[84:87], a[52:55], a[172:175], v[84:87]
    ds_read_b64_tr_b16 a[118:119], v101 offset:28672
    v_mfma_f32_16x16x32_bf16 v[56:59], a[56:59], a[168:171], v[56:59]
    ds_read_b64_tr_b16 a[120:121], v102 offset:24576
    v_mfma_f32_16x16x32_bf16 v[88:91], a[56:59], a[172:175], v[88:91]
    ds_read_b64_tr_b16 a[122:123], v102 offset:28672
    v_mfma_f32_16x16x32_bf16 v[60:63], a[60:63], a[168:171], v[60:63]
    ds_read_b64_tr_b16 a[124:125], v103 offset:24576
    v_mfma_f32_16x16x32_bf16 v[92:95], a[60:63], a[172:175], v[92:95]
    ds_read_b64_tr_b16 a[126:127], v103 offset:28672
    s_waitcnt vmcnt(32) lgkmcnt(0)
    s_barrier
    v_mfma_f32_16x16x32_bf16 v[32:35], a[64:67], a[176:179], v[32:35]
    ds_read_b64_tr_b16 a[0:1], v8 offset:32768
    s_add_u32 m0, s24, 81920
    v_mfma_f32_16x16x32_bf16 v[64:67], a[64:67], a[180:183], v[64:67]
    ds_read_b64_tr_b16 a[2:3], v8 offset:36864
    s_mov_b32 s25, 1441792
    v_mfma_f32_16x16x32_bf16 v[36:39], a[68:71], a[176:179], v[36:39]
    ds_read_b64_tr_b16 a[4:5], v9 offset:32768
    v_mfma_f32_16x16x32_bf16 v[68:71], a[68:71], a[180:183], v[68:71]
    ds_read_b64_tr_b16 a[6:7], v9 offset:36864
    buffer_load_dwordx4 v16, s[8:11], s25 offen offset:0 lds
    v_mfma_f32_16x16x32_bf16 v[40:43], a[72:75], a[176:179], v[40:43]
    ds_read_b64_tr_b16 a[8:9], v10 offset:32768
    v_mfma_f32_16x16x32_bf16 v[72:75], a[72:75], a[180:183], v[72:75]
    ds_read_b64_tr_b16 a[10:11], v10 offset:36864
    v_mfma_f32_16x16x32_bf16 v[44:47], a[76:79], a[176:179], v[44:47]
    ds_read_b64_tr_b16 a[12:13], v11 offset:32768
    buffer_load_dwordx4 v17, s[8:11], s25 offen offset:1024 lds
    v_mfma_f32_16x16x32_bf16 v[76:79], a[76:79], a[180:183], v[76:79]
    ds_read_b64_tr_b16 a[14:15], v11 offset:36864
    v_mfma_f32_16x16x32_bf16 v[48:51], a[80:83], a[176:179], v[48:51]
    ds_read_b64_tr_b16 a[16:17], v12 offset:32768
    v_mfma_f32_16x16x32_bf16 v[80:83], a[80:83], a[180:183], v[80:83]
    ds_read_b64_tr_b16 a[18:19], v12 offset:36864
    buffer_load_dwordx4 v18, s[8:11], s25 offen offset:2048 lds
    v_mfma_f32_16x16x32_bf16 v[52:55], a[84:87], a[176:179], v[52:55]
    ds_read_b64_tr_b16 a[20:21], v13 offset:32768
    v_mfma_f32_16x16x32_bf16 v[84:87], a[84:87], a[180:183], v[84:87]
    ds_read_b64_tr_b16 a[22:23], v13 offset:36864
    v_mfma_f32_16x16x32_bf16 v[56:59], a[88:91], a[176:179], v[56:59]
    ds_read_b64_tr_b16 a[24:25], v14 offset:32768
    buffer_load_dwordx4 v19, s[8:11], s25 offen offset:3072 lds
    v_mfma_f32_16x16x32_bf16 v[88:91], a[88:91], a[180:183], v[88:91]
    ds_read_b64_tr_b16 a[26:27], v14 offset:36864
    s_mov_b32 s26, 36864
    v_mfma_f32_16x16x32_bf16 v[60:63], a[92:95], a[176:179], v[60:63]
    ds_read_b64_tr_b16 a[28:29], v15 offset:32768
    v_mfma_f32_16x16x32_bf16 v[92:95], a[92:95], a[180:183], v[92:95]
    ds_read_b64_tr_b16 a[30:31], v15 offset:36864
    buffer_load_dwordx4 a[128:131], v20, s[12:15], s26 offen offset:0 sc1
    v_mfma_f32_16x16x32_bf16 v[32:35], a[96:99], a[184:187], v[32:35]
    ds_read_b64_tr_b16 a[32:33], v8 offset:40960
    v_mfma_f32_16x16x32_bf16 v[64:67], a[96:99], a[188:191], v[64:67]
    ds_read_b64_tr_b16 a[34:35], v8 offset:45056
    v_mfma_f32_16x16x32_bf16 v[36:39], a[100:103], a[184:187], v[36:39]
    ds_read_b64_tr_b16 a[36:37], v9 offset:40960
    buffer_load_dwordx4 a[132:135], v21, s[12:15], s26 offen offset:0 sc1
    v_mfma_f32_16x16x32_bf16 v[68:71], a[100:103], a[188:191], v[68:71]
    ds_read_b64_tr_b16 a[38:39], v9 offset:45056
    v_mfma_f32_16x16x32_bf16 v[40:43], a[104:107], a[184:187], v[40:43]
    ds_read_b64_tr_b16 a[40:41], v10 offset:40960
    v_mfma_f32_16x16x32_bf16 v[72:75], a[104:107], a[188:191], v[72:75]
    ds_read_b64_tr_b16 a[42:43], v10 offset:45056
    buffer_load_dwordx4 a[136:139], v20, s[12:15], s26 offen offset:1024 sc1
    v_mfma_f32_16x16x32_bf16 v[44:47], a[108:111], a[184:187], v[44:47]
    ds_read_b64_tr_b16 a[44:45], v11 offset:40960
    v_mfma_f32_16x16x32_bf16 v[76:79], a[108:111], a[188:191], v[76:79]
    ds_read_b64_tr_b16 a[46:47], v11 offset:45056
    v_mfma_f32_16x16x32_bf16 v[48:51], a[112:115], a[184:187], v[48:51]
    ds_read_b64_tr_b16 a[48:49], v12 offset:40960
    buffer_load_dwordx4 a[140:143], v21, s[12:15], s26 offen offset:1024 sc1
    v_mfma_f32_16x16x32_bf16 v[80:83], a[112:115], a[188:191], v[80:83]
    ds_read_b64_tr_b16 a[50:51], v12 offset:45056
    v_mfma_f32_16x16x32_bf16 v[52:55], a[116:119], a[184:187], v[52:55]
    ds_read_b64_tr_b16 a[52:53], v13 offset:40960
    v_mfma_f32_16x16x32_bf16 v[84:87], a[116:119], a[188:191], v[84:87]
    ds_read_b64_tr_b16 a[54:55], v13 offset:45056
    v_mfma_f32_16x16x32_bf16 v[56:59], a[120:123], a[184:187], v[56:59]
    ds_read_b64_tr_b16 a[56:57], v14 offset:40960
    v_mfma_f32_16x16x32_bf16 v[88:91], a[120:123], a[188:191], v[88:91]
    ds_read_b64_tr_b16 a[58:59], v14 offset:45056
    v_mfma_f32_16x16x32_bf16 v[60:63], a[124:127], a[184:187], v[60:63]
    ds_read_b64_tr_b16 a[60:61], v15 offset:40960
    v_mfma_f32_16x16x32_bf16 v[92:95], a[124:127], a[188:191], v[92:95]
    ds_read_b64_tr_b16 a[62:63], v15 offset:45056
    s_waitcnt vmcnt(32) lgkmcnt(0)
    v_mfma_f32_16x16x32_bf16 v[32:35], a[0:3], a[192:195], v[32:35]
    ds_read_b64_tr_b16 a[64:65], v96 offset:32768
    s_add_u32 m0, s24, 16384
    v_mfma_f32_16x16x32_bf16 v[64:67], a[0:3], a[196:199], v[64:67]
    ds_read_b64_tr_b16 a[66:67], v96 offset:36864
    s_mov_b32 s25, 1507328
    v_mfma_f32_16x16x32_bf16 v[36:39], a[4:7], a[192:195], v[36:39]
    ds_read_b64_tr_b16 a[68:69], v97 offset:32768
    v_mfma_f32_16x16x32_bf16 v[68:71], a[4:7], a[196:199], v[68:71]
    ds_read_b64_tr_b16 a[70:71], v97 offset:36864
    buffer_load_dwordx4 v16, s[8:11], s25 offen offset:0 lds
    v_mfma_f32_16x16x32_bf16 v[40:43], a[8:11], a[192:195], v[40:43]
    ds_read_b64_tr_b16 a[72:73], v98 offset:32768
    v_mfma_f32_16x16x32_bf16 v[72:75], a[8:11], a[196:199], v[72:75]
    ds_read_b64_tr_b16 a[74:75], v98 offset:36864
    v_mfma_f32_16x16x32_bf16 v[44:47], a[12:15], a[192:195], v[44:47]
    ds_read_b64_tr_b16 a[76:77], v99 offset:32768
    buffer_load_dwordx4 v17, s[8:11], s25 offen offset:1024 lds
    v_mfma_f32_16x16x32_bf16 v[76:79], a[12:15], a[196:199], v[76:79]
    ds_read_b64_tr_b16 a[78:79], v99 offset:36864
    v_mfma_f32_16x16x32_bf16 v[48:51], a[16:19], a[192:195], v[48:51]
    ds_read_b64_tr_b16 a[80:81], v100 offset:32768
    v_mfma_f32_16x16x32_bf16 v[80:83], a[16:19], a[196:199], v[80:83]
    ds_read_b64_tr_b16 a[82:83], v100 offset:36864
    buffer_load_dwordx4 v18, s[8:11], s25 offen offset:2048 lds
    v_mfma_f32_16x16x32_bf16 v[52:55], a[20:23], a[192:195], v[52:55]
    ds_read_b64_tr_b16 a[84:85], v101 offset:32768
    v_mfma_f32_16x16x32_bf16 v[84:87], a[20:23], a[196:199], v[84:87]
    ds_read_b64_tr_b16 a[86:87], v101 offset:36864
    v_mfma_f32_16x16x32_bf16 v[56:59], a[24:27], a[192:195], v[56:59]
    ds_read_b64_tr_b16 a[88:89], v102 offset:32768
    buffer_load_dwordx4 v19, s[8:11], s25 offen offset:3072 lds
    v_mfma_f32_16x16x32_bf16 v[88:91], a[24:27], a[196:199], v[88:91]
    ds_read_b64_tr_b16 a[90:91], v102 offset:36864
    s_mov_b32 s26, 38912
    v_mfma_f32_16x16x32_bf16 v[60:63], a[28:31], a[192:195], v[60:63]
    ds_read_b64_tr_b16 a[92:93], v103 offset:32768
    v_mfma_f32_16x16x32_bf16 v[92:95], a[28:31], a[196:199], v[92:95]
    ds_read_b64_tr_b16 a[94:95], v103 offset:36864
    buffer_load_dwordx4 a[144:147], v20, s[12:15], s26 offen offset:0 sc1
    v_mfma_f32_16x16x32_bf16 v[32:35], a[32:35], a[200:203], v[32:35]
    ds_read_b64_tr_b16 a[96:97], v96 offset:40960
    v_mfma_f32_16x16x32_bf16 v[64:67], a[32:35], a[204:207], v[64:67]
    ds_read_b64_tr_b16 a[98:99], v96 offset:45056
    v_mfma_f32_16x16x32_bf16 v[36:39], a[36:39], a[200:203], v[36:39]
    ds_read_b64_tr_b16 a[100:101], v97 offset:40960
    buffer_load_dwordx4 a[148:151], v21, s[12:15], s26 offen offset:0 sc1
    v_mfma_f32_16x16x32_bf16 v[68:71], a[36:39], a[204:207], v[68:71]
    ds_read_b64_tr_b16 a[102:103], v97 offset:45056
    v_mfma_f32_16x16x32_bf16 v[40:43], a[40:43], a[200:203], v[40:43]
    ds_read_b64_tr_b16 a[104:105], v98 offset:40960
    v_mfma_f32_16x16x32_bf16 v[72:75], a[40:43], a[204:207], v[72:75]
    ds_read_b64_tr_b16 a[106:107], v98 offset:45056
    buffer_load_dwordx4 a[152:155], v20, s[12:15], s26 offen offset:1024 sc1
    v_mfma_f32_16x16x32_bf16 v[44:47], a[44:47], a[200:203], v[44:47]
    ds_read_b64_tr_b16 a[108:109], v99 offset:40960
    v_mfma_f32_16x16x32_bf16 v[76:79], a[44:47], a[204:207], v[76:79]
    ds_read_b64_tr_b16 a[110:111], v99 offset:45056
    v_mfma_f32_16x16x32_bf16 v[48:51], a[48:51], a[200:203], v[48:51]
    ds_read_b64_tr_b16 a[112:113], v100 offset:40960
    buffer_load_dwordx4 a[156:159], v21, s[12:15], s26 offen offset:1024 sc1
    v_mfma_f32_16x16x32_bf16 v[80:83], a[48:51], a[204:207], v[80:83]
    ds_read_b64_tr_b16 a[114:115], v100 offset:45056
    v_mfma_f32_16x16x32_bf16 v[52:55], a[52:55], a[200:203], v[52:55]
    ds_read_b64_tr_b16 a[116:117], v101 offset:40960
    v_mfma_f32_16x16x32_bf16 v[84:87], a[52:55], a[204:207], v[84:87]
    ds_read_b64_tr_b16 a[118:119], v101 offset:45056
    v_mfma_f32_16x16x32_bf16 v[56:59], a[56:59], a[200:203], v[56:59]
    ds_read_b64_tr_b16 a[120:121], v102 offset:40960
    v_mfma_f32_16x16x32_bf16 v[88:91], a[56:59], a[204:207], v[88:91]
    ds_read_b64_tr_b16 a[122:123], v102 offset:45056
    v_mfma_f32_16x16x32_bf16 v[60:63], a[60:63], a[200:203], v[60:63]
    ds_read_b64_tr_b16 a[124:125], v103 offset:40960
    v_mfma_f32_16x16x32_bf16 v[92:95], a[60:63], a[204:207], v[92:95]
    ds_read_b64_tr_b16 a[126:127], v103 offset:45056
    s_waitcnt vmcnt(32) lgkmcnt(0)
    s_barrier
    v_mfma_f32_16x16x32_bf16 v[32:35], a[64:67], a[208:211], v[32:35]
    ds_read_b64_tr_b16 a[0:1], v8 offset:49152
    s_add_u32 m0, s24, 98304
    v_mfma_f32_16x16x32_bf16 v[64:67], a[64:67], a[212:215], v[64:67]
    ds_read_b64_tr_b16 a[2:3], v8 offset:53248
    s_mov_b32 s25, 1703936
    v_mfma_f32_16x16x32_bf16 v[36:39], a[68:71], a[208:211], v[36:39]
    ds_read_b64_tr_b16 a[4:5], v9 offset:49152
    v_mfma_f32_16x16x32_bf16 v[68:71], a[68:71], a[212:215], v[68:71]
    ds_read_b64_tr_b16 a[6:7], v9 offset:53248
    buffer_load_dwordx4 v16, s[8:11], s25 offen offset:0 lds
    v_mfma_f32_16x16x32_bf16 v[40:43], a[72:75], a[208:211], v[40:43]
    ds_read_b64_tr_b16 a[8:9], v10 offset:49152
    v_mfma_f32_16x16x32_bf16 v[72:75], a[72:75], a[212:215], v[72:75]
    ds_read_b64_tr_b16 a[10:11], v10 offset:53248
    v_mfma_f32_16x16x32_bf16 v[44:47], a[76:79], a[208:211], v[44:47]
    ds_read_b64_tr_b16 a[12:13], v11 offset:49152
    buffer_load_dwordx4 v17, s[8:11], s25 offen offset:1024 lds
    v_mfma_f32_16x16x32_bf16 v[76:79], a[76:79], a[212:215], v[76:79]
    ds_read_b64_tr_b16 a[14:15], v11 offset:53248
    v_mfma_f32_16x16x32_bf16 v[48:51], a[80:83], a[208:211], v[48:51]
    ds_read_b64_tr_b16 a[16:17], v12 offset:49152
    v_mfma_f32_16x16x32_bf16 v[80:83], a[80:83], a[212:215], v[80:83]
    ds_read_b64_tr_b16 a[18:19], v12 offset:53248
    buffer_load_dwordx4 v18, s[8:11], s25 offen offset:2048 lds
    v_mfma_f32_16x16x32_bf16 v[52:55], a[84:87], a[208:211], v[52:55]
    ds_read_b64_tr_b16 a[20:21], v13 offset:49152
    v_mfma_f32_16x16x32_bf16 v[84:87], a[84:87], a[212:215], v[84:87]
    ds_read_b64_tr_b16 a[22:23], v13 offset:53248
    v_mfma_f32_16x16x32_bf16 v[56:59], a[88:91], a[208:211], v[56:59]
    ds_read_b64_tr_b16 a[24:25], v14 offset:49152
    buffer_load_dwordx4 v19, s[8:11], s25 offen offset:3072 lds
    v_mfma_f32_16x16x32_bf16 v[88:91], a[88:91], a[212:215], v[88:91]
    ds_read_b64_tr_b16 a[26:27], v14 offset:53248
    s_mov_b32 s26, 45056
    v_mfma_f32_16x16x32_bf16 v[60:63], a[92:95], a[208:211], v[60:63]
    ds_read_b64_tr_b16 a[28:29], v15 offset:49152
    v_mfma_f32_16x16x32_bf16 v[92:95], a[92:95], a[212:215], v[92:95]
    ds_read_b64_tr_b16 a[30:31], v15 offset:53248
    buffer_load_dwordx4 a[160:163], v20, s[12:15], s26 offen offset:0 sc1
    v_mfma_f32_16x16x32_bf16 v[32:35], a[96:99], a[216:219], v[32:35]
    ds_read_b64_tr_b16 a[32:33], v8 offset:57344
    v_mfma_f32_16x16x32_bf16 v[64:67], a[96:99], a[220:223], v[64:67]
    ds_read_b64_tr_b16 a[34:35], v8 offset:61440
    v_mfma_f32_16x16x32_bf16 v[36:39], a[100:103], a[216:219], v[36:39]
    ds_read_b64_tr_b16 a[36:37], v9 offset:57344
    buffer_load_dwordx4 a[164:167], v21, s[12:15], s26 offen offset:0 sc1
    v_mfma_f32_16x16x32_bf16 v[68:71], a[100:103], a[220:223], v[68:71]
    ds_read_b64_tr_b16 a[38:39], v9 offset:61440
    v_mfma_f32_16x16x32_bf16 v[40:43], a[104:107], a[216:219], v[40:43]
    ds_read_b64_tr_b16 a[40:41], v10 offset:57344
    v_mfma_f32_16x16x32_bf16 v[72:75], a[104:107], a[220:223], v[72:75]
    ds_read_b64_tr_b16 a[42:43], v10 offset:61440
    buffer_load_dwordx4 a[168:171], v20, s[12:15], s26 offen offset:1024 sc1
    v_mfma_f32_16x16x32_bf16 v[44:47], a[108:111], a[216:219], v[44:47]
    ds_read_b64_tr_b16 a[44:45], v11 offset:57344
    v_mfma_f32_16x16x32_bf16 v[76:79], a[108:111], a[220:223], v[76:79]
    ds_read_b64_tr_b16 a[46:47], v11 offset:61440
    v_mfma_f32_16x16x32_bf16 v[48:51], a[112:115], a[216:219], v[48:51]
    ds_read_b64_tr_b16 a[48:49], v12 offset:57344
    buffer_load_dwordx4 a[172:175], v21, s[12:15], s26 offen offset:1024 sc1
    v_mfma_f32_16x16x32_bf16 v[80:83], a[112:115], a[220:223], v[80:83]
    ds_read_b64_tr_b16 a[50:51], v12 offset:61440
    v_mfma_f32_16x16x32_bf16 v[52:55], a[116:119], a[216:219], v[52:55]
    ds_read_b64_tr_b16 a[52:53], v13 offset:57344
    v_mfma_f32_16x16x32_bf16 v[84:87], a[116:119], a[220:223], v[84:87]
    ds_read_b64_tr_b16 a[54:55], v13 offset:61440
    v_mfma_f32_16x16x32_bf16 v[56:59], a[120:123], a[216:219], v[56:59]
    ds_read_b64_tr_b16 a[56:57], v14 offset:57344
    v_mfma_f32_16x16x32_bf16 v[88:91], a[120:123], a[220:223], v[88:91]
    ds_read_b64_tr_b16 a[58:59], v14 offset:61440
    v_mfma_f32_16x16x32_bf16 v[60:63], a[124:127], a[216:219], v[60:63]
    ds_read_b64_tr_b16 a[60:61], v15 offset:57344
    v_mfma_f32_16x16x32_bf16 v[92:95], a[124:127], a[220:223], v[92:95]
    ds_read_b64_tr_b16 a[62:63], v15 offset:61440
    s_waitcnt vmcnt(32) lgkmcnt(0)
    v_mfma_f32_16x16x32_bf16 v[32:35], a[0:3], a[224:227], v[32:35]
    ds_read_b64_tr_b16 a[64:65], v96 offset:49152
    s_add_u32 m0, s24, 32768
    v_mfma_f32_16x16x32_bf16 v[64:67], a[0:3], a[228:231], v[64:67]
    ds_read_b64_tr_b16 a[66:67], v96 offset:53248
    s_mov_b32 s25, 1769472
    v_mfma_f32_16x16x32_bf16 v[36:39], a[4:7], a[224:227], v[36:39]
    ds_read_b64_tr_b16 a[68:69], v97 offset:49152
    v_mfma_f32_16x16x32_bf16 v[68:71], a[4:7], a[228:231], v[68:71]
    ds_read_b64_tr_b16 a[70:71], v97 offset:53248
    buffer_load_dwordx4 v16, s[8:11], s25 offen offset:0 lds
    v_mfma_f32_16x16x32_bf16 v[40:43], a[8:11], a[224:227], v[40:43]
    ds_read_b64_tr_b16 a[72:73], v98 offset:49152
    v_mfma_f32_16x16x32_bf16 v[72:75], a[8:11], a[228:231], v[72:75]
    ds_read_b64_tr_b16 a[74:75], v98 offset:53248
    v_mfma_f32_16x16x32_bf16 v[44:47], a[12:15], a[224:227], v[44:47]
    ds_read_b64_tr_b16 a[76:77], v99 offset:49152
    buffer_load_dwordx4 v17, s[8:11], s25 offen offset:1024 lds
    v_mfma_f32_16x16x32_bf16 v[76:79], a[12:15], a[228:231], v[76:79]
    ds_read_b64_tr_b16 a[78:79], v99 offset:53248
    v_mfma_f32_16x16x32_bf16 v[48:51], a[16:19], a[224:227], v[48:51]
    ds_read_b64_tr_b16 a[80:81], v100 offset:49152
    v_mfma_f32_16x16x32_bf16 v[80:83], a[16:19], a[228:231], v[80:83]
    ds_read_b64_tr_b16 a[82:83], v100 offset:53248
    buffer_load_dwordx4 v18, s[8:11], s25 offen offset:2048 lds
    v_mfma_f32_16x16x32_bf16 v[52:55], a[20:23], a[224:227], v[52:55]
    ds_read_b64_tr_b16 a[84:85], v101 offset:49152
    v_mfma_f32_16x16x32_bf16 v[84:87], a[20:23], a[228:231], v[84:87]
    ds_read_b64_tr_b16 a[86:87], v101 offset:53248
    v_mfma_f32_16x16x32_bf16 v[56:59], a[24:27], a[224:227], v[56:59]
    ds_read_b64_tr_b16 a[88:89], v102 offset:49152
    buffer_load_dwordx4 v19, s[8:11], s25 offen offset:3072 lds
    v_mfma_f32_16x16x32_bf16 v[88:91], a[24:27], a[228:231], v[88:91]
    ds_read_b64_tr_b16 a[90:91], v102 offset:53248
    s_mov_b32 s26, 47104
    v_mfma_f32_16x16x32_bf16 v[60:63], a[28:31], a[224:227], v[60:63]
    ds_read_b64_tr_b16 a[92:93], v103 offset:49152
    v_mfma_f32_16x16x32_bf16 v[92:95], a[28:31], a[228:231], v[92:95]
    ds_read_b64_tr_b16 a[94:95], v103 offset:53248
    buffer_load_dwordx4 a[176:179], v20, s[12:15], s26 offen offset:0 sc1
    v_mfma_f32_16x16x32_bf16 v[32:35], a[32:35], a[232:235], v[32:35]
    ds_read_b64_tr_b16 a[96:97], v96 offset:57344
    v_mfma_f32_16x16x32_bf16 v[64:67], a[32:35], a[236:239], v[64:67]
    ds_read_b64_tr_b16 a[98:99], v96 offset:61440
    v_mfma_f32_16x16x32_bf16 v[36:39], a[36:39], a[232:235], v[36:39]
    ds_read_b64_tr_b16 a[100:101], v97 offset:57344
    buffer_load_dwordx4 a[180:183], v21, s[12:15], s26 offen offset:0 sc1
    v_mfma_f32_16x16x32_bf16 v[68:71], a[36:39], a[236:239], v[68:71]
    ds_read_b64_tr_b16 a[102:103], v97 offset:61440
    v_mfma_f32_16x16x32_bf16 v[40:43], a[40:43], a[232:235], v[40:43]
    ds_read_b64_tr_b16 a[104:105], v98 offset:57344
    v_mfma_f32_16x16x32_bf16 v[72:75], a[40:43], a[236:239], v[72:75]
    ds_read_b64_tr_b16 a[106:107], v98 offset:61440
    buffer_load_dwordx4 a[184:187], v20, s[12:15], s26 offen offset:1024 sc1
    v_mfma_f32_16x16x32_bf16 v[44:47], a[44:47], a[232:235], v[44:47]
    ds_read_b64_tr_b16 a[108:109], v99 offset:57344
    v_mfma_f32_16x16x32_bf16 v[76:79], a[44:47], a[236:239], v[76:79]
    ds_read_b64_tr_b16 a[110:111], v99 offset:61440
    v_mfma_f32_16x16x32_bf16 v[48:51], a[48:51], a[232:235], v[48:51]
    ds_read_b64_tr_b16 a[112:113], v100 offset:57344
    buffer_load_dwordx4 a[188:191], v21, s[12:15], s26 offen offset:1024 sc1
    v_mfma_f32_16x16x32_bf16 v[80:83], a[48:51], a[236:239], v[80:83]
    ds_read_b64_tr_b16 a[114:115], v100 offset:61440
    v_mfma_f32_16x16x32_bf16 v[52:55], a[52:55], a[232:235], v[52:55]
    ds_read_b64_tr_b16 a[116:117], v101 offset:57344
    v_mfma_f32_16x16x32_bf16 v[84:87], a[52:55], a[236:239], v[84:87]
    ds_read_b64_tr_b16 a[118:119], v101 offset:61440
    v_mfma_f32_16x16x32_bf16 v[56:59], a[56:59], a[232:235], v[56:59]
    ds_read_b64_tr_b16 a[120:121], v102 offset:57344
    v_mfma_f32_16x16x32_bf16 v[88:91], a[56:59], a[236:239], v[88:91]
    ds_read_b64_tr_b16 a[122:123], v102 offset:61440
    v_mfma_f32_16x16x32_bf16 v[60:63], a[60:63], a[232:235], v[60:63]
    ds_read_b64_tr_b16 a[124:125], v103 offset:57344
    v_mfma_f32_16x16x32_bf16 v[92:95], a[60:63], a[236:239], v[92:95]
    ds_read_b64_tr_b16 a[126:127], v103 offset:61440
    s_waitcnt vmcnt(32) lgkmcnt(0)
    s_barrier
    v_mfma_f32_16x16x32_bf16 v[32:35], a[64:67], a[240:243], v[32:35]
    ds_read_b64_tr_b16 a[0:1], v8 offset:0
    s_add_u32 m0, s24, 114688
    v_mfma_f32_16x16x32_bf16 v[64:67], a[64:67], a[244:247], v[64:67]
    ds_read_b64_tr_b16 a[2:3], v8 offset:4096
    s_mov_b32 s25, 1966080
    v_mfma_f32_16x16x32_bf16 v[36:39], a[68:71], a[240:243], v[36:39]
    ds_read_b64_tr_b16 a[4:5], v9 offset:0
    v_mfma_f32_16x16x32_bf16 v[68:71], a[68:71], a[244:247], v[68:71]
    ds_read_b64_tr_b16 a[6:7], v9 offset:4096
    buffer_load_dwordx4 v16, s[8:11], s25 offen offset:0 lds
    v_mfma_f32_16x16x32_bf16 v[40:43], a[72:75], a[240:243], v[40:43]
    ds_read_b64_tr_b16 a[8:9], v10 offset:0
    v_mfma_f32_16x16x32_bf16 v[72:75], a[72:75], a[244:247], v[72:75]
    ds_read_b64_tr_b16 a[10:11], v10 offset:4096
    v_mfma_f32_16x16x32_bf16 v[44:47], a[76:79], a[240:243], v[44:47]
    ds_read_b64_tr_b16 a[12:13], v11 offset:0
    buffer_load_dwordx4 v17, s[8:11], s25 offen offset:1024 lds
    v_mfma_f32_16x16x32_bf16 v[76:79], a[76:79], a[244:247], v[76:79]
    ds_read_b64_tr_b16 a[14:15], v11 offset:4096
    v_mfma_f32_16x16x32_bf16 v[48:51], a[80:83], a[240:243], v[48:51]
    ds_read_b64_tr_b16 a[16:17], v12 offset:0
    v_mfma_f32_16x16x32_bf16 v[80:83], a[80:83], a[244:247], v[80:83]
    ds_read_b64_tr_b16 a[18:19], v12 offset:4096
    buffer_load_dwordx4 v18, s[8:11], s25 offen offset:2048 lds
    v_mfma_f32_16x16x32_bf16 v[52:55], a[84:87], a[240:243], v[52:55]
    ds_read_b64_tr_b16 a[20:21], v13 offset:0
    v_mfma_f32_16x16x32_bf16 v[84:87], a[84:87], a[244:247], v[84:87]
    ds_read_b64_tr_b16 a[22:23], v13 offset:4096
    v_mfma_f32_16x16x32_bf16 v[56:59], a[88:91], a[240:243], v[56:59]
    ds_read_b64_tr_b16 a[24:25], v14 offset:0
    buffer_load_dwordx4 v19, s[8:11], s25 offen offset:3072 lds
    v_mfma_f32_16x16x32_bf16 v[88:91], a[88:91], a[244:247], v[88:91]
    ds_read_b64_tr_b16 a[26:27], v14 offset:4096
    s_mov_b32 s26, 53248
    v_mfma_f32_16x16x32_bf16 v[60:63], a[92:95], a[240:243], v[60:63]
    ds_read_b64_tr_b16 a[28:29], v15 offset:0
    v_mfma_f32_16x16x32_bf16 v[92:95], a[92:95], a[244:247], v[92:95]
    ds_read_b64_tr_b16 a[30:31], v15 offset:4096
    buffer_load_dwordx4 a[192:195], v20, s[12:15], s26 offen offset:0 sc1
    v_mfma_f32_16x16x32_bf16 v[32:35], a[96:99], a[248:251], v[32:35]
    ds_read_b64_tr_b16 a[32:33], v8 offset:8192
    v_mfma_f32_16x16x32_bf16 v[64:67], a[96:99], a[252:255], v[64:67]
    ds_read_b64_tr_b16 a[34:35], v8 offset:12288
    v_mfma_f32_16x16x32_bf16 v[36:39], a[100:103], a[248:251], v[36:39]
    ds_read_b64_tr_b16 a[36:37], v9 offset:8192
    buffer_load_dwordx4 a[196:199], v21, s[12:15], s26 offen offset:0 sc1
    v_mfma_f32_16x16x32_bf16 v[68:71], a[100:103], a[252:255], v[68:71]
    ds_read_b64_tr_b16 a[38:39], v9 offset:12288
    v_mfma_f32_16x16x32_bf16 v[40:43], a[104:107], a[248:251], v[40:43]
    ds_read_b64_tr_b16 a[40:41], v10 offset:8192
    v_mfma_f32_16x16x32_bf16 v[72:75], a[104:107], a[252:255], v[72:75]
    ds_read_b64_tr_b16 a[42:43], v10 offset:12288
    buffer_load_dwordx4 a[200:203], v20, s[12:15], s26 offen offset:1024 sc1
    v_mfma_f32_16x16x32_bf16 v[44:47], a[108:111], a[248:251], v[44:47]
    ds_read_b64_tr_b16 a[44:45], v11 offset:8192
    v_mfma_f32_16x16x32_bf16 v[76:79], a[108:111], a[252:255], v[76:79]
    ds_read_b64_tr_b16 a[46:47], v11 offset:12288
    v_mfma_f32_16x16x32_bf16 v[48:51], a[112:115], a[248:251], v[48:51]
    ds_read_b64_tr_b16 a[48:49], v12 offset:8192
    buffer_load_dwordx4 a[204:207], v21, s[12:15], s26 offen offset:1024 sc1
    v_mfma_f32_16x16x32_bf16 v[80:83], a[112:115], a[252:255], v[80:83]
    ds_read_b64_tr_b16 a[50:51], v12 offset:12288
    v_mfma_f32_16x16x32_bf16 v[52:55], a[116:119], a[248:251], v[52:55]
    ds_read_b64_tr_b16 a[52:53], v13 offset:8192
    v_mfma_f32_16x16x32_bf16 v[84:87], a[116:119], a[252:255], v[84:87]
    ds_read_b64_tr_b16 a[54:55], v13 offset:12288
    v_mfma_f32_16x16x32_bf16 v[56:59], a[120:123], a[248:251], v[56:59]
    ds_read_b64_tr_b16 a[56:57], v14 offset:8192
    v_mfma_f32_16x16x32_bf16 v[88:91], a[120:123], a[252:255], v[88:91]
    ds_read_b64_tr_b16 a[58:59], v14 offset:12288
    v_mfma_f32_16x16x32_bf16 v[60:63], a[124:127], a[248:251], v[60:63]
    ds_read_b64_tr_b16 a[60:61], v15 offset:8192
    v_mfma_f32_16x16x32_bf16 v[92:95], a[124:127], a[252:255], v[92:95]
    ds_read_b64_tr_b16 a[62:63], v15 offset:12288
    s_waitcnt vmcnt(32) lgkmcnt(0)
    v_mfma_f32_16x16x32_bf16 v[32:35], a[0:3], a[128:131], v[32:35]
    ds_read_b64_tr_b16 a[64:65], v96 offset:0
    s_add_u32 m0, s24, 49152
    v_mfma_f32_16x16x32_bf16 v[64:67], a[0:3], a[132:135], v[64:67]
    ds_read_b64_tr_b16 a[66:67], v96 offset:4096
    s_mov_b32 s25, 2031616
    v_mfma_f32_16x16x32_bf16 v[36:39], a[4:7], a[128:131], v[36:39]
    ds_read_b64_tr_b16 a[68:69], v97 offset:0
    v_mfma_f32_16x16x32_bf16 v[68:71], a[4:7], a[132:135], v[68:71]
    ds_read_b64_tr_b16 a[70:71], v97 offset:4096
    buffer_load_dwordx4 v16, s[8:11], s25 offen offset:0 lds
    v_mfma_f32_16x16x32_bf16 v[40:43], a[8:11], a[128:131], v[40:43]
    ds_read_b64_tr_b16 a[72:73], v98 offset:0
    v_mfma_f32_16x16x32_bf16 v[72:75], a[8:11], a[132:135], v[72:75]
    ds_read_b64_tr_b16 a[74:75], v98 offset:4096
    v_mfma_f32_16x16x32_bf16 v[44:47], a[12:15], a[128:131], v[44:47]
    ds_read_b64_tr_b16 a[76:77], v99 offset:0
    buffer_load_dwordx4 v17, s[8:11], s25 offen offset:1024 lds
    v_mfma_f32_16x16x32_bf16 v[76:79], a[12:15], a[132:135], v[76:79]
    ds_read_b64_tr_b16 a[78:79], v99 offset:4096
    v_mfma_f32_16x16x32_bf16 v[48:51], a[16:19], a[128:131], v[48:51]
    ds_read_b64_tr_b16 a[80:81], v100 offset:0
    v_mfma_f32_16x16x32_bf16 v[80:83], a[16:19], a[132:135], v[80:83]
    ds_read_b64_tr_b16 a[82:83], v100 offset:4096
    buffer_load_dwordx4 v18, s[8:11], s25 offen offset:2048 lds
    v_mfma_f32_16x16x32_bf16 v[52:55], a[20:23], a[128:131], v[52:55]
    ds_read_b64_tr_b16 a[84:85], v101 offset:0
    v_mfma_f32_16x16x32_bf16 v[84:87], a[20:23], a[132:135], v[84:87]
    ds_read_b64_tr_b16 a[86:87], v101 offset:4096
    v_mfma_f32_16x16x32_bf16 v[56:59], a[24:27], a[128:131], v[56:59]
    ds_read_b64_tr_b16 a[88:89], v102 offset:0
    buffer_load_dwordx4 v19, s[8:11], s25 offen offset:3072 lds
    v_mfma_f32_16x16x32_bf16 v[88:91], a[24:27], a[132:135], v[88:91]
    ds_read_b64_tr_b16 a[90:91], v102 offset:4096
    s_mov_b32 s26, 55296
    v_mfma_f32_16x16x32_bf16 v[60:63], a[28:31], a[128:131], v[60:63]
    ds_read_b64_tr_b16 a[92:93], v103 offset:0
    v_mfma_f32_16x16x32_bf16 v[92:95], a[28:31], a[132:135], v[92:95]
    ds_read_b64_tr_b16 a[94:95], v103 offset:4096
    buffer_load_dwordx4 a[208:211], v20, s[12:15], s26 offen offset:0 sc1
    v_mfma_f32_16x16x32_bf16 v[32:35], a[32:35], a[136:139], v[32:35]
    ds_read_b64_tr_b16 a[96:97], v96 offset:8192
    v_mfma_f32_16x16x32_bf16 v[64:67], a[32:35], a[140:143], v[64:67]
    ds_read_b64_tr_b16 a[98:99], v96 offset:12288
    v_mfma_f32_16x16x32_bf16 v[36:39], a[36:39], a[136:139], v[36:39]
    ds_read_b64_tr_b16 a[100:101], v97 offset:8192
    buffer_load_dwordx4 a[212:215], v21, s[12:15], s26 offen offset:0 sc1
    v_mfma_f32_16x16x32_bf16 v[68:71], a[36:39], a[140:143], v[68:71]
    ds_read_b64_tr_b16 a[102:103], v97 offset:12288
    v_mfma_f32_16x16x32_bf16 v[40:43], a[40:43], a[136:139], v[40:43]
    ds_read_b64_tr_b16 a[104:105], v98 offset:8192
    v_mfma_f32_16x16x32_bf16 v[72:75], a[40:43], a[140:143], v[72:75]
    ds_read_b64_tr_b16 a[106:107], v98 offset:12288
    buffer_load_dwordx4 a[216:219], v20, s[12:15], s26 offen offset:1024 sc1
    v_mfma_f32_16x16x32_bf16 v[44:47], a[44:47], a[136:139], v[44:47]
    ds_read_b64_tr_b16 a[108:109], v99 offset:8192
    v_mfma_f32_16x16x32_bf16 v[76:79], a[44:47], a[140:143], v[76:79]
    ds_read_b64_tr_b16 a[110:111], v99 offset:12288
    v_mfma_f32_16x16x32_bf16 v[48:51], a[48:51], a[136:139], v[48:51]
    ds_read_b64_tr_b16 a[112:113], v100 offset:8192
    buffer_load_dwordx4 a[220:223], v21, s[12:15], s26 offen offset:1024 sc1
    v_mfma_f32_16x16x32_bf16 v[80:83], a[48:51], a[140:143], v[80:83]
    ds_read_b64_tr_b16 a[114:115], v100 offset:12288
    v_mfma_f32_16x16x32_bf16 v[52:55], a[52:55], a[136:139], v[52:55]
    ds_read_b64_tr_b16 a[116:117], v101 offset:8192
    v_mfma_f32_16x16x32_bf16 v[84:87], a[52:55], a[140:143], v[84:87]
    ds_read_b64_tr_b16 a[118:119], v101 offset:12288
    v_mfma_f32_16x16x32_bf16 v[56:59], a[56:59], a[136:139], v[56:59]
    ds_read_b64_tr_b16 a[120:121], v102 offset:8192
    v_mfma_f32_16x16x32_bf16 v[88:91], a[56:59], a[140:143], v[88:91]
    ds_read_b64_tr_b16 a[122:123], v102 offset:12288
    v_mfma_f32_16x16x32_bf16 v[60:63], a[60:63], a[136:139], v[60:63]
    ds_read_b64_tr_b16 a[124:125], v103 offset:8192
    v_mfma_f32_16x16x32_bf16 v[92:95], a[60:63], a[140:143], v[92:95]
    ds_read_b64_tr_b16 a[126:127], v103 offset:12288
    s_waitcnt vmcnt(32) lgkmcnt(0)
    s_barrier
    v_mfma_f32_16x16x32_bf16 v[32:35], a[64:67], a[144:147], v[32:35]
    ds_read_b64_tr_b16 a[0:1], v8 offset:16384
    s_mov_b32 s26, 61440
    v_mfma_f32_16x16x32_bf16 v[64:67], a[64:67], a[148:151], v[64:67]
    ds_read_b64_tr_b16 a[2:3], v8 offset:20480
    v_mfma_f32_16x16x32_bf16 v[36:39], a[68:71], a[144:147], v[36:39]
    ds_read_b64_tr_b16 a[4:5], v9 offset:16384
    v_mfma_f32_16x16x32_bf16 v[68:71], a[68:71], a[148:151], v[68:71]
    ds_read_b64_tr_b16 a[6:7], v9 offset:20480
    buffer_load_dwordx4 a[224:227], v20, s[12:15], s26 offen offset:0 sc1
    v_mfma_f32_16x16x32_bf16 v[40:43], a[72:75], a[144:147], v[40:43]
    ds_read_b64_tr_b16 a[8:9], v10 offset:16384
    v_mfma_f32_16x16x32_bf16 v[72:75], a[72:75], a[148:151], v[72:75]
    ds_read_b64_tr_b16 a[10:11], v10 offset:20480
    v_mfma_f32_16x16x32_bf16 v[44:47], a[76:79], a[144:147], v[44:47]
    ds_read_b64_tr_b16 a[12:13], v11 offset:16384
    buffer_load_dwordx4 a[228:231], v21, s[12:15], s26 offen offset:0 sc1
    v_mfma_f32_16x16x32_bf16 v[76:79], a[76:79], a[148:151], v[76:79]
    ds_read_b64_tr_b16 a[14:15], v11 offset:20480
    v_mfma_f32_16x16x32_bf16 v[48:51], a[80:83], a[144:147], v[48:51]
    ds_read_b64_tr_b16 a[16:17], v12 offset:16384
    v_mfma_f32_16x16x32_bf16 v[80:83], a[80:83], a[148:151], v[80:83]
    ds_read_b64_tr_b16 a[18:19], v12 offset:20480
    buffer_load_dwordx4 a[232:235], v20, s[12:15], s26 offen offset:1024 sc1
    v_mfma_f32_16x16x32_bf16 v[52:55], a[84:87], a[144:147], v[52:55]
    ds_read_b64_tr_b16 a[20:21], v13 offset:16384
    v_mfma_f32_16x16x32_bf16 v[84:87], a[84:87], a[148:151], v[84:87]
    ds_read_b64_tr_b16 a[22:23], v13 offset:20480
    v_mfma_f32_16x16x32_bf16 v[56:59], a[88:91], a[144:147], v[56:59]
    ds_read_b64_tr_b16 a[24:25], v14 offset:16384
    buffer_load_dwordx4 a[236:239], v21, s[12:15], s26 offen offset:1024 sc1
    v_mfma_f32_16x16x32_bf16 v[88:91], a[88:91], a[148:151], v[88:91]
    ds_read_b64_tr_b16 a[26:27], v14 offset:20480
    v_mfma_f32_16x16x32_bf16 v[60:63], a[92:95], a[144:147], v[60:63]
    ds_read_b64_tr_b16 a[28:29], v15 offset:16384
    v_mfma_f32_16x16x32_bf16 v[92:95], a[92:95], a[148:151], v[92:95]
    ds_read_b64_tr_b16 a[30:31], v15 offset:20480
    v_mfma_f32_16x16x32_bf16 v[32:35], a[96:99], a[152:155], v[32:35]
    ds_read_b64_tr_b16 a[32:33], v8 offset:24576
    v_mfma_f32_16x16x32_bf16 v[64:67], a[96:99], a[156:159], v[64:67]
    ds_read_b64_tr_b16 a[34:35], v8 offset:28672
    v_mfma_f32_16x16x32_bf16 v[36:39], a[100:103], a[152:155], v[36:39]
    ds_read_b64_tr_b16 a[36:37], v9 offset:24576
    v_mfma_f32_16x16x32_bf16 v[68:71], a[100:103], a[156:159], v[68:71]
    ds_read_b64_tr_b16 a[38:39], v9 offset:28672
    v_mfma_f32_16x16x32_bf16 v[40:43], a[104:107], a[152:155], v[40:43]
    ds_read_b64_tr_b16 a[40:41], v10 offset:24576
    v_mfma_f32_16x16x32_bf16 v[72:75], a[104:107], a[156:159], v[72:75]
    ds_read_b64_tr_b16 a[42:43], v10 offset:28672
    v_mfma_f32_16x16x32_bf16 v[44:47], a[108:111], a[152:155], v[44:47]
    ds_read_b64_tr_b16 a[44:45], v11 offset:24576
    v_mfma_f32_16x16x32_bf16 v[76:79], a[108:111], a[156:159], v[76:79]
    ds_read_b64_tr_b16 a[46:47], v11 offset:28672
    v_mfma_f32_16x16x32_bf16 v[48:51], a[112:115], a[152:155], v[48:51]
    ds_read_b64_tr_b16 a[48:49], v12 offset:24576
    v_mfma_f32_16x16x32_bf16 v[80:83], a[112:115], a[156:159], v[80:83]
    ds_read_b64_tr_b16 a[50:51], v12 offset:28672
    v_mfma_f32_16x16x32_bf16 v[52:55], a[116:119], a[152:155], v[52:55]
    ds_read_b64_tr_b16 a[52:53], v13 offset:24576
    v_mfma_f32_16x16x32_bf16 v[84:87], a[116:119], a[156:159], v[84:87]
    ds_read_b64_tr_b16 a[54:55], v13 offset:28672
    v_mfma_f32_16x16x32_bf16 v[56:59], a[120:123], a[152:155], v[56:59]
    ds_read_b64_tr_b16 a[56:57], v14 offset:24576
    v_mfma_f32_16x16x32_bf16 v[88:91], a[120:123], a[156:159], v[88:91]
    ds_read_b64_tr_b16 a[58:59], v14 offset:28672
    v_mfma_f32_16x16x32_bf16 v[60:63], a[124:127], a[152:155], v[60:63]
    ds_read_b64_tr_b16 a[60:61], v15 offset:24576
    v_mfma_f32_16x16x32_bf16 v[92:95], a[124:127], a[156:159], v[92:95]
    ds_read_b64_tr_b16 a[62:63], v15 offset:28672
    s_waitcnt vmcnt(28) lgkmcnt(0)
    v_mfma_f32_16x16x32_bf16 v[32:35], a[0:3], a[160:163], v[32:35]
    ds_read_b64_tr_b16 a[64:65], v96 offset:16384
    s_mov_b32 s26, 63488
    v_mfma_f32_16x16x32_bf16 v[64:67], a[0:3], a[164:167], v[64:67]
    ds_read_b64_tr_b16 a[66:67], v96 offset:20480
    v_mfma_f32_16x16x32_bf16 v[36:39], a[4:7], a[160:163], v[36:39]
    ds_read_b64_tr_b16 a[68:69], v97 offset:16384
    v_mfma_f32_16x16x32_bf16 v[68:71], a[4:7], a[164:167], v[68:71]
    ds_read_b64_tr_b16 a[70:71], v97 offset:20480
    buffer_load_dwordx4 a[240:243], v20, s[12:15], s26 offen offset:0 sc1
    v_mfma_f32_16x16x32_bf16 v[40:43], a[8:11], a[160:163], v[40:43]
    ds_read_b64_tr_b16 a[72:73], v98 offset:16384
    v_mfma_f32_16x16x32_bf16 v[72:75], a[8:11], a[164:167], v[72:75]
    ds_read_b64_tr_b16 a[74:75], v98 offset:20480
    v_mfma_f32_16x16x32_bf16 v[44:47], a[12:15], a[160:163], v[44:47]
    ds_read_b64_tr_b16 a[76:77], v99 offset:16384
    buffer_load_dwordx4 a[244:247], v21, s[12:15], s26 offen offset:0 sc1
    v_mfma_f32_16x16x32_bf16 v[76:79], a[12:15], a[164:167], v[76:79]
    ds_read_b64_tr_b16 a[78:79], v99 offset:20480
    v_mfma_f32_16x16x32_bf16 v[48:51], a[16:19], a[160:163], v[48:51]
    ds_read_b64_tr_b16 a[80:81], v100 offset:16384
    v_mfma_f32_16x16x32_bf16 v[80:83], a[16:19], a[164:167], v[80:83]
    ds_read_b64_tr_b16 a[82:83], v100 offset:20480
    buffer_load_dwordx4 a[248:251], v20, s[12:15], s26 offen offset:1024 sc1
    v_mfma_f32_16x16x32_bf16 v[52:55], a[20:23], a[160:163], v[52:55]
    ds_read_b64_tr_b16 a[84:85], v101 offset:16384
    v_mfma_f32_16x16x32_bf16 v[84:87], a[20:23], a[164:167], v[84:87]
    ds_read_b64_tr_b16 a[86:87], v101 offset:20480
    v_mfma_f32_16x16x32_bf16 v[56:59], a[24:27], a[160:163], v[56:59]
    ds_read_b64_tr_b16 a[88:89], v102 offset:16384
    buffer_load_dwordx4 a[252:255], v21, s[12:15], s26 offen offset:1024 sc1
    v_mfma_f32_16x16x32_bf16 v[88:91], a[24:27], a[164:167], v[88:91]
    ds_read_b64_tr_b16 a[90:91], v102 offset:20480
    v_mfma_f32_16x16x32_bf16 v[60:63], a[28:31], a[160:163], v[60:63]
    ds_read_b64_tr_b16 a[92:93], v103 offset:16384
    v_mfma_f32_16x16x32_bf16 v[92:95], a[28:31], a[164:167], v[92:95]
    ds_read_b64_tr_b16 a[94:95], v103 offset:20480
    v_mfma_f32_16x16x32_bf16 v[32:35], a[32:35], a[168:171], v[32:35]
    ds_read_b64_tr_b16 a[96:97], v96 offset:24576
    v_mfma_f32_16x16x32_bf16 v[64:67], a[32:35], a[172:175], v[64:67]
    ds_read_b64_tr_b16 a[98:99], v96 offset:28672
    v_mfma_f32_16x16x32_bf16 v[36:39], a[36:39], a[168:171], v[36:39]
    ds_read_b64_tr_b16 a[100:101], v97 offset:24576
    v_mfma_f32_16x16x32_bf16 v[68:71], a[36:39], a[172:175], v[68:71]
    ds_read_b64_tr_b16 a[102:103], v97 offset:28672
    v_mfma_f32_16x16x32_bf16 v[40:43], a[40:43], a[168:171], v[40:43]
    ds_read_b64_tr_b16 a[104:105], v98 offset:24576
    v_mfma_f32_16x16x32_bf16 v[72:75], a[40:43], a[172:175], v[72:75]
    ds_read_b64_tr_b16 a[106:107], v98 offset:28672
    v_mfma_f32_16x16x32_bf16 v[44:47], a[44:47], a[168:171], v[44:47]
    ds_read_b64_tr_b16 a[108:109], v99 offset:24576
    v_mfma_f32_16x16x32_bf16 v[76:79], a[44:47], a[172:175], v[76:79]
    ds_read_b64_tr_b16 a[110:111], v99 offset:28672
    v_mfma_f32_16x16x32_bf16 v[48:51], a[48:51], a[168:171], v[48:51]
    ds_read_b64_tr_b16 a[112:113], v100 offset:24576
    v_mfma_f32_16x16x32_bf16 v[80:83], a[48:51], a[172:175], v[80:83]
    ds_read_b64_tr_b16 a[114:115], v100 offset:28672
    v_mfma_f32_16x16x32_bf16 v[52:55], a[52:55], a[168:171], v[52:55]
    ds_read_b64_tr_b16 a[116:117], v101 offset:24576
    v_mfma_f32_16x16x32_bf16 v[84:87], a[52:55], a[172:175], v[84:87]
    ds_read_b64_tr_b16 a[118:119], v101 offset:28672
    v_mfma_f32_16x16x32_bf16 v[56:59], a[56:59], a[168:171], v[56:59]
    ds_read_b64_tr_b16 a[120:121], v102 offset:24576
    v_mfma_f32_16x16x32_bf16 v[88:91], a[56:59], a[172:175], v[88:91]
    ds_read_b64_tr_b16 a[122:123], v102 offset:28672
    v_mfma_f32_16x16x32_bf16 v[60:63], a[60:63], a[168:171], v[60:63]
    ds_read_b64_tr_b16 a[124:125], v103 offset:24576
    v_mfma_f32_16x16x32_bf16 v[92:95], a[60:63], a[172:175], v[92:95]
    ds_read_b64_tr_b16 a[126:127], v103 offset:28672
    s_waitcnt vmcnt(24) lgkmcnt(0)
    s_barrier
    v_mfma_f32_16x16x32_bf16 v[32:35], a[64:67], a[176:179], v[32:35]
    ds_read_b64_tr_b16 a[0:1], v8 offset:32768
    v_mfma_f32_16x16x32_bf16 v[64:67], a[64:67], a[180:183], v[64:67]
    ds_read_b64_tr_b16 a[2:3], v8 offset:36864
    v_mfma_f32_16x16x32_bf16 v[36:39], a[68:71], a[176:179], v[36:39]
    ds_read_b64_tr_b16 a[4:5], v9 offset:32768
    v_mfma_f32_16x16x32_bf16 v[68:71], a[68:71], a[180:183], v[68:71]
    ds_read_b64_tr_b16 a[6:7], v9 offset:36864
    v_mfma_f32_16x16x32_bf16 v[40:43], a[72:75], a[176:179], v[40:43]
    ds_read_b64_tr_b16 a[8:9], v10 offset:32768
    v_mfma_f32_16x16x32_bf16 v[72:75], a[72:75], a[180:183], v[72:75]
    ds_read_b64_tr_b16 a[10:11], v10 offset:36864
    v_mfma_f32_16x16x32_bf16 v[44:47], a[76:79], a[176:179], v[44:47]
    ds_read_b64_tr_b16 a[12:13], v11 offset:32768
    v_mfma_f32_16x16x32_bf16 v[76:79], a[76:79], a[180:183], v[76:79]
    ds_read_b64_tr_b16 a[14:15], v11 offset:36864
    v_mfma_f32_16x16x32_bf16 v[48:51], a[80:83], a[176:179], v[48:51]
    ds_read_b64_tr_b16 a[16:17], v12 offset:32768
    v_mfma_f32_16x16x32_bf16 v[80:83], a[80:83], a[180:183], v[80:83]
    ds_read_b64_tr_b16 a[18:19], v12 offset:36864
    v_mfma_f32_16x16x32_bf16 v[52:55], a[84:87], a[176:179], v[52:55]
    ds_read_b64_tr_b16 a[20:21], v13 offset:32768
    v_mfma_f32_16x16x32_bf16 v[84:87], a[84:87], a[180:183], v[84:87]
    ds_read_b64_tr_b16 a[22:23], v13 offset:36864
    v_mfma_f32_16x16x32_bf16 v[56:59], a[88:91], a[176:179], v[56:59]
    ds_read_b64_tr_b16 a[24:25], v14 offset:32768
    v_mfma_f32_16x16x32_bf16 v[88:91], a[88:91], a[180:183], v[88:91]
    ds_read_b64_tr_b16 a[26:27], v14 offset:36864
    v_mfma_f32_16x16x32_bf16 v[60:63], a[92:95], a[176:179], v[60:63]
    ds_read_b64_tr_b16 a[28:29], v15 offset:32768
    v_mfma_f32_16x16x32_bf16 v[92:95], a[92:95], a[180:183], v[92:95]
    ds_read_b64_tr_b16 a[30:31], v15 offset:36864
    v_mfma_f32_16x16x32_bf16 v[32:35], a[96:99], a[184:187], v[32:35]
    ds_read_b64_tr_b16 a[32:33], v8 offset:40960
    v_mfma_f32_16x16x32_bf16 v[64:67], a[96:99], a[188:191], v[64:67]
    ds_read_b64_tr_b16 a[34:35], v8 offset:45056
    v_mfma_f32_16x16x32_bf16 v[36:39], a[100:103], a[184:187], v[36:39]
    ds_read_b64_tr_b16 a[36:37], v9 offset:40960
    v_mfma_f32_16x16x32_bf16 v[68:71], a[100:103], a[188:191], v[68:71]
    ds_read_b64_tr_b16 a[38:39], v9 offset:45056
    v_mfma_f32_16x16x32_bf16 v[40:43], a[104:107], a[184:187], v[40:43]
    ds_read_b64_tr_b16 a[40:41], v10 offset:40960
    v_mfma_f32_16x16x32_bf16 v[72:75], a[104:107], a[188:191], v[72:75]
    ds_read_b64_tr_b16 a[42:43], v10 offset:45056
    v_mfma_f32_16x16x32_bf16 v[44:47], a[108:111], a[184:187], v[44:47]
    ds_read_b64_tr_b16 a[44:45], v11 offset:40960
    v_mfma_f32_16x16x32_bf16 v[76:79], a[108:111], a[188:191], v[76:79]
    ds_read_b64_tr_b16 a[46:47], v11 offset:45056
    v_mfma_f32_16x16x32_bf16 v[48:51], a[112:115], a[184:187], v[48:51]
    ds_read_b64_tr_b16 a[48:49], v12 offset:40960
    v_mfma_f32_16x16x32_bf16 v[80:83], a[112:115], a[188:191], v[80:83]
    ds_read_b64_tr_b16 a[50:51], v12 offset:45056
    v_mfma_f32_16x16x32_bf16 v[52:55], a[116:119], a[184:187], v[52:55]
    ds_read_b64_tr_b16 a[52:53], v13 offset:40960
    v_mfma_f32_16x16x32_bf16 v[84:87], a[116:119], a[188:191], v[84:87]
    ds_read_b64_tr_b16 a[54:55], v13 offset:45056
    v_mfma_f32_16x16x32_bf16 v[56:59], a[120:123], a[184:187], v[56:59]
    ds_read_b64_tr_b16 a[56:57], v14 offset:40960
    v_mfma_f32_16x16x32_bf16 v[88:91], a[120:123], a[188:191], v[88:91]
    ds_read_b64_tr_b16 a[58:59], v14 offset:45056
    v_mfma_f32_16x16x32_bf16 v[60:63], a[124:127], a[184:187], v[60:63]
    ds_read_b64_tr_b16 a[60:61], v15 offset:40960
    v_mfma_f32_16x16x32_bf16 v[92:95], a[124:127], a[188:191], v[92:95]
    ds_read_b64_tr_b16 a[62:63], v15 offset:45056
    s_waitcnt vmcnt(16) lgkmcnt(0)
    v_mfma_f32_16x16x32_bf16 v[32:35], a[0:3], a[192:195], v[32:35]
    ds_read_b64_tr_b16 a[64:65], v96 offset:32768
    v_mfma_f32_16x16x32_bf16 v[64:67], a[0:3], a[196:199], v[64:67]
    ds_read_b64_tr_b16 a[66:67], v96 offset:36864
    v_mfma_f32_16x16x32_bf16 v[36:39], a[4:7], a[192:195], v[36:39]
    ds_read_b64_tr_b16 a[68:69], v97 offset:32768
    v_mfma_f32_16x16x32_bf16 v[68:71], a[4:7], a[196:199], v[68:71]
    ds_read_b64_tr_b16 a[70:71], v97 offset:36864
    v_mfma_f32_16x16x32_bf16 v[40:43], a[8:11], a[192:195], v[40:43]
    ds_read_b64_tr_b16 a[72:73], v98 offset:32768
    v_mfma_f32_16x16x32_bf16 v[72:75], a[8:11], a[196:199], v[72:75]
    ds_read_b64_tr_b16 a[74:75], v98 offset:36864
    v_mfma_f32_16x16x32_bf16 v[44:47], a[12:15], a[192:195], v[44:47]
    ds_read_b64_tr_b16 a[76:77], v99 offset:32768
    v_mfma_f32_16x16x32_bf16 v[76:79], a[12:15], a[196:199], v[76:79]
    ds_read_b64_tr_b16 a[78:79], v99 offset:36864
    v_mfma_f32_16x16x32_bf16 v[48:51], a[16:19], a[192:195], v[48:51]
    ds_read_b64_tr_b16 a[80:81], v100 offset:32768
    v_mfma_f32_16x16x32_bf16 v[80:83], a[16:19], a[196:199], v[80:83]
    ds_read_b64_tr_b16 a[82:83], v100 offset:36864
    v_mfma_f32_16x16x32_bf16 v[52:55], a[20:23], a[192:195], v[52:55]
    ds_read_b64_tr_b16 a[84:85], v101 offset:32768
    v_mfma_f32_16x16x32_bf16 v[84:87], a[20:23], a[196:199], v[84:87]
    ds_read_b64_tr_b16 a[86:87], v101 offset:36864
    v_mfma_f32_16x16x32_bf16 v[56:59], a[24:27], a[192:195], v[56:59]
    ds_read_b64_tr_b16 a[88:89], v102 offset:32768
    v_mfma_f32_16x16x32_bf16 v[88:91], a[24:27], a[196:199], v[88:91]
    ds_read_b64_tr_b16 a[90:91], v102 offset:36864
    v_mfma_f32_16x16x32_bf16 v[60:63], a[28:31], a[192:195], v[60:63]
    ds_read_b64_tr_b16 a[92:93], v103 offset:32768
    v_mfma_f32_16x16x32_bf16 v[92:95], a[28:31], a[196:199], v[92:95]
    ds_read_b64_tr_b16 a[94:95], v103 offset:36864
    v_mfma_f32_16x16x32_bf16 v[32:35], a[32:35], a[200:203], v[32:35]
    ds_read_b64_tr_b16 a[96:97], v96 offset:40960
    v_mfma_f32_16x16x32_bf16 v[64:67], a[32:35], a[204:207], v[64:67]
    ds_read_b64_tr_b16 a[98:99], v96 offset:45056
    v_mfma_f32_16x16x32_bf16 v[36:39], a[36:39], a[200:203], v[36:39]
    ds_read_b64_tr_b16 a[100:101], v97 offset:40960
    v_mfma_f32_16x16x32_bf16 v[68:71], a[36:39], a[204:207], v[68:71]
    ds_read_b64_tr_b16 a[102:103], v97 offset:45056
    v_mfma_f32_16x16x32_bf16 v[40:43], a[40:43], a[200:203], v[40:43]
    ds_read_b64_tr_b16 a[104:105], v98 offset:40960
    v_mfma_f32_16x16x32_bf16 v[72:75], a[40:43], a[204:207], v[72:75]
    ds_read_b64_tr_b16 a[106:107], v98 offset:45056
    v_mfma_f32_16x16x32_bf16 v[44:47], a[44:47], a[200:203], v[44:47]
    ds_read_b64_tr_b16 a[108:109], v99 offset:40960
    v_mfma_f32_16x16x32_bf16 v[76:79], a[44:47], a[204:207], v[76:79]
    ds_read_b64_tr_b16 a[110:111], v99 offset:45056
    v_mfma_f32_16x16x32_bf16 v[48:51], a[48:51], a[200:203], v[48:51]
    ds_read_b64_tr_b16 a[112:113], v100 offset:40960
    v_mfma_f32_16x16x32_bf16 v[80:83], a[48:51], a[204:207], v[80:83]
    ds_read_b64_tr_b16 a[114:115], v100 offset:45056
    v_mfma_f32_16x16x32_bf16 v[52:55], a[52:55], a[200:203], v[52:55]
    ds_read_b64_tr_b16 a[116:117], v101 offset:40960
    v_mfma_f32_16x16x32_bf16 v[84:87], a[52:55], a[204:207], v[84:87]
    ds_read_b64_tr_b16 a[118:119], v101 offset:45056
    v_mfma_f32_16x16x32_bf16 v[56:59], a[56:59], a[200:203], v[56:59]
    ds_read_b64_tr_b16 a[120:121], v102 offset:40960
    v_mfma_f32_16x16x32_bf16 v[88:91], a[56:59], a[204:207], v[88:91]
    ds_read_b64_tr_b16 a[122:123], v102 offset:45056
    v_mfma_f32_16x16x32_bf16 v[60:63], a[60:63], a[200:203], v[60:63]
    ds_read_b64_tr_b16 a[124:125], v103 offset:40960
    v_mfma_f32_16x16x32_bf16 v[92:95], a[60:63], a[204:207], v[92:95]
    ds_read_b64_tr_b16 a[126:127], v103 offset:45056
    s_waitcnt vmcnt(8) lgkmcnt(0)
    s_barrier
    v_mfma_f32_16x16x32_bf16 v[32:35], a[64:67], a[208:211], v[32:35]
    ds_read_b64_tr_b16 a[0:1], v8 offset:49152
    v_mfma_f32_16x16x32_bf16 v[64:67], a[64:67], a[212:215], v[64:67]
    ds_read_b64_tr_b16 a[2:3], v8 offset:53248
    v_mfma_f32_16x16x32_bf16 v[36:39], a[68:71], a[208:211], v[36:39]
    ds_read_b64_tr_b16 a[4:5], v9 offset:49152
    v_mfma_f32_16x16x32_bf16 v[68:71], a[68:71], a[212:215], v[68:71]
    ds_read_b64_tr_b16 a[6:7], v9 offset:53248
    v_mfma_f32_16x16x32_bf16 v[40:43], a[72:75], a[208:211], v[40:43]
    ds_read_b64_tr_b16 a[8:9], v10 offset:49152
    v_mfma_f32_16x16x32_bf16 v[72:75], a[72:75], a[212:215], v[72:75]
    ds_read_b64_tr_b16 a[10:11], v10 offset:53248
    v_mfma_f32_16x16x32_bf16 v[44:47], a[76:79], a[208:211], v[44:47]
    ds_read_b64_tr_b16 a[12:13], v11 offset:49152
    v_mfma_f32_16x16x32_bf16 v[76:79], a[76:79], a[212:215], v[76:79]
    ds_read_b64_tr_b16 a[14:15], v11 offset:53248
    v_mfma_f32_16x16x32_bf16 v[48:51], a[80:83], a[208:211], v[48:51]
    ds_read_b64_tr_b16 a[16:17], v12 offset:49152
    v_mfma_f32_16x16x32_bf16 v[80:83], a[80:83], a[212:215], v[80:83]
    ds_read_b64_tr_b16 a[18:19], v12 offset:53248
    v_mfma_f32_16x16x32_bf16 v[52:55], a[84:87], a[208:211], v[52:55]
    ds_read_b64_tr_b16 a[20:21], v13 offset:49152
    v_mfma_f32_16x16x32_bf16 v[84:87], a[84:87], a[212:215], v[84:87]
    ds_read_b64_tr_b16 a[22:23], v13 offset:53248
    v_mfma_f32_16x16x32_bf16 v[56:59], a[88:91], a[208:211], v[56:59]
    ds_read_b64_tr_b16 a[24:25], v14 offset:49152
    v_mfma_f32_16x16x32_bf16 v[88:91], a[88:91], a[212:215], v[88:91]
    ds_read_b64_tr_b16 a[26:27], v14 offset:53248
    v_mfma_f32_16x16x32_bf16 v[60:63], a[92:95], a[208:211], v[60:63]
    ds_read_b64_tr_b16 a[28:29], v15 offset:49152
    v_mfma_f32_16x16x32_bf16 v[92:95], a[92:95], a[212:215], v[92:95]
    ds_read_b64_tr_b16 a[30:31], v15 offset:53248
    v_mfma_f32_16x16x32_bf16 v[32:35], a[96:99], a[216:219], v[32:35]
    ds_read_b64_tr_b16 a[32:33], v8 offset:57344
    v_mfma_f32_16x16x32_bf16 v[64:67], a[96:99], a[220:223], v[64:67]
    ds_read_b64_tr_b16 a[34:35], v8 offset:61440
    v_mfma_f32_16x16x32_bf16 v[36:39], a[100:103], a[216:219], v[36:39]
    ds_read_b64_tr_b16 a[36:37], v9 offset:57344
    v_mfma_f32_16x16x32_bf16 v[68:71], a[100:103], a[220:223], v[68:71]
    ds_read_b64_tr_b16 a[38:39], v9 offset:61440
    v_mfma_f32_16x16x32_bf16 v[40:43], a[104:107], a[216:219], v[40:43]
    ds_read_b64_tr_b16 a[40:41], v10 offset:57344
    v_mfma_f32_16x16x32_bf16 v[72:75], a[104:107], a[220:223], v[72:75]
    ds_read_b64_tr_b16 a[42:43], v10 offset:61440
    v_mfma_f32_16x16x32_bf16 v[44:47], a[108:111], a[216:219], v[44:47]
    ds_read_b64_tr_b16 a[44:45], v11 offset:57344
    v_mfma_f32_16x16x32_bf16 v[76:79], a[108:111], a[220:223], v[76:79]
    ds_read_b64_tr_b16 a[46:47], v11 offset:61440
    v_mfma_f32_16x16x32_bf16 v[48:51], a[112:115], a[216:219], v[48:51]
    ds_read_b64_tr_b16 a[48:49], v12 offset:57344
    v_mfma_f32_16x16x32_bf16 v[80:83], a[112:115], a[220:223], v[80:83]
    ds_read_b64_tr_b16 a[50:51], v12 offset:61440
    v_mfma_f32_16x16x32_bf16 v[52:55], a[116:119], a[216:219], v[52:55]
    ds_read_b64_tr_b16 a[52:53], v13 offset:57344
    v_mfma_f32_16x16x32_bf16 v[84:87], a[116:119], a[220:223], v[84:87]
    ds_read_b64_tr_b16 a[54:55], v13 offset:61440
    v_mfma_f32_16x16x32_bf16 v[56:59], a[120:123], a[216:219], v[56:59]
    ds_read_b64_tr_b16 a[56:57], v14 offset:57344
    v_mfma_f32_16x16x32_bf16 v[88:91], a[120:123], a[220:223], v[88:91]
    ds_read_b64_tr_b16 a[58:59], v14 offset:61440
    v_mfma_f32_16x16x32_bf16 v[60:63], a[124:127], a[216:219], v[60:63]
    ds_read_b64_tr_b16 a[60:61], v15 offset:57344
    v_mfma_f32_16x16x32_bf16 v[92:95], a[124:127], a[220:223], v[92:95]
    ds_read_b64_tr_b16 a[62:63], v15 offset:61440
    s_waitcnt vmcnt(4) lgkmcnt(0)
    v_mfma_f32_16x16x32_bf16 v[32:35], a[0:3], a[224:227], v[32:35]
    ds_read_b64_tr_b16 a[64:65], v96 offset:49152
    v_mfma_f32_16x16x32_bf16 v[64:67], a[0:3], a[228:231], v[64:67]
    ds_read_b64_tr_b16 a[66:67], v96 offset:53248
    v_mfma_f32_16x16x32_bf16 v[36:39], a[4:7], a[224:227], v[36:39]
    ds_read_b64_tr_b16 a[68:69], v97 offset:49152
    v_mfma_f32_16x16x32_bf16 v[68:71], a[4:7], a[228:231], v[68:71]
    ds_read_b64_tr_b16 a[70:71], v97 offset:53248
    v_mfma_f32_16x16x32_bf16 v[40:43], a[8:11], a[224:227], v[40:43]
    ds_read_b64_tr_b16 a[72:73], v98 offset:49152
    v_mfma_f32_16x16x32_bf16 v[72:75], a[8:11], a[228:231], v[72:75]
    ds_read_b64_tr_b16 a[74:75], v98 offset:53248
    v_mfma_f32_16x16x32_bf16 v[44:47], a[12:15], a[224:227], v[44:47]
    ds_read_b64_tr_b16 a[76:77], v99 offset:49152
    v_mfma_f32_16x16x32_bf16 v[76:79], a[12:15], a[228:231], v[76:79]
    ds_read_b64_tr_b16 a[78:79], v99 offset:53248
    v_mfma_f32_16x16x32_bf16 v[48:51], a[16:19], a[224:227], v[48:51]
    ds_read_b64_tr_b16 a[80:81], v100 offset:49152
    v_mfma_f32_16x16x32_bf16 v[80:83], a[16:19], a[228:231], v[80:83]
    ds_read_b64_tr_b16 a[82:83], v100 offset:53248
    v_mfma_f32_16x16x32_bf16 v[52:55], a[20:23], a[224:227], v[52:55]
    ds_read_b64_tr_b16 a[84:85], v101 offset:49152
    v_mfma_f32_16x16x32_bf16 v[84:87], a[20:23], a[228:231], v[84:87]
    ds_read_b64_tr_b16 a[86:87], v101 offset:53248
    v_mfma_f32_16x16x32_bf16 v[56:59], a[24:27], a[224:227], v[56:59]
    ds_read_b64_tr_b16 a[88:89], v102 offset:49152
    v_mfma_f32_16x16x32_bf16 v[88:91], a[24:27], a[228:231], v[88:91]
    ds_read_b64_tr_b16 a[90:91], v102 offset:53248
    v_mfma_f32_16x16x32_bf16 v[60:63], a[28:31], a[224:227], v[60:63]
    ds_read_b64_tr_b16 a[92:93], v103 offset:49152
    v_mfma_f32_16x16x32_bf16 v[92:95], a[28:31], a[228:231], v[92:95]
    ds_read_b64_tr_b16 a[94:95], v103 offset:53248
    v_mfma_f32_16x16x32_bf16 v[32:35], a[32:35], a[232:235], v[32:35]
    ds_read_b64_tr_b16 a[96:97], v96 offset:57344
    v_mfma_f32_16x16x32_bf16 v[64:67], a[32:35], a[236:239], v[64:67]
    ds_read_b64_tr_b16 a[98:99], v96 offset:61440
    v_mfma_f32_16x16x32_bf16 v[36:39], a[36:39], a[232:235], v[36:39]
    ds_read_b64_tr_b16 a[100:101], v97 offset:57344
    v_mfma_f32_16x16x32_bf16 v[68:71], a[36:39], a[236:239], v[68:71]
    ds_read_b64_tr_b16 a[102:103], v97 offset:61440
    v_mfma_f32_16x16x32_bf16 v[40:43], a[40:43], a[232:235], v[40:43]
    ds_read_b64_tr_b16 a[104:105], v98 offset:57344
    v_mfma_f32_16x16x32_bf16 v[72:75], a[40:43], a[236:239], v[72:75]
    ds_read_b64_tr_b16 a[106:107], v98 offset:61440
    v_mfma_f32_16x16x32_bf16 v[44:47], a[44:47], a[232:235], v[44:47]
    ds_read_b64_tr_b16 a[108:109], v99 offset:57344
    v_mfma_f32_16x16x32_bf16 v[76:79], a[44:47], a[236:239], v[76:79]
    ds_read_b64_tr_b16 a[110:111], v99 offset:61440
    v_mfma_f32_16x16x32_bf16 v[48:51], a[48:51], a[232:235], v[48:51]
    ds_read_b64_tr_b16 a[112:113], v100 offset:57344
    v_mfma_f32_16x16x32_bf16 v[80:83], a[48:51], a[236:239], v[80:83]
    ds_read_b64_tr_b16 a[114:115], v100 offset:61440
    v_mfma_f32_16x16x32_bf16 v[52:55], a[52:55], a[232:235], v[52:55]
    ds_read_b64_tr_b16 a[116:117], v101 offset:57344
    v_mfma_f32_16x16x32_bf16 v[84:87], a[52:55], a[236:239], v[84:87]
    ds_read_b64_tr_b16 a[118:119], v101 offset:61440
    v_mfma_f32_16x16x32_bf16 v[56:59], a[56:59], a[232:235], v[56:59]
    ds_read_b64_tr_b16 a[120:121], v102 offset:57344
    v_mfma_f32_16x16x32_bf16 v[88:91], a[56:59], a[236:239], v[88:91]
    ds_read_b64_tr_b16 a[122:123], v102 offset:61440
    v_mfma_f32_16x16x32_bf16 v[60:63], a[60:63], a[232:235], v[60:63]
    ds_read_b64_tr_b16 a[124:125], v103 offset:57344
    v_mfma_f32_16x16x32_bf16 v[92:95], a[60:63], a[236:239], v[92:95]
    ds_read_b64_tr_b16 a[126:127], v103 offset:61440
    s_waitcnt vmcnt(0) lgkmcnt(0)
    v_mfma_f32_16x16x32_bf16 v[32:35], a[64:67], a[240:243], v[32:35]
    v_mfma_f32_16x16x32_bf16 v[64:67], a[64:67], a[244:247], v[64:67]
    v_mfma_f32_16x16x32_bf16 v[36:39], a[68:71], a[240:243], v[36:39]
    v_mfma_f32_16x16x32_bf16 v[68:71], a[68:71], a[244:247], v[68:71]
    v_mfma_f32_16x16x32_bf16 v[40:43], a[72:75], a[240:243], v[40:43]
    v_mfma_f32_16x16x32_bf16 v[72:75], a[72:75], a[244:247], v[72:75]
    v_mfma_f32_16x16x32_bf16 v[44:47], a[76:79], a[240:243], v[44:47]
    v_mfma_f32_16x16x32_bf16 v[76:79], a[76:79], a[244:247], v[76:79]
    v_mfma_f32_16x16x32_bf16 v[48:51], a[80:83], a[240:243], v[48:51]
    v_mfma_f32_16x16x32_bf16 v[80:83], a[80:83], a[244:247], v[80:83]
    v_mfma_f32_16x16x32_bf16 v[52:55], a[84:87], a[240:243], v[52:55]
    v_mfma_f32_16x16x32_bf16 v[84:87], a[84:87], a[244:247], v[84:87]
    v_mfma_f32_16x16x32_bf16 v[56:59], a[88:91], a[240:243], v[56:59]
    v_mfma_f32_16x16x32_bf16 v[88:91], a[88:91], a[244:247], v[88:91]
    v_mfma_f32_16x16x32_bf16 v[60:63], a[92:95], a[240:243], v[60:63]
    v_mfma_f32_16x16x32_bf16 v[92:95], a[92:95], a[244:247], v[92:95]
    v_mfma_f32_16x16x32_bf16 v[32:35], a[96:99], a[248:251], v[32:35]
    v_mfma_f32_16x16x32_bf16 v[64:67], a[96:99], a[252:255], v[64:67]
    v_mfma_f32_16x16x32_bf16 v[36:39], a[100:103], a[248:251], v[36:39]
    v_mfma_f32_16x16x32_bf16 v[68:71], a[100:103], a[252:255], v[68:71]
    v_mfma_f32_16x16x32_bf16 v[40:43], a[104:107], a[248:251], v[40:43]
    v_mfma_f32_16x16x32_bf16 v[72:75], a[104:107], a[252:255], v[72:75]
    v_mfma_f32_16x16x32_bf16 v[44:47], a[108:111], a[248:251], v[44:47]
    v_mfma_f32_16x16x32_bf16 v[76:79], a[108:111], a[252:255], v[76:79]
    v_mfma_f32_16x16x32_bf16 v[48:51], a[112:115], a[248:251], v[48:51]
    v_mfma_f32_16x16x32_bf16 v[80:83], a[112:115], a[252:255], v[80:83]
    v_mfma_f32_16x16x32_bf16 v[52:55], a[116:119], a[248:251], v[52:55]
    v_mfma_f32_16x16x32_bf16 v[84:87], a[116:119], a[252:255], v[84:87]
    v_mfma_f32_16x16x32_bf16 v[56:59], a[120:123], a[248:251], v[56:59]
    v_mfma_f32_16x16x32_bf16 v[88:91], a[120:123], a[252:255], v[88:91]
    v_mfma_f32_16x16x32_bf16 v[60:63], a[124:127], a[248:251], v[60:63]
    v_mfma_f32_16x16x32_bf16 v[92:95], a[124:127], a[252:255], v[92:95]
    v_lshlrev_b32 v26, 13, v2
    v_lshl_add_u32 v26, v1, 4, v26
    v_add_u32 v27, 0x1000, v26
    s_mov_b32 s6, 0x800000
    v_bfe_u32 v22, v0, 4, 2
    v_lshlrev_b32 v28, 5, v2
    v_add_u32 v28, v28, v3
    v_lshlrev_b32 v28, 10, v28
    v_lshl_add_u32 v28, v22, 3, v28
    v_add_u32 v29, 0x4000, v28
    s_xor_b32 s90, s76, 8
    s_lshl_b32 s3, s75, 4
    s_add_u32 s90, s90, s3
    s_lshl_b32 s90, s90, 15
    s_nop 3
    s_cmp_eq_u32 s77, 0
    s_cbranch_scc0 L_snd1
    buffer_store_dwordx4 v[48:51], v26, s[4:7], s90 offen offset:0 sc1
    buffer_store_dwordx4 v[52:55], v26, s[4:7], s90 offen offset:1024 sc1
    buffer_store_dwordx4 v[56:59], v26, s[4:7], s90 offen offset:2048 sc1
    buffer_store_dwordx4 v[60:63], v26, s[4:7], s90 offen offset:3072 sc1
    buffer_store_dwordx4 v[80:83], v27, s[4:7], s90 offen offset:0 sc1
    buffer_store_dwordx4 v[84:87], v27, s[4:7], s90 offen offset:1024 sc1
    buffer_store_dwordx4 v[88:91], v27, s[4:7], s90 offen offset:2048 sc1
    buffer_store_dwordx4 v[92:95], v27, s[4:7], s90 offen offset:3072 sc1
    s_branch L_snd2
L_snd1:
    buffer_store_dwordx4 v[32:35], v26, s[4:7], s90 offen offset:0 sc1
    buffer_store_dwordx4 v[36:39], v26, s[4:7], s90 offen offset:1024 sc1
    buffer_store_dwordx4 v[40:43], v26, s[4:7], s90 offen offset:2048 sc1
    buffer_store_dwordx4 v[44:47], v26, s[4:7], s90 offen offset:3072 sc1
    buffer_store_dwordx4 v[64:67], v27, s[4:7], s90 offen offset:0 sc1
    buffer_store_dwordx4 v[68:71], v27, s[4:7], s90 offen offset:1024 sc1
    buffer_store_dwordx4 v[72:75], v27, s[4:7], s90 offen offset:2048 sc1
    buffer_store_dwordx4 v[76:79], v27, s[4:7], s90 offen offset:3072 sc1
L_snd2:
    s_mov_b32 s90, s79
    s_mov_b32 s91, 262144
L_rx:
    buffer_load_dwordx4 v[128:131], v26, s[4:7], s90 offen offset:0 sc1
    buffer_load_dwordx4 v[132:135], v26, s[4:7], s90 offen offset:1024 sc1
    buffer_load_dwordx4 v[136:139], v26, s[4:7], s90 offen offset:2048 sc1
    buffer_load_dwordx4 v[140:143], v26, s[4:7], s90 offen offset:3072 sc1
    buffer_load_dwordx4 v[144:147], v27, s[4:7], s90 offen offset:0 sc1
    buffer_load_dwordx4 v[148:151], v27, s[4:7], s90 offen offset:1024 sc1
    buffer_load_dwordx4 v[152:155], v27, s[4:7], s90 offen offset:2048 sc1
    buffer_load_dwordx4 v[156:159], v27, s[4:7], s90 offen offset:3072 sc1
    s_waitcnt vmcnt(0)
    v_max3_u32 v24, v128, v129, v130
    v_max3_u32 v24, v24, v131, v132
    v_max3_u32 v24, v24, v133, v134
    v_max3_u32 v24, v24, v135, v136
    v_max3_u32 v24, v24, v137, v138
    v_max3_u32 v24, v24, v139, v140
    v_max3_u32 v24, v24, v141, v142
    v_max3_u32 v24, v24, v143, v144
    v_max3_u32 v24, v24, v145, v146
    v_max3_u32 v24, v24, v147, v148
    v_max3_u32 v24, v24, v149, v150
    v_max3_u32 v24, v24, v151, v152
    v_max3_u32 v24, v24, v153, v154
    v_max3_u32 v24, v24, v155, v156
    v_max3_u32 v24, v24, v157, v158
    v_max_u32 v24, v24, v159
    v_cmp_eq_u32 vcc, -1, v24
    s_nop 1
    s_cbranch_vccz L_rx_ok
    s_sleep 1
    s_sub_u32 s91, s91, 1
    s_cmp_lg_u32 s91, 0
    s_cbranch_scc1 L_rx
L_rx_ok:
    s_cmp_eq_u32 s77, 0
    s_cbranch_scc0 L_rcv1
    v_add_f32 v32, v32, v128
    v_add_f32 v33, v33, v129
    v_add_f32 v34, v34, v130
    v_add_f32 v35, v35, v131
    v_cvt_pk_bf16_f32 v32, v32, v33
    v_cvt_pk_bf16_f32 v33, v34, v35
    buffer_store_dwordx2 v[32:33], v28, s[16:19], 0 offen offset:0
    v_add_f32 v36, v36, v132
    v_add_f32 v37, v37, v133
    v_add_f32 v38, v38, v134
    v_add_f32 v39, v39, v135
    v_cvt_pk_bf16_f32 v36, v36, v37
    v_cvt_pk_bf16_f32 v37, v38, v39
    buffer_store_dwordx2 v[36:37], v28, s[16:19], 0 offen offset:32
    v_add_f32 v40, v40, v136
    v_add_f32 v41, v41, v137
    v_add_f32 v42, v42, v138
    v_add_f32 v43, v43, v139
    v_cvt_pk_bf16_f32 v40, v40, v41
    v_cvt_pk_bf16_f32 v41, v42, v43
    buffer_store_dwordx2 v[40:41], v28, s[16:19], 0 offen offset:64
    v_add_f32 v44, v44, v140
    v_add_f32 v45, v45, v141
    v_add_f32 v46, v46, v142
    v_add_f32 v47, v47, v143
    v_cvt_pk_bf16_f32 v44, v44, v45
    v_cvt_pk_bf16_f32 v45, v46, v47
    buffer_store_dwordx2 v[44:45], v28, s[16:19], 0 offen offset:96
    v_add_f32 v64, v64, v144
    v_add_f32 v65, v65, v145
    v_add_f32 v66, v66, v146
    v_add_f32 v67, v67, v147
    v_cvt_pk_bf16_f32 v64, v64, v65
    v_cvt_pk_bf16_f32 v65, v66, v67
    buffer_store_dwordx2 v[64:65], v29, s[16:19], 0 offen offset:0
    v_add_f32 v68, v68, v148
    v_add_f32 v69, v69, v149
    v_add_f32 v70, v70, v150
    v_add_f32 v71, v71, v151
    v_cvt_pk_bf16_f32 v68, v68, v69
    v_cvt_pk_bf16_f32 v69, v70, v71
    buffer_store_dwordx2 v[68:69], v29, s[16:19], 0 offen offset:32
    v_add_f32 v72, v72, v152
    v_add_f32 v73, v73, v153
    v_add_f32 v74, v74, v154
    v_add_f32 v75, v75, v155
    v_cvt_pk_bf16_f32 v72, v72, v73
    v_cvt_pk_bf16_f32 v73, v74, v75
    buffer_store_dwordx2 v[72:73], v29, s[16:19], 0 offen offset:64
    v_add_f32 v76, v76, v156
    v_add_f32 v77, v77, v157
    v_add_f32 v78, v78, v158
    v_add_f32 v79, v79, v159
    v_cvt_pk_bf16_f32 v76, v76, v77
    v_cvt_pk_bf16_f32 v77, v78, v79
    buffer_store_dwordx2 v[76:77], v29, s[16:19], 0 offen offset:96
    s_branch L_rcv2
L_rcv1:
    v_add_f32 v48, v48, v128
    v_add_f32 v49, v49, v129
    v_add_f32 v50, v50, v130
    v_add_f32 v51, v51, v131
    v_cvt_pk_bf16_f32 v48, v48, v49
    v_cvt_pk_bf16_f32 v49, v50, v51
    buffer_store_dwordx2 v[48:49], v28, s[16:19], 0 offen offset:128
    v_add_f32 v52, v52, v132
    v_add_f32 v53, v53, v133
    v_add_f32 v54, v54, v134
    v_add_f32 v55, v55, v135
    v_cvt_pk_bf16_f32 v52, v52, v53
    v_cvt_pk_bf16_f32 v53, v54, v55
    buffer_store_dwordx2 v[52:53], v28, s[16:19], 0 offen offset:160
    v_add_f32 v56, v56, v136
    v_add_f32 v57, v57, v137
    v_add_f32 v58, v58, v138
    v_add_f32 v59, v59, v139
    v_cvt_pk_bf16_f32 v56, v56, v57
    v_cvt_pk_bf16_f32 v57, v58, v59
    buffer_store_dwordx2 v[56:57], v28, s[16:19], 0 offen offset:192
    v_add_f32 v60, v60, v140
    v_add_f32 v61, v61, v141
    v_add_f32 v62, v62, v142
    v_add_f32 v63, v63, v143
    v_cvt_pk_bf16_f32 v60, v60, v61
    v_cvt_pk_bf16_f32 v61, v62, v63
    buffer_store_dwordx2 v[60:61], v28, s[16:19], 0 offen offset:224
    v_add_f32 v80, v80, v144
    v_add_f32 v81, v81, v145
    v_add_f32 v82, v82, v146
    v_add_f32 v83, v83, v147
    v_cvt_pk_bf16_f32 v80, v80, v81
    v_cvt_pk_bf16_f32 v81, v82, v83
    buffer_store_dwordx2 v[80:81], v29, s[16:19], 0 offen offset:128
    v_add_f32 v84, v84, v148
    v_add_f32 v85, v85, v149
    v_add_f32 v86, v86, v150
    v_add_f32 v87, v87, v151
    v_cvt_pk_bf16_f32 v84, v84, v85
    v_cvt_pk_bf16_f32 v85, v86, v87
    buffer_store_dwordx2 v[84:85], v29, s[16:19], 0 offen offset:160
    v_add_f32 v88, v88, v152
    v_add_f32 v89, v89, v153
    v_add_f32 v90, v90, v154
    v_add_f32 v91, v91, v155
    v_cvt_pk_bf16_f32 v88, v88, v89
    v_cvt_pk_bf16_f32 v89, v90, v91
    buffer_store_dwordx2 v[88:89], v29, s[16:19], 0 offen offset:192
    v_add_f32 v92, v92, v156
    v_add_f32 v93, v93, v157
    v_add_f32 v94, v94, v158
    v_add_f32 v95, v95, v159
    v_cvt_pk_bf16_f32 v92, v92, v93
    v_cvt_pk_bf16_f32 v93, v94, v95
    buffer_store_dwordx2 v[92:93], v29, s[16:19], 0 offen offset:224
L_rcv2:
L_done:
    s_endpgm
L_codeend:
.section .rodata,"a"
.p2align 6
.amdhsa_kernel standalone__mha_block_cached__near_ridge_kernel
  .amdhsa_next_free_vgpr 512
  .amdhsa_next_free_sgpr 102
  .amdhsa_accum_offset 256
  .amdhsa_group_segment_fixed_size 0
  .amdhsa_kernarg_size 64
  .amdhsa_user_sgpr_count 2
  .amdhsa_user_sgpr_kernarg_segment_ptr 1
  .amdhsa_system_sgpr_workgroup_id_x 1
.end_amdhsa_kernel
```
